```python
import torch

def _softmax(x, axis=-1):
    return torch.softmax(x, dim=axis)

def _gelu(x):
    return torch.nn.functional.gelu(x, approximate='tanh')

def _silu(x):
    return torch.nn.functional.silu(x)

def _sigmoid(x):
    return torch.sigmoid(x)

def _layernorm(x, axis=-1, eps=1e-05):
    m = x.mean(dim=axis, keepdim=True)
    v = x.var(dim=axis, keepdim=True, unbiased=False)
    return (x - m) / torch.sqrt(v + eps)

def _scatter_add(tgt, idx, src, axis=0):
    return tgt.clone().index_add_(axis, idx, src)

def _segment_sum(src, seg, n):
    out = torch.zeros((n,) + src.shape[1:], dtype=src.dtype)
    return out.index_add_(0, seg, src)

def _pad(x, pw):
    flat = tuple((v for pair in reversed(pw) for v in pair))
    return torch.nn.functional.pad(x, flat)
kernel_name = 'parallel_sum__memory_aug_recurrent_mem_tr__swiglu_ffn__prompt'

def setup_inputs():

    _w = lambda a: (lambda t: t.to(torch.bfloat16) if t.is_floating_point() else t)(torch.as_tensor(a))

    def _A_setup():
        B, S, Dm = (1, 2048, 640)
        H, Dh = (32, 192)
        M, seg = (8, 32)
        seg = min(seg, S)
        S = S // seg * seg
        return {'x': _w((lambda *s: torch.randn(*s, dtype=torch.bfloat16) * 0.05)(B, S, Dm)), 'mem0': _w((lambda *s: torch.randn(*s, dtype=torch.bfloat16) * 1.6)(B, M, Dm)), 'Wq': _w((lambda *s: torch.randn(*s, dtype=torch.bfloat16) * 0.8)(Dm, H, Dh) * Dm ** (-0.5)), 'Wk': _w((lambda *s: torch.randn(*s, dtype=torch.bfloat16) * 0.8)(Dm, H, Dh) * Dm ** (-0.5)), 'Wv': _w((lambda *s: torch.randn(*s, dtype=torch.bfloat16) * 1.6)(Dm, H, Dh) * Dm ** (-0.5)), 'Wo': _w((lambda *s: torch.randn(*s, dtype=torch.bfloat16) * 1.6)(H, Dh, Dm) * (H * Dh) ** (-0.5)), 'seg_len': seg}
    _A_in = _A_setup()

    def _B_setup():
        B, S, D, F = (1, 2048, 640, 1536)
        return {'x': _w((lambda *s: torch.randn(*s, dtype=torch.bfloat16) * 0.05)(B, S, D)), 'w_gate': _w((lambda *s: torch.randn(*s, dtype=torch.bfloat16) * 0.05)(D, F)), 'w_up': _w((lambda *s: torch.randn(*s, dtype=torch.bfloat16) * 0.05)(D, F)), 'w_down': _w((lambda *s: torch.randn(*s, dtype=torch.bfloat16) * 0.05)(F, D))}
    _B_in = _B_setup()
    return {'A_x': _A_in['x'], 'A_mem0': _A_in['mem0'], 'A_Wq': _A_in['Wq'], 'A_Wk': _A_in['Wk'], 'A_Wv': _A_in['Wv'], 'A_Wo': _A_in['Wo'], 'A_seg_len': _A_in['seg_len'], 'B_x': _B_in['x'], 'B_w_gate': _B_in['w_gate'], 'B_w_up': _B_in['w_up'], 'B_w_down': _B_in['w_down']}

def reference(A_x, A_mem0, A_Wq, A_Wk, A_Wv, A_Wo, A_seg_len, B_x, B_w_gate, B_w_up, B_w_down):

    def _A_ref(x, mem0, Wq, Wk, Wv, Wo, seg_len):
        B, S, Dm = x.shape
        H, Dh = (Wq.shape[1], Wq.shape[2])
        M = mem0.shape[1]
        scale = Dh ** (-0.5)
        n_seg = S // seg_len
        L = M + seg_len
        idx = torch.arange(L)
        mask = (idx[:, None] < M) | (idx[:, None] >= idx[None, :])
        mem = mem0
        outs = []
        for s in range(n_seg):
            xs = x[:, s * seg_len:(s + 1) * seg_len, :].clone()
            h = torch.concatenate([mem, xs], axis=1)
            q = torch.einsum('btd,dhe->bhte', h, Wq)
            k = torch.einsum('btd,dhe->bhte', h, Wk)
            v = torch.einsum('btd,dhe->bhte', h, Wv)
            scores = torch.einsum('bhqe,bhke->bhqk', q, k) * scale
            scores = torch.where(mask[None, None], scores, -1000000000.0)
            p = _softmax(scores, axis=-1)
            o = torch.einsum('bhqk,bhke->bhqe', p, v)
            o = torch.einsum('bhte,hed->btd', o, Wo)
            mem = o[:, :M, :].clone()
            outs.append(o[:, M:, :])
        return torch.concatenate(outs, axis=1)

    def _B_ref(x, w_gate, w_up, w_down):
        g = _silu(x @ w_gate)
        u = x @ w_up
        return g * u @ w_down
    x = A_x
    xn = _layernorm(x, axis=-1)
    return x + _A_ref(xn, A_mem0, A_Wq, A_Wk, A_Wv, A_Wo, A_seg_len) + _B_ref(xn, B_w_gate, B_w_up, B_w_down)
```

```asm
; @launch grid=(256,1,1) block=(256,1,1) lds=163840
.amdgcn_target "amdgcn-amd-amdhsa--gfx950"
.text
.globl parallel_sum__memory_aug_recurrent_mem_tr__swiglu_ffn__prompt_kernel
.p2align 8
.type parallel_sum__memory_aug_recurrent_mem_tr__swiglu_ffn__prompt_kernel,@function
parallel_sum__memory_aug_recurrent_mem_tr__swiglu_ffn__prompt_kernel:
  s_cmp_ge_u32 s2, 256
  s_cbranch_scc1 L_exit
  s_load_dwordx16 s[40:55], s[0:1], 0
  s_load_dwordx8 s[56:63], s[0:1], 64
  s_load_dwordx4 s[64:67], s[0:1], 96
  v_and_b32 v1, 63, v0
  v_lshrrev_b32 v2, 6, v0
  s_nop 0
  v_readfirstlane_b32 s24, v2
  s_and_b32 s29, s2, 7
  s_lshr_b32 s28, s2, 3
  v_lshlrev_b32 v2, 4, v1
  s_mov_b32 s26, 0
  s_mov_b32 s25, 0
  s_mov_b32 s39, 0
  s_mov_b32 s3, 0
  s_waitcnt lgkmcnt(0)
  s_mov_b32 s8, s66
  s_and_b32 s9, s67, 0xffff
  s_mov_b32 s10, 268435456
  s_mov_b32 s11, 0x20000
  s_mov_b32 s68, s64
  s_and_b32 s69, s65, 0xffff
  s_mov_b32 s70, 256
  s_mov_b32 s71, 0x20000
  s_mov_b32 s12, s66
  s_and_b32 s13, s67, 0xffff
  s_mov_b32 s14, 268435456
  s_mov_b32 s15, 0x20000
  s_mov_b32 s16, s66
  s_and_b32 s17, s67, 0xffff
  s_mov_b32 s18, 268435456
  s_mov_b32 s19, 0x20000
  s_mov_b32 s20, s66
  s_and_b32 s21, s67, 0xffff
  s_mov_b32 s22, 268435456
  s_mov_b32 s23, 0x20000
  s_lshl_b32 s30, s29, 2
  s_lshr_b32 s29, 0x74321506, s30
  s_and_b32 s29, s29, 7
  s_cmp_lt_u32 s29, 2
  s_cbranch_scc1 L_chain
  s_sub_u32 s30, s29, 2
  s_lshl_b32 s30, s30, 5
  s_add_u32 s30, s30, s28
  s_sub_u32 s25, s30, 0
  s_cmp_lt_u32 s30, 32
  s_cbranch_scc1 WK
  s_sub_u32 s25, s30, 32
  s_cmp_lt_u32 s30, 64
  s_cbranch_scc1 WV
  s_sub_u32 s25, s30, 64
  s_cmp_lt_u32 s30, 96
  s_cbranch_scc1 WO
  s_sub_u32 s25, s30, 96
  s_cmp_lt_u32 s30, 128
  s_cbranch_scc1 WQ
  s_sub_u32 s31, s30, 128
  s_mov_b32 s38, s31
  s_branch PREP
L_chain:
  s_lshl_b32 s25, s29, 4
  s_and_b32 s30, s28, 15
  s_add_u32 s25, s25, s30
  s_cmp_lt_u32 s28, 16
  s_cbranch_scc1 CQ
  s_branch CV
L_exit:
  s_endpgm
L_abort:
  s_mov_b64 exec, 1
  s_lshl_b32 s27, s39, 16
  s_or_b32 s27, s27, s2
  v_mov_b32 v5, s27
  s_and_b32 s27, s2, 7
  s_lshl_b32 s27, s27, 2
  s_add_u32 s27, s27, 224
  buffer_store_dword v5, off, s[68:71], s27
  s_endpgm
PREP:
  s_mov_b32 s12, s40
  s_and_b32 s13, s41, 0xffff
  s_mov_b32 s14, 2621440
  s_mov_b32 s15, 0x20000
  s_mov_b32 s16, s42
  s_and_b32 s17, s43, 0xffff
  s_mov_b32 s18, 10240
  s_mov_b32 s19, 0x20000
  v_and_b32 v3, 15, v1
  v_lshrrev_b32 v4, 4, v1
  v_mul_u32_u24 v5, 1280, v3
  v_lshl_add_u32 v5, v4, 4, v5
  s_mul_i32 s32, s31, 40960
  s_mul_i32 s27, s24, 320
  s_add_u32 s32, s32, s27
  s_add_u32 s33, s32, 20480
  buffer_load_dwordx4 v[16:19], v5, s[12:15], s32 offen offset:0
  buffer_load_dwordx4 v[20:23], v5, s[12:15], s32 offen offset:64
  buffer_load_dwordx4 v[24:27], v5, s[12:15], s32 offen offset:128
  buffer_load_dwordx4 v[28:31], v5, s[12:15], s32 offen offset:192
  buffer_load_dwordx4 v[32:35], v5, s[12:15], s32 offen offset:256
  buffer_load_dwordx4 v[36:39], v5, s[12:15], s33 offen offset:0
  buffer_load_dwordx4 v[40:43], v5, s[12:15], s33 offen offset:64
  buffer_load_dwordx4 v[44:47], v5, s[12:15], s33 offen offset:128
  buffer_load_dwordx4 v[48:51], v5, s[12:15], s33 offen offset:192
  buffer_load_dwordx4 v[52:55], v5, s[12:15], s33 offen offset:256
  v_lshlrev_b32 v7, 4, v0
  v_mov_b32 v8, -1
  v_mov_b32 v9, -1
  v_mov_b32 v10, -1
  v_mov_b32 v11, -1
  s_sub_u32 s30, s31, 48
  s_cmp_lt_u32 s30, 6
  s_cbranch_scc1 P_nofill
  s_lshl_b32 s27, s31, 14
  s_add_u32 s27, s27, 131072
  buffer_store_dwordx4 v[8:11], v7, s[8:11], s27 offen sc1
  s_add_u32 s27, s27, 4096
  buffer_store_dwordx4 v[8:11], v7, s[8:11], s27 offen sc1
  s_add_u32 s27, s27, 4096
  buffer_store_dwordx4 v[8:11], v7, s[8:11], s27 offen sc1
  s_add_u32 s27, s27, 4096
  buffer_store_dwordx4 v[8:11], v7, s[8:11], s27 offen sc1
  s_add_u32 s27, s27, 4096
P_nofill:
  v_mov_b32 v12, 0
  v_mov_b32 v13, 0
  v_mov_b32 v14, 0
  v_mov_b32 v15, 0
  s_cmp_ge_u32 s31, 4
  s_cbranch_scc1 P_noz
  s_lshl_b32 s27, s31, 14
  buffer_store_dwordx4 v[12:15], v7, s[8:11], s27 offen sc1
  s_add_u32 s27, s27, 4096
  buffer_store_dwordx4 v[12:15], v7, s[8:11], s27 offen sc1
  s_add_u32 s27, s27, 4096
  buffer_store_dwordx4 v[12:15], v7, s[8:11], s27 offen sc1
  s_add_u32 s27, s27, 4096
  buffer_store_dwordx4 v[12:15], v7, s[8:11], s27 offen sc1
  s_add_u32 s27, s27, 4096
P_noz:
  s_sub_u32 s30, s31, 49
  s_cmp_ge_u32 s30, 3
  s_cbranch_scc1 P_nomem
  s_lshl_b32 s27, s30, 8
  v_add_u32 v60, s27, v0
  v_cmp_gt_u32 vcc, 640, v60
  s_nop 0
  s_and_saveexec_b64 s[34:35], vcc
  s_cbranch_execz P_memdone
  v_lshrrev_b32 v61, 4, v60
  v_lshlrev_b32 v61, 5, v61
  v_bfe_u32 v62, v60, 2, 2
  v_and_b32 v63, 1, v60
  v_lshl_add_u32 v62, v62, 1, v63
  v_mul_u32_u24 v62, 1280, v62
  v_bfe_u32 v63, v60, 1, 1
  v_lshlrev_b32 v63, 4, v63
  v_add3_u32 v61, v61, v62, v63
  buffer_load_dwordx4 v[64:67], v61, s[16:19], 0 offen
  v_lshlrev_b32 v60, 4, v60
  s_waitcnt vmcnt(0)
  v_and_b32 v72, -2, v64
  v_lshlrev_b32 v73, 16, v64
  v_lshlrev_b32 v74, 16, v72
  v_sub_f32 v73, v73, v74
  v_lshrrev_b32 v73, 16, v73
  v_and_b32 v68, 0xfffe, v73
  v_mov_b32 v64, v72
  v_mov_b32 v69, 0
  v_mov_b32 v70, 0
  v_mov_b32 v71, 0
  s_mov_b32 s27, 65536
  buffer_store_dwordx4 v[64:67], v60, s[8:11], s27 offen sc1
  s_mov_b32 s27, 75776
  buffer_store_dwordx4 v[68:71], v60, s[8:11], s27 offen sc1
  v_add_u32 v61, 0, v60
  v_lshrrev_b32 v62, 13, v61
  v_mul_u32_u24 v62, 0x6000, v62
  v_add_u32 v61, v61, v62
  s_mov_b32 s27, 917504
  buffer_store_dwordx4 v[64:67], v61, s[8:11], s27 offen sc1
  s_mov_b32 s27, 925696
  buffer_store_dwordx4 v[64:67], v61, s[8:11], s27 offen sc1
  s_mov_b32 s27, 933888
  buffer_store_dwordx4 v[64:67], v61, s[8:11], s27 offen sc1
  s_mov_b32 s27, 942080
  buffer_store_dwordx4 v[64:67], v61, s[8:11], s27 offen sc1
  v_add_u32 v61, 10240, v60
  v_lshrrev_b32 v62, 13, v61
  v_mul_u32_u24 v62, 0x6000, v62
  v_add_u32 v61, v61, v62
  s_mov_b32 s27, 917504
  buffer_store_dwordx4 v[68:71], v61, s[8:11], s27 offen sc1
  s_mov_b32 s27, 925696
  buffer_store_dwordx4 v[68:71], v61, s[8:11], s27 offen sc1
  s_mov_b32 s27, 933888
  buffer_store_dwordx4 v[68:71], v61, s[8:11], s27 offen sc1
  s_mov_b32 s27, 942080
  buffer_store_dwordx4 v[68:71], v61, s[8:11], s27 offen sc1
P_memdone:
  s_mov_b64 exec, s[34:35]
P_nomem:
  v_lshlrev_b32 v61, 6, v3
  s_lshl_b32 s27, s24, 4
  v_lshl_add_u32 v62, v4, 2, s27
  v_add_u32 v62, v61, v62
  s_waitcnt vmcnt(0)
  v_lshlrev_b32 v64, 16, v16
  v_and_b32 v65, 0xffff0000, v16
  v_lshlrev_b32 v66, 16, v17
  v_and_b32 v67, 0xffff0000, v17
  v_lshlrev_b32 v68, 16, v18
  v_and_b32 v69, 0xffff0000, v18
  v_lshlrev_b32 v70, 16, v19
  v_and_b32 v71, 0xffff0000, v19
  v_lshlrev_b32 v72, 16, v20
  v_and_b32 v73, 0xffff0000, v20
  v_lshlrev_b32 v74, 16, v21
  v_and_b32 v75, 0xffff0000, v21
  v_lshlrev_b32 v76, 16, v22
  v_and_b32 v77, 0xffff0000, v22
  v_lshlrev_b32 v78, 16, v23
  v_and_b32 v79, 0xffff0000, v23
  v_lshlrev_b32 v80, 16, v24
  v_and_b32 v81, 0xffff0000, v24
  v_lshlrev_b32 v82, 16, v25
  v_and_b32 v83, 0xffff0000, v25
  v_lshlrev_b32 v84, 16, v26
  v_and_b32 v85, 0xffff0000, v26
  v_lshlrev_b32 v86, 16, v27
  v_and_b32 v87, 0xffff0000, v27
  v_lshlrev_b32 v88, 16, v28
  v_and_b32 v89, 0xffff0000, v28
  v_lshlrev_b32 v90, 16, v29
  v_and_b32 v91, 0xffff0000, v29
  v_lshlrev_b32 v92, 16, v30
  v_and_b32 v93, 0xffff0000, v30
  v_lshlrev_b32 v94, 16, v31
  v_and_b32 v95, 0xffff0000, v31
  v_lshlrev_b32 v96, 16, v32
  v_and_b32 v97, 0xffff0000, v32
  v_lshlrev_b32 v98, 16, v33
  v_and_b32 v99, 0xffff0000, v33
  v_lshlrev_b32 v100, 16, v34
  v_and_b32 v101, 0xffff0000, v34
  v_lshlrev_b32 v102, 16, v35
  v_and_b32 v103, 0xffff0000, v35
  v_add_f32 v56, v64, v65
  v_add_f32 v56, v56, v66
  v_add_f32 v56, v56, v67
  v_add_f32 v56, v56, v68
  v_add_f32 v56, v56, v69
  v_add_f32 v56, v56, v70
  v_add_f32 v56, v56, v71
  v_add_f32 v56, v56, v72
  v_add_f32 v56, v56, v73
  v_add_f32 v56, v56, v74
  v_add_f32 v56, v56, v75
  v_add_f32 v56, v56, v76
  v_add_f32 v56, v56, v77
  v_add_f32 v56, v56, v78
  v_add_f32 v56, v56, v79
  v_add_f32 v56, v56, v80
  v_add_f32 v56, v56, v81
  v_add_f32 v56, v56, v82
  v_add_f32 v56, v56, v83
  v_add_f32 v56, v56, v84
  v_add_f32 v56, v56, v85
  v_add_f32 v56, v56, v86
  v_add_f32 v56, v56, v87
  v_add_f32 v56, v56, v88
  v_add_f32 v56, v56, v89
  v_add_f32 v56, v56, v90
  v_add_f32 v56, v56, v91
  v_add_f32 v56, v56, v92
  v_add_f32 v56, v56, v93
  v_add_f32 v56, v56, v94
  v_add_f32 v56, v56, v95
  v_add_f32 v56, v56, v96
  v_add_f32 v56, v56, v97
  v_add_f32 v56, v56, v98
  v_add_f32 v56, v56, v99
  v_add_f32 v56, v56, v100
  v_add_f32 v56, v56, v101
  v_add_f32 v56, v56, v102
  v_add_f32 v56, v56, v103
  v_lshlrev_b32 v104, 16, v36
  v_and_b32 v105, 0xffff0000, v36
  v_lshlrev_b32 v106, 16, v37
  v_and_b32 v107, 0xffff0000, v37
  v_lshlrev_b32 v108, 16, v38
  v_and_b32 v109, 0xffff0000, v38
  v_lshlrev_b32 v110, 16, v39
  v_and_b32 v111, 0xffff0000, v39
  v_lshlrev_b32 v112, 16, v40
  v_and_b32 v113, 0xffff0000, v40
  v_lshlrev_b32 v114, 16, v41
  v_and_b32 v115, 0xffff0000, v41
  v_lshlrev_b32 v116, 16, v42
  v_and_b32 v117, 0xffff0000, v42
  v_lshlrev_b32 v118, 16, v43
  v_and_b32 v119, 0xffff0000, v43
  v_lshlrev_b32 v120, 16, v44
  v_and_b32 v121, 0xffff0000, v44
  v_lshlrev_b32 v122, 16, v45
  v_and_b32 v123, 0xffff0000, v45
  v_lshlrev_b32 v124, 16, v46
  v_and_b32 v125, 0xffff0000, v46
  v_lshlrev_b32 v126, 16, v47
  v_and_b32 v127, 0xffff0000, v47
  v_lshlrev_b32 v128, 16, v48
  v_and_b32 v129, 0xffff0000, v48
  v_lshlrev_b32 v130, 16, v49
  v_and_b32 v131, 0xffff0000, v49
  v_lshlrev_b32 v132, 16, v50
  v_and_b32 v133, 0xffff0000, v50
  v_lshlrev_b32 v134, 16, v51
  v_and_b32 v135, 0xffff0000, v51
  v_lshlrev_b32 v136, 16, v52
  v_and_b32 v137, 0xffff0000, v52
  v_lshlrev_b32 v138, 16, v53
  v_and_b32 v139, 0xffff0000, v53
  v_lshlrev_b32 v140, 16, v54
  v_and_b32 v141, 0xffff0000, v54
  v_lshlrev_b32 v142, 16, v55
  v_and_b32 v143, 0xffff0000, v55
  v_add_f32 v57, v104, v105
  v_add_f32 v57, v57, v106
  v_add_f32 v57, v57, v107
  v_add_f32 v57, v57, v108
  v_add_f32 v57, v57, v109
  v_add_f32 v57, v57, v110
  v_add_f32 v57, v57, v111
  v_add_f32 v57, v57, v112
  v_add_f32 v57, v57, v113
  v_add_f32 v57, v57, v114
  v_add_f32 v57, v57, v115
  v_add_f32 v57, v57, v116
  v_add_f32 v57, v57, v117
  v_add_f32 v57, v57, v118
  v_add_f32 v57, v57, v119
  v_add_f32 v57, v57, v120
  v_add_f32 v57, v57, v121
  v_add_f32 v57, v57, v122
  v_add_f32 v57, v57, v123
  v_add_f32 v57, v57, v124
  v_add_f32 v57, v57, v125
  v_add_f32 v57, v57, v126
  v_add_f32 v57, v57, v127
  v_add_f32 v57, v57, v128
  v_add_f32 v57, v57, v129
  v_add_f32 v57, v57, v130
  v_add_f32 v57, v57, v131
  v_add_f32 v57, v57, v132
  v_add_f32 v57, v57, v133
  v_add_f32 v57, v57, v134
  v_add_f32 v57, v57, v135
  v_add_f32 v57, v57, v136
  v_add_f32 v57, v57, v137
  v_add_f32 v57, v57, v138
  v_add_f32 v57, v57, v139
  v_add_f32 v57, v57, v140
  v_add_f32 v57, v57, v141
  v_add_f32 v57, v57, v142
  v_add_f32 v57, v57, v143
  ds_write_b32 v62, v56 offset:0
  ds_write_b32 v62, v57 offset:1024
  s_waitcnt lgkmcnt(0)
  s_barrier
  ds_read_b128 v[144:147], v61 offset:0
  ds_read_b128 v[148:151], v61 offset:16
  ds_read_b128 v[152:155], v61 offset:32
  ds_read_b128 v[156:159], v61 offset:48
  ds_read_b128 v[160:163], v61 offset:1024
  ds_read_b128 v[164:167], v61 offset:1040
  ds_read_b128 v[168:171], v61 offset:1056
  ds_read_b128 v[172:175], v61 offset:1072
  s_waitcnt lgkmcnt(0)
  v_add_f32 v56, v144, v145
  v_add_f32 v56, v56, v146
  v_add_f32 v56, v56, v147
  v_add_f32 v56, v56, v148
  v_add_f32 v56, v56, v149
  v_add_f32 v56, v56, v150
  v_add_f32 v56, v56, v151
  v_add_f32 v56, v56, v152
  v_add_f32 v56, v56, v153
  v_add_f32 v56, v56, v154
  v_add_f32 v56, v56, v155
  v_add_f32 v56, v56, v156
  v_add_f32 v56, v56, v157
  v_add_f32 v56, v56, v158
  v_add_f32 v56, v56, v159
  v_add_f32 v57, v160, v161
  v_add_f32 v57, v57, v162
  v_add_f32 v57, v57, v163
  v_add_f32 v57, v57, v164
  v_add_f32 v57, v57, v165
  v_add_f32 v57, v57, v166
  v_add_f32 v57, v57, v167
  v_add_f32 v57, v57, v168
  v_add_f32 v57, v57, v169
  v_add_f32 v57, v57, v170
  v_add_f32 v57, v57, v171
  v_add_f32 v57, v57, v172
  v_add_f32 v57, v57, v173
  v_add_f32 v57, v57, v174
  v_add_f32 v57, v57, v175
  v_mul_f32 v58, 0x3acccccd, v56
  v_mov_b32 v56, 0
  v_sub_f32 v60, v64, v58
  v_fmac_f32 v56, v60, v60
  v_sub_f32 v60, v65, v58
  v_fmac_f32 v56, v60, v60
  v_sub_f32 v60, v66, v58
  v_fmac_f32 v56, v60, v60
  v_sub_f32 v60, v67, v58
  v_fmac_f32 v56, v60, v60
  v_sub_f32 v60, v68, v58
  v_fmac_f32 v56, v60, v60
  v_sub_f32 v60, v69, v58
  v_fmac_f32 v56, v60, v60
  v_sub_f32 v60, v70, v58
  v_fmac_f32 v56, v60, v60
  v_sub_f32 v60, v71, v58
  v_fmac_f32 v56, v60, v60
  v_sub_f32 v60, v72, v58
  v_fmac_f32 v56, v60, v60
  v_sub_f32 v60, v73, v58
  v_fmac_f32 v56, v60, v60
  v_sub_f32 v60, v74, v58
  v_fmac_f32 v56, v60, v60
  v_sub_f32 v60, v75, v58
  v_fmac_f32 v56, v60, v60
  v_sub_f32 v60, v76, v58
  v_fmac_f32 v56, v60, v60
  v_sub_f32 v60, v77, v58
  v_fmac_f32 v56, v60, v60
  v_sub_f32 v60, v78, v58
  v_fmac_f32 v56, v60, v60
  v_sub_f32 v60, v79, v58
  v_fmac_f32 v56, v60, v60
  v_sub_f32 v60, v80, v58
  v_fmac_f32 v56, v60, v60
  v_sub_f32 v60, v81, v58
  v_fmac_f32 v56, v60, v60
  v_sub_f32 v60, v82, v58
  v_fmac_f32 v56, v60, v60
  v_sub_f32 v60, v83, v58
  v_fmac_f32 v56, v60, v60
  v_sub_f32 v60, v84, v58
  v_fmac_f32 v56, v60, v60
  v_sub_f32 v60, v85, v58
  v_fmac_f32 v56, v60, v60
  v_sub_f32 v60, v86, v58
  v_fmac_f32 v56, v60, v60
  v_sub_f32 v60, v87, v58
  v_fmac_f32 v56, v60, v60
  v_sub_f32 v60, v88, v58
  v_fmac_f32 v56, v60, v60
  v_sub_f32 v60, v89, v58
  v_fmac_f32 v56, v60, v60
  v_sub_f32 v60, v90, v58
  v_fmac_f32 v56, v60, v60
  v_sub_f32 v60, v91, v58
  v_fmac_f32 v56, v60, v60
  v_sub_f32 v60, v92, v58
  v_fmac_f32 v56, v60, v60
  v_sub_f32 v60, v93, v58
  v_fmac_f32 v56, v60, v60
  v_sub_f32 v60, v94, v58
  v_fmac_f32 v56, v60, v60
  v_sub_f32 v60, v95, v58
  v_fmac_f32 v56, v60, v60
  v_sub_f32 v60, v96, v58
  v_fmac_f32 v56, v60, v60
  v_sub_f32 v60, v97, v58
  v_fmac_f32 v56, v60, v60
  v_sub_f32 v60, v98, v58
  v_fmac_f32 v56, v60, v60
  v_sub_f32 v60, v99, v58
  v_fmac_f32 v56, v60, v60
  v_sub_f32 v60, v100, v58
  v_fmac_f32 v56, v60, v60
  v_sub_f32 v60, v101, v58
  v_fmac_f32 v56, v60, v60
  v_sub_f32 v60, v102, v58
  v_fmac_f32 v56, v60, v60
  v_sub_f32 v60, v103, v58
  v_fmac_f32 v56, v60, v60
  v_mul_f32 v59, 0x3acccccd, v57
  v_mov_b32 v57, 0
  v_sub_f32 v60, v104, v59
  v_fmac_f32 v57, v60, v60
  v_sub_f32 v60, v105, v59
  v_fmac_f32 v57, v60, v60
  v_sub_f32 v60, v106, v59
  v_fmac_f32 v57, v60, v60
  v_sub_f32 v60, v107, v59
  v_fmac_f32 v57, v60, v60
  v_sub_f32 v60, v108, v59
  v_fmac_f32 v57, v60, v60
  v_sub_f32 v60, v109, v59
  v_fmac_f32 v57, v60, v60
  v_sub_f32 v60, v110, v59
  v_fmac_f32 v57, v60, v60
  v_sub_f32 v60, v111, v59
  v_fmac_f32 v57, v60, v60
  v_sub_f32 v60, v112, v59
  v_fmac_f32 v57, v60, v60
  v_sub_f32 v60, v113, v59
  v_fmac_f32 v57, v60, v60
  v_sub_f32 v60, v114, v59
  v_fmac_f32 v57, v60, v60
  v_sub_f32 v60, v115, v59
  v_fmac_f32 v57, v60, v60
  v_sub_f32 v60, v116, v59
  v_fmac_f32 v57, v60, v60
  v_sub_f32 v60, v117, v59
  v_fmac_f32 v57, v60, v60
  v_sub_f32 v60, v118, v59
  v_fmac_f32 v57, v60, v60
  v_sub_f32 v60, v119, v59
  v_fmac_f32 v57, v60, v60
  v_sub_f32 v60, v120, v59
  v_fmac_f32 v57, v60, v60
  v_sub_f32 v60, v121, v59
  v_fmac_f32 v57, v60, v60
  v_sub_f32 v60, v122, v59
  v_fmac_f32 v57, v60, v60
  v_sub_f32 v60, v123, v59
  v_fmac_f32 v57, v60, v60
  v_sub_f32 v60, v124, v59
  v_fmac_f32 v57, v60, v60
  v_sub_f32 v60, v125, v59
  v_fmac_f32 v57, v60, v60
  v_sub_f32 v60, v126, v59
  v_fmac_f32 v57, v60, v60
  v_sub_f32 v60, v127, v59
  v_fmac_f32 v57, v60, v60
  v_sub_f32 v60, v128, v59
  v_fmac_f32 v57, v60, v60
  v_sub_f32 v60, v129, v59
  v_fmac_f32 v57, v60, v60
  v_sub_f32 v60, v130, v59
  v_fmac_f32 v57, v60, v60
  v_sub_f32 v60, v131, v59
  v_fmac_f32 v57, v60, v60
  v_sub_f32 v60, v132, v59
  v_fmac_f32 v57, v60, v60
  v_sub_f32 v60, v133, v59
  v_fmac_f32 v57, v60, v60
  v_sub_f32 v60, v134, v59
  v_fmac_f32 v57, v60, v60
  v_sub_f32 v60, v135, v59
  v_fmac_f32 v57, v60, v60
  v_sub_f32 v60, v136, v59
  v_fmac_f32 v57, v60, v60
  v_sub_f32 v60, v137, v59
  v_fmac_f32 v57, v60, v60
  v_sub_f32 v60, v138, v59
  v_fmac_f32 v57, v60, v60
  v_sub_f32 v60, v139, v59
  v_fmac_f32 v57, v60, v60
  v_sub_f32 v60, v140, v59
  v_fmac_f32 v57, v60, v60
  v_sub_f32 v60, v141, v59
  v_fmac_f32 v57, v60, v60
  v_sub_f32 v60, v142, v59
  v_fmac_f32 v57, v60, v60
  v_sub_f32 v60, v143, v59
  v_fmac_f32 v57, v60, v60
  ds_write_b32 v62, v56 offset:2048
  ds_write_b32 v62, v57 offset:3072
  s_waitcnt lgkmcnt(0)
  s_barrier
  ds_read_b128 v[144:147], v61 offset:2048
  ds_read_b128 v[148:151], v61 offset:2064
  ds_read_b128 v[152:155], v61 offset:2080
  ds_read_b128 v[156:159], v61 offset:2096
  ds_read_b128 v[160:163], v61 offset:3072
  ds_read_b128 v[164:167], v61 offset:3088
  ds_read_b128 v[168:171], v61 offset:3104
  ds_read_b128 v[172:175], v61 offset:3120
  s_waitcnt lgkmcnt(0)
  v_add_f32 v56, v144, v145
  v_add_f32 v56, v56, v146
  v_add_f32 v56, v56, v147
  v_add_f32 v56, v56, v148
  v_add_f32 v56, v56, v149
  v_add_f32 v56, v56, v150
  v_add_f32 v56, v56, v151
  v_add_f32 v56, v56, v152
  v_add_f32 v56, v56, v153
  v_add_f32 v56, v56, v154
  v_add_f32 v56, v56, v155
  v_add_f32 v56, v56, v156
  v_add_f32 v56, v56, v157
  v_add_f32 v56, v56, v158
  v_add_f32 v56, v56, v159
  v_add_f32 v57, v160, v161
  v_add_f32 v57, v57, v162
  v_add_f32 v57, v57, v163
  v_add_f32 v57, v57, v164
  v_add_f32 v57, v57, v165
  v_add_f32 v57, v57, v166
  v_add_f32 v57, v57, v167
  v_add_f32 v57, v57, v168
  v_add_f32 v57, v57, v169
  v_add_f32 v57, v57, v170
  v_add_f32 v57, v57, v171
  v_add_f32 v57, v57, v172
  v_add_f32 v57, v57, v173
  v_add_f32 v57, v57, v174
  v_add_f32 v57, v57, v175
  v_mul_f32 v56, 0x3acccccd, v56
  v_cvt_pk_bf16_f32 v58, v58, v56
  v_and_b32 v56, 0xffff0000, v58
  v_lshlrev_b32 v58, 16, v58
  v_add_f32 v56, 0x3727c5ac, v56
  v_cvt_pk_bf16_f32 v56, v56, v56
  v_lshlrev_b32 v56, 16, v56
  v_sqrt_f32 v56, v56
  s_nop 0
  v_cvt_pk_bf16_f32 v56, v56, v56
  v_lshlrev_b32 v56, 16, v56
  v_rcp_f32 v56, v56
  v_sub_f32 v64, v64, v58
  v_sub_f32 v65, v65, v58
  v_cvt_pk_bf16_f32 v60, v64, v65
  v_lshlrev_b32 v64, 16, v60
  v_and_b32 v65, 0xffff0000, v60
  v_mul_f32 v64, v64, v56
  v_mul_f32 v65, v65, v56
  v_cvt_pk_bf16_f32 v16, v64, v65
  v_sub_f32 v66, v66, v58
  v_sub_f32 v67, v67, v58
  v_cvt_pk_bf16_f32 v60, v66, v67
  v_lshlrev_b32 v66, 16, v60
  v_and_b32 v67, 0xffff0000, v60
  v_mul_f32 v66, v66, v56
  v_mul_f32 v67, v67, v56
  v_cvt_pk_bf16_f32 v17, v66, v67
  v_sub_f32 v68, v68, v58
  v_sub_f32 v69, v69, v58
  v_cvt_pk_bf16_f32 v60, v68, v69
  v_lshlrev_b32 v68, 16, v60
  v_and_b32 v69, 0xffff0000, v60
  v_mul_f32 v68, v68, v56
  v_mul_f32 v69, v69, v56
  v_cvt_pk_bf16_f32 v18, v68, v69
  v_sub_f32 v70, v70, v58
  v_sub_f32 v71, v71, v58
  v_cvt_pk_bf16_f32 v60, v70, v71
  v_lshlrev_b32 v70, 16, v60
  v_and_b32 v71, 0xffff0000, v60
  v_mul_f32 v70, v70, v56
  v_mul_f32 v71, v71, v56
  v_cvt_pk_bf16_f32 v19, v70, v71
  v_sub_f32 v72, v72, v58
  v_sub_f32 v73, v73, v58
  v_cvt_pk_bf16_f32 v60, v72, v73
  v_lshlrev_b32 v72, 16, v60
  v_and_b32 v73, 0xffff0000, v60
  v_mul_f32 v72, v72, v56
  v_mul_f32 v73, v73, v56
  v_cvt_pk_bf16_f32 v20, v72, v73
  v_sub_f32 v74, v74, v58
  v_sub_f32 v75, v75, v58
  v_cvt_pk_bf16_f32 v60, v74, v75
  v_lshlrev_b32 v74, 16, v60
  v_and_b32 v75, 0xffff0000, v60
  v_mul_f32 v74, v74, v56
  v_mul_f32 v75, v75, v56
  v_cvt_pk_bf16_f32 v21, v74, v75
  v_sub_f32 v76, v76, v58
  v_sub_f32 v77, v77, v58
  v_cvt_pk_bf16_f32 v60, v76, v77
  v_lshlrev_b32 v76, 16, v60
  v_and_b32 v77, 0xffff0000, v60
  v_mul_f32 v76, v76, v56
  v_mul_f32 v77, v77, v56
  v_cvt_pk_bf16_f32 v22, v76, v77
  v_sub_f32 v78, v78, v58
  v_sub_f32 v79, v79, v58
  v_cvt_pk_bf16_f32 v60, v78, v79
  v_lshlrev_b32 v78, 16, v60
  v_and_b32 v79, 0xffff0000, v60
  v_mul_f32 v78, v78, v56
  v_mul_f32 v79, v79, v56
  v_cvt_pk_bf16_f32 v23, v78, v79
  v_sub_f32 v80, v80, v58
  v_sub_f32 v81, v81, v58
  v_cvt_pk_bf16_f32 v60, v80, v81
  v_lshlrev_b32 v80, 16, v60
  v_and_b32 v81, 0xffff0000, v60
  v_mul_f32 v80, v80, v56
  v_mul_f32 v81, v81, v56
  v_cvt_pk_bf16_f32 v24, v80, v81
  v_sub_f32 v82, v82, v58
  v_sub_f32 v83, v83, v58
  v_cvt_pk_bf16_f32 v60, v82, v83
  v_lshlrev_b32 v82, 16, v60
  v_and_b32 v83, 0xffff0000, v60
  v_mul_f32 v82, v82, v56
  v_mul_f32 v83, v83, v56
  v_cvt_pk_bf16_f32 v25, v82, v83
  v_sub_f32 v84, v84, v58
  v_sub_f32 v85, v85, v58
  v_cvt_pk_bf16_f32 v60, v84, v85
  v_lshlrev_b32 v84, 16, v60
  v_and_b32 v85, 0xffff0000, v60
  v_mul_f32 v84, v84, v56
  v_mul_f32 v85, v85, v56
  v_cvt_pk_bf16_f32 v26, v84, v85
  v_sub_f32 v86, v86, v58
  v_sub_f32 v87, v87, v58
  v_cvt_pk_bf16_f32 v60, v86, v87
  v_lshlrev_b32 v86, 16, v60
  v_and_b32 v87, 0xffff0000, v60
  v_mul_f32 v86, v86, v56
  v_mul_f32 v87, v87, v56
  v_cvt_pk_bf16_f32 v27, v86, v87
  v_sub_f32 v88, v88, v58
  v_sub_f32 v89, v89, v58
  v_cvt_pk_bf16_f32 v60, v88, v89
  v_lshlrev_b32 v88, 16, v60
  v_and_b32 v89, 0xffff0000, v60
  v_mul_f32 v88, v88, v56
  v_mul_f32 v89, v89, v56
  v_cvt_pk_bf16_f32 v28, v88, v89
  v_sub_f32 v90, v90, v58
  v_sub_f32 v91, v91, v58
  v_cvt_pk_bf16_f32 v60, v90, v91
  v_lshlrev_b32 v90, 16, v60
  v_and_b32 v91, 0xffff0000, v60
  v_mul_f32 v90, v90, v56
  v_mul_f32 v91, v91, v56
  v_cvt_pk_bf16_f32 v29, v90, v91
  v_sub_f32 v92, v92, v58
  v_sub_f32 v93, v93, v58
  v_cvt_pk_bf16_f32 v60, v92, v93
  v_lshlrev_b32 v92, 16, v60
  v_and_b32 v93, 0xffff0000, v60
  v_mul_f32 v92, v92, v56
  v_mul_f32 v93, v93, v56
  v_cvt_pk_bf16_f32 v30, v92, v93
  v_sub_f32 v94, v94, v58
  v_sub_f32 v95, v95, v58
  v_cvt_pk_bf16_f32 v60, v94, v95
  v_lshlrev_b32 v94, 16, v60
  v_and_b32 v95, 0xffff0000, v60
  v_mul_f32 v94, v94, v56
  v_mul_f32 v95, v95, v56
  v_cvt_pk_bf16_f32 v31, v94, v95
  v_sub_f32 v96, v96, v58
  v_sub_f32 v97, v97, v58
  v_cvt_pk_bf16_f32 v60, v96, v97
  v_lshlrev_b32 v96, 16, v60
  v_and_b32 v97, 0xffff0000, v60
  v_mul_f32 v96, v96, v56
  v_mul_f32 v97, v97, v56
  v_cvt_pk_bf16_f32 v32, v96, v97
  v_sub_f32 v98, v98, v58
  v_sub_f32 v99, v99, v58
  v_cvt_pk_bf16_f32 v60, v98, v99
  v_lshlrev_b32 v98, 16, v60
  v_and_b32 v99, 0xffff0000, v60
  v_mul_f32 v98, v98, v56
  v_mul_f32 v99, v99, v56
  v_cvt_pk_bf16_f32 v33, v98, v99
  v_sub_f32 v100, v100, v58
  v_sub_f32 v101, v101, v58
  v_cvt_pk_bf16_f32 v60, v100, v101
  v_lshlrev_b32 v100, 16, v60
  v_and_b32 v101, 0xffff0000, v60
  v_mul_f32 v100, v100, v56
  v_mul_f32 v101, v101, v56
  v_cvt_pk_bf16_f32 v34, v100, v101
  v_sub_f32 v102, v102, v58
  v_sub_f32 v103, v103, v58
  v_cvt_pk_bf16_f32 v60, v102, v103
  v_lshlrev_b32 v102, 16, v60
  v_and_b32 v103, 0xffff0000, v60
  v_mul_f32 v102, v102, v56
  v_mul_f32 v103, v103, v56
  v_cvt_pk_bf16_f32 v35, v102, v103
  s_mul_i32 s32, s31, 40960
  s_mul_i32 s27, s24, 5120
  s_add_u32 s32, s32, s27
  s_add_u32 s32, s32, 2097152
  buffer_store_dwordx4 v[16:19], v2, s[8:11], s32 offen offset:0 sc1
  buffer_store_dwordx4 v[20:23], v2, s[8:11], s32 offen offset:1024 sc1
  buffer_store_dwordx4 v[24:27], v2, s[8:11], s32 offen offset:2048 sc1
  buffer_store_dwordx4 v[28:31], v2, s[8:11], s32 offen offset:3072 sc1
  s_add_u32 s32, s32, 4096
  buffer_store_dwordx4 v[32:35], v2, s[8:11], s32 offen sc1
  v_mul_f32 v57, 0x3acccccd, v57
  v_cvt_pk_bf16_f32 v59, v59, v57
  v_and_b32 v57, 0xffff0000, v59
  v_lshlrev_b32 v59, 16, v59
  v_add_f32 v57, 0x3727c5ac, v57
  v_cvt_pk_bf16_f32 v57, v57, v57
  v_lshlrev_b32 v57, 16, v57
  v_sqrt_f32 v57, v57
  s_nop 0
  v_cvt_pk_bf16_f32 v57, v57, v57
  v_lshlrev_b32 v57, 16, v57
  v_rcp_f32 v57, v57
  v_sub_f32 v104, v104, v59
  v_sub_f32 v105, v105, v59
  v_cvt_pk_bf16_f32 v60, v104, v105
  v_lshlrev_b32 v104, 16, v60
  v_and_b32 v105, 0xffff0000, v60
  v_mul_f32 v104, v104, v57
  v_mul_f32 v105, v105, v57
  v_cvt_pk_bf16_f32 v36, v104, v105
  v_sub_f32 v106, v106, v59
  v_sub_f32 v107, v107, v59
  v_cvt_pk_bf16_f32 v60, v106, v107
  v_lshlrev_b32 v106, 16, v60
  v_and_b32 v107, 0xffff0000, v60
  v_mul_f32 v106, v106, v57
  v_mul_f32 v107, v107, v57
  v_cvt_pk_bf16_f32 v37, v106, v107
  v_sub_f32 v108, v108, v59
  v_sub_f32 v109, v109, v59
  v_cvt_pk_bf16_f32 v60, v108, v109
  v_lshlrev_b32 v108, 16, v60
  v_and_b32 v109, 0xffff0000, v60
  v_mul_f32 v108, v108, v57
  v_mul_f32 v109, v109, v57
  v_cvt_pk_bf16_f32 v38, v108, v109
  v_sub_f32 v110, v110, v59
  v_sub_f32 v111, v111, v59
  v_cvt_pk_bf16_f32 v60, v110, v111
  v_lshlrev_b32 v110, 16, v60
  v_and_b32 v111, 0xffff0000, v60
  v_mul_f32 v110, v110, v57
  v_mul_f32 v111, v111, v57
  v_cvt_pk_bf16_f32 v39, v110, v111
  v_sub_f32 v112, v112, v59
  v_sub_f32 v113, v113, v59
  v_cvt_pk_bf16_f32 v60, v112, v113
  v_lshlrev_b32 v112, 16, v60
  v_and_b32 v113, 0xffff0000, v60
  v_mul_f32 v112, v112, v57
  v_mul_f32 v113, v113, v57
  v_cvt_pk_bf16_f32 v40, v112, v113
  v_sub_f32 v114, v114, v59
  v_sub_f32 v115, v115, v59
  v_cvt_pk_bf16_f32 v60, v114, v115
  v_lshlrev_b32 v114, 16, v60
  v_and_b32 v115, 0xffff0000, v60
  v_mul_f32 v114, v114, v57
  v_mul_f32 v115, v115, v57
  v_cvt_pk_bf16_f32 v41, v114, v115
  v_sub_f32 v116, v116, v59
  v_sub_f32 v117, v117, v59
  v_cvt_pk_bf16_f32 v60, v116, v117
  v_lshlrev_b32 v116, 16, v60
  v_and_b32 v117, 0xffff0000, v60
  v_mul_f32 v116, v116, v57
  v_mul_f32 v117, v117, v57
  v_cvt_pk_bf16_f32 v42, v116, v117
  v_sub_f32 v118, v118, v59
  v_sub_f32 v119, v119, v59
  v_cvt_pk_bf16_f32 v60, v118, v119
  v_lshlrev_b32 v118, 16, v60
  v_and_b32 v119, 0xffff0000, v60
  v_mul_f32 v118, v118, v57
  v_mul_f32 v119, v119, v57
  v_cvt_pk_bf16_f32 v43, v118, v119
  v_sub_f32 v120, v120, v59
  v_sub_f32 v121, v121, v59
  v_cvt_pk_bf16_f32 v60, v120, v121
  v_lshlrev_b32 v120, 16, v60
  v_and_b32 v121, 0xffff0000, v60
  v_mul_f32 v120, v120, v57
  v_mul_f32 v121, v121, v57
  v_cvt_pk_bf16_f32 v44, v120, v121
  v_sub_f32 v122, v122, v59
  v_sub_f32 v123, v123, v59
  v_cvt_pk_bf16_f32 v60, v122, v123
  v_lshlrev_b32 v122, 16, v60
  v_and_b32 v123, 0xffff0000, v60
  v_mul_f32 v122, v122, v57
  v_mul_f32 v123, v123, v57
  v_cvt_pk_bf16_f32 v45, v122, v123
  v_sub_f32 v124, v124, v59
  v_sub_f32 v125, v125, v59
  v_cvt_pk_bf16_f32 v60, v124, v125
  v_lshlrev_b32 v124, 16, v60
  v_and_b32 v125, 0xffff0000, v60
  v_mul_f32 v124, v124, v57
  v_mul_f32 v125, v125, v57
  v_cvt_pk_bf16_f32 v46, v124, v125
  v_sub_f32 v126, v126, v59
  v_sub_f32 v127, v127, v59
  v_cvt_pk_bf16_f32 v60, v126, v127
  v_lshlrev_b32 v126, 16, v60
  v_and_b32 v127, 0xffff0000, v60
  v_mul_f32 v126, v126, v57
  v_mul_f32 v127, v127, v57
  v_cvt_pk_bf16_f32 v47, v126, v127
  v_sub_f32 v128, v128, v59
  v_sub_f32 v129, v129, v59
  v_cvt_pk_bf16_f32 v60, v128, v129
  v_lshlrev_b32 v128, 16, v60
  v_and_b32 v129, 0xffff0000, v60
  v_mul_f32 v128, v128, v57
  v_mul_f32 v129, v129, v57
  v_cvt_pk_bf16_f32 v48, v128, v129
  v_sub_f32 v130, v130, v59
  v_sub_f32 v131, v131, v59
  v_cvt_pk_bf16_f32 v60, v130, v131
  v_lshlrev_b32 v130, 16, v60
  v_and_b32 v131, 0xffff0000, v60
  v_mul_f32 v130, v130, v57
  v_mul_f32 v131, v131, v57
  v_cvt_pk_bf16_f32 v49, v130, v131
  v_sub_f32 v132, v132, v59
  v_sub_f32 v133, v133, v59
  v_cvt_pk_bf16_f32 v60, v132, v133
  v_lshlrev_b32 v132, 16, v60
  v_and_b32 v133, 0xffff0000, v60
  v_mul_f32 v132, v132, v57
  v_mul_f32 v133, v133, v57
  v_cvt_pk_bf16_f32 v50, v132, v133
  v_sub_f32 v134, v134, v59
  v_sub_f32 v135, v135, v59
  v_cvt_pk_bf16_f32 v60, v134, v135
  v_lshlrev_b32 v134, 16, v60
  v_and_b32 v135, 0xffff0000, v60
  v_mul_f32 v134, v134, v57
  v_mul_f32 v135, v135, v57
  v_cvt_pk_bf16_f32 v51, v134, v135
  v_sub_f32 v136, v136, v59
  v_sub_f32 v137, v137, v59
  v_cvt_pk_bf16_f32 v60, v136, v137
  v_lshlrev_b32 v136, 16, v60
  v_and_b32 v137, 0xffff0000, v60
  v_mul_f32 v136, v136, v57
  v_mul_f32 v137, v137, v57
  v_cvt_pk_bf16_f32 v52, v136, v137
  v_sub_f32 v138, v138, v59
  v_sub_f32 v139, v139, v59
  v_cvt_pk_bf16_f32 v60, v138, v139
  v_lshlrev_b32 v138, 16, v60
  v_and_b32 v139, 0xffff0000, v60
  v_mul_f32 v138, v138, v57
  v_mul_f32 v139, v139, v57
  v_cvt_pk_bf16_f32 v53, v138, v139
  v_sub_f32 v140, v140, v59
  v_sub_f32 v141, v141, v59
  v_cvt_pk_bf16_f32 v60, v140, v141
  v_lshlrev_b32 v140, 16, v60
  v_and_b32 v141, 0xffff0000, v60
  v_mul_f32 v140, v140, v57
  v_mul_f32 v141, v141, v57
  v_cvt_pk_bf16_f32 v54, v140, v141
  v_sub_f32 v142, v142, v59
  v_sub_f32 v143, v143, v59
  v_cvt_pk_bf16_f32 v60, v142, v143
  v_lshlrev_b32 v142, 16, v60
  v_and_b32 v143, 0xffff0000, v60
  v_mul_f32 v142, v142, v57
  v_mul_f32 v143, v143, v57
  v_cvt_pk_bf16_f32 v55, v142, v143
  s_mul_i32 s32, s31, 40960
  s_mul_i32 s27, s24, 5120
  s_add_u32 s32, s32, s27
  s_add_u32 s32, s32, 2117632
  buffer_store_dwordx4 v[36:39], v2, s[8:11], s32 offen offset:0 sc1
  buffer_store_dwordx4 v[40:43], v2, s[8:11], s32 offen offset:1024 sc1
  buffer_store_dwordx4 v[44:47], v2, s[8:11], s32 offen offset:2048 sc1
  buffer_store_dwordx4 v[48:51], v2, s[8:11], s32 offen offset:3072 sc1
  s_add_u32 s32, s32, 4096
  buffer_store_dwordx4 v[52:55], v2, s[8:11], s32 offen sc1
  s_waitcnt vmcnt(0)
  s_barrier
  s_cmp_lg_u32 s24, 0
  s_cbranch_scc1 P_done
  s_mov_b64 exec, 1
  v_mov_b32 v12, 1
  s_cmp_ge_u32 s31, 4
  s_cbranch_scc1 P_nop0
  buffer_atomic_add v12, off, s[68:71], 0 offset:72 sc1
P_nop0:
  buffer_atomic_add v12, off, s[68:71], 0 offset:64 sc1
  s_cmp_lg_u32 s31, 63
  s_cbranch_scc1 P_flag
  s_mov_b32 s72, -1
  s_mov_b32 s73, -1
  s_mov_b32 s74, -1
  s_mov_b32 s75, -1
  s_mov_b32 s30, 1310720
  s_memtime s[32:33]
  s_waitcnt lgkmcnt(0)
  buffer_load_dword v12, off, s[8:11], s30 sc1
  s_waitcnt vmcnt(0)
  s_memtime s[34:35]
  s_waitcnt lgkmcnt(0)
  s_sub_u32 s34, s34, s32
  s_min_u32 s72, s72, s34
  s_mov_b32 s30, 1318912
  s_memtime s[32:33]
  s_waitcnt lgkmcnt(0)
  buffer_load_dword v12, off, s[8:11], s30 sc1
  s_waitcnt vmcnt(0)
  s_memtime s[34:35]
  s_waitcnt lgkmcnt(0)
  s_sub_u32 s34, s34, s32
  s_min_u32 s73, s73, s34
  s_mov_b32 s30, 1327104
  s_memtime s[32:33]
  s_waitcnt lgkmcnt(0)
  buffer_load_dword v12, off, s[8:11], s30 sc1
  s_waitcnt vmcnt(0)
  s_memtime s[34:35]
  s_waitcnt lgkmcnt(0)
  s_sub_u32 s34, s34, s32
  s_min_u32 s74, s74, s34
  s_mov_b32 s30, 1335296
  s_memtime s[32:33]
  s_waitcnt lgkmcnt(0)
  buffer_load_dword v12, off, s[8:11], s30 sc1
  s_waitcnt vmcnt(0)
  s_memtime s[34:35]
  s_waitcnt lgkmcnt(0)
  s_sub_u32 s34, s34, s32
  s_min_u32 s75, s75, s34
  s_mov_b32 s30, 1314816
  s_memtime s[32:33]
  s_waitcnt lgkmcnt(0)
  buffer_load_dword v12, off, s[8:11], s30 sc1
  s_waitcnt vmcnt(0)
  s_memtime s[34:35]
  s_waitcnt lgkmcnt(0)
  s_sub_u32 s34, s34, s32
  s_min_u32 s72, s72, s34
  s_mov_b32 s30, 1323008
  s_memtime s[32:33]
  s_waitcnt lgkmcnt(0)
  buffer_load_dword v12, off, s[8:11], s30 sc1
  s_waitcnt vmcnt(0)
  s_memtime s[34:35]
  s_waitcnt lgkmcnt(0)
  s_sub_u32 s34, s34, s32
  s_min_u32 s73, s73, s34
  s_mov_b32 s30, 1331200
  s_memtime s[32:33]
  s_waitcnt lgkmcnt(0)
  buffer_load_dword v12, off, s[8:11], s30 sc1
  s_waitcnt vmcnt(0)
  s_memtime s[34:35]
  s_waitcnt lgkmcnt(0)
  s_sub_u32 s34, s34, s32
  s_min_u32 s74, s74, s34
  s_mov_b32 s30, 1339392
  s_memtime s[32:33]
  s_waitcnt lgkmcnt(0)
  buffer_load_dword v12, off, s[8:11], s30 sc1
  s_waitcnt vmcnt(0)
  s_memtime s[34:35]
  s_waitcnt lgkmcnt(0)
  s_sub_u32 s34, s34, s32
  s_min_u32 s75, s75, s34
  s_mov_b32 s30, 1310848
  s_memtime s[32:33]
  s_waitcnt lgkmcnt(0)
  buffer_load_dword v12, off, s[8:11], s30 sc1
  s_waitcnt vmcnt(0)
  s_memtime s[34:35]
  s_waitcnt lgkmcnt(0)
  s_sub_u32 s34, s34, s32
  s_min_u32 s72, s72, s34
  s_mov_b32 s30, 1319040
  s_memtime s[32:33]
  s_waitcnt lgkmcnt(0)
  buffer_load_dword v12, off, s[8:11], s30 sc1
  s_waitcnt vmcnt(0)
  s_memtime s[34:35]
  s_waitcnt lgkmcnt(0)
  s_sub_u32 s34, s34, s32
  s_min_u32 s73, s73, s34
  s_mov_b32 s30, 1327232
  s_memtime s[32:33]
  s_waitcnt lgkmcnt(0)
  buffer_load_dword v12, off, s[8:11], s30 sc1
  s_waitcnt vmcnt(0)
  s_memtime s[34:35]
  s_waitcnt lgkmcnt(0)
  s_sub_u32 s34, s34, s32
  s_min_u32 s74, s74, s34
  s_mov_b32 s30, 1335424
  s_memtime s[32:33]
  s_waitcnt lgkmcnt(0)
  buffer_load_dword v12, off, s[8:11], s30 sc1
  s_waitcnt vmcnt(0)
  s_memtime s[34:35]
  s_waitcnt lgkmcnt(0)
  s_sub_u32 s34, s34, s32
  s_min_u32 s75, s75, s34
  s_mov_b32 s30, 1314944
  s_memtime s[32:33]
  s_waitcnt lgkmcnt(0)
  buffer_load_dword v12, off, s[8:11], s30 sc1
  s_waitcnt vmcnt(0)
  s_memtime s[34:35]
  s_waitcnt lgkmcnt(0)
  s_sub_u32 s34, s34, s32
  s_min_u32 s72, s72, s34
  s_mov_b32 s30, 1323136
  s_memtime s[32:33]
  s_waitcnt lgkmcnt(0)
  buffer_load_dword v12, off, s[8:11], s30 sc1
  s_waitcnt vmcnt(0)
  s_memtime s[34:35]
  s_waitcnt lgkmcnt(0)
  s_sub_u32 s34, s34, s32
  s_min_u32 s73, s73, s34
  s_mov_b32 s30, 1331328
  s_memtime s[32:33]
  s_waitcnt lgkmcnt(0)
  buffer_load_dword v12, off, s[8:11], s30 sc1
  s_waitcnt vmcnt(0)
  s_memtime s[34:35]
  s_waitcnt lgkmcnt(0)
  s_sub_u32 s34, s34, s32
  s_min_u32 s74, s74, s34
  s_mov_b32 s30, 1339520
  s_memtime s[32:33]
  s_waitcnt lgkmcnt(0)
  buffer_load_dword v12, off, s[8:11], s30 sc1
  s_waitcnt vmcnt(0)
  s_memtime s[34:35]
  s_waitcnt lgkmcnt(0)
  s_sub_u32 s34, s34, s32
  s_min_u32 s75, s75, s34
  s_mov_b32 s30, 1310976
  s_memtime s[32:33]
  s_waitcnt lgkmcnt(0)
  buffer_load_dword v12, off, s[8:11], s30 sc1
  s_waitcnt vmcnt(0)
  s_memtime s[34:35]
  s_waitcnt lgkmcnt(0)
  s_sub_u32 s34, s34, s32
  s_min_u32 s72, s72, s34
  s_mov_b32 s30, 1319168
  s_memtime s[32:33]
  s_waitcnt lgkmcnt(0)
  buffer_load_dword v12, off, s[8:11], s30 sc1
  s_waitcnt vmcnt(0)
  s_memtime s[34:35]
  s_waitcnt lgkmcnt(0)
  s_sub_u32 s34, s34, s32
  s_min_u32 s73, s73, s34
  s_mov_b32 s30, 1327360
  s_memtime s[32:33]
  s_waitcnt lgkmcnt(0)
  buffer_load_dword v12, off, s[8:11], s30 sc1
  s_waitcnt vmcnt(0)
  s_memtime s[34:35]
  s_waitcnt lgkmcnt(0)
  s_sub_u32 s34, s34, s32
  s_min_u32 s74, s74, s34
  s_mov_b32 s30, 1335552
  s_memtime s[32:33]
  s_waitcnt lgkmcnt(0)
  buffer_load_dword v12, off, s[8:11], s30 sc1
  s_waitcnt vmcnt(0)
  s_memtime s[34:35]
  s_waitcnt lgkmcnt(0)
  s_sub_u32 s34, s34, s32
  s_min_u32 s75, s75, s34
  s_mov_b32 s30, 1315072
  s_memtime s[32:33]
  s_waitcnt lgkmcnt(0)
  buffer_load_dword v12, off, s[8:11], s30 sc1
  s_waitcnt vmcnt(0)
  s_memtime s[34:35]
  s_waitcnt lgkmcnt(0)
  s_sub_u32 s34, s34, s32
  s_min_u32 s72, s72, s34
  s_mov_b32 s30, 1323264
  s_memtime s[32:33]
  s_waitcnt lgkmcnt(0)
  buffer_load_dword v12, off, s[8:11], s30 sc1
  s_waitcnt vmcnt(0)
  s_memtime s[34:35]
  s_waitcnt lgkmcnt(0)
  s_sub_u32 s34, s34, s32
  s_min_u32 s73, s73, s34
  s_mov_b32 s30, 1331456
  s_memtime s[32:33]
  s_waitcnt lgkmcnt(0)
  buffer_load_dword v12, off, s[8:11], s30 sc1
  s_waitcnt vmcnt(0)
  s_memtime s[34:35]
  s_waitcnt lgkmcnt(0)
  s_sub_u32 s34, s34, s32
  s_min_u32 s74, s74, s34
  s_mov_b32 s30, 1339648
  s_memtime s[32:33]
  s_waitcnt lgkmcnt(0)
  buffer_load_dword v12, off, s[8:11], s30 sc1
  s_waitcnt vmcnt(0)
  s_memtime s[34:35]
  s_waitcnt lgkmcnt(0)
  s_sub_u32 s34, s34, s32
  s_min_u32 s75, s75, s34
  s_add_u32 s36, s72, s74
  s_add_u32 s37, s73, s75
  s_cmp_lt_u32 s37, s36
  s_cselect_b32 s30, 1, 0
  s_getreg_b32 s32, hwreg(HW_REG_XCC_ID, 2, 1)
  s_xor_b32 s30, s30, s32
  s_cmp_eq_u32 s30, 0
  s_cselect_b32 s36, s72, s73
  s_cselect_b32 s37, s74, s75
  s_cmp_lt_u32 s37, s36
  s_cselect_b32 s33, 2, 0
  s_or_b32 s30, s30, s33
  s_lshl_b32 s30, s30, 1
  s_or_b32 s30, s30, 1
  v_mov_b32 v12, s30
  buffer_store_dword v12, off, s[68:71], 0 offset:68 sc1
P_flag:
  s_mov_b64 exec, -1
P_done:
  s_mov_b32 s25, s38
  s_cmp_lt_u32 s38, 24
  s_cbranch_scc1 WGU
  s_sub_u32 s25, s38, 24
  s_cmp_lt_u32 s38, 44
  s_cbranch_scc1 WD
  s_sub_u32 s25, s38, 44
  s_cmp_lt_u32 s38, 60
  s_cbranch_scc1 AT
  s_branch PY
CQ:
  s_cmp_lg_u32 s24, 0
  s_cbranch_scc1 an_1
  s_getreg_b32 s27, hwreg(HW_REG_XCC_ID, 0, 3)
  s_lshl_b32 s27, s27, 3
  s_lshl_b64 s[30:31], 1, s27
  v_mov_b32 v4, s30
  v_mov_b32 v5, s31
  s_lshl_b32 s30, s29, 3
  s_mov_b64 exec, 1
  buffer_atomic_add_x2 v[4:5], off, s[68:71], s30 offset:128 sc1
  s_mov_b64 exec, -1
an_1:
  s_mov_b32 s12, s44
  s_and_b32 s13, s45, 0xffff
  s_mov_b32 s14, 7864320
  s_mov_b32 s15, 0x20000
  s_mov_b32 s16, s46
  s_and_b32 s17, s47, 0xffff
  s_mov_b32 s18, 7864320
  s_mov_b32 s19, 0x20000
  s_mov_b32 s30, 12288
  v_add_u32 v28, 0, v1
  s_mov_b32 s27, 43691
  v_mul_lo_u32 v29, v28, s27
  v_lshrrev_b32 v29, 18, v29
  v_mul_u32_u24 v8, 6, v29
  v_sub_u32 v30, v28, v8
  v_mul_lo_u32 v29, v29, s30
  v_lshl_add_u32 v8, v30, 4, v29
  v_add_u32 v28, 64, v1
  s_mov_b32 s27, 43691
  v_mul_lo_u32 v29, v28, s27
  v_lshrrev_b32 v29, 18, v29
  v_mul_u32_u24 v9, 6, v29
  v_sub_u32 v30, v28, v9
  v_mul_lo_u32 v29, v29, s30
  v_lshl_add_u32 v9, v30, 4, v29
  v_add_u32 v28, 128, v1
  s_mov_b32 s27, 43691
  v_mul_lo_u32 v29, v28, s27
  v_lshrrev_b32 v29, 18, v29
  v_mul_u32_u24 v10, 6, v29
  v_sub_u32 v30, v28, v10
  v_mul_lo_u32 v29, v29, s30
  v_lshl_add_u32 v10, v30, 4, v29
  v_add_u32 v28, 192, v1
  s_mov_b32 s27, 43691
  v_mul_lo_u32 v29, v28, s27
  v_lshrrev_b32 v29, 18, v29
  v_mul_u32_u24 v11, 6, v29
  v_sub_u32 v30, v28, v11
  v_mul_lo_u32 v29, v29, s30
  v_lshl_add_u32 v11, v30, 4, v29
  v_add_u32 v28, 256, v1
  s_mov_b32 s27, 43691
  v_mul_lo_u32 v29, v28, s27
  v_lshrrev_b32 v29, 18, v29
  v_mul_u32_u24 v12, 6, v29
  v_sub_u32 v30, v28, v12
  v_mul_lo_u32 v29, v29, s30
  v_lshl_add_u32 v12, v30, 4, v29
  v_add_u32 v28, 320, v1
  s_mov_b32 s27, 43691
  v_mul_lo_u32 v29, v28, s27
  v_lshrrev_b32 v29, 18, v29
  v_mul_u32_u24 v13, 6, v29
  v_sub_u32 v30, v28, v13
  v_mul_lo_u32 v29, v29, s30
  v_lshl_add_u32 v13, v30, 4, v29
  v_bfe_u32 v28, v1, 5, 1
  v_mul_u32_u24 v3, 1536, v28
  v_bfe_u32 v28, v1, 4, 1
  v_mul_u32_u24 v28, 384, v28
  v_add_u32 v3, v3, v28
  v_bfe_u32 v28, v1, 2, 1
  v_mul_u32_u24 v28, 96, v28
  v_add_u32 v3, v3, v28
  v_bfe_u32 v28, v1, 3, 1
  v_mul_u32_u24 v28, 768, v28
  v_add_u32 v3, v3, v28
  v_and_b32 v28, 3, v1
  v_lshl_add_u32 v3, v28, 3, v3
  s_mul_i32 s27, s24, 30720
  v_add_u32 v3, s27, v3
  s_mul_i32 s27, s24, 30720
  v_add_u32 v7, s27, v2
  s_mul_i32 s32, s25, 384
  s_mul_i32 s27, s24, 96
  s_add_u32 s32, s32, s27
  s_mul_i32 s75, s24, 3
  s_min_u32 s75, s75, 7
  s_mul_i32 s27, s24, -24576
  s_add_u32 s27, s27, 122880
  v_add_u32 v4, s27, v3
CQ_ld0:
  s_cmp_lg_u32 s24, 0
  s_cbranch_scc1 CQ_ld1
  s_mov_b32 m0, 122880
  s_add_u32 s27, s32, 0
  buffer_load_dwordx4 v8, s[16:19], s27 offen  lds
  s_mov_b32 m0, 123904
  s_add_u32 s27, s32, 0
  buffer_load_dwordx4 v9, s[16:19], s27 offen  lds
  s_mov_b32 m0, 124928
  s_add_u32 s27, s32, 0
  buffer_load_dwordx4 v10, s[16:19], s27 offen  lds
  s_mov_b32 m0, 125952
  s_add_u32 s27, s32, 0
  buffer_load_dwordx4 v11, s[16:19], s27 offen  lds
  s_mov_b32 m0, 126976
  s_add_u32 s27, s32, 0
  buffer_load_dwordx4 v12, s[16:19], s27 offen  lds
  s_mov_b32 m0, 128000
  s_add_u32 s27, s32, 0
  buffer_load_dwordx4 v13, s[16:19], s27 offen  lds
  s_mov_b32 m0, 24576
  s_add_u32 s27, s32, 786432
  buffer_load_dwordx4 v8, s[16:19], s27 offen  lds
  s_mov_b32 m0, 25600
  s_add_u32 s27, s32, 786432
  buffer_load_dwordx4 v9, s[16:19], s27 offen  lds
  s_mov_b32 m0, 26624
  s_add_u32 s27, s32, 786432
  buffer_load_dwordx4 v10, s[16:19], s27 offen  lds
  s_mov_b32 m0, 27648
  s_add_u32 s27, s32, 786432
  buffer_load_dwordx4 v11, s[16:19], s27 offen  lds
  s_mov_b32 m0, 28672
  s_add_u32 s27, s32, 786432
  buffer_load_dwordx4 v12, s[16:19], s27 offen  lds
  s_mov_b32 m0, 29696
  s_add_u32 s27, s32, 786432
  buffer_load_dwordx4 v13, s[16:19], s27 offen  lds
  s_mov_b32 m0, 18432
  s_add_u32 s27, s32, 1572864
  buffer_load_dwordx4 v8, s[16:19], s27 offen  lds
  s_mov_b32 m0, 19456
  s_add_u32 s27, s32, 1572864
  buffer_load_dwordx4 v9, s[16:19], s27 offen  lds
  s_mov_b32 m0, 20480
  s_add_u32 s27, s32, 1572864
  buffer_load_dwordx4 v10, s[16:19], s27 offen  lds
  s_mov_b32 m0, 21504
  s_add_u32 s27, s32, 1572864
  buffer_load_dwordx4 v11, s[16:19], s27 offen  lds
  s_mov_b32 m0, 22528
  s_add_u32 s27, s32, 1572864
  buffer_load_dwordx4 v12, s[16:19], s27 offen  lds
  s_mov_b32 m0, 23552
  s_add_u32 s27, s32, 1572864
  buffer_load_dwordx4 v13, s[16:19], s27 offen  lds
  s_waitcnt vmcnt(12)
  ds_read_b64_tr_b16 a[120:121], v4 offset:0
  ds_read_b64_tr_b16 a[122:123], v4 offset:192
  ds_read_b64_tr_b16 a[124:125], v4 offset:3072
  ds_read_b64_tr_b16 a[126:127], v4 offset:3264
  ds_read_b64_tr_b16 a[128:129], v4 offset:32
  ds_read_b64_tr_b16 a[130:131], v4 offset:224
  ds_read_b64_tr_b16 a[132:133], v4 offset:3104
  ds_read_b64_tr_b16 a[134:135], v4 offset:3296
  ds_read_b64_tr_b16 a[136:137], v4 offset:64
  ds_read_b64_tr_b16 a[138:139], v4 offset:256
  ds_read_b64_tr_b16 a[140:141], v4 offset:3136
  ds_read_b64_tr_b16 a[142:143], v4 offset:3328
  s_waitcnt lgkmcnt(0)
  s_mov_b32 m0, 122880
  s_add_u32 s27, s32, 2359296
  buffer_load_dwordx4 v8, s[16:19], s27 offen  lds
  s_mov_b32 m0, 123904
  s_add_u32 s27, s32, 2359296
  buffer_load_dwordx4 v9, s[16:19], s27 offen  lds
  s_mov_b32 m0, 124928
  s_add_u32 s27, s32, 2359296
  buffer_load_dwordx4 v10, s[16:19], s27 offen  lds
  s_mov_b32 m0, 125952
  s_add_u32 s27, s32, 2359296
  buffer_load_dwordx4 v11, s[16:19], s27 offen  lds
  s_mov_b32 m0, 126976
  s_add_u32 s27, s32, 2359296
  buffer_load_dwordx4 v12, s[16:19], s27 offen  lds
  s_mov_b32 m0, 128000
  s_add_u32 s27, s32, 2359296
  buffer_load_dwordx4 v13, s[16:19], s27 offen  lds
  s_waitcnt vmcnt(12)
  ds_read_b64_tr_b16 a[144:145], v3 offset:24576
  ds_read_b64_tr_b16 a[146:147], v3 offset:24768
  ds_read_b64_tr_b16 a[148:149], v3 offset:27648
  ds_read_b64_tr_b16 a[150:151], v3 offset:27840
  ds_read_b64_tr_b16 a[152:153], v3 offset:24608
  ds_read_b64_tr_b16 a[154:155], v3 offset:24800
  ds_read_b64_tr_b16 a[156:157], v3 offset:27680
  ds_read_b64_tr_b16 a[158:159], v3 offset:27872
  ds_read_b64_tr_b16 a[160:161], v3 offset:24640
  ds_read_b64_tr_b16 a[162:163], v3 offset:24832
  ds_read_b64_tr_b16 a[164:165], v3 offset:27712
  ds_read_b64_tr_b16 a[166:167], v3 offset:27904
  s_waitcnt lgkmcnt(0)
  s_mov_b32 m0, 24576
  s_add_u32 s27, s32, 3145728
  buffer_load_dwordx4 v8, s[16:19], s27 offen  lds
  s_mov_b32 m0, 25600
  s_add_u32 s27, s32, 3145728
  buffer_load_dwordx4 v9, s[16:19], s27 offen  lds
  s_mov_b32 m0, 26624
  s_add_u32 s27, s32, 3145728
  buffer_load_dwordx4 v10, s[16:19], s27 offen  lds
  s_mov_b32 m0, 27648
  s_add_u32 s27, s32, 3145728
  buffer_load_dwordx4 v11, s[16:19], s27 offen  lds
  s_mov_b32 m0, 28672
  s_add_u32 s27, s32, 3145728
  buffer_load_dwordx4 v12, s[16:19], s27 offen  lds
  s_mov_b32 m0, 29696
  s_add_u32 s27, s32, 3145728
  buffer_load_dwordx4 v13, s[16:19], s27 offen  lds
  s_waitcnt vmcnt(12)
  ds_read_b64_tr_b16 a[168:169], v3 offset:18432
  ds_read_b64_tr_b16 a[170:171], v3 offset:18624
  ds_read_b64_tr_b16 a[172:173], v3 offset:21504
  ds_read_b64_tr_b16 a[174:175], v3 offset:21696
  ds_read_b64_tr_b16 a[176:177], v3 offset:18464
  ds_read_b64_tr_b16 a[178:179], v3 offset:18656
  ds_read_b64_tr_b16 a[180:181], v3 offset:21536
  ds_read_b64_tr_b16 a[182:183], v3 offset:21728
  ds_read_b64_tr_b16 a[184:185], v3 offset:18496
  ds_read_b64_tr_b16 a[186:187], v3 offset:18688
  ds_read_b64_tr_b16 a[188:189], v3 offset:21568
  ds_read_b64_tr_b16 a[190:191], v3 offset:21760
  s_waitcnt lgkmcnt(0)
  s_mov_b32 m0, 18432
  s_add_u32 s27, s32, 3932160
  buffer_load_dwordx4 v8, s[16:19], s27 offen  lds
  s_mov_b32 m0, 19456
  s_add_u32 s27, s32, 3932160
  buffer_load_dwordx4 v9, s[16:19], s27 offen  lds
  s_mov_b32 m0, 20480
  s_add_u32 s27, s32, 3932160
  buffer_load_dwordx4 v10, s[16:19], s27 offen  lds
  s_mov_b32 m0, 21504
  s_add_u32 s27, s32, 3932160
  buffer_load_dwordx4 v11, s[16:19], s27 offen  lds
  s_mov_b32 m0, 22528
  s_add_u32 s27, s32, 3932160
  buffer_load_dwordx4 v12, s[16:19], s27 offen  lds
  s_mov_b32 m0, 23552
  s_add_u32 s27, s32, 3932160
  buffer_load_dwordx4 v13, s[16:19], s27 offen  lds
  s_waitcnt vmcnt(12)
  ds_read_b64_tr_b16 a[192:193], v4 offset:0
  ds_read_b64_tr_b16 a[194:195], v4 offset:192
  ds_read_b64_tr_b16 a[196:197], v4 offset:3072
  ds_read_b64_tr_b16 a[198:199], v4 offset:3264
  ds_read_b64_tr_b16 a[200:201], v4 offset:32
  ds_read_b64_tr_b16 a[202:203], v4 offset:224
  ds_read_b64_tr_b16 a[204:205], v4 offset:3104
  ds_read_b64_tr_b16 a[206:207], v4 offset:3296
  ds_read_b64_tr_b16 a[208:209], v4 offset:64
  ds_read_b64_tr_b16 a[210:211], v4 offset:256
  ds_read_b64_tr_b16 a[212:213], v4 offset:3136
  ds_read_b64_tr_b16 a[214:215], v4 offset:3328
  s_waitcnt lgkmcnt(0)
  s_mov_b32 m0, 122880
  s_add_u32 s27, s32, 4718592
  buffer_load_dwordx4 v8, s[16:19], s27 offen  lds
  s_mov_b32 m0, 123904
  s_add_u32 s27, s32, 4718592
  buffer_load_dwordx4 v9, s[16:19], s27 offen  lds
  s_mov_b32 m0, 124928
  s_add_u32 s27, s32, 4718592
  buffer_load_dwordx4 v10, s[16:19], s27 offen  lds
  s_mov_b32 m0, 125952
  s_add_u32 s27, s32, 4718592
  buffer_load_dwordx4 v11, s[16:19], s27 offen  lds
  s_mov_b32 m0, 126976
  s_add_u32 s27, s32, 4718592
  buffer_load_dwordx4 v12, s[16:19], s27 offen  lds
  s_mov_b32 m0, 128000
  s_add_u32 s27, s32, 4718592
  buffer_load_dwordx4 v13, s[16:19], s27 offen  lds
  s_waitcnt vmcnt(12)
  ds_read_b64_tr_b16 a[216:217], v3 offset:24576
  ds_read_b64_tr_b16 a[218:219], v3 offset:24768
  ds_read_b64_tr_b16 a[220:221], v3 offset:27648
  ds_read_b64_tr_b16 a[222:223], v3 offset:27840
  ds_read_b64_tr_b16 a[224:225], v3 offset:24608
  ds_read_b64_tr_b16 a[226:227], v3 offset:24800
  ds_read_b64_tr_b16 a[228:229], v3 offset:27680
  ds_read_b64_tr_b16 a[230:231], v3 offset:27872
  ds_read_b64_tr_b16 a[232:233], v3 offset:24640
  ds_read_b64_tr_b16 a[234:235], v3 offset:24832
  ds_read_b64_tr_b16 a[236:237], v3 offset:27712
  ds_read_b64_tr_b16 a[238:239], v3 offset:27904
  s_waitcnt lgkmcnt(0)
  s_mov_b32 m0, 24576
  s_add_u32 s27, s32, 5505024
  buffer_load_dwordx4 v8, s[16:19], s27 offen  lds
  s_mov_b32 m0, 25600
  s_add_u32 s27, s32, 5505024
  buffer_load_dwordx4 v9, s[16:19], s27 offen  lds
  s_mov_b32 m0, 26624
  s_add_u32 s27, s32, 5505024
  buffer_load_dwordx4 v10, s[16:19], s27 offen  lds
  s_mov_b32 m0, 27648
  s_add_u32 s27, s32, 5505024
  buffer_load_dwordx4 v11, s[16:19], s27 offen  lds
  s_mov_b32 m0, 28672
  s_add_u32 s27, s32, 5505024
  buffer_load_dwordx4 v12, s[16:19], s27 offen  lds
  s_mov_b32 m0, 29696
  s_add_u32 s27, s32, 5505024
  buffer_load_dwordx4 v13, s[16:19], s27 offen  lds
  s_waitcnt vmcnt(12)
  ds_read_b64_tr_b16 a[240:241], v3 offset:18432
  ds_read_b64_tr_b16 a[242:243], v3 offset:18624
  ds_read_b64_tr_b16 a[244:245], v3 offset:21504
  ds_read_b64_tr_b16 a[246:247], v3 offset:21696
  ds_read_b64_tr_b16 a[248:249], v3 offset:18464
  ds_read_b64_tr_b16 a[250:251], v3 offset:18656
  ds_read_b64_tr_b16 a[252:253], v3 offset:21536
  ds_read_b64_tr_b16 a[254:255], v3 offset:21728
  ds_read_b64_tr_b16 v[152:153], v3 offset:18496
  ds_read_b64_tr_b16 v[154:155], v3 offset:18688
  ds_read_b64_tr_b16 v[156:157], v3 offset:21568
  ds_read_b64_tr_b16 v[158:159], v3 offset:21760
  s_waitcnt lgkmcnt(0)
  s_mov_b32 m0, 18432
  s_add_u32 s27, s32, 6291456
  buffer_load_dwordx4 v8, s[16:19], s27 offen  lds
  s_mov_b32 m0, 19456
  s_add_u32 s27, s32, 6291456
  buffer_load_dwordx4 v9, s[16:19], s27 offen  lds
  s_mov_b32 m0, 20480
  s_add_u32 s27, s32, 6291456
  buffer_load_dwordx4 v10, s[16:19], s27 offen  lds
  s_mov_b32 m0, 21504
  s_add_u32 s27, s32, 6291456
  buffer_load_dwordx4 v11, s[16:19], s27 offen  lds
  s_mov_b32 m0, 22528
  s_add_u32 s27, s32, 6291456
  buffer_load_dwordx4 v12, s[16:19], s27 offen  lds
  s_mov_b32 m0, 23552
  s_add_u32 s27, s32, 6291456
  buffer_load_dwordx4 v13, s[16:19], s27 offen  lds
  s_waitcnt vmcnt(12)
  ds_read_b64_tr_b16 v[160:161], v4 offset:0
  ds_read_b64_tr_b16 v[162:163], v4 offset:192
  ds_read_b64_tr_b16 v[164:165], v4 offset:3072
  ds_read_b64_tr_b16 v[166:167], v4 offset:3264
  ds_read_b64_tr_b16 v[168:169], v4 offset:32
  ds_read_b64_tr_b16 v[170:171], v4 offset:224
  ds_read_b64_tr_b16 v[172:173], v4 offset:3104
  ds_read_b64_tr_b16 v[174:175], v4 offset:3296
  ds_read_b64_tr_b16 v[176:177], v4 offset:64
  ds_read_b64_tr_b16 v[178:179], v4 offset:256
  ds_read_b64_tr_b16 v[180:181], v4 offset:3136
  ds_read_b64_tr_b16 v[182:183], v4 offset:3328
  s_waitcnt lgkmcnt(0)
  s_mov_b32 m0, 122880
  s_add_u32 s27, s32, 7077888
  buffer_load_dwordx4 v8, s[16:19], s27 offen  lds
  s_mov_b32 m0, 123904
  s_add_u32 s27, s32, 7077888
  buffer_load_dwordx4 v9, s[16:19], s27 offen  lds
  s_mov_b32 m0, 124928
  s_add_u32 s27, s32, 7077888
  buffer_load_dwordx4 v10, s[16:19], s27 offen  lds
  s_mov_b32 m0, 125952
  s_add_u32 s27, s32, 7077888
  buffer_load_dwordx4 v11, s[16:19], s27 offen  lds
  s_mov_b32 m0, 126976
  s_add_u32 s27, s32, 7077888
  buffer_load_dwordx4 v12, s[16:19], s27 offen  lds
  s_mov_b32 m0, 128000
  s_add_u32 s27, s32, 7077888
  buffer_load_dwordx4 v13, s[16:19], s27 offen  lds
  s_waitcnt vmcnt(12)
  ds_read_b64_tr_b16 v[184:185], v3 offset:24576
  ds_read_b64_tr_b16 v[186:187], v3 offset:24768
  ds_read_b64_tr_b16 v[188:189], v3 offset:27648
  ds_read_b64_tr_b16 v[190:191], v3 offset:27840
  ds_read_b64_tr_b16 v[192:193], v3 offset:24608
  ds_read_b64_tr_b16 v[194:195], v3 offset:24800
  ds_read_b64_tr_b16 v[196:197], v3 offset:27680
  ds_read_b64_tr_b16 v[198:199], v3 offset:27872
  ds_read_b64_tr_b16 v[200:201], v3 offset:24640
  ds_read_b64_tr_b16 v[202:203], v3 offset:24832
  ds_read_b64_tr_b16 v[204:205], v3 offset:27712
  ds_read_b64_tr_b16 v[206:207], v3 offset:27904
  s_waitcnt lgkmcnt(0)
  s_mov_b32 m0, 24576
  s_add_u32 s27, s32, 0
  buffer_load_dwordx4 v8, s[12:15], s27 offen  lds
  s_mov_b32 m0, 25600
  s_add_u32 s27, s32, 0
  buffer_load_dwordx4 v9, s[12:15], s27 offen  lds
  s_mov_b32 m0, 26624
  s_add_u32 s27, s32, 0
  buffer_load_dwordx4 v10, s[12:15], s27 offen  lds
  s_mov_b32 m0, 27648
  s_add_u32 s27, s32, 0
  buffer_load_dwordx4 v11, s[12:15], s27 offen  lds
  s_mov_b32 m0, 28672
  s_add_u32 s27, s32, 0
  buffer_load_dwordx4 v12, s[12:15], s27 offen  lds
  s_mov_b32 m0, 29696
  s_add_u32 s27, s32, 0
  buffer_load_dwordx4 v13, s[12:15], s27 offen  lds
  s_waitcnt vmcnt(12)
  ds_read_b64_tr_b16 v[208:209], v3 offset:18432
  ds_read_b64_tr_b16 v[210:211], v3 offset:18624
  ds_read_b64_tr_b16 v[212:213], v3 offset:21504
  ds_read_b64_tr_b16 v[214:215], v3 offset:21696
  ds_read_b64_tr_b16 v[216:217], v3 offset:18464
  ds_read_b64_tr_b16 v[218:219], v3 offset:18656
  ds_read_b64_tr_b16 v[220:221], v3 offset:21536
  ds_read_b64_tr_b16 v[222:223], v3 offset:21728
  ds_read_b64_tr_b16 v[224:225], v3 offset:18496
  ds_read_b64_tr_b16 v[226:227], v3 offset:18688
  ds_read_b64_tr_b16 v[228:229], v3 offset:21568
  ds_read_b64_tr_b16 v[230:231], v3 offset:21760
  s_waitcnt lgkmcnt(0)
  s_mov_b32 m0, 0
  s_add_u32 s27, s32, 786432
  buffer_load_dwordx4 v8, s[12:15], s27 offen  lds
  s_mov_b32 m0, 1024
  s_add_u32 s27, s32, 786432
  buffer_load_dwordx4 v9, s[12:15], s27 offen  lds
  s_mov_b32 m0, 2048
  s_add_u32 s27, s32, 786432
  buffer_load_dwordx4 v10, s[12:15], s27 offen  lds
  s_mov_b32 m0, 3072
  s_add_u32 s27, s32, 786432
  buffer_load_dwordx4 v11, s[12:15], s27 offen  lds
  s_mov_b32 m0, 4096
  s_add_u32 s27, s32, 786432
  buffer_load_dwordx4 v12, s[12:15], s27 offen  lds
  s_mov_b32 m0, 5120
  s_add_u32 s27, s32, 786432
  buffer_load_dwordx4 v13, s[12:15], s27 offen  lds
  s_waitcnt vmcnt(12)
  ds_read_b64_tr_b16 v[232:233], v4 offset:0
  ds_read_b64_tr_b16 v[234:235], v4 offset:192
  ds_read_b64_tr_b16 v[236:237], v4 offset:3072
  ds_read_b64_tr_b16 v[238:239], v4 offset:3264
  ds_read_b64_tr_b16 v[240:241], v4 offset:32
  ds_read_b64_tr_b16 v[242:243], v4 offset:224
  ds_read_b64_tr_b16 v[244:245], v4 offset:3104
  ds_read_b64_tr_b16 v[246:247], v4 offset:3296
  ds_read_b64_tr_b16 v[248:249], v4 offset:64
  ds_read_b64_tr_b16 v[250:251], v4 offset:256
  ds_read_b64_tr_b16 v[252:253], v4 offset:3136
  ds_read_b64_tr_b16 v[254:255], v4 offset:3328
  s_waitcnt lgkmcnt(0)
  s_mov_b32 m0, 122880
  s_add_u32 s27, s32, 1572864
  buffer_load_dwordx4 v8, s[12:15], s27 offen  lds
  s_mov_b32 m0, 123904
  s_add_u32 s27, s32, 1572864
  buffer_load_dwordx4 v9, s[12:15], s27 offen  lds
  s_mov_b32 m0, 124928
  s_add_u32 s27, s32, 1572864
  buffer_load_dwordx4 v10, s[12:15], s27 offen  lds
  s_mov_b32 m0, 125952
  s_add_u32 s27, s32, 1572864
  buffer_load_dwordx4 v11, s[12:15], s27 offen  lds
  s_mov_b32 m0, 126976
  s_add_u32 s27, s32, 1572864
  buffer_load_dwordx4 v12, s[12:15], s27 offen  lds
  s_mov_b32 m0, 128000
  s_add_u32 s27, s32, 1572864
  buffer_load_dwordx4 v13, s[12:15], s27 offen  lds
  s_waitcnt vmcnt(12)
  ds_read_b64_tr_b16 a[0:1], v3 offset:24576
  ds_read_b64_tr_b16 a[2:3], v3 offset:24768
  ds_read_b64_tr_b16 a[4:5], v3 offset:27648
  ds_read_b64_tr_b16 a[6:7], v3 offset:27840
  ds_read_b64_tr_b16 a[8:9], v3 offset:24608
  ds_read_b64_tr_b16 a[10:11], v3 offset:24800
  ds_read_b64_tr_b16 a[12:13], v3 offset:27680
  ds_read_b64_tr_b16 a[14:15], v3 offset:27872
  ds_read_b64_tr_b16 a[16:17], v3 offset:24640
  ds_read_b64_tr_b16 a[18:19], v3 offset:24832
  ds_read_b64_tr_b16 a[20:21], v3 offset:27712
  ds_read_b64_tr_b16 a[22:23], v3 offset:27904
  s_waitcnt lgkmcnt(0)
  s_mov_b32 m0, 6144
  s_add_u32 s27, s32, 2359296
  buffer_load_dwordx4 v8, s[12:15], s27 offen  lds
  s_mov_b32 m0, 7168
  s_add_u32 s27, s32, 2359296
  buffer_load_dwordx4 v9, s[12:15], s27 offen  lds
  s_mov_b32 m0, 8192
  s_add_u32 s27, s32, 2359296
  buffer_load_dwordx4 v10, s[12:15], s27 offen  lds
  s_mov_b32 m0, 9216
  s_add_u32 s27, s32, 2359296
  buffer_load_dwordx4 v11, s[12:15], s27 offen  lds
  s_mov_b32 m0, 10240
  s_add_u32 s27, s32, 2359296
  buffer_load_dwordx4 v12, s[12:15], s27 offen  lds
  s_mov_b32 m0, 11264
  s_add_u32 s27, s32, 2359296
  buffer_load_dwordx4 v13, s[12:15], s27 offen  lds
  s_waitcnt vmcnt(12)
  ds_read_b64_tr_b16 v[32:33], v3 offset:0
  ds_read_b64_tr_b16 v[34:35], v3 offset:192
  ds_read_b64_tr_b16 v[36:37], v3 offset:3072
  ds_read_b64_tr_b16 v[38:39], v3 offset:3264
  ds_read_b64_tr_b16 v[40:41], v3 offset:32
  ds_read_b64_tr_b16 v[42:43], v3 offset:224
  ds_read_b64_tr_b16 v[44:45], v3 offset:3104
  ds_read_b64_tr_b16 v[46:47], v3 offset:3296
  ds_read_b64_tr_b16 v[48:49], v3 offset:64
  ds_read_b64_tr_b16 v[50:51], v3 offset:256
  ds_read_b64_tr_b16 v[52:53], v3 offset:3136
  ds_read_b64_tr_b16 v[54:55], v3 offset:3328
  s_waitcnt lgkmcnt(0)
  ds_write_b128 v7, v[32:35] offset:0
  ds_write_b128 v7, v[36:39] offset:1024
  ds_write_b128 v7, v[40:43] offset:2048
  ds_write_b128 v7, v[44:47] offset:3072
  ds_write_b128 v7, v[48:51] offset:4096
  ds_write_b128 v7, v[52:55] offset:5120
  s_waitcnt lgkmcnt(0)
  s_mov_b32 m0, 24576
  s_add_u32 s27, s32, 3145728
  buffer_load_dwordx4 v8, s[12:15], s27 offen  lds
  s_mov_b32 m0, 25600
  s_add_u32 s27, s32, 3145728
  buffer_load_dwordx4 v9, s[12:15], s27 offen  lds
  s_mov_b32 m0, 26624
  s_add_u32 s27, s32, 3145728
  buffer_load_dwordx4 v10, s[12:15], s27 offen  lds
  s_mov_b32 m0, 27648
  s_add_u32 s27, s32, 3145728
  buffer_load_dwordx4 v11, s[12:15], s27 offen  lds
  s_mov_b32 m0, 28672
  s_add_u32 s27, s32, 3145728
  buffer_load_dwordx4 v12, s[12:15], s27 offen  lds
  s_mov_b32 m0, 29696
  s_add_u32 s27, s32, 3145728
  buffer_load_dwordx4 v13, s[12:15], s27 offen  lds
  s_waitcnt vmcnt(12)
  ds_read_b64_tr_b16 a[24:25], v4 offset:0
  ds_read_b64_tr_b16 a[26:27], v4 offset:192
  ds_read_b64_tr_b16 a[28:29], v4 offset:3072
  ds_read_b64_tr_b16 a[30:31], v4 offset:3264
  ds_read_b64_tr_b16 a[32:33], v4 offset:32
  ds_read_b64_tr_b16 a[34:35], v4 offset:224
  ds_read_b64_tr_b16 a[36:37], v4 offset:3104
  ds_read_b64_tr_b16 a[38:39], v4 offset:3296
  ds_read_b64_tr_b16 a[40:41], v4 offset:64
  ds_read_b64_tr_b16 a[42:43], v4 offset:256
  ds_read_b64_tr_b16 a[44:45], v4 offset:3136
  ds_read_b64_tr_b16 a[46:47], v4 offset:3328
  s_waitcnt lgkmcnt(0)
  s_mov_b32 m0, 12288
  s_add_u32 s27, s32, 3932160
  buffer_load_dwordx4 v8, s[12:15], s27 offen  lds
  s_mov_b32 m0, 13312
  s_add_u32 s27, s32, 3932160
  buffer_load_dwordx4 v9, s[12:15], s27 offen  lds
  s_mov_b32 m0, 14336
  s_add_u32 s27, s32, 3932160
  buffer_load_dwordx4 v10, s[12:15], s27 offen  lds
  s_mov_b32 m0, 15360
  s_add_u32 s27, s32, 3932160
  buffer_load_dwordx4 v11, s[12:15], s27 offen  lds
  s_mov_b32 m0, 16384
  s_add_u32 s27, s32, 3932160
  buffer_load_dwordx4 v12, s[12:15], s27 offen  lds
  s_mov_b32 m0, 17408
  s_add_u32 s27, s32, 3932160
  buffer_load_dwordx4 v13, s[12:15], s27 offen  lds
  s_waitcnt vmcnt(12)
  ds_read_b64_tr_b16 v[32:33], v3 offset:6144
  ds_read_b64_tr_b16 v[34:35], v3 offset:6336
  ds_read_b64_tr_b16 v[36:37], v3 offset:9216
  ds_read_b64_tr_b16 v[38:39], v3 offset:9408
  ds_read_b64_tr_b16 v[40:41], v3 offset:6176
  ds_read_b64_tr_b16 v[42:43], v3 offset:6368
  ds_read_b64_tr_b16 v[44:45], v3 offset:9248
  ds_read_b64_tr_b16 v[46:47], v3 offset:9440
  ds_read_b64_tr_b16 v[48:49], v3 offset:6208
  ds_read_b64_tr_b16 v[50:51], v3 offset:6400
  ds_read_b64_tr_b16 v[52:53], v3 offset:9280
  ds_read_b64_tr_b16 v[54:55], v3 offset:9472
  s_waitcnt lgkmcnt(0)
  ds_write_b128 v7, v[32:35] offset:6144
  ds_write_b128 v7, v[36:39] offset:7168
  ds_write_b128 v7, v[40:43] offset:8192
  ds_write_b128 v7, v[44:47] offset:9216
  ds_write_b128 v7, v[48:51] offset:10240
  ds_write_b128 v7, v[52:55] offset:11264
  s_waitcnt lgkmcnt(0)
  s_mov_b32 m0, 122880
  s_add_u32 s27, s32, 4718592
  buffer_load_dwordx4 v8, s[12:15], s27 offen  lds
  s_mov_b32 m0, 123904
  s_add_u32 s27, s32, 4718592
  buffer_load_dwordx4 v9, s[12:15], s27 offen  lds
  s_mov_b32 m0, 124928
  s_add_u32 s27, s32, 4718592
  buffer_load_dwordx4 v10, s[12:15], s27 offen  lds
  s_mov_b32 m0, 125952
  s_add_u32 s27, s32, 4718592
  buffer_load_dwordx4 v11, s[12:15], s27 offen  lds
  s_mov_b32 m0, 126976
  s_add_u32 s27, s32, 4718592
  buffer_load_dwordx4 v12, s[12:15], s27 offen  lds
  s_mov_b32 m0, 128000
  s_add_u32 s27, s32, 4718592
  buffer_load_dwordx4 v13, s[12:15], s27 offen  lds
  s_waitcnt vmcnt(12)
  ds_read_b64_tr_b16 a[48:49], v3 offset:24576
  ds_read_b64_tr_b16 a[50:51], v3 offset:24768
  ds_read_b64_tr_b16 a[52:53], v3 offset:27648
  ds_read_b64_tr_b16 a[54:55], v3 offset:27840
  ds_read_b64_tr_b16 a[56:57], v3 offset:24608
  ds_read_b64_tr_b16 a[58:59], v3 offset:24800
  ds_read_b64_tr_b16 a[60:61], v3 offset:27680
  ds_read_b64_tr_b16 a[62:63], v3 offset:27872
  ds_read_b64_tr_b16 a[64:65], v3 offset:24640
  ds_read_b64_tr_b16 a[66:67], v3 offset:24832
  ds_read_b64_tr_b16 a[68:69], v3 offset:27712
  ds_read_b64_tr_b16 a[70:71], v3 offset:27904
  s_waitcnt lgkmcnt(0)
  s_mov_b32 m0, 18432
  s_add_u32 s27, s32, 5505024
  buffer_load_dwordx4 v8, s[12:15], s27 offen  lds
  s_mov_b32 m0, 19456
  s_add_u32 s27, s32, 5505024
  buffer_load_dwordx4 v9, s[12:15], s27 offen  lds
  s_mov_b32 m0, 20480
  s_add_u32 s27, s32, 5505024
  buffer_load_dwordx4 v10, s[12:15], s27 offen  lds
  s_mov_b32 m0, 21504
  s_add_u32 s27, s32, 5505024
  buffer_load_dwordx4 v11, s[12:15], s27 offen  lds
  s_mov_b32 m0, 22528
  s_add_u32 s27, s32, 5505024
  buffer_load_dwordx4 v12, s[12:15], s27 offen  lds
  s_mov_b32 m0, 23552
  s_add_u32 s27, s32, 5505024
  buffer_load_dwordx4 v13, s[12:15], s27 offen  lds
  s_waitcnt vmcnt(12)
  ds_read_b64_tr_b16 v[32:33], v3 offset:12288
  ds_read_b64_tr_b16 v[34:35], v3 offset:12480
  ds_read_b64_tr_b16 v[36:37], v3 offset:15360
  ds_read_b64_tr_b16 v[38:39], v3 offset:15552
  ds_read_b64_tr_b16 v[40:41], v3 offset:12320
  ds_read_b64_tr_b16 v[42:43], v3 offset:12512
  ds_read_b64_tr_b16 v[44:45], v3 offset:15392
  ds_read_b64_tr_b16 v[46:47], v3 offset:15584
  ds_read_b64_tr_b16 v[48:49], v3 offset:12352
  ds_read_b64_tr_b16 v[50:51], v3 offset:12544
  ds_read_b64_tr_b16 v[52:53], v3 offset:15424
  ds_read_b64_tr_b16 v[54:55], v3 offset:15616
  s_waitcnt lgkmcnt(0)
  ds_write_b128 v7, v[32:35] offset:12288
  ds_write_b128 v7, v[36:39] offset:13312
  ds_write_b128 v7, v[40:43] offset:14336
  ds_write_b128 v7, v[44:47] offset:15360
  ds_write_b128 v7, v[48:51] offset:16384
  ds_write_b128 v7, v[52:55] offset:17408
  s_waitcnt lgkmcnt(0)
  s_waitcnt vmcnt(6)
  ds_read_b64_tr_b16 a[72:73], v4 offset:0
  ds_read_b64_tr_b16 a[74:75], v4 offset:192
  ds_read_b64_tr_b16 a[76:77], v4 offset:3072
  ds_read_b64_tr_b16 a[78:79], v4 offset:3264
  ds_read_b64_tr_b16 a[80:81], v4 offset:32
  ds_read_b64_tr_b16 a[82:83], v4 offset:224
  ds_read_b64_tr_b16 a[84:85], v4 offset:3104
  ds_read_b64_tr_b16 a[86:87], v4 offset:3296
  ds_read_b64_tr_b16 a[88:89], v4 offset:64
  ds_read_b64_tr_b16 a[90:91], v4 offset:256
  ds_read_b64_tr_b16 a[92:93], v4 offset:3136
  ds_read_b64_tr_b16 a[94:95], v4 offset:3328
  s_waitcnt lgkmcnt(0)
  s_mov_b32 m0, 122880
  s_add_u32 s27, s32, 6291456
  buffer_load_dwordx4 v8, s[12:15], s27 offen  lds
  s_mov_b32 m0, 123904
  s_add_u32 s27, s32, 6291456
  buffer_load_dwordx4 v9, s[12:15], s27 offen  lds
  s_mov_b32 m0, 124928
  s_add_u32 s27, s32, 6291456
  buffer_load_dwordx4 v10, s[12:15], s27 offen  lds
  s_mov_b32 m0, 125952
  s_add_u32 s27, s32, 6291456
  buffer_load_dwordx4 v11, s[12:15], s27 offen  lds
  s_mov_b32 m0, 126976
  s_add_u32 s27, s32, 6291456
  buffer_load_dwordx4 v12, s[12:15], s27 offen  lds
  s_mov_b32 m0, 128000
  s_add_u32 s27, s32, 6291456
  buffer_load_dwordx4 v13, s[12:15], s27 offen  lds
  s_mov_b32 m0, 24576
  s_add_u32 s27, s32, 7077888
  buffer_load_dwordx4 v8, s[12:15], s27 offen  lds
  s_mov_b32 m0, 25600
  s_add_u32 s27, s32, 7077888
  buffer_load_dwordx4 v9, s[12:15], s27 offen  lds
  s_mov_b32 m0, 26624
  s_add_u32 s27, s32, 7077888
  buffer_load_dwordx4 v10, s[12:15], s27 offen  lds
  s_mov_b32 m0, 27648
  s_add_u32 s27, s32, 7077888
  buffer_load_dwordx4 v11, s[12:15], s27 offen  lds
  s_mov_b32 m0, 28672
  s_add_u32 s27, s32, 7077888
  buffer_load_dwordx4 v12, s[12:15], s27 offen  lds
  s_mov_b32 m0, 29696
  s_add_u32 s27, s32, 7077888
  buffer_load_dwordx4 v13, s[12:15], s27 offen  lds
  buffer_load_dwordx4 v[64:67], off, s[68:71], 0 offset:128 sc1
  buffer_load_dwordx2 v[68:69], off, s[68:71], 0 offset:64 sc1
  s_waitcnt vmcnt(14)
  ds_read_b64_tr_b16 v[32:33], v3 offset:18432
  ds_read_b64_tr_b16 v[34:35], v3 offset:18624
  ds_read_b64_tr_b16 v[36:37], v3 offset:21504
  ds_read_b64_tr_b16 v[38:39], v3 offset:21696
  ds_read_b64_tr_b16 v[40:41], v3 offset:18464
  ds_read_b64_tr_b16 v[42:43], v3 offset:18656
  ds_read_b64_tr_b16 v[44:45], v3 offset:21536
  ds_read_b64_tr_b16 v[46:47], v3 offset:21728
  ds_read_b64_tr_b16 v[48:49], v3 offset:18496
  ds_read_b64_tr_b16 v[50:51], v3 offset:18688
  ds_read_b64_tr_b16 v[52:53], v3 offset:21568
  ds_read_b64_tr_b16 v[54:55], v3 offset:21760
  s_waitcnt lgkmcnt(0)
  ds_write_b128 v7, v[32:35] offset:18432
  ds_write_b128 v7, v[36:39] offset:19456
  ds_write_b128 v7, v[40:43] offset:20480
  ds_write_b128 v7, v[44:47] offset:21504
  ds_write_b128 v7, v[48:51] offset:22528
  ds_write_b128 v7, v[52:55] offset:23552
  s_waitcnt lgkmcnt(0)
  s_waitcnt vmcnt(8)
  ds_read_b64_tr_b16 a[96:97], v4 offset:0
  ds_read_b64_tr_b16 a[98:99], v4 offset:192
  ds_read_b64_tr_b16 a[100:101], v4 offset:3072
  ds_read_b64_tr_b16 a[102:103], v4 offset:3264
  ds_read_b64_tr_b16 a[104:105], v4 offset:32
  ds_read_b64_tr_b16 a[106:107], v4 offset:224
  ds_read_b64_tr_b16 a[108:109], v4 offset:3104
  ds_read_b64_tr_b16 a[110:111], v4 offset:3296
  ds_read_b64_tr_b16 a[112:113], v4 offset:64
  ds_read_b64_tr_b16 a[114:115], v4 offset:256
  ds_read_b64_tr_b16 a[116:117], v4 offset:3136
  ds_read_b64_tr_b16 a[118:119], v4 offset:3328
  s_waitcnt lgkmcnt(0)
  s_waitcnt vmcnt(2)
  ds_read_b64_tr_b16 v[32:33], v3 offset:24576
  ds_read_b64_tr_b16 v[34:35], v3 offset:24768
  ds_read_b64_tr_b16 v[36:37], v3 offset:27648
  ds_read_b64_tr_b16 v[38:39], v3 offset:27840
  ds_read_b64_tr_b16 v[40:41], v3 offset:24608
  ds_read_b64_tr_b16 v[42:43], v3 offset:24800
  ds_read_b64_tr_b16 v[44:45], v3 offset:27680
  ds_read_b64_tr_b16 v[46:47], v3 offset:27872
  ds_read_b64_tr_b16 v[48:49], v3 offset:24640
  ds_read_b64_tr_b16 v[50:51], v3 offset:24832
  ds_read_b64_tr_b16 v[52:53], v3 offset:27712
  ds_read_b64_tr_b16 v[54:55], v3 offset:27904
  s_waitcnt lgkmcnt(0)
  ds_write_b128 v7, v[32:35] offset:24576
  ds_write_b128 v7, v[36:39] offset:25600
  ds_write_b128 v7, v[40:43] offset:26624
  ds_write_b128 v7, v[44:47] offset:27648
  ds_write_b128 v7, v[48:51] offset:28672
  ds_write_b128 v7, v[52:55] offset:29696
  s_waitcnt lgkmcnt(0)
  s_branch CQ_ldd
CQ_ld1:
  s_cmp_lg_u32 s24, 1
  s_cbranch_scc1 CQ_ld2
  s_mov_b32 m0, 129024
  s_add_u32 s27, s32, 0
  buffer_load_dwordx4 v8, s[16:19], s27 offen  lds
  s_mov_b32 m0, 130048
  s_add_u32 s27, s32, 0
  buffer_load_dwordx4 v9, s[16:19], s27 offen  lds
  s_mov_b32 m0, 131072
  s_add_u32 s27, s32, 0
  buffer_load_dwordx4 v10, s[16:19], s27 offen  lds
  s_mov_b32 m0, 132096
  s_add_u32 s27, s32, 0
  buffer_load_dwordx4 v11, s[16:19], s27 offen  lds
  s_mov_b32 m0, 133120
  s_add_u32 s27, s32, 0
  buffer_load_dwordx4 v12, s[16:19], s27 offen  lds
  s_mov_b32 m0, 134144
  s_add_u32 s27, s32, 0
  buffer_load_dwordx4 v13, s[16:19], s27 offen  lds
  s_mov_b32 m0, 43008
  s_add_u32 s27, s32, 786432
  buffer_load_dwordx4 v8, s[16:19], s27 offen  lds
  s_mov_b32 m0, 44032
  s_add_u32 s27, s32, 786432
  buffer_load_dwordx4 v9, s[16:19], s27 offen  lds
  s_mov_b32 m0, 45056
  s_add_u32 s27, s32, 786432
  buffer_load_dwordx4 v10, s[16:19], s27 offen  lds
  s_mov_b32 m0, 46080
  s_add_u32 s27, s32, 786432
  buffer_load_dwordx4 v11, s[16:19], s27 offen  lds
  s_mov_b32 m0, 47104
  s_add_u32 s27, s32, 786432
  buffer_load_dwordx4 v12, s[16:19], s27 offen  lds
  s_mov_b32 m0, 48128
  s_add_u32 s27, s32, 786432
  buffer_load_dwordx4 v13, s[16:19], s27 offen  lds
  s_mov_b32 m0, 36864
  s_add_u32 s27, s32, 1572864
  buffer_load_dwordx4 v8, s[16:19], s27 offen  lds
  s_mov_b32 m0, 37888
  s_add_u32 s27, s32, 1572864
  buffer_load_dwordx4 v9, s[16:19], s27 offen  lds
  s_mov_b32 m0, 38912
  s_add_u32 s27, s32, 1572864
  buffer_load_dwordx4 v10, s[16:19], s27 offen  lds
  s_mov_b32 m0, 39936
  s_add_u32 s27, s32, 1572864
  buffer_load_dwordx4 v11, s[16:19], s27 offen  lds
  s_mov_b32 m0, 40960
  s_add_u32 s27, s32, 1572864
  buffer_load_dwordx4 v12, s[16:19], s27 offen  lds
  s_mov_b32 m0, 41984
  s_add_u32 s27, s32, 1572864
  buffer_load_dwordx4 v13, s[16:19], s27 offen  lds
  s_waitcnt vmcnt(12)
  ds_read_b64_tr_b16 v[184:185], v4 offset:0
  ds_read_b64_tr_b16 v[186:187], v4 offset:192
  ds_read_b64_tr_b16 v[188:189], v4 offset:3072
  ds_read_b64_tr_b16 v[190:191], v4 offset:3264
  ds_read_b64_tr_b16 v[192:193], v4 offset:32
  ds_read_b64_tr_b16 v[194:195], v4 offset:224
  ds_read_b64_tr_b16 v[196:197], v4 offset:3104
  ds_read_b64_tr_b16 v[198:199], v4 offset:3296
  ds_read_b64_tr_b16 v[200:201], v4 offset:64
  ds_read_b64_tr_b16 v[202:203], v4 offset:256
  ds_read_b64_tr_b16 v[204:205], v4 offset:3136
  ds_read_b64_tr_b16 v[206:207], v4 offset:3328
  s_waitcnt lgkmcnt(0)
  s_mov_b32 m0, 129024
  s_add_u32 s27, s32, 2359296
  buffer_load_dwordx4 v8, s[16:19], s27 offen  lds
  s_mov_b32 m0, 130048
  s_add_u32 s27, s32, 2359296
  buffer_load_dwordx4 v9, s[16:19], s27 offen  lds
  s_mov_b32 m0, 131072
  s_add_u32 s27, s32, 2359296
  buffer_load_dwordx4 v10, s[16:19], s27 offen  lds
  s_mov_b32 m0, 132096
  s_add_u32 s27, s32, 2359296
  buffer_load_dwordx4 v11, s[16:19], s27 offen  lds
  s_mov_b32 m0, 133120
  s_add_u32 s27, s32, 2359296
  buffer_load_dwordx4 v12, s[16:19], s27 offen  lds
  s_mov_b32 m0, 134144
  s_add_u32 s27, s32, 2359296
  buffer_load_dwordx4 v13, s[16:19], s27 offen  lds
  s_waitcnt vmcnt(12)
  ds_read_b64_tr_b16 v[208:209], v3 offset:12288
  ds_read_b64_tr_b16 v[210:211], v3 offset:12480
  ds_read_b64_tr_b16 v[212:213], v3 offset:15360
  ds_read_b64_tr_b16 v[214:215], v3 offset:15552
  ds_read_b64_tr_b16 v[216:217], v3 offset:12320
  ds_read_b64_tr_b16 v[218:219], v3 offset:12512
  ds_read_b64_tr_b16 v[220:221], v3 offset:15392
  ds_read_b64_tr_b16 v[222:223], v3 offset:15584
  ds_read_b64_tr_b16 v[224:225], v3 offset:12352
  ds_read_b64_tr_b16 v[226:227], v3 offset:12544
  ds_read_b64_tr_b16 v[228:229], v3 offset:15424
  ds_read_b64_tr_b16 v[230:231], v3 offset:15616
  s_waitcnt lgkmcnt(0)
  s_mov_b32 m0, 43008
  s_add_u32 s27, s32, 3145728
  buffer_load_dwordx4 v8, s[16:19], s27 offen  lds
  s_mov_b32 m0, 44032
  s_add_u32 s27, s32, 3145728
  buffer_load_dwordx4 v9, s[16:19], s27 offen  lds
  s_mov_b32 m0, 45056
  s_add_u32 s27, s32, 3145728
  buffer_load_dwordx4 v10, s[16:19], s27 offen  lds
  s_mov_b32 m0, 46080
  s_add_u32 s27, s32, 3145728
  buffer_load_dwordx4 v11, s[16:19], s27 offen  lds
  s_mov_b32 m0, 47104
  s_add_u32 s27, s32, 3145728
  buffer_load_dwordx4 v12, s[16:19], s27 offen  lds
  s_mov_b32 m0, 48128
  s_add_u32 s27, s32, 3145728
  buffer_load_dwordx4 v13, s[16:19], s27 offen  lds
  s_waitcnt vmcnt(12)
  ds_read_b64_tr_b16 v[232:233], v3 offset:6144
  ds_read_b64_tr_b16 v[234:235], v3 offset:6336
  ds_read_b64_tr_b16 v[236:237], v3 offset:9216
  ds_read_b64_tr_b16 v[238:239], v3 offset:9408
  ds_read_b64_tr_b16 v[240:241], v3 offset:6176
  ds_read_b64_tr_b16 v[242:243], v3 offset:6368
  ds_read_b64_tr_b16 v[244:245], v3 offset:9248
  ds_read_b64_tr_b16 v[246:247], v3 offset:9440
  ds_read_b64_tr_b16 v[248:249], v3 offset:6208
  ds_read_b64_tr_b16 v[250:251], v3 offset:6400
  ds_read_b64_tr_b16 v[252:253], v3 offset:9280
  ds_read_b64_tr_b16 v[254:255], v3 offset:9472
  s_waitcnt lgkmcnt(0)
  s_mov_b32 m0, 36864
  s_add_u32 s27, s32, 3932160
  buffer_load_dwordx4 v8, s[16:19], s27 offen  lds
  s_mov_b32 m0, 37888
  s_add_u32 s27, s32, 3932160
  buffer_load_dwordx4 v9, s[16:19], s27 offen  lds
  s_mov_b32 m0, 38912
  s_add_u32 s27, s32, 3932160
  buffer_load_dwordx4 v10, s[16:19], s27 offen  lds
  s_mov_b32 m0, 39936
  s_add_u32 s27, s32, 3932160
  buffer_load_dwordx4 v11, s[16:19], s27 offen  lds
  s_mov_b32 m0, 40960
  s_add_u32 s27, s32, 3932160
  buffer_load_dwordx4 v12, s[16:19], s27 offen  lds
  s_mov_b32 m0, 41984
  s_add_u32 s27, s32, 3932160
  buffer_load_dwordx4 v13, s[16:19], s27 offen  lds
  s_waitcnt vmcnt(12)
  ds_read_b64_tr_b16 a[120:121], v4 offset:0
  ds_read_b64_tr_b16 a[122:123], v4 offset:192
  ds_read_b64_tr_b16 a[124:125], v4 offset:3072
  ds_read_b64_tr_b16 a[126:127], v4 offset:3264
  ds_read_b64_tr_b16 a[128:129], v4 offset:32
  ds_read_b64_tr_b16 a[130:131], v4 offset:224
  ds_read_b64_tr_b16 a[132:133], v4 offset:3104
  ds_read_b64_tr_b16 a[134:135], v4 offset:3296
  ds_read_b64_tr_b16 a[136:137], v4 offset:64
  ds_read_b64_tr_b16 a[138:139], v4 offset:256
  ds_read_b64_tr_b16 a[140:141], v4 offset:3136
  ds_read_b64_tr_b16 a[142:143], v4 offset:3328
  s_waitcnt lgkmcnt(0)
  s_mov_b32 m0, 129024
  s_add_u32 s27, s32, 4718592
  buffer_load_dwordx4 v8, s[16:19], s27 offen  lds
  s_mov_b32 m0, 130048
  s_add_u32 s27, s32, 4718592
  buffer_load_dwordx4 v9, s[16:19], s27 offen  lds
  s_mov_b32 m0, 131072
  s_add_u32 s27, s32, 4718592
  buffer_load_dwordx4 v10, s[16:19], s27 offen  lds
  s_mov_b32 m0, 132096
  s_add_u32 s27, s32, 4718592
  buffer_load_dwordx4 v11, s[16:19], s27 offen  lds
  s_mov_b32 m0, 133120
  s_add_u32 s27, s32, 4718592
  buffer_load_dwordx4 v12, s[16:19], s27 offen  lds
  s_mov_b32 m0, 134144
  s_add_u32 s27, s32, 4718592
  buffer_load_dwordx4 v13, s[16:19], s27 offen  lds
  s_waitcnt vmcnt(12)
  ds_read_b64_tr_b16 a[144:145], v3 offset:12288
  ds_read_b64_tr_b16 a[146:147], v3 offset:12480
  ds_read_b64_tr_b16 a[148:149], v3 offset:15360
  ds_read_b64_tr_b16 a[150:151], v3 offset:15552
  ds_read_b64_tr_b16 a[152:153], v3 offset:12320
  ds_read_b64_tr_b16 a[154:155], v3 offset:12512
  ds_read_b64_tr_b16 a[156:157], v3 offset:15392
  ds_read_b64_tr_b16 a[158:159], v3 offset:15584
  ds_read_b64_tr_b16 a[160:161], v3 offset:12352
  ds_read_b64_tr_b16 a[162:163], v3 offset:12544
  ds_read_b64_tr_b16 a[164:165], v3 offset:15424
  ds_read_b64_tr_b16 a[166:167], v3 offset:15616
  s_waitcnt lgkmcnt(0)
  s_mov_b32 m0, 43008
  s_add_u32 s27, s32, 5505024
  buffer_load_dwordx4 v8, s[16:19], s27 offen  lds
  s_mov_b32 m0, 44032
  s_add_u32 s27, s32, 5505024
  buffer_load_dwordx4 v9, s[16:19], s27 offen  lds
  s_mov_b32 m0, 45056
  s_add_u32 s27, s32, 5505024
  buffer_load_dwordx4 v10, s[16:19], s27 offen  lds
  s_mov_b32 m0, 46080
  s_add_u32 s27, s32, 5505024
  buffer_load_dwordx4 v11, s[16:19], s27 offen  lds
  s_mov_b32 m0, 47104
  s_add_u32 s27, s32, 5505024
  buffer_load_dwordx4 v12, s[16:19], s27 offen  lds
  s_mov_b32 m0, 48128
  s_add_u32 s27, s32, 5505024
  buffer_load_dwordx4 v13, s[16:19], s27 offen  lds
  s_waitcnt vmcnt(12)
  ds_read_b64_tr_b16 a[168:169], v3 offset:6144
  ds_read_b64_tr_b16 a[170:171], v3 offset:6336
  ds_read_b64_tr_b16 a[172:173], v3 offset:9216
  ds_read_b64_tr_b16 a[174:175], v3 offset:9408
  ds_read_b64_tr_b16 a[176:177], v3 offset:6176
  ds_read_b64_tr_b16 a[178:179], v3 offset:6368
  ds_read_b64_tr_b16 a[180:181], v3 offset:9248
  ds_read_b64_tr_b16 a[182:183], v3 offset:9440
  ds_read_b64_tr_b16 a[184:185], v3 offset:6208
  ds_read_b64_tr_b16 a[186:187], v3 offset:6400
  ds_read_b64_tr_b16 a[188:189], v3 offset:9280
  ds_read_b64_tr_b16 a[190:191], v3 offset:9472
  s_waitcnt lgkmcnt(0)
  s_mov_b32 m0, 36864
  s_add_u32 s27, s32, 6291456
  buffer_load_dwordx4 v8, s[16:19], s27 offen  lds
  s_mov_b32 m0, 37888
  s_add_u32 s27, s32, 6291456
  buffer_load_dwordx4 v9, s[16:19], s27 offen  lds
  s_mov_b32 m0, 38912
  s_add_u32 s27, s32, 6291456
  buffer_load_dwordx4 v10, s[16:19], s27 offen  lds
  s_mov_b32 m0, 39936
  s_add_u32 s27, s32, 6291456
  buffer_load_dwordx4 v11, s[16:19], s27 offen  lds
  s_mov_b32 m0, 40960
  s_add_u32 s27, s32, 6291456
  buffer_load_dwordx4 v12, s[16:19], s27 offen  lds
  s_mov_b32 m0, 41984
  s_add_u32 s27, s32, 6291456
  buffer_load_dwordx4 v13, s[16:19], s27 offen  lds
  s_waitcnt vmcnt(12)
  ds_read_b64_tr_b16 a[192:193], v4 offset:0
  ds_read_b64_tr_b16 a[194:195], v4 offset:192
  ds_read_b64_tr_b16 a[196:197], v4 offset:3072
  ds_read_b64_tr_b16 a[198:199], v4 offset:3264
  ds_read_b64_tr_b16 a[200:201], v4 offset:32
  ds_read_b64_tr_b16 a[202:203], v4 offset:224
  ds_read_b64_tr_b16 a[204:205], v4 offset:3104
  ds_read_b64_tr_b16 a[206:207], v4 offset:3296
  ds_read_b64_tr_b16 a[208:209], v4 offset:64
  ds_read_b64_tr_b16 a[210:211], v4 offset:256
  ds_read_b64_tr_b16 a[212:213], v4 offset:3136
  ds_read_b64_tr_b16 a[214:215], v4 offset:3328
  s_waitcnt lgkmcnt(0)
  s_mov_b32 m0, 129024
  s_add_u32 s27, s32, 7077888
  buffer_load_dwordx4 v8, s[16:19], s27 offen  lds
  s_mov_b32 m0, 130048
  s_add_u32 s27, s32, 7077888
  buffer_load_dwordx4 v9, s[16:19], s27 offen  lds
  s_mov_b32 m0, 131072
  s_add_u32 s27, s32, 7077888
  buffer_load_dwordx4 v10, s[16:19], s27 offen  lds
  s_mov_b32 m0, 132096
  s_add_u32 s27, s32, 7077888
  buffer_load_dwordx4 v11, s[16:19], s27 offen  lds
  s_mov_b32 m0, 133120
  s_add_u32 s27, s32, 7077888
  buffer_load_dwordx4 v12, s[16:19], s27 offen  lds
  s_mov_b32 m0, 134144
  s_add_u32 s27, s32, 7077888
  buffer_load_dwordx4 v13, s[16:19], s27 offen  lds
  s_waitcnt vmcnt(12)
  ds_read_b64_tr_b16 a[216:217], v3 offset:12288
  ds_read_b64_tr_b16 a[218:219], v3 offset:12480
  ds_read_b64_tr_b16 a[220:221], v3 offset:15360
  ds_read_b64_tr_b16 a[222:223], v3 offset:15552
  ds_read_b64_tr_b16 a[224:225], v3 offset:12320
  ds_read_b64_tr_b16 a[226:227], v3 offset:12512
  ds_read_b64_tr_b16 a[228:229], v3 offset:15392
  ds_read_b64_tr_b16 a[230:231], v3 offset:15584
  ds_read_b64_tr_b16 a[232:233], v3 offset:12352
  ds_read_b64_tr_b16 a[234:235], v3 offset:12544
  ds_read_b64_tr_b16 a[236:237], v3 offset:15424
  ds_read_b64_tr_b16 a[238:239], v3 offset:15616
  s_waitcnt lgkmcnt(0)
  s_mov_b32 m0, 49152
  s_add_u32 s27, s32, 0
  buffer_load_dwordx4 v8, s[12:15], s27 offen  lds
  s_mov_b32 m0, 50176
  s_add_u32 s27, s32, 0
  buffer_load_dwordx4 v9, s[12:15], s27 offen  lds
  s_mov_b32 m0, 51200
  s_add_u32 s27, s32, 0
  buffer_load_dwordx4 v10, s[12:15], s27 offen  lds
  s_mov_b32 m0, 52224
  s_add_u32 s27, s32, 0
  buffer_load_dwordx4 v11, s[12:15], s27 offen  lds
  s_mov_b32 m0, 53248
  s_add_u32 s27, s32, 0
  buffer_load_dwordx4 v12, s[12:15], s27 offen  lds
  s_mov_b32 m0, 54272
  s_add_u32 s27, s32, 0
  buffer_load_dwordx4 v13, s[12:15], s27 offen  lds
  s_waitcnt vmcnt(12)
  ds_read_b64_tr_b16 a[240:241], v3 offset:6144
  ds_read_b64_tr_b16 a[242:243], v3 offset:6336
  ds_read_b64_tr_b16 a[244:245], v3 offset:9216
  ds_read_b64_tr_b16 a[246:247], v3 offset:9408
  ds_read_b64_tr_b16 a[248:249], v3 offset:6176
  ds_read_b64_tr_b16 a[250:251], v3 offset:6368
  ds_read_b64_tr_b16 a[252:253], v3 offset:9248
  ds_read_b64_tr_b16 a[254:255], v3 offset:9440
  ds_read_b64_tr_b16 v[152:153], v3 offset:6208
  ds_read_b64_tr_b16 v[154:155], v3 offset:6400
  ds_read_b64_tr_b16 v[156:157], v3 offset:9280
  ds_read_b64_tr_b16 v[158:159], v3 offset:9472
  s_waitcnt lgkmcnt(0)
  s_mov_b32 m0, 43008
  s_add_u32 s27, s32, 786432
  buffer_load_dwordx4 v8, s[12:15], s27 offen  lds
  s_mov_b32 m0, 44032
  s_add_u32 s27, s32, 786432
  buffer_load_dwordx4 v9, s[12:15], s27 offen  lds
  s_mov_b32 m0, 45056
  s_add_u32 s27, s32, 786432
  buffer_load_dwordx4 v10, s[12:15], s27 offen  lds
  s_mov_b32 m0, 46080
  s_add_u32 s27, s32, 786432
  buffer_load_dwordx4 v11, s[12:15], s27 offen  lds
  s_mov_b32 m0, 47104
  s_add_u32 s27, s32, 786432
  buffer_load_dwordx4 v12, s[12:15], s27 offen  lds
  s_mov_b32 m0, 48128
  s_add_u32 s27, s32, 786432
  buffer_load_dwordx4 v13, s[12:15], s27 offen  lds
  s_waitcnt vmcnt(12)
  ds_read_b64_tr_b16 v[160:161], v4 offset:0
  ds_read_b64_tr_b16 v[162:163], v4 offset:192
  ds_read_b64_tr_b16 v[164:165], v4 offset:3072
  ds_read_b64_tr_b16 v[166:167], v4 offset:3264
  ds_read_b64_tr_b16 v[168:169], v4 offset:32
  ds_read_b64_tr_b16 v[170:171], v4 offset:224
  ds_read_b64_tr_b16 v[172:173], v4 offset:3104
  ds_read_b64_tr_b16 v[174:175], v4 offset:3296
  ds_read_b64_tr_b16 v[176:177], v4 offset:64
  ds_read_b64_tr_b16 v[178:179], v4 offset:256
  ds_read_b64_tr_b16 v[180:181], v4 offset:3136
  ds_read_b64_tr_b16 v[182:183], v4 offset:3328
  s_waitcnt lgkmcnt(0)
  s_mov_b32 m0, 55296
  s_add_u32 s27, s32, 1572864
  buffer_load_dwordx4 v8, s[12:15], s27 offen  lds
  s_mov_b32 m0, 56320
  s_add_u32 s27, s32, 1572864
  buffer_load_dwordx4 v9, s[12:15], s27 offen  lds
  s_mov_b32 m0, 57344
  s_add_u32 s27, s32, 1572864
  buffer_load_dwordx4 v10, s[12:15], s27 offen  lds
  s_mov_b32 m0, 58368
  s_add_u32 s27, s32, 1572864
  buffer_load_dwordx4 v11, s[12:15], s27 offen  lds
  s_mov_b32 m0, 59392
  s_add_u32 s27, s32, 1572864
  buffer_load_dwordx4 v12, s[12:15], s27 offen  lds
  s_mov_b32 m0, 60416
  s_add_u32 s27, s32, 1572864
  buffer_load_dwordx4 v13, s[12:15], s27 offen  lds
  s_waitcnt vmcnt(12)
  ds_read_b64_tr_b16 v[32:33], v3 offset:18432
  ds_read_b64_tr_b16 v[34:35], v3 offset:18624
  ds_read_b64_tr_b16 v[36:37], v3 offset:21504
  ds_read_b64_tr_b16 v[38:39], v3 offset:21696
  ds_read_b64_tr_b16 v[40:41], v3 offset:18464
  ds_read_b64_tr_b16 v[42:43], v3 offset:18656
  ds_read_b64_tr_b16 v[44:45], v3 offset:21536
  ds_read_b64_tr_b16 v[46:47], v3 offset:21728
  ds_read_b64_tr_b16 v[48:49], v3 offset:18496
  ds_read_b64_tr_b16 v[50:51], v3 offset:18688
  ds_read_b64_tr_b16 v[52:53], v3 offset:21568
  ds_read_b64_tr_b16 v[54:55], v3 offset:21760
  s_waitcnt lgkmcnt(0)
  ds_write_b128 v7, v[32:35] offset:18432
  ds_write_b128 v7, v[36:39] offset:19456
  ds_write_b128 v7, v[40:43] offset:20480
  ds_write_b128 v7, v[44:47] offset:21504
  ds_write_b128 v7, v[48:51] offset:22528
  ds_write_b128 v7, v[52:55] offset:23552
  s_waitcnt lgkmcnt(0)
  s_mov_b32 m0, 129024
  s_add_u32 s27, s32, 2359296
  buffer_load_dwordx4 v8, s[12:15], s27 offen  lds
  s_mov_b32 m0, 130048
  s_add_u32 s27, s32, 2359296
  buffer_load_dwordx4 v9, s[12:15], s27 offen  lds
  s_mov_b32 m0, 131072
  s_add_u32 s27, s32, 2359296
  buffer_load_dwordx4 v10, s[12:15], s27 offen  lds
  s_mov_b32 m0, 132096
  s_add_u32 s27, s32, 2359296
  buffer_load_dwordx4 v11, s[12:15], s27 offen  lds
  s_mov_b32 m0, 133120
  s_add_u32 s27, s32, 2359296
  buffer_load_dwordx4 v12, s[12:15], s27 offen  lds
  s_mov_b32 m0, 134144
  s_add_u32 s27, s32, 2359296
  buffer_load_dwordx4 v13, s[12:15], s27 offen  lds
  s_waitcnt vmcnt(12)
  ds_read_b64_tr_b16 a[96:97], v3 offset:12288
  ds_read_b64_tr_b16 a[98:99], v3 offset:12480
  ds_read_b64_tr_b16 a[100:101], v3 offset:15360
  ds_read_b64_tr_b16 a[102:103], v3 offset:15552
  ds_read_b64_tr_b16 a[104:105], v3 offset:12320
  ds_read_b64_tr_b16 a[106:107], v3 offset:12512
  ds_read_b64_tr_b16 a[108:109], v3 offset:15392
  ds_read_b64_tr_b16 a[110:111], v3 offset:15584
  ds_read_b64_tr_b16 a[112:113], v3 offset:12352
  ds_read_b64_tr_b16 a[114:115], v3 offset:12544
  ds_read_b64_tr_b16 a[116:117], v3 offset:15424
  ds_read_b64_tr_b16 a[118:119], v3 offset:15616
  s_waitcnt lgkmcnt(0)
  s_mov_b32 m0, 30720
  s_add_u32 s27, s32, 3145728
  buffer_load_dwordx4 v8, s[12:15], s27 offen  lds
  s_mov_b32 m0, 31744
  s_add_u32 s27, s32, 3145728
  buffer_load_dwordx4 v9, s[12:15], s27 offen  lds
  s_mov_b32 m0, 32768
  s_add_u32 s27, s32, 3145728
  buffer_load_dwordx4 v10, s[12:15], s27 offen  lds
  s_mov_b32 m0, 33792
  s_add_u32 s27, s32, 3145728
  buffer_load_dwordx4 v11, s[12:15], s27 offen  lds
  s_mov_b32 m0, 34816
  s_add_u32 s27, s32, 3145728
  buffer_load_dwordx4 v12, s[12:15], s27 offen  lds
  s_mov_b32 m0, 35840
  s_add_u32 s27, s32, 3145728
  buffer_load_dwordx4 v13, s[12:15], s27 offen  lds
  s_waitcnt vmcnt(12)
  ds_read_b64_tr_b16 v[32:33], v3 offset:24576
  ds_read_b64_tr_b16 v[34:35], v3 offset:24768
  ds_read_b64_tr_b16 v[36:37], v3 offset:27648
  ds_read_b64_tr_b16 v[38:39], v3 offset:27840
  ds_read_b64_tr_b16 v[40:41], v3 offset:24608
  ds_read_b64_tr_b16 v[42:43], v3 offset:24800
  ds_read_b64_tr_b16 v[44:45], v3 offset:27680
  ds_read_b64_tr_b16 v[46:47], v3 offset:27872
  ds_read_b64_tr_b16 v[48:49], v3 offset:24640
  ds_read_b64_tr_b16 v[50:51], v3 offset:24832
  ds_read_b64_tr_b16 v[52:53], v3 offset:27712
  ds_read_b64_tr_b16 v[54:55], v3 offset:27904
  s_waitcnt lgkmcnt(0)
  ds_write_b128 v7, v[32:35] offset:24576
  ds_write_b128 v7, v[36:39] offset:25600
  ds_write_b128 v7, v[40:43] offset:26624
  ds_write_b128 v7, v[44:47] offset:27648
  ds_write_b128 v7, v[48:51] offset:28672
  ds_write_b128 v7, v[52:55] offset:29696
  s_waitcnt lgkmcnt(0)
  s_mov_b32 m0, 43008
  s_add_u32 s27, s32, 3932160
  buffer_load_dwordx4 v8, s[12:15], s27 offen  lds
  s_mov_b32 m0, 44032
  s_add_u32 s27, s32, 3932160
  buffer_load_dwordx4 v9, s[12:15], s27 offen  lds
  s_mov_b32 m0, 45056
  s_add_u32 s27, s32, 3932160
  buffer_load_dwordx4 v10, s[12:15], s27 offen  lds
  s_mov_b32 m0, 46080
  s_add_u32 s27, s32, 3932160
  buffer_load_dwordx4 v11, s[12:15], s27 offen  lds
  s_mov_b32 m0, 47104
  s_add_u32 s27, s32, 3932160
  buffer_load_dwordx4 v12, s[12:15], s27 offen  lds
  s_mov_b32 m0, 48128
  s_add_u32 s27, s32, 3932160
  buffer_load_dwordx4 v13, s[12:15], s27 offen  lds
  s_waitcnt vmcnt(12)
  ds_read_b64_tr_b16 a[0:1], v4 offset:0
  ds_read_b64_tr_b16 a[2:3], v4 offset:192
  ds_read_b64_tr_b16 a[4:5], v4 offset:3072
  ds_read_b64_tr_b16 a[6:7], v4 offset:3264
  ds_read_b64_tr_b16 a[8:9], v4 offset:32
  ds_read_b64_tr_b16 a[10:11], v4 offset:224
  ds_read_b64_tr_b16 a[12:13], v4 offset:3104
  ds_read_b64_tr_b16 a[14:15], v4 offset:3296
  ds_read_b64_tr_b16 a[16:17], v4 offset:64
  ds_read_b64_tr_b16 a[18:19], v4 offset:256
  ds_read_b64_tr_b16 a[20:21], v4 offset:3136
  ds_read_b64_tr_b16 a[22:23], v4 offset:3328
  s_waitcnt lgkmcnt(0)
  s_mov_b32 m0, 36864
  s_add_u32 s27, s32, 4718592
  buffer_load_dwordx4 v8, s[12:15], s27 offen  lds
  s_mov_b32 m0, 37888
  s_add_u32 s27, s32, 4718592
  buffer_load_dwordx4 v9, s[12:15], s27 offen  lds
  s_mov_b32 m0, 38912
  s_add_u32 s27, s32, 4718592
  buffer_load_dwordx4 v10, s[12:15], s27 offen  lds
  s_mov_b32 m0, 39936
  s_add_u32 s27, s32, 4718592
  buffer_load_dwordx4 v11, s[12:15], s27 offen  lds
  s_mov_b32 m0, 40960
  s_add_u32 s27, s32, 4718592
  buffer_load_dwordx4 v12, s[12:15], s27 offen  lds
  s_mov_b32 m0, 41984
  s_add_u32 s27, s32, 4718592
  buffer_load_dwordx4 v13, s[12:15], s27 offen  lds
  s_waitcnt vmcnt(12)
  ds_read_b64_tr_b16 v[32:33], v3 offset:0
  ds_read_b64_tr_b16 v[34:35], v3 offset:192
  ds_read_b64_tr_b16 v[36:37], v3 offset:3072
  ds_read_b64_tr_b16 v[38:39], v3 offset:3264
  ds_read_b64_tr_b16 v[40:41], v3 offset:32
  ds_read_b64_tr_b16 v[42:43], v3 offset:224
  ds_read_b64_tr_b16 v[44:45], v3 offset:3104
  ds_read_b64_tr_b16 v[46:47], v3 offset:3296
  ds_read_b64_tr_b16 v[48:49], v3 offset:64
  ds_read_b64_tr_b16 v[50:51], v3 offset:256
  ds_read_b64_tr_b16 v[52:53], v3 offset:3136
  ds_read_b64_tr_b16 v[54:55], v3 offset:3328
  s_waitcnt lgkmcnt(0)
  ds_write_b128 v7, v[32:35] offset:0
  ds_write_b128 v7, v[36:39] offset:1024
  ds_write_b128 v7, v[40:43] offset:2048
  ds_write_b128 v7, v[44:47] offset:3072
  ds_write_b128 v7, v[48:51] offset:4096
  ds_write_b128 v7, v[52:55] offset:5120
  s_waitcnt lgkmcnt(0)
  s_mov_b32 m0, 129024
  s_add_u32 s27, s32, 5505024
  buffer_load_dwordx4 v8, s[12:15], s27 offen  lds
  s_mov_b32 m0, 130048
  s_add_u32 s27, s32, 5505024
  buffer_load_dwordx4 v9, s[12:15], s27 offen  lds
  s_mov_b32 m0, 131072
  s_add_u32 s27, s32, 5505024
  buffer_load_dwordx4 v10, s[12:15], s27 offen  lds
  s_mov_b32 m0, 132096
  s_add_u32 s27, s32, 5505024
  buffer_load_dwordx4 v11, s[12:15], s27 offen  lds
  s_mov_b32 m0, 133120
  s_add_u32 s27, s32, 5505024
  buffer_load_dwordx4 v12, s[12:15], s27 offen  lds
  s_mov_b32 m0, 134144
  s_add_u32 s27, s32, 5505024
  buffer_load_dwordx4 v13, s[12:15], s27 offen  lds
  s_waitcnt vmcnt(12)
  ds_read_b64_tr_b16 a[24:25], v3 offset:12288
  ds_read_b64_tr_b16 a[26:27], v3 offset:12480
  ds_read_b64_tr_b16 a[28:29], v3 offset:15360
  ds_read_b64_tr_b16 a[30:31], v3 offset:15552
  ds_read_b64_tr_b16 a[32:33], v3 offset:12320
  ds_read_b64_tr_b16 a[34:35], v3 offset:12512
  ds_read_b64_tr_b16 a[36:37], v3 offset:15392
  ds_read_b64_tr_b16 a[38:39], v3 offset:15584
  ds_read_b64_tr_b16 a[40:41], v3 offset:12352
  ds_read_b64_tr_b16 a[42:43], v3 offset:12544
  ds_read_b64_tr_b16 a[44:45], v3 offset:15424
  ds_read_b64_tr_b16 a[46:47], v3 offset:15616
  s_waitcnt lgkmcnt(0)
  s_mov_b32 m0, 43008
  s_add_u32 s27, s32, 6291456
  buffer_load_dwordx4 v8, s[12:15], s27 offen  lds
  s_mov_b32 m0, 44032
  s_add_u32 s27, s32, 6291456
  buffer_load_dwordx4 v9, s[12:15], s27 offen  lds
  s_mov_b32 m0, 45056
  s_add_u32 s27, s32, 6291456
  buffer_load_dwordx4 v10, s[12:15], s27 offen  lds
  s_mov_b32 m0, 46080
  s_add_u32 s27, s32, 6291456
  buffer_load_dwordx4 v11, s[12:15], s27 offen  lds
  s_mov_b32 m0, 47104
  s_add_u32 s27, s32, 6291456
  buffer_load_dwordx4 v12, s[12:15], s27 offen  lds
  s_mov_b32 m0, 48128
  s_add_u32 s27, s32, 6291456
  buffer_load_dwordx4 v13, s[12:15], s27 offen  lds
  s_waitcnt vmcnt(12)
  ds_read_b64_tr_b16 v[32:33], v3 offset:6144
  ds_read_b64_tr_b16 v[34:35], v3 offset:6336
  ds_read_b64_tr_b16 v[36:37], v3 offset:9216
  ds_read_b64_tr_b16 v[38:39], v3 offset:9408
  ds_read_b64_tr_b16 v[40:41], v3 offset:6176
  ds_read_b64_tr_b16 v[42:43], v3 offset:6368
  ds_read_b64_tr_b16 v[44:45], v3 offset:9248
  ds_read_b64_tr_b16 v[46:47], v3 offset:9440
  ds_read_b64_tr_b16 v[48:49], v3 offset:6208
  ds_read_b64_tr_b16 v[50:51], v3 offset:6400
  ds_read_b64_tr_b16 v[52:53], v3 offset:9280
  ds_read_b64_tr_b16 v[54:55], v3 offset:9472
  s_waitcnt lgkmcnt(0)
  ds_write_b128 v7, v[32:35] offset:6144
  ds_write_b128 v7, v[36:39] offset:7168
  ds_write_b128 v7, v[40:43] offset:8192
  ds_write_b128 v7, v[44:47] offset:9216
  ds_write_b128 v7, v[48:51] offset:10240
  ds_write_b128 v7, v[52:55] offset:11264
  s_waitcnt lgkmcnt(0)
  s_waitcnt vmcnt(6)
  ds_read_b64_tr_b16 a[48:49], v4 offset:0
  ds_read_b64_tr_b16 a[50:51], v4 offset:192
  ds_read_b64_tr_b16 a[52:53], v4 offset:3072
  ds_read_b64_tr_b16 a[54:55], v4 offset:3264
  ds_read_b64_tr_b16 a[56:57], v4 offset:32
  ds_read_b64_tr_b16 a[58:59], v4 offset:224
  ds_read_b64_tr_b16 a[60:61], v4 offset:3104
  ds_read_b64_tr_b16 a[62:63], v4 offset:3296
  ds_read_b64_tr_b16 a[64:65], v4 offset:64
  ds_read_b64_tr_b16 a[66:67], v4 offset:256
  ds_read_b64_tr_b16 a[68:69], v4 offset:3136
  ds_read_b64_tr_b16 a[70:71], v4 offset:3328
  s_waitcnt lgkmcnt(0)
  s_mov_b32 m0, 129024
  s_add_u32 s27, s32, 7077888
  buffer_load_dwordx4 v8, s[12:15], s27 offen  lds
  s_mov_b32 m0, 130048
  s_add_u32 s27, s32, 7077888
  buffer_load_dwordx4 v9, s[12:15], s27 offen  lds
  s_mov_b32 m0, 131072
  s_add_u32 s27, s32, 7077888
  buffer_load_dwordx4 v10, s[12:15], s27 offen  lds
  s_mov_b32 m0, 132096
  s_add_u32 s27, s32, 7077888
  buffer_load_dwordx4 v11, s[12:15], s27 offen  lds
  s_mov_b32 m0, 133120
  s_add_u32 s27, s32, 7077888
  buffer_load_dwordx4 v12, s[12:15], s27 offen  lds
  s_mov_b32 m0, 134144
  s_add_u32 s27, s32, 7077888
  buffer_load_dwordx4 v13, s[12:15], s27 offen  lds
  buffer_load_dwordx4 v[64:67], off, s[68:71], 0 offset:128 sc1
  buffer_load_dwordx2 v[68:69], off, s[68:71], 0 offset:64 sc1
  s_waitcnt vmcnt(8)
  ds_read_b64_tr_b16 v[32:33], v3 offset:12288
  ds_read_b64_tr_b16 v[34:35], v3 offset:12480
  ds_read_b64_tr_b16 v[36:37], v3 offset:15360
  ds_read_b64_tr_b16 v[38:39], v3 offset:15552
  ds_read_b64_tr_b16 v[40:41], v3 offset:12320
  ds_read_b64_tr_b16 v[42:43], v3 offset:12512
  ds_read_b64_tr_b16 v[44:45], v3 offset:15392
  ds_read_b64_tr_b16 v[46:47], v3 offset:15584
  ds_read_b64_tr_b16 v[48:49], v3 offset:12352
  ds_read_b64_tr_b16 v[50:51], v3 offset:12544
  ds_read_b64_tr_b16 v[52:53], v3 offset:15424
  ds_read_b64_tr_b16 v[54:55], v3 offset:15616
  s_waitcnt lgkmcnt(0)
  ds_write_b128 v7, v[32:35] offset:12288
  ds_write_b128 v7, v[36:39] offset:13312
  ds_write_b128 v7, v[40:43] offset:14336
  ds_write_b128 v7, v[44:47] offset:15360
  ds_write_b128 v7, v[48:51] offset:16384
  ds_write_b128 v7, v[52:55] offset:17408
  s_waitcnt lgkmcnt(0)
  s_waitcnt vmcnt(2)
  ds_read_b64_tr_b16 a[72:73], v4 offset:0
  ds_read_b64_tr_b16 a[74:75], v4 offset:192
  ds_read_b64_tr_b16 a[76:77], v4 offset:3072
  ds_read_b64_tr_b16 a[78:79], v4 offset:3264
  ds_read_b64_tr_b16 a[80:81], v4 offset:32
  ds_read_b64_tr_b16 a[82:83], v4 offset:224
  ds_read_b64_tr_b16 a[84:85], v4 offset:3104
  ds_read_b64_tr_b16 a[86:87], v4 offset:3296
  ds_read_b64_tr_b16 a[88:89], v4 offset:64
  ds_read_b64_tr_b16 a[90:91], v4 offset:256
  ds_read_b64_tr_b16 a[92:93], v4 offset:3136
  ds_read_b64_tr_b16 a[94:95], v4 offset:3328
  s_waitcnt lgkmcnt(0)
  s_branch CQ_ldd
CQ_ld2:
  s_cmp_lg_u32 s24, 2
  s_cbranch_scc1 CQ_ld3
  s_mov_b32 m0, 135168
  s_add_u32 s27, s32, 0
  buffer_load_dwordx4 v8, s[16:19], s27 offen  lds
  s_mov_b32 m0, 136192
  s_add_u32 s27, s32, 0
  buffer_load_dwordx4 v9, s[16:19], s27 offen  lds
  s_mov_b32 m0, 137216
  s_add_u32 s27, s32, 0
  buffer_load_dwordx4 v10, s[16:19], s27 offen  lds
  s_mov_b32 m0, 138240
  s_add_u32 s27, s32, 0
  buffer_load_dwordx4 v11, s[16:19], s27 offen  lds
  s_mov_b32 m0, 139264
  s_add_u32 s27, s32, 0
  buffer_load_dwordx4 v12, s[16:19], s27 offen  lds
  s_mov_b32 m0, 140288
  s_add_u32 s27, s32, 0
  buffer_load_dwordx4 v13, s[16:19], s27 offen  lds
  s_mov_b32 m0, 67584
  s_add_u32 s27, s32, 786432
  buffer_load_dwordx4 v8, s[16:19], s27 offen  lds
  s_mov_b32 m0, 68608
  s_add_u32 s27, s32, 786432
  buffer_load_dwordx4 v9, s[16:19], s27 offen  lds
  s_mov_b32 m0, 69632
  s_add_u32 s27, s32, 786432
  buffer_load_dwordx4 v10, s[16:19], s27 offen  lds
  s_mov_b32 m0, 70656
  s_add_u32 s27, s32, 786432
  buffer_load_dwordx4 v11, s[16:19], s27 offen  lds
  s_mov_b32 m0, 71680
  s_add_u32 s27, s32, 786432
  buffer_load_dwordx4 v12, s[16:19], s27 offen  lds
  s_mov_b32 m0, 72704
  s_add_u32 s27, s32, 786432
  buffer_load_dwordx4 v13, s[16:19], s27 offen  lds
  s_mov_b32 m0, 61440
  s_add_u32 s27, s32, 1572864
  buffer_load_dwordx4 v8, s[16:19], s27 offen  lds
  s_mov_b32 m0, 62464
  s_add_u32 s27, s32, 1572864
  buffer_load_dwordx4 v9, s[16:19], s27 offen  lds
  s_mov_b32 m0, 63488
  s_add_u32 s27, s32, 1572864
  buffer_load_dwordx4 v10, s[16:19], s27 offen  lds
  s_mov_b32 m0, 64512
  s_add_u32 s27, s32, 1572864
  buffer_load_dwordx4 v11, s[16:19], s27 offen  lds
  s_mov_b32 m0, 65536
  s_add_u32 s27, s32, 1572864
  buffer_load_dwordx4 v12, s[16:19], s27 offen  lds
  s_mov_b32 m0, 66560
  s_add_u32 s27, s32, 1572864
  buffer_load_dwordx4 v13, s[16:19], s27 offen  lds
  s_waitcnt vmcnt(12)
  ds_read_b64_tr_b16 a[216:217], v4 offset:0
  ds_read_b64_tr_b16 a[218:219], v4 offset:192
  ds_read_b64_tr_b16 a[220:221], v4 offset:3072
  ds_read_b64_tr_b16 a[222:223], v4 offset:3264
  ds_read_b64_tr_b16 a[224:225], v4 offset:32
  ds_read_b64_tr_b16 a[226:227], v4 offset:224
  ds_read_b64_tr_b16 a[228:229], v4 offset:3104
  ds_read_b64_tr_b16 a[230:231], v4 offset:3296
  ds_read_b64_tr_b16 a[232:233], v4 offset:64
  ds_read_b64_tr_b16 a[234:235], v4 offset:256
  ds_read_b64_tr_b16 a[236:237], v4 offset:3136
  ds_read_b64_tr_b16 a[238:239], v4 offset:3328
  s_waitcnt lgkmcnt(0)
  s_mov_b32 m0, 135168
  s_add_u32 s27, s32, 2359296
  buffer_load_dwordx4 v8, s[16:19], s27 offen  lds
  s_mov_b32 m0, 136192
  s_add_u32 s27, s32, 2359296
  buffer_load_dwordx4 v9, s[16:19], s27 offen  lds
  s_mov_b32 m0, 137216
  s_add_u32 s27, s32, 2359296
  buffer_load_dwordx4 v10, s[16:19], s27 offen  lds
  s_mov_b32 m0, 138240
  s_add_u32 s27, s32, 2359296
  buffer_load_dwordx4 v11, s[16:19], s27 offen  lds
  s_mov_b32 m0, 139264
  s_add_u32 s27, s32, 2359296
  buffer_load_dwordx4 v12, s[16:19], s27 offen  lds
  s_mov_b32 m0, 140288
  s_add_u32 s27, s32, 2359296
  buffer_load_dwordx4 v13, s[16:19], s27 offen  lds
  s_waitcnt vmcnt(12)
  ds_read_b64_tr_b16 a[240:241], v3 offset:6144
  ds_read_b64_tr_b16 a[242:243], v3 offset:6336
  ds_read_b64_tr_b16 a[244:245], v3 offset:9216
  ds_read_b64_tr_b16 a[246:247], v3 offset:9408
  ds_read_b64_tr_b16 a[248:249], v3 offset:6176
  ds_read_b64_tr_b16 a[250:251], v3 offset:6368
  ds_read_b64_tr_b16 a[252:253], v3 offset:9248
  ds_read_b64_tr_b16 a[254:255], v3 offset:9440
  ds_read_b64_tr_b16 v[152:153], v3 offset:6208
  ds_read_b64_tr_b16 v[154:155], v3 offset:6400
  ds_read_b64_tr_b16 v[156:157], v3 offset:9280
  ds_read_b64_tr_b16 v[158:159], v3 offset:9472
  s_waitcnt lgkmcnt(0)
  s_mov_b32 m0, 67584
  s_add_u32 s27, s32, 3145728
  buffer_load_dwordx4 v8, s[16:19], s27 offen  lds
  s_mov_b32 m0, 68608
  s_add_u32 s27, s32, 3145728
  buffer_load_dwordx4 v9, s[16:19], s27 offen  lds
  s_mov_b32 m0, 69632
  s_add_u32 s27, s32, 3145728
  buffer_load_dwordx4 v10, s[16:19], s27 offen  lds
  s_mov_b32 m0, 70656
  s_add_u32 s27, s32, 3145728
  buffer_load_dwordx4 v11, s[16:19], s27 offen  lds
  s_mov_b32 m0, 71680
  s_add_u32 s27, s32, 3145728
  buffer_load_dwordx4 v12, s[16:19], s27 offen  lds
  s_mov_b32 m0, 72704
  s_add_u32 s27, s32, 3145728
  buffer_load_dwordx4 v13, s[16:19], s27 offen  lds
  s_waitcnt vmcnt(12)
  ds_read_b64_tr_b16 v[160:161], v3 offset:0
  ds_read_b64_tr_b16 v[162:163], v3 offset:192
  ds_read_b64_tr_b16 v[164:165], v3 offset:3072
  ds_read_b64_tr_b16 v[166:167], v3 offset:3264
  ds_read_b64_tr_b16 v[168:169], v3 offset:32
  ds_read_b64_tr_b16 v[170:171], v3 offset:224
  ds_read_b64_tr_b16 v[172:173], v3 offset:3104
  ds_read_b64_tr_b16 v[174:175], v3 offset:3296
  ds_read_b64_tr_b16 v[176:177], v3 offset:64
  ds_read_b64_tr_b16 v[178:179], v3 offset:256
  ds_read_b64_tr_b16 v[180:181], v3 offset:3136
  ds_read_b64_tr_b16 v[182:183], v3 offset:3328
  s_waitcnt lgkmcnt(0)
  s_mov_b32 m0, 61440
  s_add_u32 s27, s32, 3932160
  buffer_load_dwordx4 v8, s[16:19], s27 offen  lds
  s_mov_b32 m0, 62464
  s_add_u32 s27, s32, 3932160
  buffer_load_dwordx4 v9, s[16:19], s27 offen  lds
  s_mov_b32 m0, 63488
  s_add_u32 s27, s32, 3932160
  buffer_load_dwordx4 v10, s[16:19], s27 offen  lds
  s_mov_b32 m0, 64512
  s_add_u32 s27, s32, 3932160
  buffer_load_dwordx4 v11, s[16:19], s27 offen  lds
  s_mov_b32 m0, 65536
  s_add_u32 s27, s32, 3932160
  buffer_load_dwordx4 v12, s[16:19], s27 offen  lds
  s_mov_b32 m0, 66560
  s_add_u32 s27, s32, 3932160
  buffer_load_dwordx4 v13, s[16:19], s27 offen  lds
  s_waitcnt vmcnt(12)
  ds_read_b64_tr_b16 v[184:185], v4 offset:0
  ds_read_b64_tr_b16 v[186:187], v4 offset:192
  ds_read_b64_tr_b16 v[188:189], v4 offset:3072
  ds_read_b64_tr_b16 v[190:191], v4 offset:3264
  ds_read_b64_tr_b16 v[192:193], v4 offset:32
  ds_read_b64_tr_b16 v[194:195], v4 offset:224
  ds_read_b64_tr_b16 v[196:197], v4 offset:3104
  ds_read_b64_tr_b16 v[198:199], v4 offset:3296
  ds_read_b64_tr_b16 v[200:201], v4 offset:64
  ds_read_b64_tr_b16 v[202:203], v4 offset:256
  ds_read_b64_tr_b16 v[204:205], v4 offset:3136
  ds_read_b64_tr_b16 v[206:207], v4 offset:3328
  s_waitcnt lgkmcnt(0)
  s_mov_b32 m0, 135168
  s_add_u32 s27, s32, 4718592
  buffer_load_dwordx4 v8, s[16:19], s27 offen  lds
  s_mov_b32 m0, 136192
  s_add_u32 s27, s32, 4718592
  buffer_load_dwordx4 v9, s[16:19], s27 offen  lds
  s_mov_b32 m0, 137216
  s_add_u32 s27, s32, 4718592
  buffer_load_dwordx4 v10, s[16:19], s27 offen  lds
  s_mov_b32 m0, 138240
  s_add_u32 s27, s32, 4718592
  buffer_load_dwordx4 v11, s[16:19], s27 offen  lds
  s_mov_b32 m0, 139264
  s_add_u32 s27, s32, 4718592
  buffer_load_dwordx4 v12, s[16:19], s27 offen  lds
  s_mov_b32 m0, 140288
  s_add_u32 s27, s32, 4718592
  buffer_load_dwordx4 v13, s[16:19], s27 offen  lds
  s_waitcnt vmcnt(12)
  ds_read_b64_tr_b16 v[208:209], v3 offset:6144
  ds_read_b64_tr_b16 v[210:211], v3 offset:6336
  ds_read_b64_tr_b16 v[212:213], v3 offset:9216
  ds_read_b64_tr_b16 v[214:215], v3 offset:9408
  ds_read_b64_tr_b16 v[216:217], v3 offset:6176
  ds_read_b64_tr_b16 v[218:219], v3 offset:6368
  ds_read_b64_tr_b16 v[220:221], v3 offset:9248
  ds_read_b64_tr_b16 v[222:223], v3 offset:9440
  ds_read_b64_tr_b16 v[224:225], v3 offset:6208
  ds_read_b64_tr_b16 v[226:227], v3 offset:6400
  ds_read_b64_tr_b16 v[228:229], v3 offset:9280
  ds_read_b64_tr_b16 v[230:231], v3 offset:9472
  s_waitcnt lgkmcnt(0)
  s_mov_b32 m0, 67584
  s_add_u32 s27, s32, 5505024
  buffer_load_dwordx4 v8, s[16:19], s27 offen  lds
  s_mov_b32 m0, 68608
  s_add_u32 s27, s32, 5505024
  buffer_load_dwordx4 v9, s[16:19], s27 offen  lds
  s_mov_b32 m0, 69632
  s_add_u32 s27, s32, 5505024
  buffer_load_dwordx4 v10, s[16:19], s27 offen  lds
  s_mov_b32 m0, 70656
  s_add_u32 s27, s32, 5505024
  buffer_load_dwordx4 v11, s[16:19], s27 offen  lds
  s_mov_b32 m0, 71680
  s_add_u32 s27, s32, 5505024
  buffer_load_dwordx4 v12, s[16:19], s27 offen  lds
  s_mov_b32 m0, 72704
  s_add_u32 s27, s32, 5505024
  buffer_load_dwordx4 v13, s[16:19], s27 offen  lds
  s_waitcnt vmcnt(12)
  ds_read_b64_tr_b16 v[232:233], v3 offset:0
  ds_read_b64_tr_b16 v[234:235], v3 offset:192
  ds_read_b64_tr_b16 v[236:237], v3 offset:3072
  ds_read_b64_tr_b16 v[238:239], v3 offset:3264
  ds_read_b64_tr_b16 v[240:241], v3 offset:32
  ds_read_b64_tr_b16 v[242:243], v3 offset:224
  ds_read_b64_tr_b16 v[244:245], v3 offset:3104
  ds_read_b64_tr_b16 v[246:247], v3 offset:3296
  ds_read_b64_tr_b16 v[248:249], v3 offset:64
  ds_read_b64_tr_b16 v[250:251], v3 offset:256
  ds_read_b64_tr_b16 v[252:253], v3 offset:3136
  ds_read_b64_tr_b16 v[254:255], v3 offset:3328
  s_waitcnt lgkmcnt(0)
  s_mov_b32 m0, 61440
  s_add_u32 s27, s32, 6291456
  buffer_load_dwordx4 v8, s[16:19], s27 offen  lds
  s_mov_b32 m0, 62464
  s_add_u32 s27, s32, 6291456
  buffer_load_dwordx4 v9, s[16:19], s27 offen  lds
  s_mov_b32 m0, 63488
  s_add_u32 s27, s32, 6291456
  buffer_load_dwordx4 v10, s[16:19], s27 offen  lds
  s_mov_b32 m0, 64512
  s_add_u32 s27, s32, 6291456
  buffer_load_dwordx4 v11, s[16:19], s27 offen  lds
  s_mov_b32 m0, 65536
  s_add_u32 s27, s32, 6291456
  buffer_load_dwordx4 v12, s[16:19], s27 offen  lds
  s_mov_b32 m0, 66560
  s_add_u32 s27, s32, 6291456
  buffer_load_dwordx4 v13, s[16:19], s27 offen  lds
  s_waitcnt vmcnt(12)
  ds_read_b64_tr_b16 a[120:121], v4 offset:0
  ds_read_b64_tr_b16 a[122:123], v4 offset:192
  ds_read_b64_tr_b16 a[124:125], v4 offset:3072
  ds_read_b64_tr_b16 a[126:127], v4 offset:3264
  ds_read_b64_tr_b16 a[128:129], v4 offset:32
  ds_read_b64_tr_b16 a[130:131], v4 offset:224
  ds_read_b64_tr_b16 a[132:133], v4 offset:3104
  ds_read_b64_tr_b16 a[134:135], v4 offset:3296
  ds_read_b64_tr_b16 a[136:137], v4 offset:64
  ds_read_b64_tr_b16 a[138:139], v4 offset:256
  ds_read_b64_tr_b16 a[140:141], v4 offset:3136
  ds_read_b64_tr_b16 a[142:143], v4 offset:3328
  s_waitcnt lgkmcnt(0)
  s_mov_b32 m0, 135168
  s_add_u32 s27, s32, 7077888
  buffer_load_dwordx4 v8, s[16:19], s27 offen  lds
  s_mov_b32 m0, 136192
  s_add_u32 s27, s32, 7077888
  buffer_load_dwordx4 v9, s[16:19], s27 offen  lds
  s_mov_b32 m0, 137216
  s_add_u32 s27, s32, 7077888
  buffer_load_dwordx4 v10, s[16:19], s27 offen  lds
  s_mov_b32 m0, 138240
  s_add_u32 s27, s32, 7077888
  buffer_load_dwordx4 v11, s[16:19], s27 offen  lds
  s_mov_b32 m0, 139264
  s_add_u32 s27, s32, 7077888
  buffer_load_dwordx4 v12, s[16:19], s27 offen  lds
  s_mov_b32 m0, 140288
  s_add_u32 s27, s32, 7077888
  buffer_load_dwordx4 v13, s[16:19], s27 offen  lds
  s_waitcnt vmcnt(12)
  ds_read_b64_tr_b16 a[144:145], v3 offset:6144
  ds_read_b64_tr_b16 a[146:147], v3 offset:6336
  ds_read_b64_tr_b16 a[148:149], v3 offset:9216
  ds_read_b64_tr_b16 a[150:151], v3 offset:9408
  ds_read_b64_tr_b16 a[152:153], v3 offset:6176
  ds_read_b64_tr_b16 a[154:155], v3 offset:6368
  ds_read_b64_tr_b16 a[156:157], v3 offset:9248
  ds_read_b64_tr_b16 a[158:159], v3 offset:9440
  ds_read_b64_tr_b16 a[160:161], v3 offset:6208
  ds_read_b64_tr_b16 a[162:163], v3 offset:6400
  ds_read_b64_tr_b16 a[164:165], v3 offset:9280
  ds_read_b64_tr_b16 a[166:167], v3 offset:9472
  s_waitcnt lgkmcnt(0)
  s_mov_b32 m0, 67584
  s_add_u32 s27, s32, 0
  buffer_load_dwordx4 v8, s[12:15], s27 offen  lds
  s_mov_b32 m0, 68608
  s_add_u32 s27, s32, 0
  buffer_load_dwordx4 v9, s[12:15], s27 offen  lds
  s_mov_b32 m0, 69632
  s_add_u32 s27, s32, 0
  buffer_load_dwordx4 v10, s[12:15], s27 offen  lds
  s_mov_b32 m0, 70656
  s_add_u32 s27, s32, 0
  buffer_load_dwordx4 v11, s[12:15], s27 offen  lds
  s_mov_b32 m0, 71680
  s_add_u32 s27, s32, 0
  buffer_load_dwordx4 v12, s[12:15], s27 offen  lds
  s_mov_b32 m0, 72704
  s_add_u32 s27, s32, 0
  buffer_load_dwordx4 v13, s[12:15], s27 offen  lds
  s_waitcnt vmcnt(12)
  ds_read_b64_tr_b16 a[168:169], v3 offset:0
  ds_read_b64_tr_b16 a[170:171], v3 offset:192
  ds_read_b64_tr_b16 a[172:173], v3 offset:3072
  ds_read_b64_tr_b16 a[174:175], v3 offset:3264
  ds_read_b64_tr_b16 a[176:177], v3 offset:32
  ds_read_b64_tr_b16 a[178:179], v3 offset:224
  ds_read_b64_tr_b16 a[180:181], v3 offset:3104
  ds_read_b64_tr_b16 a[182:183], v3 offset:3296
  ds_read_b64_tr_b16 a[184:185], v3 offset:64
  ds_read_b64_tr_b16 a[186:187], v3 offset:256
  ds_read_b64_tr_b16 a[188:189], v3 offset:3136
  ds_read_b64_tr_b16 a[190:191], v3 offset:3328
  s_waitcnt lgkmcnt(0)
  s_mov_b32 m0, 73728
  s_add_u32 s27, s32, 786432
  buffer_load_dwordx4 v8, s[12:15], s27 offen  lds
  s_mov_b32 m0, 74752
  s_add_u32 s27, s32, 786432
  buffer_load_dwordx4 v9, s[12:15], s27 offen  lds
  s_mov_b32 m0, 75776
  s_add_u32 s27, s32, 786432
  buffer_load_dwordx4 v10, s[12:15], s27 offen  lds
  s_mov_b32 m0, 76800
  s_add_u32 s27, s32, 786432
  buffer_load_dwordx4 v11, s[12:15], s27 offen  lds
  s_mov_b32 m0, 77824
  s_add_u32 s27, s32, 786432
  buffer_load_dwordx4 v12, s[12:15], s27 offen  lds
  s_mov_b32 m0, 78848
  s_add_u32 s27, s32, 786432
  buffer_load_dwordx4 v13, s[12:15], s27 offen  lds
  s_waitcnt vmcnt(12)
  ds_read_b64_tr_b16 a[192:193], v4 offset:0
  ds_read_b64_tr_b16 a[194:195], v4 offset:192
  ds_read_b64_tr_b16 a[196:197], v4 offset:3072
  ds_read_b64_tr_b16 a[198:199], v4 offset:3264
  ds_read_b64_tr_b16 a[200:201], v4 offset:32
  ds_read_b64_tr_b16 a[202:203], v4 offset:224
  ds_read_b64_tr_b16 a[204:205], v4 offset:3104
  ds_read_b64_tr_b16 a[206:207], v4 offset:3296
  ds_read_b64_tr_b16 a[208:209], v4 offset:64
  ds_read_b64_tr_b16 a[210:211], v4 offset:256
  ds_read_b64_tr_b16 a[212:213], v4 offset:3136
  ds_read_b64_tr_b16 a[214:215], v4 offset:3328
  s_waitcnt lgkmcnt(0)
  s_mov_b32 m0, 135168
  s_add_u32 s27, s32, 1572864
  buffer_load_dwordx4 v8, s[12:15], s27 offen  lds
  s_mov_b32 m0, 136192
  s_add_u32 s27, s32, 1572864
  buffer_load_dwordx4 v9, s[12:15], s27 offen  lds
  s_mov_b32 m0, 137216
  s_add_u32 s27, s32, 1572864
  buffer_load_dwordx4 v10, s[12:15], s27 offen  lds
  s_mov_b32 m0, 138240
  s_add_u32 s27, s32, 1572864
  buffer_load_dwordx4 v11, s[12:15], s27 offen  lds
  s_mov_b32 m0, 139264
  s_add_u32 s27, s32, 1572864
  buffer_load_dwordx4 v12, s[12:15], s27 offen  lds
  s_mov_b32 m0, 140288
  s_add_u32 s27, s32, 1572864
  buffer_load_dwordx4 v13, s[12:15], s27 offen  lds
  s_waitcnt vmcnt(12)
  ds_read_b64_tr_b16 a[48:49], v3 offset:6144
  ds_read_b64_tr_b16 a[50:51], v3 offset:6336
  ds_read_b64_tr_b16 a[52:53], v3 offset:9216
  ds_read_b64_tr_b16 a[54:55], v3 offset:9408
  ds_read_b64_tr_b16 a[56:57], v3 offset:6176
  ds_read_b64_tr_b16 a[58:59], v3 offset:6368
  ds_read_b64_tr_b16 a[60:61], v3 offset:9248
  ds_read_b64_tr_b16 a[62:63], v3 offset:9440
  ds_read_b64_tr_b16 a[64:65], v3 offset:6208
  ds_read_b64_tr_b16 a[66:67], v3 offset:6400
  ds_read_b64_tr_b16 a[68:69], v3 offset:9280
  ds_read_b64_tr_b16 a[70:71], v3 offset:9472
  s_waitcnt lgkmcnt(0)
  s_mov_b32 m0, 79872
  s_add_u32 s27, s32, 2359296
  buffer_load_dwordx4 v8, s[12:15], s27 offen  lds
  s_mov_b32 m0, 80896
  s_add_u32 s27, s32, 2359296
  buffer_load_dwordx4 v9, s[12:15], s27 offen  lds
  s_mov_b32 m0, 81920
  s_add_u32 s27, s32, 2359296
  buffer_load_dwordx4 v10, s[12:15], s27 offen  lds
  s_mov_b32 m0, 82944
  s_add_u32 s27, s32, 2359296
  buffer_load_dwordx4 v11, s[12:15], s27 offen  lds
  s_mov_b32 m0, 83968
  s_add_u32 s27, s32, 2359296
  buffer_load_dwordx4 v12, s[12:15], s27 offen  lds
  s_mov_b32 m0, 84992
  s_add_u32 s27, s32, 2359296
  buffer_load_dwordx4 v13, s[12:15], s27 offen  lds
  s_waitcnt vmcnt(12)
  ds_read_b64_tr_b16 v[32:33], v3 offset:12288
  ds_read_b64_tr_b16 v[34:35], v3 offset:12480
  ds_read_b64_tr_b16 v[36:37], v3 offset:15360
  ds_read_b64_tr_b16 v[38:39], v3 offset:15552
  ds_read_b64_tr_b16 v[40:41], v3 offset:12320
  ds_read_b64_tr_b16 v[42:43], v3 offset:12512
  ds_read_b64_tr_b16 v[44:45], v3 offset:15392
  ds_read_b64_tr_b16 v[46:47], v3 offset:15584
  ds_read_b64_tr_b16 v[48:49], v3 offset:12352
  ds_read_b64_tr_b16 v[50:51], v3 offset:12544
  ds_read_b64_tr_b16 v[52:53], v3 offset:15424
  ds_read_b64_tr_b16 v[54:55], v3 offset:15616
  s_waitcnt lgkmcnt(0)
  ds_write_b128 v7, v[32:35] offset:12288
  ds_write_b128 v7, v[36:39] offset:13312
  ds_write_b128 v7, v[40:43] offset:14336
  ds_write_b128 v7, v[44:47] offset:15360
  ds_write_b128 v7, v[48:51] offset:16384
  ds_write_b128 v7, v[52:55] offset:17408
  s_waitcnt lgkmcnt(0)
  s_mov_b32 m0, 67584
  s_add_u32 s27, s32, 3145728
  buffer_load_dwordx4 v8, s[12:15], s27 offen  lds
  s_mov_b32 m0, 68608
  s_add_u32 s27, s32, 3145728
  buffer_load_dwordx4 v9, s[12:15], s27 offen  lds
  s_mov_b32 m0, 69632
  s_add_u32 s27, s32, 3145728
  buffer_load_dwordx4 v10, s[12:15], s27 offen  lds
  s_mov_b32 m0, 70656
  s_add_u32 s27, s32, 3145728
  buffer_load_dwordx4 v11, s[12:15], s27 offen  lds
  s_mov_b32 m0, 71680
  s_add_u32 s27, s32, 3145728
  buffer_load_dwordx4 v12, s[12:15], s27 offen  lds
  s_mov_b32 m0, 72704
  s_add_u32 s27, s32, 3145728
  buffer_load_dwordx4 v13, s[12:15], s27 offen  lds
  s_waitcnt vmcnt(12)
  ds_read_b64_tr_b16 a[72:73], v4 offset:0
  ds_read_b64_tr_b16 a[74:75], v4 offset:192
  ds_read_b64_tr_b16 a[76:77], v4 offset:3072
  ds_read_b64_tr_b16 a[78:79], v4 offset:3264
  ds_read_b64_tr_b16 a[80:81], v4 offset:32
  ds_read_b64_tr_b16 a[82:83], v4 offset:224
  ds_read_b64_tr_b16 a[84:85], v4 offset:3104
  ds_read_b64_tr_b16 a[86:87], v4 offset:3296
  ds_read_b64_tr_b16 a[88:89], v4 offset:64
  ds_read_b64_tr_b16 a[90:91], v4 offset:256
  ds_read_b64_tr_b16 a[92:93], v4 offset:3136
  ds_read_b64_tr_b16 a[94:95], v4 offset:3328
  s_waitcnt lgkmcnt(0)
  s_mov_b32 m0, 86016
  s_add_u32 s27, s32, 3932160
  buffer_load_dwordx4 v8, s[12:15], s27 offen  lds
  s_mov_b32 m0, 87040
  s_add_u32 s27, s32, 3932160
  buffer_load_dwordx4 v9, s[12:15], s27 offen  lds
  s_mov_b32 m0, 88064
  s_add_u32 s27, s32, 3932160
  buffer_load_dwordx4 v10, s[12:15], s27 offen  lds
  s_mov_b32 m0, 89088
  s_add_u32 s27, s32, 3932160
  buffer_load_dwordx4 v11, s[12:15], s27 offen  lds
  s_mov_b32 m0, 90112
  s_add_u32 s27, s32, 3932160
  buffer_load_dwordx4 v12, s[12:15], s27 offen  lds
  s_mov_b32 m0, 91136
  s_add_u32 s27, s32, 3932160
  buffer_load_dwordx4 v13, s[12:15], s27 offen  lds
  s_waitcnt vmcnt(12)
  ds_read_b64_tr_b16 v[32:33], v3 offset:18432
  ds_read_b64_tr_b16 v[34:35], v3 offset:18624
  ds_read_b64_tr_b16 v[36:37], v3 offset:21504
  ds_read_b64_tr_b16 v[38:39], v3 offset:21696
  ds_read_b64_tr_b16 v[40:41], v3 offset:18464
  ds_read_b64_tr_b16 v[42:43], v3 offset:18656
  ds_read_b64_tr_b16 v[44:45], v3 offset:21536
  ds_read_b64_tr_b16 v[46:47], v3 offset:21728
  ds_read_b64_tr_b16 v[48:49], v3 offset:18496
  ds_read_b64_tr_b16 v[50:51], v3 offset:18688
  ds_read_b64_tr_b16 v[52:53], v3 offset:21568
  ds_read_b64_tr_b16 v[54:55], v3 offset:21760
  s_waitcnt lgkmcnt(0)
  ds_write_b128 v7, v[32:35] offset:18432
  ds_write_b128 v7, v[36:39] offset:19456
  ds_write_b128 v7, v[40:43] offset:20480
  ds_write_b128 v7, v[44:47] offset:21504
  ds_write_b128 v7, v[48:51] offset:22528
  ds_write_b128 v7, v[52:55] offset:23552
  s_waitcnt lgkmcnt(0)
  s_mov_b32 m0, 135168
  s_add_u32 s27, s32, 4718592
  buffer_load_dwordx4 v8, s[12:15], s27 offen  lds
  s_mov_b32 m0, 136192
  s_add_u32 s27, s32, 4718592
  buffer_load_dwordx4 v9, s[12:15], s27 offen  lds
  s_mov_b32 m0, 137216
  s_add_u32 s27, s32, 4718592
  buffer_load_dwordx4 v10, s[12:15], s27 offen  lds
  s_mov_b32 m0, 138240
  s_add_u32 s27, s32, 4718592
  buffer_load_dwordx4 v11, s[12:15], s27 offen  lds
  s_mov_b32 m0, 139264
  s_add_u32 s27, s32, 4718592
  buffer_load_dwordx4 v12, s[12:15], s27 offen  lds
  s_mov_b32 m0, 140288
  s_add_u32 s27, s32, 4718592
  buffer_load_dwordx4 v13, s[12:15], s27 offen  lds
  s_waitcnt vmcnt(12)
  ds_read_b64_tr_b16 a[96:97], v3 offset:6144
  ds_read_b64_tr_b16 a[98:99], v3 offset:6336
  ds_read_b64_tr_b16 a[100:101], v3 offset:9216
  ds_read_b64_tr_b16 a[102:103], v3 offset:9408
  ds_read_b64_tr_b16 a[104:105], v3 offset:6176
  ds_read_b64_tr_b16 a[106:107], v3 offset:6368
  ds_read_b64_tr_b16 a[108:109], v3 offset:9248
  ds_read_b64_tr_b16 a[110:111], v3 offset:9440
  ds_read_b64_tr_b16 a[112:113], v3 offset:6208
  ds_read_b64_tr_b16 a[114:115], v3 offset:6400
  ds_read_b64_tr_b16 a[116:117], v3 offset:9280
  ds_read_b64_tr_b16 a[118:119], v3 offset:9472
  s_waitcnt lgkmcnt(0)
  s_mov_b32 m0, 61440
  s_add_u32 s27, s32, 5505024
  buffer_load_dwordx4 v8, s[12:15], s27 offen  lds
  s_mov_b32 m0, 62464
  s_add_u32 s27, s32, 5505024
  buffer_load_dwordx4 v9, s[12:15], s27 offen  lds
  s_mov_b32 m0, 63488
  s_add_u32 s27, s32, 5505024
  buffer_load_dwordx4 v10, s[12:15], s27 offen  lds
  s_mov_b32 m0, 64512
  s_add_u32 s27, s32, 5505024
  buffer_load_dwordx4 v11, s[12:15], s27 offen  lds
  s_mov_b32 m0, 65536
  s_add_u32 s27, s32, 5505024
  buffer_load_dwordx4 v12, s[12:15], s27 offen  lds
  s_mov_b32 m0, 66560
  s_add_u32 s27, s32, 5505024
  buffer_load_dwordx4 v13, s[12:15], s27 offen  lds
  s_waitcnt vmcnt(12)
  ds_read_b64_tr_b16 v[32:33], v3 offset:24576
  ds_read_b64_tr_b16 v[34:35], v3 offset:24768
  ds_read_b64_tr_b16 v[36:37], v3 offset:27648
  ds_read_b64_tr_b16 v[38:39], v3 offset:27840
  ds_read_b64_tr_b16 v[40:41], v3 offset:24608
  ds_read_b64_tr_b16 v[42:43], v3 offset:24800
  ds_read_b64_tr_b16 v[44:45], v3 offset:27680
  ds_read_b64_tr_b16 v[46:47], v3 offset:27872
  ds_read_b64_tr_b16 v[48:49], v3 offset:24640
  ds_read_b64_tr_b16 v[50:51], v3 offset:24832
  ds_read_b64_tr_b16 v[52:53], v3 offset:27712
  ds_read_b64_tr_b16 v[54:55], v3 offset:27904
  s_waitcnt lgkmcnt(0)
  ds_write_b128 v7, v[32:35] offset:24576
  ds_write_b128 v7, v[36:39] offset:25600
  ds_write_b128 v7, v[40:43] offset:26624
  ds_write_b128 v7, v[44:47] offset:27648
  ds_write_b128 v7, v[48:51] offset:28672
  ds_write_b128 v7, v[52:55] offset:29696
  s_waitcnt lgkmcnt(0)
  s_waitcnt vmcnt(6)
  ds_read_b64_tr_b16 a[0:1], v4 offset:0
  ds_read_b64_tr_b16 a[2:3], v4 offset:192
  ds_read_b64_tr_b16 a[4:5], v4 offset:3072
  ds_read_b64_tr_b16 a[6:7], v4 offset:3264
  ds_read_b64_tr_b16 a[8:9], v4 offset:32
  ds_read_b64_tr_b16 a[10:11], v4 offset:224
  ds_read_b64_tr_b16 a[12:13], v4 offset:3104
  ds_read_b64_tr_b16 a[14:15], v4 offset:3296
  ds_read_b64_tr_b16 a[16:17], v4 offset:64
  ds_read_b64_tr_b16 a[18:19], v4 offset:256
  ds_read_b64_tr_b16 a[20:21], v4 offset:3136
  ds_read_b64_tr_b16 a[22:23], v4 offset:3328
  s_waitcnt lgkmcnt(0)
  s_mov_b32 m0, 135168
  s_add_u32 s27, s32, 6291456
  buffer_load_dwordx4 v8, s[12:15], s27 offen  lds
  s_mov_b32 m0, 136192
  s_add_u32 s27, s32, 6291456
  buffer_load_dwordx4 v9, s[12:15], s27 offen  lds
  s_mov_b32 m0, 137216
  s_add_u32 s27, s32, 6291456
  buffer_load_dwordx4 v10, s[12:15], s27 offen  lds
  s_mov_b32 m0, 138240
  s_add_u32 s27, s32, 6291456
  buffer_load_dwordx4 v11, s[12:15], s27 offen  lds
  s_mov_b32 m0, 139264
  s_add_u32 s27, s32, 6291456
  buffer_load_dwordx4 v12, s[12:15], s27 offen  lds
  s_mov_b32 m0, 140288
  s_add_u32 s27, s32, 6291456
  buffer_load_dwordx4 v13, s[12:15], s27 offen  lds
  s_mov_b32 m0, 67584
  s_add_u32 s27, s32, 7077888
  buffer_load_dwordx4 v8, s[12:15], s27 offen  lds
  s_mov_b32 m0, 68608
  s_add_u32 s27, s32, 7077888
  buffer_load_dwordx4 v9, s[12:15], s27 offen  lds
  s_mov_b32 m0, 69632
  s_add_u32 s27, s32, 7077888
  buffer_load_dwordx4 v10, s[12:15], s27 offen  lds
  s_mov_b32 m0, 70656
  s_add_u32 s27, s32, 7077888
  buffer_load_dwordx4 v11, s[12:15], s27 offen  lds
  s_mov_b32 m0, 71680
  s_add_u32 s27, s32, 7077888
  buffer_load_dwordx4 v12, s[12:15], s27 offen  lds
  s_mov_b32 m0, 72704
  s_add_u32 s27, s32, 7077888
  buffer_load_dwordx4 v13, s[12:15], s27 offen  lds
  buffer_load_dwordx4 v[64:67], off, s[68:71], 0 offset:128 sc1
  buffer_load_dwordx2 v[68:69], off, s[68:71], 0 offset:64 sc1
  s_waitcnt vmcnt(14)
  ds_read_b64_tr_b16 v[32:33], v3 offset:0
  ds_read_b64_tr_b16 v[34:35], v3 offset:192
  ds_read_b64_tr_b16 v[36:37], v3 offset:3072
  ds_read_b64_tr_b16 v[38:39], v3 offset:3264
  ds_read_b64_tr_b16 v[40:41], v3 offset:32
  ds_read_b64_tr_b16 v[42:43], v3 offset:224
  ds_read_b64_tr_b16 v[44:45], v3 offset:3104
  ds_read_b64_tr_b16 v[46:47], v3 offset:3296
  ds_read_b64_tr_b16 v[48:49], v3 offset:64
  ds_read_b64_tr_b16 v[50:51], v3 offset:256
  ds_read_b64_tr_b16 v[52:53], v3 offset:3136
  ds_read_b64_tr_b16 v[54:55], v3 offset:3328
  s_waitcnt lgkmcnt(0)
  ds_write_b128 v7, v[32:35] offset:0
  ds_write_b128 v7, v[36:39] offset:1024
  ds_write_b128 v7, v[40:43] offset:2048
  ds_write_b128 v7, v[44:47] offset:3072
  ds_write_b128 v7, v[48:51] offset:4096
  ds_write_b128 v7, v[52:55] offset:5120
  s_waitcnt lgkmcnt(0)
  s_waitcnt vmcnt(8)
  ds_read_b64_tr_b16 a[24:25], v4 offset:0
  ds_read_b64_tr_b16 a[26:27], v4 offset:192
  ds_read_b64_tr_b16 a[28:29], v4 offset:3072
  ds_read_b64_tr_b16 a[30:31], v4 offset:3264
  ds_read_b64_tr_b16 a[32:33], v4 offset:32
  ds_read_b64_tr_b16 a[34:35], v4 offset:224
  ds_read_b64_tr_b16 a[36:37], v4 offset:3104
  ds_read_b64_tr_b16 a[38:39], v4 offset:3296
  ds_read_b64_tr_b16 a[40:41], v4 offset:64
  ds_read_b64_tr_b16 a[42:43], v4 offset:256
  ds_read_b64_tr_b16 a[44:45], v4 offset:3136
  ds_read_b64_tr_b16 a[46:47], v4 offset:3328
  s_waitcnt lgkmcnt(0)
  s_waitcnt vmcnt(2)
  ds_read_b64_tr_b16 v[32:33], v3 offset:6144
  ds_read_b64_tr_b16 v[34:35], v3 offset:6336
  ds_read_b64_tr_b16 v[36:37], v3 offset:9216
  ds_read_b64_tr_b16 v[38:39], v3 offset:9408
  ds_read_b64_tr_b16 v[40:41], v3 offset:6176
  ds_read_b64_tr_b16 v[42:43], v3 offset:6368
  ds_read_b64_tr_b16 v[44:45], v3 offset:9248
  ds_read_b64_tr_b16 v[46:47], v3 offset:9440
  ds_read_b64_tr_b16 v[48:49], v3 offset:6208
  ds_read_b64_tr_b16 v[50:51], v3 offset:6400
  ds_read_b64_tr_b16 v[52:53], v3 offset:9280
  ds_read_b64_tr_b16 v[54:55], v3 offset:9472
  s_waitcnt lgkmcnt(0)
  ds_write_b128 v7, v[32:35] offset:6144
  ds_write_b128 v7, v[36:39] offset:7168
  ds_write_b128 v7, v[40:43] offset:8192
  ds_write_b128 v7, v[44:47] offset:9216
  ds_write_b128 v7, v[48:51] offset:10240
  ds_write_b128 v7, v[52:55] offset:11264
  s_waitcnt lgkmcnt(0)
  s_branch CQ_ldd
CQ_ld3:
  s_mov_b32 m0, 141312
  s_add_u32 s27, s32, 0
  buffer_load_dwordx4 v8, s[16:19], s27 offen  lds
  s_mov_b32 m0, 142336
  s_add_u32 s27, s32, 0
  buffer_load_dwordx4 v9, s[16:19], s27 offen  lds
  s_mov_b32 m0, 143360
  s_add_u32 s27, s32, 0
  buffer_load_dwordx4 v10, s[16:19], s27 offen  lds
  s_mov_b32 m0, 144384
  s_add_u32 s27, s32, 0
  buffer_load_dwordx4 v11, s[16:19], s27 offen  lds
  s_mov_b32 m0, 145408
  s_add_u32 s27, s32, 0
  buffer_load_dwordx4 v12, s[16:19], s27 offen  lds
  s_mov_b32 m0, 146432
  s_add_u32 s27, s32, 0
  buffer_load_dwordx4 v13, s[16:19], s27 offen  lds
  s_mov_b32 m0, 92160
  s_add_u32 s27, s32, 786432
  buffer_load_dwordx4 v8, s[16:19], s27 offen  lds
  s_mov_b32 m0, 93184
  s_add_u32 s27, s32, 786432
  buffer_load_dwordx4 v9, s[16:19], s27 offen  lds
  s_mov_b32 m0, 94208
  s_add_u32 s27, s32, 786432
  buffer_load_dwordx4 v10, s[16:19], s27 offen  lds
  s_mov_b32 m0, 95232
  s_add_u32 s27, s32, 786432
  buffer_load_dwordx4 v11, s[16:19], s27 offen  lds
  s_mov_b32 m0, 96256
  s_add_u32 s27, s32, 786432
  buffer_load_dwordx4 v12, s[16:19], s27 offen  lds
  s_mov_b32 m0, 97280
  s_add_u32 s27, s32, 786432
  buffer_load_dwordx4 v13, s[16:19], s27 offen  lds
  s_mov_b32 m0, 116736
  s_add_u32 s27, s32, 1572864
  buffer_load_dwordx4 v8, s[16:19], s27 offen  lds
  s_mov_b32 m0, 117760
  s_add_u32 s27, s32, 1572864
  buffer_load_dwordx4 v9, s[16:19], s27 offen  lds
  s_mov_b32 m0, 118784
  s_add_u32 s27, s32, 1572864
  buffer_load_dwordx4 v10, s[16:19], s27 offen  lds
  s_mov_b32 m0, 119808
  s_add_u32 s27, s32, 1572864
  buffer_load_dwordx4 v11, s[16:19], s27 offen  lds
  s_mov_b32 m0, 120832
  s_add_u32 s27, s32, 1572864
  buffer_load_dwordx4 v12, s[16:19], s27 offen  lds
  s_mov_b32 m0, 121856
  s_add_u32 s27, s32, 1572864
  buffer_load_dwordx4 v13, s[16:19], s27 offen  lds
  s_waitcnt vmcnt(12)
  ds_read_b64_tr_b16 a[192:193], v4 offset:0
  ds_read_b64_tr_b16 a[194:195], v4 offset:192
  ds_read_b64_tr_b16 a[196:197], v4 offset:3072
  ds_read_b64_tr_b16 a[198:199], v4 offset:3264
  ds_read_b64_tr_b16 a[200:201], v4 offset:32
  ds_read_b64_tr_b16 a[202:203], v4 offset:224
  ds_read_b64_tr_b16 a[204:205], v4 offset:3104
  ds_read_b64_tr_b16 a[206:207], v4 offset:3296
  ds_read_b64_tr_b16 a[208:209], v4 offset:64
  ds_read_b64_tr_b16 a[210:211], v4 offset:256
  ds_read_b64_tr_b16 a[212:213], v4 offset:3136
  ds_read_b64_tr_b16 a[214:215], v4 offset:3328
  s_waitcnt lgkmcnt(0)
  s_mov_b32 m0, 141312
  s_add_u32 s27, s32, 2359296
  buffer_load_dwordx4 v8, s[16:19], s27 offen  lds
  s_mov_b32 m0, 142336
  s_add_u32 s27, s32, 2359296
  buffer_load_dwordx4 v9, s[16:19], s27 offen  lds
  s_mov_b32 m0, 143360
  s_add_u32 s27, s32, 2359296
  buffer_load_dwordx4 v10, s[16:19], s27 offen  lds
  s_mov_b32 m0, 144384
  s_add_u32 s27, s32, 2359296
  buffer_load_dwordx4 v11, s[16:19], s27 offen  lds
  s_mov_b32 m0, 145408
  s_add_u32 s27, s32, 2359296
  buffer_load_dwordx4 v12, s[16:19], s27 offen  lds
  s_mov_b32 m0, 146432
  s_add_u32 s27, s32, 2359296
  buffer_load_dwordx4 v13, s[16:19], s27 offen  lds
  s_waitcnt vmcnt(12)
  ds_read_b64_tr_b16 a[216:217], v3 offset:0
  ds_read_b64_tr_b16 a[218:219], v3 offset:192
  ds_read_b64_tr_b16 a[220:221], v3 offset:3072
  ds_read_b64_tr_b16 a[222:223], v3 offset:3264
  ds_read_b64_tr_b16 a[224:225], v3 offset:32
  ds_read_b64_tr_b16 a[226:227], v3 offset:224
  ds_read_b64_tr_b16 a[228:229], v3 offset:3104
  ds_read_b64_tr_b16 a[230:231], v3 offset:3296
  ds_read_b64_tr_b16 a[232:233], v3 offset:64
  ds_read_b64_tr_b16 a[234:235], v3 offset:256
  ds_read_b64_tr_b16 a[236:237], v3 offset:3136
  ds_read_b64_tr_b16 a[238:239], v3 offset:3328
  s_waitcnt lgkmcnt(0)
  s_mov_b32 m0, 92160
  s_add_u32 s27, s32, 3145728
  buffer_load_dwordx4 v8, s[16:19], s27 offen  lds
  s_mov_b32 m0, 93184
  s_add_u32 s27, s32, 3145728
  buffer_load_dwordx4 v9, s[16:19], s27 offen  lds
  s_mov_b32 m0, 94208
  s_add_u32 s27, s32, 3145728
  buffer_load_dwordx4 v10, s[16:19], s27 offen  lds
  s_mov_b32 m0, 95232
  s_add_u32 s27, s32, 3145728
  buffer_load_dwordx4 v11, s[16:19], s27 offen  lds
  s_mov_b32 m0, 96256
  s_add_u32 s27, s32, 3145728
  buffer_load_dwordx4 v12, s[16:19], s27 offen  lds
  s_mov_b32 m0, 97280
  s_add_u32 s27, s32, 3145728
  buffer_load_dwordx4 v13, s[16:19], s27 offen  lds
  s_waitcnt vmcnt(12)
  ds_read_b64_tr_b16 a[240:241], v3 offset:24576
  ds_read_b64_tr_b16 a[242:243], v3 offset:24768
  ds_read_b64_tr_b16 a[244:245], v3 offset:27648
  ds_read_b64_tr_b16 a[246:247], v3 offset:27840
  ds_read_b64_tr_b16 a[248:249], v3 offset:24608
  ds_read_b64_tr_b16 a[250:251], v3 offset:24800
  ds_read_b64_tr_b16 a[252:253], v3 offset:27680
  ds_read_b64_tr_b16 a[254:255], v3 offset:27872
  ds_read_b64_tr_b16 v[152:153], v3 offset:24640
  ds_read_b64_tr_b16 v[154:155], v3 offset:24832
  ds_read_b64_tr_b16 v[156:157], v3 offset:27712
  ds_read_b64_tr_b16 v[158:159], v3 offset:27904
  s_waitcnt lgkmcnt(0)
  s_mov_b32 m0, 116736
  s_add_u32 s27, s32, 3932160
  buffer_load_dwordx4 v8, s[16:19], s27 offen  lds
  s_mov_b32 m0, 117760
  s_add_u32 s27, s32, 3932160
  buffer_load_dwordx4 v9, s[16:19], s27 offen  lds
  s_mov_b32 m0, 118784
  s_add_u32 s27, s32, 3932160
  buffer_load_dwordx4 v10, s[16:19], s27 offen  lds
  s_mov_b32 m0, 119808
  s_add_u32 s27, s32, 3932160
  buffer_load_dwordx4 v11, s[16:19], s27 offen  lds
  s_mov_b32 m0, 120832
  s_add_u32 s27, s32, 3932160
  buffer_load_dwordx4 v12, s[16:19], s27 offen  lds
  s_mov_b32 m0, 121856
  s_add_u32 s27, s32, 3932160
  buffer_load_dwordx4 v13, s[16:19], s27 offen  lds
  s_waitcnt vmcnt(12)
  ds_read_b64_tr_b16 v[160:161], v4 offset:0
  ds_read_b64_tr_b16 v[162:163], v4 offset:192
  ds_read_b64_tr_b16 v[164:165], v4 offset:3072
  ds_read_b64_tr_b16 v[166:167], v4 offset:3264
  ds_read_b64_tr_b16 v[168:169], v4 offset:32
  ds_read_b64_tr_b16 v[170:171], v4 offset:224
  ds_read_b64_tr_b16 v[172:173], v4 offset:3104
  ds_read_b64_tr_b16 v[174:175], v4 offset:3296
  ds_read_b64_tr_b16 v[176:177], v4 offset:64
  ds_read_b64_tr_b16 v[178:179], v4 offset:256
  ds_read_b64_tr_b16 v[180:181], v4 offset:3136
  ds_read_b64_tr_b16 v[182:183], v4 offset:3328
  s_waitcnt lgkmcnt(0)
  s_mov_b32 m0, 141312
  s_add_u32 s27, s32, 4718592
  buffer_load_dwordx4 v8, s[16:19], s27 offen  lds
  s_mov_b32 m0, 142336
  s_add_u32 s27, s32, 4718592
  buffer_load_dwordx4 v9, s[16:19], s27 offen  lds
  s_mov_b32 m0, 143360
  s_add_u32 s27, s32, 4718592
  buffer_load_dwordx4 v10, s[16:19], s27 offen  lds
  s_mov_b32 m0, 144384
  s_add_u32 s27, s32, 4718592
  buffer_load_dwordx4 v11, s[16:19], s27 offen  lds
  s_mov_b32 m0, 145408
  s_add_u32 s27, s32, 4718592
  buffer_load_dwordx4 v12, s[16:19], s27 offen  lds
  s_mov_b32 m0, 146432
  s_add_u32 s27, s32, 4718592
  buffer_load_dwordx4 v13, s[16:19], s27 offen  lds
  s_waitcnt vmcnt(12)
  ds_read_b64_tr_b16 v[184:185], v3 offset:0
  ds_read_b64_tr_b16 v[186:187], v3 offset:192
  ds_read_b64_tr_b16 v[188:189], v3 offset:3072
  ds_read_b64_tr_b16 v[190:191], v3 offset:3264
  ds_read_b64_tr_b16 v[192:193], v3 offset:32
  ds_read_b64_tr_b16 v[194:195], v3 offset:224
  ds_read_b64_tr_b16 v[196:197], v3 offset:3104
  ds_read_b64_tr_b16 v[198:199], v3 offset:3296
  ds_read_b64_tr_b16 v[200:201], v3 offset:64
  ds_read_b64_tr_b16 v[202:203], v3 offset:256
  ds_read_b64_tr_b16 v[204:205], v3 offset:3136
  ds_read_b64_tr_b16 v[206:207], v3 offset:3328
  s_waitcnt lgkmcnt(0)
  s_mov_b32 m0, 92160
  s_add_u32 s27, s32, 5505024
  buffer_load_dwordx4 v8, s[16:19], s27 offen  lds
  s_mov_b32 m0, 93184
  s_add_u32 s27, s32, 5505024
  buffer_load_dwordx4 v9, s[16:19], s27 offen  lds
  s_mov_b32 m0, 94208
  s_add_u32 s27, s32, 5505024
  buffer_load_dwordx4 v10, s[16:19], s27 offen  lds
  s_mov_b32 m0, 95232
  s_add_u32 s27, s32, 5505024
  buffer_load_dwordx4 v11, s[16:19], s27 offen  lds
  s_mov_b32 m0, 96256
  s_add_u32 s27, s32, 5505024
  buffer_load_dwordx4 v12, s[16:19], s27 offen  lds
  s_mov_b32 m0, 97280
  s_add_u32 s27, s32, 5505024
  buffer_load_dwordx4 v13, s[16:19], s27 offen  lds
  s_waitcnt vmcnt(12)
  ds_read_b64_tr_b16 v[208:209], v3 offset:24576
  ds_read_b64_tr_b16 v[210:211], v3 offset:24768
  ds_read_b64_tr_b16 v[212:213], v3 offset:27648
  ds_read_b64_tr_b16 v[214:215], v3 offset:27840
  ds_read_b64_tr_b16 v[216:217], v3 offset:24608
  ds_read_b64_tr_b16 v[218:219], v3 offset:24800
  ds_read_b64_tr_b16 v[220:221], v3 offset:27680
  ds_read_b64_tr_b16 v[222:223], v3 offset:27872
  ds_read_b64_tr_b16 v[224:225], v3 offset:24640
  ds_read_b64_tr_b16 v[226:227], v3 offset:24832
  ds_read_b64_tr_b16 v[228:229], v3 offset:27712
  ds_read_b64_tr_b16 v[230:231], v3 offset:27904
  s_waitcnt lgkmcnt(0)
  s_mov_b32 m0, 116736
  s_add_u32 s27, s32, 6291456
  buffer_load_dwordx4 v8, s[16:19], s27 offen  lds
  s_mov_b32 m0, 117760
  s_add_u32 s27, s32, 6291456
  buffer_load_dwordx4 v9, s[16:19], s27 offen  lds
  s_mov_b32 m0, 118784
  s_add_u32 s27, s32, 6291456
  buffer_load_dwordx4 v10, s[16:19], s27 offen  lds
  s_mov_b32 m0, 119808
  s_add_u32 s27, s32, 6291456
  buffer_load_dwordx4 v11, s[16:19], s27 offen  lds
  s_mov_b32 m0, 120832
  s_add_u32 s27, s32, 6291456
  buffer_load_dwordx4 v12, s[16:19], s27 offen  lds
  s_mov_b32 m0, 121856
  s_add_u32 s27, s32, 6291456
  buffer_load_dwordx4 v13, s[16:19], s27 offen  lds
  s_waitcnt vmcnt(12)
  ds_read_b64_tr_b16 v[232:233], v4 offset:0
  ds_read_b64_tr_b16 v[234:235], v4 offset:192
  ds_read_b64_tr_b16 v[236:237], v4 offset:3072
  ds_read_b64_tr_b16 v[238:239], v4 offset:3264
  ds_read_b64_tr_b16 v[240:241], v4 offset:32
  ds_read_b64_tr_b16 v[242:243], v4 offset:224
  ds_read_b64_tr_b16 v[244:245], v4 offset:3104
  ds_read_b64_tr_b16 v[246:247], v4 offset:3296
  ds_read_b64_tr_b16 v[248:249], v4 offset:64
  ds_read_b64_tr_b16 v[250:251], v4 offset:256
  ds_read_b64_tr_b16 v[252:253], v4 offset:3136
  ds_read_b64_tr_b16 v[254:255], v4 offset:3328
  s_waitcnt lgkmcnt(0)
  s_mov_b32 m0, 141312
  s_add_u32 s27, s32, 7077888
  buffer_load_dwordx4 v8, s[16:19], s27 offen  lds
  s_mov_b32 m0, 142336
  s_add_u32 s27, s32, 7077888
  buffer_load_dwordx4 v9, s[16:19], s27 offen  lds
  s_mov_b32 m0, 143360
  s_add_u32 s27, s32, 7077888
  buffer_load_dwordx4 v10, s[16:19], s27 offen  lds
  s_mov_b32 m0, 144384
  s_add_u32 s27, s32, 7077888
  buffer_load_dwordx4 v11, s[16:19], s27 offen  lds
  s_mov_b32 m0, 145408
  s_add_u32 s27, s32, 7077888
  buffer_load_dwordx4 v12, s[16:19], s27 offen  lds
  s_mov_b32 m0, 146432
  s_add_u32 s27, s32, 7077888
  buffer_load_dwordx4 v13, s[16:19], s27 offen  lds
  s_waitcnt vmcnt(12)
  ds_read_b64_tr_b16 a[120:121], v3 offset:0
  ds_read_b64_tr_b16 a[122:123], v3 offset:192
  ds_read_b64_tr_b16 a[124:125], v3 offset:3072
  ds_read_b64_tr_b16 a[126:127], v3 offset:3264
  ds_read_b64_tr_b16 a[128:129], v3 offset:32
  ds_read_b64_tr_b16 a[130:131], v3 offset:224
  ds_read_b64_tr_b16 a[132:133], v3 offset:3104
  ds_read_b64_tr_b16 a[134:135], v3 offset:3296
  ds_read_b64_tr_b16 a[136:137], v3 offset:64
  ds_read_b64_tr_b16 a[138:139], v3 offset:256
  ds_read_b64_tr_b16 a[140:141], v3 offset:3136
  ds_read_b64_tr_b16 a[142:143], v3 offset:3328
  s_waitcnt lgkmcnt(0)
  s_mov_b32 m0, 98304
  s_add_u32 s27, s32, 0
  buffer_load_dwordx4 v8, s[12:15], s27 offen  lds
  s_mov_b32 m0, 99328
  s_add_u32 s27, s32, 0
  buffer_load_dwordx4 v9, s[12:15], s27 offen  lds
  s_mov_b32 m0, 100352
  s_add_u32 s27, s32, 0
  buffer_load_dwordx4 v10, s[12:15], s27 offen  lds
  s_mov_b32 m0, 101376
  s_add_u32 s27, s32, 0
  buffer_load_dwordx4 v11, s[12:15], s27 offen  lds
  s_mov_b32 m0, 102400
  s_add_u32 s27, s32, 0
  buffer_load_dwordx4 v12, s[12:15], s27 offen  lds
  s_mov_b32 m0, 103424
  s_add_u32 s27, s32, 0
  buffer_load_dwordx4 v13, s[12:15], s27 offen  lds
  s_waitcnt vmcnt(12)
  ds_read_b64_tr_b16 a[144:145], v3 offset:24576
  ds_read_b64_tr_b16 a[146:147], v3 offset:24768
  ds_read_b64_tr_b16 a[148:149], v3 offset:27648
  ds_read_b64_tr_b16 a[150:151], v3 offset:27840
  ds_read_b64_tr_b16 a[152:153], v3 offset:24608
  ds_read_b64_tr_b16 a[154:155], v3 offset:24800
  ds_read_b64_tr_b16 a[156:157], v3 offset:27680
  ds_read_b64_tr_b16 a[158:159], v3 offset:27872
  ds_read_b64_tr_b16 a[160:161], v3 offset:24640
  ds_read_b64_tr_b16 a[162:163], v3 offset:24832
  ds_read_b64_tr_b16 a[164:165], v3 offset:27712
  ds_read_b64_tr_b16 a[166:167], v3 offset:27904
  s_waitcnt lgkmcnt(0)
  s_mov_b32 m0, 92160
  s_add_u32 s27, s32, 786432
  buffer_load_dwordx4 v8, s[12:15], s27 offen  lds
  s_mov_b32 m0, 93184
  s_add_u32 s27, s32, 786432
  buffer_load_dwordx4 v9, s[12:15], s27 offen  lds
  s_mov_b32 m0, 94208
  s_add_u32 s27, s32, 786432
  buffer_load_dwordx4 v10, s[12:15], s27 offen  lds
  s_mov_b32 m0, 95232
  s_add_u32 s27, s32, 786432
  buffer_load_dwordx4 v11, s[12:15], s27 offen  lds
  s_mov_b32 m0, 96256
  s_add_u32 s27, s32, 786432
  buffer_load_dwordx4 v12, s[12:15], s27 offen  lds
  s_mov_b32 m0, 97280
  s_add_u32 s27, s32, 786432
  buffer_load_dwordx4 v13, s[12:15], s27 offen  lds
  s_waitcnt vmcnt(12)
  ds_read_b64_tr_b16 a[168:169], v4 offset:0
  ds_read_b64_tr_b16 a[170:171], v4 offset:192
  ds_read_b64_tr_b16 a[172:173], v4 offset:3072
  ds_read_b64_tr_b16 a[174:175], v4 offset:3264
  ds_read_b64_tr_b16 a[176:177], v4 offset:32
  ds_read_b64_tr_b16 a[178:179], v4 offset:224
  ds_read_b64_tr_b16 a[180:181], v4 offset:3104
  ds_read_b64_tr_b16 a[182:183], v4 offset:3296
  ds_read_b64_tr_b16 a[184:185], v4 offset:64
  ds_read_b64_tr_b16 a[186:187], v4 offset:256
  ds_read_b64_tr_b16 a[188:189], v4 offset:3136
  ds_read_b64_tr_b16 a[190:191], v4 offset:3328
  s_waitcnt lgkmcnt(0)
  s_mov_b32 m0, 104448
  s_add_u32 s27, s32, 1572864
  buffer_load_dwordx4 v8, s[12:15], s27 offen  lds
  s_mov_b32 m0, 105472
  s_add_u32 s27, s32, 1572864
  buffer_load_dwordx4 v9, s[12:15], s27 offen  lds
  s_mov_b32 m0, 106496
  s_add_u32 s27, s32, 1572864
  buffer_load_dwordx4 v10, s[12:15], s27 offen  lds
  s_mov_b32 m0, 107520
  s_add_u32 s27, s32, 1572864
  buffer_load_dwordx4 v11, s[12:15], s27 offen  lds
  s_mov_b32 m0, 108544
  s_add_u32 s27, s32, 1572864
  buffer_load_dwordx4 v12, s[12:15], s27 offen  lds
  s_mov_b32 m0, 109568
  s_add_u32 s27, s32, 1572864
  buffer_load_dwordx4 v13, s[12:15], s27 offen  lds
  s_waitcnt vmcnt(12)
  ds_read_b64_tr_b16 v[32:33], v3 offset:6144
  ds_read_b64_tr_b16 v[34:35], v3 offset:6336
  ds_read_b64_tr_b16 v[36:37], v3 offset:9216
  ds_read_b64_tr_b16 v[38:39], v3 offset:9408
  ds_read_b64_tr_b16 v[40:41], v3 offset:6176
  ds_read_b64_tr_b16 v[42:43], v3 offset:6368
  ds_read_b64_tr_b16 v[44:45], v3 offset:9248
  ds_read_b64_tr_b16 v[46:47], v3 offset:9440
  ds_read_b64_tr_b16 v[48:49], v3 offset:6208
  ds_read_b64_tr_b16 v[50:51], v3 offset:6400
  ds_read_b64_tr_b16 v[52:53], v3 offset:9280
  ds_read_b64_tr_b16 v[54:55], v3 offset:9472
  s_waitcnt lgkmcnt(0)
  ds_write_b128 v7, v[32:35] offset:6144
  ds_write_b128 v7, v[36:39] offset:7168
  ds_write_b128 v7, v[40:43] offset:8192
  ds_write_b128 v7, v[44:47] offset:9216
  ds_write_b128 v7, v[48:51] offset:10240
  ds_write_b128 v7, v[52:55] offset:11264
  s_waitcnt lgkmcnt(0)
  s_mov_b32 m0, 141312
  s_add_u32 s27, s32, 2359296
  buffer_load_dwordx4 v8, s[12:15], s27 offen  lds
  s_mov_b32 m0, 142336
  s_add_u32 s27, s32, 2359296
  buffer_load_dwordx4 v9, s[12:15], s27 offen  lds
  s_mov_b32 m0, 143360
  s_add_u32 s27, s32, 2359296
  buffer_load_dwordx4 v10, s[12:15], s27 offen  lds
  s_mov_b32 m0, 144384
  s_add_u32 s27, s32, 2359296
  buffer_load_dwordx4 v11, s[12:15], s27 offen  lds
  s_mov_b32 m0, 145408
  s_add_u32 s27, s32, 2359296
  buffer_load_dwordx4 v12, s[12:15], s27 offen  lds
  s_mov_b32 m0, 146432
  s_add_u32 s27, s32, 2359296
  buffer_load_dwordx4 v13, s[12:15], s27 offen  lds
  s_waitcnt vmcnt(12)
  ds_read_b64_tr_b16 a[48:49], v3 offset:0
  ds_read_b64_tr_b16 a[50:51], v3 offset:192
  ds_read_b64_tr_b16 a[52:53], v3 offset:3072
  ds_read_b64_tr_b16 a[54:55], v3 offset:3264
  ds_read_b64_tr_b16 a[56:57], v3 offset:32
  ds_read_b64_tr_b16 a[58:59], v3 offset:224
  ds_read_b64_tr_b16 a[60:61], v3 offset:3104
  ds_read_b64_tr_b16 a[62:63], v3 offset:3296
  ds_read_b64_tr_b16 a[64:65], v3 offset:64
  ds_read_b64_tr_b16 a[66:67], v3 offset:256
  ds_read_b64_tr_b16 a[68:69], v3 offset:3136
  ds_read_b64_tr_b16 a[70:71], v3 offset:3328
  s_waitcnt lgkmcnt(0)
  s_mov_b32 m0, 110592
  s_add_u32 s27, s32, 3145728
  buffer_load_dwordx4 v8, s[12:15], s27 offen  lds
  s_mov_b32 m0, 111616
  s_add_u32 s27, s32, 3145728
  buffer_load_dwordx4 v9, s[12:15], s27 offen  lds
  s_mov_b32 m0, 112640
  s_add_u32 s27, s32, 3145728
  buffer_load_dwordx4 v10, s[12:15], s27 offen  lds
  s_mov_b32 m0, 113664
  s_add_u32 s27, s32, 3145728
  buffer_load_dwordx4 v11, s[12:15], s27 offen  lds
  s_mov_b32 m0, 114688
  s_add_u32 s27, s32, 3145728
  buffer_load_dwordx4 v12, s[12:15], s27 offen  lds
  s_mov_b32 m0, 115712
  s_add_u32 s27, s32, 3145728
  buffer_load_dwordx4 v13, s[12:15], s27 offen  lds
  s_waitcnt vmcnt(12)
  ds_read_b64_tr_b16 v[32:33], v3 offset:12288
  ds_read_b64_tr_b16 v[34:35], v3 offset:12480
  ds_read_b64_tr_b16 v[36:37], v3 offset:15360
  ds_read_b64_tr_b16 v[38:39], v3 offset:15552
  ds_read_b64_tr_b16 v[40:41], v3 offset:12320
  ds_read_b64_tr_b16 v[42:43], v3 offset:12512
  ds_read_b64_tr_b16 v[44:45], v3 offset:15392
  ds_read_b64_tr_b16 v[46:47], v3 offset:15584
  ds_read_b64_tr_b16 v[48:49], v3 offset:12352
  ds_read_b64_tr_b16 v[50:51], v3 offset:12544
  ds_read_b64_tr_b16 v[52:53], v3 offset:15424
  ds_read_b64_tr_b16 v[54:55], v3 offset:15616
  s_waitcnt lgkmcnt(0)
  ds_write_b128 v7, v[32:35] offset:12288
  ds_write_b128 v7, v[36:39] offset:13312
  ds_write_b128 v7, v[40:43] offset:14336
  ds_write_b128 v7, v[44:47] offset:15360
  ds_write_b128 v7, v[48:51] offset:16384
  ds_write_b128 v7, v[52:55] offset:17408
  s_waitcnt lgkmcnt(0)
  s_mov_b32 m0, 92160
  s_add_u32 s27, s32, 3932160
  buffer_load_dwordx4 v8, s[12:15], s27 offen  lds
  s_mov_b32 m0, 93184
  s_add_u32 s27, s32, 3932160
  buffer_load_dwordx4 v9, s[12:15], s27 offen  lds
  s_mov_b32 m0, 94208
  s_add_u32 s27, s32, 3932160
  buffer_load_dwordx4 v10, s[12:15], s27 offen  lds
  s_mov_b32 m0, 95232
  s_add_u32 s27, s32, 3932160
  buffer_load_dwordx4 v11, s[12:15], s27 offen  lds
  s_mov_b32 m0, 96256
  s_add_u32 s27, s32, 3932160
  buffer_load_dwordx4 v12, s[12:15], s27 offen  lds
  s_mov_b32 m0, 97280
  s_add_u32 s27, s32, 3932160
  buffer_load_dwordx4 v13, s[12:15], s27 offen  lds
  s_waitcnt vmcnt(12)
  ds_read_b64_tr_b16 a[72:73], v4 offset:0
  ds_read_b64_tr_b16 a[74:75], v4 offset:192
  ds_read_b64_tr_b16 a[76:77], v4 offset:3072
  ds_read_b64_tr_b16 a[78:79], v4 offset:3264
  ds_read_b64_tr_b16 a[80:81], v4 offset:32
  ds_read_b64_tr_b16 a[82:83], v4 offset:224
  ds_read_b64_tr_b16 a[84:85], v4 offset:3104
  ds_read_b64_tr_b16 a[86:87], v4 offset:3296
  ds_read_b64_tr_b16 a[88:89], v4 offset:64
  ds_read_b64_tr_b16 a[90:91], v4 offset:256
  ds_read_b64_tr_b16 a[92:93], v4 offset:3136
  ds_read_b64_tr_b16 a[94:95], v4 offset:3328
  s_waitcnt lgkmcnt(0)
  s_mov_b32 m0, 116736
  s_add_u32 s27, s32, 4718592
  buffer_load_dwordx4 v8, s[12:15], s27 offen  lds
  s_mov_b32 m0, 117760
  s_add_u32 s27, s32, 4718592
  buffer_load_dwordx4 v9, s[12:15], s27 offen  lds
  s_mov_b32 m0, 118784
  s_add_u32 s27, s32, 4718592
  buffer_load_dwordx4 v10, s[12:15], s27 offen  lds
  s_mov_b32 m0, 119808
  s_add_u32 s27, s32, 4718592
  buffer_load_dwordx4 v11, s[12:15], s27 offen  lds
  s_mov_b32 m0, 120832
  s_add_u32 s27, s32, 4718592
  buffer_load_dwordx4 v12, s[12:15], s27 offen  lds
  s_mov_b32 m0, 121856
  s_add_u32 s27, s32, 4718592
  buffer_load_dwordx4 v13, s[12:15], s27 offen  lds
  s_waitcnt vmcnt(12)
  ds_read_b64_tr_b16 v[32:33], v3 offset:18432
  ds_read_b64_tr_b16 v[34:35], v3 offset:18624
  ds_read_b64_tr_b16 v[36:37], v3 offset:21504
  ds_read_b64_tr_b16 v[38:39], v3 offset:21696
  ds_read_b64_tr_b16 v[40:41], v3 offset:18464
  ds_read_b64_tr_b16 v[42:43], v3 offset:18656
  ds_read_b64_tr_b16 v[44:45], v3 offset:21536
  ds_read_b64_tr_b16 v[46:47], v3 offset:21728
  ds_read_b64_tr_b16 v[48:49], v3 offset:18496
  ds_read_b64_tr_b16 v[50:51], v3 offset:18688
  ds_read_b64_tr_b16 v[52:53], v3 offset:21568
  ds_read_b64_tr_b16 v[54:55], v3 offset:21760
  s_waitcnt lgkmcnt(0)
  ds_write_b128 v7, v[32:35] offset:18432
  ds_write_b128 v7, v[36:39] offset:19456
  ds_write_b128 v7, v[40:43] offset:20480
  ds_write_b128 v7, v[44:47] offset:21504
  ds_write_b128 v7, v[48:51] offset:22528
  ds_write_b128 v7, v[52:55] offset:23552
  s_waitcnt lgkmcnt(0)
  s_mov_b32 m0, 141312
  s_add_u32 s27, s32, 5505024
  buffer_load_dwordx4 v8, s[12:15], s27 offen  lds
  s_mov_b32 m0, 142336
  s_add_u32 s27, s32, 5505024
  buffer_load_dwordx4 v9, s[12:15], s27 offen  lds
  s_mov_b32 m0, 143360
  s_add_u32 s27, s32, 5505024
  buffer_load_dwordx4 v10, s[12:15], s27 offen  lds
  s_mov_b32 m0, 144384
  s_add_u32 s27, s32, 5505024
  buffer_load_dwordx4 v11, s[12:15], s27 offen  lds
  s_mov_b32 m0, 145408
  s_add_u32 s27, s32, 5505024
  buffer_load_dwordx4 v12, s[12:15], s27 offen  lds
  s_mov_b32 m0, 146432
  s_add_u32 s27, s32, 5505024
  buffer_load_dwordx4 v13, s[12:15], s27 offen  lds
  s_waitcnt vmcnt(12)
  ds_read_b64_tr_b16 a[96:97], v3 offset:0
  ds_read_b64_tr_b16 a[98:99], v3 offset:192
  ds_read_b64_tr_b16 a[100:101], v3 offset:3072
  ds_read_b64_tr_b16 a[102:103], v3 offset:3264
  ds_read_b64_tr_b16 a[104:105], v3 offset:32
  ds_read_b64_tr_b16 a[106:107], v3 offset:224
  ds_read_b64_tr_b16 a[108:109], v3 offset:3104
  ds_read_b64_tr_b16 a[110:111], v3 offset:3296
  ds_read_b64_tr_b16 a[112:113], v3 offset:64
  ds_read_b64_tr_b16 a[114:115], v3 offset:256
  ds_read_b64_tr_b16 a[116:117], v3 offset:3136
  ds_read_b64_tr_b16 a[118:119], v3 offset:3328
  s_waitcnt lgkmcnt(0)
  s_mov_b32 m0, 92160
  s_add_u32 s27, s32, 6291456
  buffer_load_dwordx4 v8, s[12:15], s27 offen  lds
  s_mov_b32 m0, 93184
  s_add_u32 s27, s32, 6291456
  buffer_load_dwordx4 v9, s[12:15], s27 offen  lds
  s_mov_b32 m0, 94208
  s_add_u32 s27, s32, 6291456
  buffer_load_dwordx4 v10, s[12:15], s27 offen  lds
  s_mov_b32 m0, 95232
  s_add_u32 s27, s32, 6291456
  buffer_load_dwordx4 v11, s[12:15], s27 offen  lds
  s_mov_b32 m0, 96256
  s_add_u32 s27, s32, 6291456
  buffer_load_dwordx4 v12, s[12:15], s27 offen  lds
  s_mov_b32 m0, 97280
  s_add_u32 s27, s32, 6291456
  buffer_load_dwordx4 v13, s[12:15], s27 offen  lds
  s_waitcnt vmcnt(12)
  ds_read_b64_tr_b16 v[32:33], v3 offset:24576
  ds_read_b64_tr_b16 v[34:35], v3 offset:24768
  ds_read_b64_tr_b16 v[36:37], v3 offset:27648
  ds_read_b64_tr_b16 v[38:39], v3 offset:27840
  ds_read_b64_tr_b16 v[40:41], v3 offset:24608
  ds_read_b64_tr_b16 v[42:43], v3 offset:24800
  ds_read_b64_tr_b16 v[44:45], v3 offset:27680
  ds_read_b64_tr_b16 v[46:47], v3 offset:27872
  ds_read_b64_tr_b16 v[48:49], v3 offset:24640
  ds_read_b64_tr_b16 v[50:51], v3 offset:24832
  ds_read_b64_tr_b16 v[52:53], v3 offset:27712
  ds_read_b64_tr_b16 v[54:55], v3 offset:27904
  s_waitcnt lgkmcnt(0)
  ds_write_b128 v7, v[32:35] offset:24576
  ds_write_b128 v7, v[36:39] offset:25600
  ds_write_b128 v7, v[40:43] offset:26624
  ds_write_b128 v7, v[44:47] offset:27648
  ds_write_b128 v7, v[48:51] offset:28672
  ds_write_b128 v7, v[52:55] offset:29696
  s_waitcnt lgkmcnt(0)
  s_waitcnt vmcnt(6)
  ds_read_b64_tr_b16 a[0:1], v4 offset:0
  ds_read_b64_tr_b16 a[2:3], v4 offset:192
  ds_read_b64_tr_b16 a[4:5], v4 offset:3072
  ds_read_b64_tr_b16 a[6:7], v4 offset:3264
  ds_read_b64_tr_b16 a[8:9], v4 offset:32
  ds_read_b64_tr_b16 a[10:11], v4 offset:224
  ds_read_b64_tr_b16 a[12:13], v4 offset:3104
  ds_read_b64_tr_b16 a[14:15], v4 offset:3296
  ds_read_b64_tr_b16 a[16:17], v4 offset:64
  ds_read_b64_tr_b16 a[18:19], v4 offset:256
  ds_read_b64_tr_b16 a[20:21], v4 offset:3136
  ds_read_b64_tr_b16 a[22:23], v4 offset:3328
  s_waitcnt lgkmcnt(0)
  s_mov_b32 m0, 141312
  s_add_u32 s27, s32, 7077888
  buffer_load_dwordx4 v8, s[12:15], s27 offen  lds
  s_mov_b32 m0, 142336
  s_add_u32 s27, s32, 7077888
  buffer_load_dwordx4 v9, s[12:15], s27 offen  lds
  s_mov_b32 m0, 143360
  s_add_u32 s27, s32, 7077888
  buffer_load_dwordx4 v10, s[12:15], s27 offen  lds
  s_mov_b32 m0, 144384
  s_add_u32 s27, s32, 7077888
  buffer_load_dwordx4 v11, s[12:15], s27 offen  lds
  s_mov_b32 m0, 145408
  s_add_u32 s27, s32, 7077888
  buffer_load_dwordx4 v12, s[12:15], s27 offen  lds
  s_mov_b32 m0, 146432
  s_add_u32 s27, s32, 7077888
  buffer_load_dwordx4 v13, s[12:15], s27 offen  lds
  buffer_load_dwordx4 v[64:67], off, s[68:71], 0 offset:128 sc1
  buffer_load_dwordx2 v[68:69], off, s[68:71], 0 offset:64 sc1
  s_getpc_b64 s[4:5]
pc_2:
  s_add_u32 s4, s4, CQ_ldd-pc_2
  s_addc_u32 s5, s5, 0
  v_lshlrev_b32 v70, 7, v1
  global_load_dword v71, v70, s[4:5]
  s_waitcnt vmcnt(9)
  ds_read_b64_tr_b16 v[32:33], v3 offset:0
  ds_read_b64_tr_b16 v[34:35], v3 offset:192
  ds_read_b64_tr_b16 v[36:37], v3 offset:3072
  ds_read_b64_tr_b16 v[38:39], v3 offset:3264
  ds_read_b64_tr_b16 v[40:41], v3 offset:32
  ds_read_b64_tr_b16 v[42:43], v3 offset:224
  ds_read_b64_tr_b16 v[44:45], v3 offset:3104
  ds_read_b64_tr_b16 v[46:47], v3 offset:3296
  ds_read_b64_tr_b16 v[48:49], v3 offset:64
  ds_read_b64_tr_b16 v[50:51], v3 offset:256
  ds_read_b64_tr_b16 v[52:53], v3 offset:3136
  ds_read_b64_tr_b16 v[54:55], v3 offset:3328
  s_waitcnt lgkmcnt(0)
  ds_write_b128 v7, v[32:35] offset:0
  ds_write_b128 v7, v[36:39] offset:1024
  ds_write_b128 v7, v[40:43] offset:2048
  ds_write_b128 v7, v[44:47] offset:3072
  ds_write_b128 v7, v[48:51] offset:4096
  ds_write_b128 v7, v[52:55] offset:5120
  s_waitcnt lgkmcnt(0)
  s_waitcnt vmcnt(3)
  ds_read_b64_tr_b16 a[24:25], v4 offset:0
  ds_read_b64_tr_b16 a[26:27], v4 offset:192
  ds_read_b64_tr_b16 a[28:29], v4 offset:3072
  ds_read_b64_tr_b16 a[30:31], v4 offset:3264
  ds_read_b64_tr_b16 a[32:33], v4 offset:32
  ds_read_b64_tr_b16 a[34:35], v4 offset:224
  ds_read_b64_tr_b16 a[36:37], v4 offset:3104
  ds_read_b64_tr_b16 a[38:39], v4 offset:3296
  ds_read_b64_tr_b16 a[40:41], v4 offset:64
  ds_read_b64_tr_b16 a[42:43], v4 offset:256
  ds_read_b64_tr_b16 a[44:45], v4 offset:3136
  ds_read_b64_tr_b16 a[46:47], v4 offset:3328
  s_waitcnt lgkmcnt(0)
CQ_ldd:
  s_branch cg_4
cg_3:
  s_sleep 4
  buffer_load_dwordx4 v[64:67], off, s[68:71], 0 offset:128 sc1
  buffer_load_dwordx2 v[68:69], off, s[68:71], 0 offset:64 sc1
  s_add_u32 s26, s26, 1
  s_mov_b32 s39, 97
  s_cmp_gt_u32 s26, 2097152
  s_cbranch_scc1 L_abort
cg_4:
  s_waitcnt vmcnt(0)
  v_readfirstlane_b32 s32, v64
  v_readfirstlane_b32 s33, v65
  v_readfirstlane_b32 s34, v66
  v_readfirstlane_b32 s35, v67
  v_readfirstlane_b32 s31, v68
  v_readfirstlane_b32 s74, v69
  s_add_u32 s27, s32, s33
  s_add_u32 s30, s34, s35
  s_add_u32 s27, s27, s30
  s_mul_i32 s27, s27, 0x01010101
  s_lshr_b32 s27, s27, 24
  s_cmp_lt_u32 s27, 64
  s_cbranch_scc1 cg_3
  s_cmp_lt_u32 s31, 64
  s_cbranch_scc1 cg_3
  s_cmp_eq_u32 s74, 0
  s_cbranch_scc1 cg_3
  s_and_b32 s74, s74, 6
  s_lshl_b32 s74, s74, 12
  s_xor_b32 s74, s74, 0x4000
  s_or_b32 s27, s32, s33
  s_or_b32 s27, s27, s34
  s_or_b32 s27, s27, s35
  s_and_b32 s3, s27, 0x1f1f1f1f
  s_and_b32 s85, s25, 15
  v_bfe_u32 v3, v1, 1, 1
  v_mul_u32_u24 v3, 0xaaaa, v3
  v_add_u32 v3, 0x4444, v3
  s_lshl_b32 s27, s75, 10
  v_add_u32 v4, s27, v2
  s_mov_b32 s83, 0x3f80
  s_mov_b32 s84, 0x3f800000
  s_mov_b32 s77, 0x80008000
  s_mul_i32 s86, s29, 10240
  s_add_u32 s86, s86, 65536
  s_xor_b32 s27, s29, 1
  s_mul_i32 s27, s27, 10
  s_add_u32 s27, s27, s75
  s_add_u32 s30, s27, 0
  s_lshr_b32 s31, s30, 3
  s_mul_i32 s31, s31, 24
  s_add_u32 s30, s30, s31
  s_lshl_b32 s30, s30, 10
  s_add_u32 s30, s30, s74
  s_add_u32 s64, s30, 917504
  s_add_u32 s30, s27, 1
  s_lshr_b32 s31, s30, 3
  s_mul_i32 s31, s31, 24
  s_add_u32 s30, s30, s31
  s_lshl_b32 s30, s30, 10
  s_add_u32 s30, s30, s74
  s_add_u32 s65, s30, 917504
  s_add_u32 s30, s27, 2
  s_lshr_b32 s31, s30, 3
  s_mul_i32 s31, s31, 24
  s_add_u32 s30, s30, s31
  s_lshl_b32 s30, s30, 10
  s_add_u32 s30, s30, s74
  s_add_u32 s66, s30, 917504
  v_add_u32 v5, 122880, v4
  s_cmp_ge_u32 s24, 3
  s_cselect_b32 s27, 10, 0
  s_sub_u32 s27, s75, s27
  s_lshl_b32 s27, s27, 10
  s_add_u32 s27, s27, 122880
  v_add_u32 v0, s27, v2
  s_cmp_ge_u32 s24, 2
  s_cselect_b32 s27, 10, 0
  s_sub_u32 s27, s75, s27
  s_lshl_b32 s27, s27, 10
  s_add_u32 s27, s27, 122880
  v_add_u32 v6, s27, v2
  s_cmp_ge_u32 s24, 1
  s_cselect_b32 s27, 10, 0
  s_sub_u32 s27, s75, s27
  s_lshl_b32 s27, s27, 10
  s_add_u32 s27, s27, 122880
  v_add_u32 v23, s27, v2
  v_and_b32 v40, 15, v1
  v_lshlrev_b32 v28, 2, v40
  s_lshl_b32 s27, s29, 11
  s_add_u32 s27, s27, 40960
  v_add_u32 v28, s27, v28
  s_mov_b32 s80, 0
  s_mov_b32 s92, 0x3dd53b95
  s_mov_b32 s93, 0x3dd53b95
  v_and_b32 v41, 15, v1
  v_lshrrev_b32 v42, 4, v1
  v_lshrrev_b32 v43, 3, v1
  v_and_b32 v44, 7, v1
  s_mul_i32 s27, s24, 1536
  s_add_u32 s27, s27, 133120
  v_lshlrev_b32 v8, 5, v41
  v_lshl_add_u32 v8, v42, 2, v8
  v_add_u32 v8, s27, v8
  v_lshrrev_b32 v9, 2, v1
  v_lshlrev_b32 v9, 5, v9
  v_and_b32 v32, 3, v1
  v_lshl_add_u32 v9, v32, 3, v9
  v_add_u32 v9, s27, v9
  v_mul_u32_u24 v10, 160, v41
  v_lshl_add_u32 v10, v42, 4, v10
  s_mul_i32 s27, s24, 1280
  s_add_u32 s27, s27, 139264
  v_add_u32 v10, s27, v10
  v_mul_u32_u24 v32, 160, v43
  v_add_u32 v32, 139264, v32
  v_bfe_u32 v33, v1, 2, 1
  v_bfe_u32 v34, v1, 1, 1
  v_and_b32 v35, 1, v1
  v_lshl_add_u32 v12, v33, 5, v32
  v_lshl_add_u32 v12, v35, 4, v12
  v_lshl_add_u32 v12, v34, 3, v12
  v_add_u32 v13, 2560, v12
  v_lshl_add_u32 v14, v44, 2, v32
  v_add_u32 v14, 128, v14
  v_lshrrev_b32 v37, 1, v44
  s_lshr_b32 s27, s85, 1
  s_lshl_b32 s27, s27, 10
  s_and_b32 s30, s85, 1
  s_lshl_b32 s30, s30, 9
  s_add_u32 s27, s27, s30
  v_lshrrev_b32 v45, 1, v43
  v_lshlrev_b32 v45, 6, v45
  v_and_b32 v46, 1, v43
  v_lshl_add_u32 v45, v46, 4, v45
  v_lshl_add_u32 v17, v33, 8, v45
  v_lshl_add_u32 v17, v34, 5, v17
  v_lshl_add_u32 v17, v35, 3, v17
  v_add_u32 v17, s27, v17
  s_lshr_b32 s27, s85, 2
  s_lshl_b32 s27, s27, 10
  s_and_b32 s30, s85, 3
  s_lshl_b32 s30, s30, 8
  s_add_u32 s27, s27, s30
  s_add_u32 s27, s27, 8192
  v_lshl_add_u32 v18, v37, 2, v45
  v_add_u32 v18, s27, v18
  v_mul_u32_u24 v21, 12288, v35
  s_lshl_b32 s27, s25, 7
  s_lshl_b32 s30, s24, 2
  s_add_u32 s31, s27, s30
  s_add_u32 s31, s31, 4096
  v_add_u32 v21, s31, v21
  v_and_b32 v40, 3, v1
  v_lshlrev_b32 v40, 2, v40
  s_add_u32 s27, s27, 12288
  v_add_u32 v40, s27, v40
  v_cmp_eq_u32 vcc, 1, v33
  s_nop 1
  v_cndmask_b32 v21, v21, v40, vcc
  v_lshlrev_b32 v29, 7, v1
  v_lshlrev_b32 v30, 7, v41
  v_add_u32 v30, 8192, v30
  s_mul_i32 s37, s25, 40960
  s_mul_i32 s27, s24, 10240
  s_add_u32 s37, s37, s27
  s_add_u32 s37, s37, 119275520
  s_add_u32 s34, s25, 192
  s_lshl_b32 s34, s34, 7
  s_add_u32 s34, s34, s30
  s_add_u32 s34, s34, 4096
  v_mov_b32 v27, 0x7fff7fff
  s_lshl_b32 s35, s25, 2
  s_add_u32 s35, s35, s24
  s_mul_i32 s35, s35, 3072
  s_lshl_b32 s36, s25, 2
  s_add_u32 s36, s36, s24
  s_lshl_b32 s76, s36, 9
  s_lshl_b32 s36, s36, 10
  s_add_u32 s36, s36, 201850880
  s_add_u32 s76, s76, 210239488
  v_lshlrev_b32 v11, 3, v1
  s_mul_i32 s78, s25, 10240
  s_mul_i32 s27, s24, 2560
  s_add_u32 s78, s78, s27
  s_add_u32 s100, s78, 21495808
  v_mov_b32 v22, 0
  s_mov_b64 exec, 1
wp_5:
  buffer_load_dword v22, v21, s[8:11], 0 offen sc1
  s_add_u32 s26, s26, 1
  s_mov_b32 s39, 64
  s_cmp_gt_u32 s26, 2097152
  s_cbranch_scc1 L_abort
  s_waitcnt vmcnt(0)
  v_cmp_ge_u32 vcc, s80, v22
  s_cbranch_vccnz wp_5
  s_mov_b64 exec, -1
  s_add_u32 s27, s35, 42467328
  buffer_load_dwordx4 v[120:123], v2, s[8:11], s27 offen offset:0 sc1
  buffer_load_dwordx4 v[124:127], v2, s[8:11], s27 offen offset:1024 sc1
  buffer_load_dwordx4 v[128:131], v2, s[8:11], s27 offen offset:2048 sc1
  s_add_u32 s35, s35, 393216
  s_barrier
  ds_read_b128 v[96:99], v7 offset:0
  ds_read_b128 v[100:103], v7 offset:1024
  ds_read_b128 v[104:107], v7 offset:2048
  ds_read_b128 v[108:111], v7 offset:3072
  ds_read_b128 v[112:115], v7 offset:4096
  ds_read_b128 v[116:119], v7 offset:5120
  v_mov_b64 v[72:73], 0
  v_mov_b64 v[74:75], 0
  v_mov_b64 v[76:77], 0
  v_mov_b64 v[78:79], 0
  v_mov_b64 v[80:81], 0
  v_mov_b64 v[82:83], 0
  v_mov_b64 v[84:85], 0
  v_mov_b64 v[86:87], 0
  v_mov_b64 v[88:89], 0
  v_mov_b64 v[90:91], 0
  v_mov_b64 v[92:93], 0
  v_mov_b64 v[94:95], 0
  s_waitcnt lgkmcnt(0)
  s_cmp_lg_u32 s3, 0
  s_cbranch_scc1 CQS_step
CQ_step:
  s_and_b32 s88, s80, 1
  s_lshl_b32 s81, s88, 16
  s_bfe_u32 s82, s80, 0x10001
  s_sub_u32 s79, 0, s82
  s_add_u32 s89, s81, s86
  s_mul_i32 s27, s88, 0x18000
  s_add_u32 s90, s27, s64
  s_add_u32 s87, s27, s65
  s_add_u32 s67, s27, s66
CQ_can:
  buffer_load_dword v68, v28, s[8:11], 0 offen sc1
  s_add_u32 s26, s26, 1
  s_mov_b32 s39, 66
  s_cmp_gt_u32 s26, 2097152
  s_cbranch_scc1 L_abort
  s_waitcnt vmcnt(0)
  v_cmp_gt_u32 vcc, s80, v68
  s_cbranch_vccz CQ_can2
  s_sleep 1
  s_branch CQ_can
CQ_can2:
CQ_loc:
  buffer_load_dwordx4 v[32:35], v4, s[8:11], s89 offen offset:0 sc1
  buffer_load_dwordx4 v[36:39], v4, s[8:11], s89 offen offset:1024 sc1
  buffer_load_dwordx4 v[40:43], v4, s[8:11], s89 offen offset:2048 sc1
  s_add_u32 s26, s26, 1
  s_mov_b32 s39, 66
  s_cmp_gt_u32 s26, 2097152
  s_cbranch_scc1 L_abort
  s_waitcnt vmcnt(1)
  v_bitop3_b32 v68, v32, v36, s79 bitop3:0x7e
  s_waitcnt vmcnt(0)
  v_bitop3_b32 v68, v68, v40, s79 bitop3:0xf6
  v_and_b32 v68, 1, v68
  v_cmp_ne_u32 vcc, 0, v68
  s_cbranch_vccnz CQ_loc
  buffer_load_dwordx4 v[56:59], v2, s[8:11], s90 offen sc1
  buffer_load_dwordx4 v[60:63], v2, s[8:11], s87 offen sc1
  buffer_load_dwordx4 v[64:67], v2, s[8:11], s67 offen sc1
CQ_x0:
  s_lshl_b32 s72, s88, 1
  s_add_u32 s72, s72, s29
  s_lshl_b32 s72, s72, 14
  s_add_u32 s72, s72, 196608
  s_mul_i32 s73, s82, 0x80008000
  v_mov_b32 v31, s80
  s_add_u32 s30, s80, 1
  v_cmp_ge_i32 vcc, s30, v22
  s_nop 0
  s_and_b32 s30, vcc_lo, 0xf0
  s_cmp_eq_u32 s30, 0
  s_cselect_b32 s38, s37, 2097152
  s_add_u32 s37, s37, 1310720
  v_lshlrev_b32 v44, 16, v32
  v_and_b32 v32, 0xffff0000, v32
  v_lshlrev_b32 v45, 16, v33
  v_and_b32 v33, 0xffff0000, v33
  v_lshlrev_b32 v46, 16, v34
  v_and_b32 v34, 0xffff0000, v34
  v_lshlrev_b32 v47, 16, v35
  v_and_b32 v35, 0xffff0000, v35
  v_lshlrev_b32 v48, 16, v36
  v_and_b32 v36, 0xffff0000, v36
  v_lshlrev_b32 v49, 16, v37
  v_and_b32 v37, 0xffff0000, v37
  v_lshlrev_b32 v50, 16, v38
  v_and_b32 v38, 0xffff0000, v38
  v_lshlrev_b32 v51, 16, v39
  v_and_b32 v39, 0xffff0000, v39
  v_lshlrev_b32 v52, 16, v40
  v_and_b32 v40, 0xffff0000, v40
  v_lshlrev_b32 v53, 16, v41
  v_and_b32 v41, 0xffff0000, v41
  v_lshlrev_b32 v54, 16, v42
  v_and_b32 v42, 0xffff0000, v42
  v_lshlrev_b32 v55, 16, v43
  v_and_b32 v43, 0xffff0000, v43
  s_waitcnt vmcnt(1)
  v_bitop3_b32 v68, v56, v60, s79 bitop3:0x7e
  s_waitcnt vmcnt(0)
  v_bitop3_b32 v68, v68, v64, s79 bitop3:0xf6
  v_and_b32 v68, 1, v68
  v_cmp_ne_u32 vcc, 0, v68
  s_cbranch_vccnz CQ_rem
CQ_got:
  v_dot2_f32_bf16 v44, v56, s83, v44
  v_dot2_f32_bf16 v32, v56, s84, v32
  v_dot2_f32_bf16 v45, v57, s83, v45
  v_dot2_f32_bf16 v33, v57, s84, v33
  v_dot2_f32_bf16 v46, v58, s83, v46
  v_dot2_f32_bf16 v34, v58, s84, v34
  v_dot2_f32_bf16 v47, v59, s83, v47
  v_dot2_f32_bf16 v35, v59, s84, v35
  v_dot2_f32_bf16 v48, v60, s83, v48
  v_dot2_f32_bf16 v36, v60, s84, v36
  v_dot2_f32_bf16 v49, v61, s83, v49
  v_dot2_f32_bf16 v37, v61, s84, v37
  v_dot2_f32_bf16 v50, v62, s83, v50
  v_dot2_f32_bf16 v38, v62, s84, v38
  v_dot2_f32_bf16 v51, v63, s83, v51
  v_dot2_f32_bf16 v39, v63, s84, v39
  v_cvt_pk_bf16_f32 v32, v44, v32
  v_cvt_pk_bf16_f32 v33, v45, v33
  v_cvt_pk_bf16_f32 v34, v46, v34
  v_cvt_pk_bf16_f32 v35, v47, v35
  ds_write_b128 v5, v[32:35] offset:0
  v_dot2_f32_bf16 v52, v64, s83, v52
  v_dot2_f32_bf16 v40, v64, s84, v40
  v_dot2_f32_bf16 v53, v65, s83, v53
  v_dot2_f32_bf16 v41, v65, s84, v41
  v_dot2_f32_bf16 v54, v66, s83, v54
  v_dot2_f32_bf16 v42, v66, s84, v42
  v_dot2_f32_bf16 v55, v67, s83, v55
  v_dot2_f32_bf16 v43, v67, s84, v43
  v_cvt_pk_bf16_f32 v36, v48, v36
  v_cvt_pk_bf16_f32 v37, v49, v37
  v_cvt_pk_bf16_f32 v38, v50, v38
  v_cvt_pk_bf16_f32 v39, v51, v39
  ds_write_b128 v5, v[36:39] offset:1024
  v_smfmac_f32_16x16x64_bf16 v[72:75], v[32:35], a[0:7], v3
  s_nop 1
  v_cvt_pk_bf16_f32 v40, v52, v40
  v_cvt_pk_bf16_f32 v41, v53, v41
  v_cvt_pk_bf16_f32 v42, v54, v42
  v_cvt_pk_bf16_f32 v43, v55, v43
  ds_write_b128 v5, v[40:43] offset:2048
  v_smfmac_f32_16x16x64_bf16 v[76:79], v[32:35], a[120:127], v3
  v_smfmac_f32_16x16x64_bf16 v[80:83], v[32:35], a[8:15], v3
  v_smfmac_f32_16x16x64_bf16 v[84:87], v[32:35], a[128:135], v3
  s_waitcnt lgkmcnt(0)
  s_barrier
  ds_read_b128 v[44:47], v0 offset:3072
  ds_read_b128 v[48:51], v6 offset:4096
  ds_read_b128 v[52:55], v6 offset:5120
  ds_read_b128 v[56:59], v6 offset:6144
  ds_read_b128 v[60:63], v23 offset:7168
  ds_read_b128 v[64:67], v23 offset:8192
  ds_read_b128 v[68:71], v23 offset:9216
  v_smfmac_f32_16x16x64_bf16 v[88:91], v[32:35], a[16:23], v3
  s_mov_b64 exec, 1
  buffer_store_dword v31, off, s[8:11], s34 sc1
  s_mov_b64 exec, -1
  v_smfmac_f32_16x16x64_bf16 v[92:95], v[32:35], a[136:143], v3
  buffer_store_dwordx4 v[132:135], v2, s[8:11], s100 offen offset:0 sc1
  v_smfmac_f32_16x16x64_bf16 v[72:75], v[36:39], v[96:103], v3
  ds_read_b128 v[96:99], v7 offset:6144
  v_smfmac_f32_16x16x64_bf16 v[76:79], v[36:39], a[144:151], v3
  ds_read_b128 v[100:103], v7 offset:7168
  v_smfmac_f32_16x16x64_bf16 v[80:83], v[36:39], v[104:111], v3
  ds_read_b128 v[104:107], v7 offset:12288
  v_smfmac_f32_16x16x64_bf16 v[84:87], v[36:39], a[152:159], v3
  ds_read_b128 v[108:111], v7 offset:13312
  v_smfmac_f32_16x16x64_bf16 v[88:91], v[36:39], v[112:119], v3
  ds_read_b128 v[112:115], v7 offset:18432
  v_smfmac_f32_16x16x64_bf16 v[92:95], v[36:39], a[160:167], v3
  ds_read_b128 v[116:119], v7 offset:19456
  v_smfmac_f32_16x16x64_bf16 v[72:75], v[40:43], a[24:31], v3
  buffer_store_dwordx4 v[136:139], v2, s[8:11], s100 offen offset:1024 sc1
  v_smfmac_f32_16x16x64_bf16 v[76:79], v[40:43], a[168:175], v3
  s_mov_b32 exec_hi, 0
  buffer_store_dwordx4 v[140:143], v2, s[8:11], s100 offen offset:2048 sc1
  s_mov_b32 exec_hi, -1
  v_smfmac_f32_16x16x64_bf16 v[80:83], v[40:43], a[32:39], v3
  buffer_load_dword v22, v21, s[8:11], 0 offen sc1
  v_smfmac_f32_16x16x64_bf16 v[84:87], v[40:43], a[176:183], v3
  buffer_load_dword v26, v29, s[8:11], s38 offen sc1
  v_smfmac_f32_16x16x64_bf16 v[88:91], v[40:43], a[40:47], v3
  buffer_load_dword v26, v30, s[8:11], s38 offen sc1
  v_smfmac_f32_16x16x64_bf16 v[92:95], v[40:43], a[184:191], v3
  s_waitcnt lgkmcnt(12)
  s_waitcnt lgkmcnt(4)
  v_smfmac_f32_16x16x64_bf16 v[72:75], v[44:47], v[96:103], v3
  ds_read_b128 v[96:99], v7 offset:24576
  v_smfmac_f32_16x16x64_bf16 v[76:79], v[44:47], a[192:199], v3
  ds_read_b128 v[100:103], v7 offset:25600
  v_smfmac_f32_16x16x64_bf16 v[72:75], v[48:51], a[48:55], v3
  v_smfmac_f32_16x16x64_bf16 v[76:79], v[48:51], a[216:223], v3
  s_waitcnt lgkmcnt(4)
  v_smfmac_f32_16x16x64_bf16 v[72:75], v[52:55], v[104:111], v3
  ds_read_b128 v[104:107], v7 offset:8192
  v_smfmac_f32_16x16x64_bf16 v[76:79], v[52:55], a[240:247], v3
  ds_read_b128 v[108:111], v7 offset:9216
  v_smfmac_f32_16x16x64_bf16 v[72:75], v[56:59], a[72:79], v3
  s_cmp_lg_u32 s80, 63
  s_cbranch_scc1 q63_7
  s_add_u32 s27, s35, 67239936
  buffer_load_dwordx4 v[132:135], v2, s[8:11], s27 offen offset:0 sc1
  buffer_load_dwordx4 v[136:139], v2, s[8:11], s27 offen offset:1024 sc1
  buffer_load_dwordx4 v[140:143], v2, s[8:11], s27 offen offset:2048 sc1
q63_7:
  v_smfmac_f32_16x16x64_bf16 v[76:79], v[56:59], v[160:167], v3
  s_waitcnt lgkmcnt(4)
  v_smfmac_f32_16x16x64_bf16 v[72:75], v[60:63], v[112:119], v3
  ds_read_b128 v[112:115], v7 offset:14336
  v_smfmac_f32_16x16x64_bf16 v[76:79], v[60:63], v[184:191], v3
  ds_read_b128 v[116:119], v7 offset:15360
  v_smfmac_f32_16x16x64_bf16 v[72:75], v[64:67], a[96:103], v3
  v_smfmac_f32_16x16x64_bf16 v[76:79], v[64:67], v[208:215], v3
  s_waitcnt lgkmcnt(4)
  v_smfmac_f32_16x16x64_bf16 v[72:75], v[68:71], v[96:103], v3
  ds_read_b128 v[96:99], v7 offset:20480
  v_smfmac_f32_16x16x64_bf16 v[76:79], v[68:71], v[232:239], v3
  ds_read_b128 v[100:103], v7 offset:21504
  s_waitcnt lgkmcnt(4)
  v_smfmac_f32_16x16x64_bf16 v[80:83], v[44:47], v[104:111], v3
  ds_read_b128 v[104:107], v7 offset:26624
  v_smfmac_f32_16x16x64_bf16 v[84:87], v[44:47], a[200:207], v3
  ds_read_b128 v[108:111], v7 offset:27648
  v_smfmac_f32_16x16x64_bf16 v[80:83], v[48:51], a[56:63], v3
  v_smfmac_f32_16x16x64_bf16 v[84:87], v[48:51], a[224:231], v3
  s_waitcnt lgkmcnt(4)
  v_smfmac_f32_16x16x64_bf16 v[80:83], v[52:55], v[112:119], v3
  ds_read_b128 v[112:115], v7 offset:10240
  v_smfmac_f32_16x16x64_bf16 v[84:87], v[52:55], a[248:255], v3
  ds_read_b128 v[116:119], v7 offset:11264
  v_smfmac_f32_16x16x64_bf16 v[80:83], v[56:59], a[80:87], v3
  v_add_f32 v72, v72, v74
  v_smfmac_f32_16x16x64_bf16 v[84:87], v[56:59], v[168:175], v3
  v_add_f32 v73, v73, v75
  s_waitcnt lgkmcnt(4)
  v_smfmac_f32_16x16x64_bf16 v[80:83], v[60:63], v[96:103], v3
  ds_read_b128 v[96:99], v7 offset:16384
  v_smfmac_f32_16x16x64_bf16 v[84:87], v[60:63], v[192:199], v3
  ds_read_b128 v[100:103], v7 offset:17408
  v_smfmac_f32_16x16x64_bf16 v[80:83], v[64:67], a[104:111], v3
  v_add_f32 v76, v76, v78
  v_smfmac_f32_16x16x64_bf16 v[84:87], v[64:67], v[216:223], v3
  v_add_f32 v77, v77, v79
  s_waitcnt lgkmcnt(4)
  v_smfmac_f32_16x16x64_bf16 v[80:83], v[68:71], v[104:111], v3
  ds_read_b128 v[104:107], v7 offset:22528
  v_smfmac_f32_16x16x64_bf16 v[84:87], v[68:71], v[240:247], v3
  ds_read_b128 v[108:111], v7 offset:23552
  s_waitcnt lgkmcnt(4)
  v_smfmac_f32_16x16x64_bf16 v[88:91], v[44:47], v[112:119], v3
  ds_read_b128 v[112:115], v7 offset:28672
  v_smfmac_f32_16x16x64_bf16 v[92:95], v[44:47], a[208:215], v3
  ds_read_b128 v[116:119], v7 offset:29696
  v_smfmac_f32_16x16x64_bf16 v[88:91], v[48:51], a[64:71], v3
  v_cvt_pk_bf16_f32 v150, v72, v73
  v_smfmac_f32_16x16x64_bf16 v[92:95], v[48:51], a[232:239], v3
  ds_write_b32 v8, v150 offset:0
  s_waitcnt lgkmcnt(5)
  v_smfmac_f32_16x16x64_bf16 v[88:91], v[52:55], v[96:103], v3
  v_cvt_pk_bf16_f32 v151, v76, v77
  v_smfmac_f32_16x16x64_bf16 v[92:95], v[52:55], v[152:159], v3
  ds_write_b32 v8, v151 offset:16
  v_smfmac_f32_16x16x64_bf16 v[88:91], v[56:59], a[88:95], v3
  v_add_f32 v80, v80, v82
  v_smfmac_f32_16x16x64_bf16 v[92:95], v[56:59], v[176:183], v3
  v_add_f32 v81, v81, v83
  s_waitcnt lgkmcnt(4)
  v_smfmac_f32_16x16x64_bf16 v[88:91], v[60:63], v[104:111], v3
  v_add_f32 v84, v84, v86
  v_smfmac_f32_16x16x64_bf16 v[92:95], v[60:63], v[200:207], v3
  v_add_f32 v85, v85, v87
  v_smfmac_f32_16x16x64_bf16 v[88:91], v[64:67], a[112:119], v3
  v_cvt_pk_bf16_f32 v150, v80, v81
  v_smfmac_f32_16x16x64_bf16 v[92:95], v[64:67], v[224:231], v3
  ds_write_b32 v8, v150 offset:512
  s_waitcnt lgkmcnt(3)
  v_smfmac_f32_16x16x64_bf16 v[88:91], v[68:71], v[112:119], v3
  v_cvt_pk_bf16_f32 v151, v84, v85
  v_smfmac_f32_16x16x64_bf16 v[92:95], v[68:71], v[248:255], v3
  ds_write_b32 v8, v151 offset:528
  ds_read_b64_tr_b16 v[144:145], v9 offset:0
  ds_read_b64_tr_b16 v[146:147], v9 offset:512
  s_nop 2
  v_pk_add_f32 v[88:89], v[88:89], v[90:91]
  s_nop 0
  v_pk_add_f32 v[92:93], v[92:93], v[94:95]
  v_cvt_pk_bf16_f32 v150, v88, v89
  ds_write_b32 v8, v150 offset:1024
  v_cvt_pk_bf16_f32 v151, v92, v93
  ds_write_b32 v8, v151 offset:1040
  ds_read_b64_tr_b16 v[148:149], v9 offset:1024
  s_cmp_eq_u32 s80, 63
  s_cbranch_scc1 CQ_last
  s_waitcnt lgkmcnt(3)
  v_mfma_f32_16x16x32_bf16 v[72:75], v[120:123], v[144:147], 0
  v_mfma_f32_16x16x32_bf16 v[76:79], v[124:127], v[144:147], 0
  v_mfma_f32_16x16x32_bf16 v[80:83], v[144:147], v[144:147], 0
  s_waitcnt lgkmcnt(0)
  v_mfma_f32_16x16x16_bf16 v[72:75], v[128:129], v[148:149], v[72:75]
  v_mfma_f32_16x16x16_bf16 v[76:79], v[130:131], v[148:149], v[76:79]
  v_mfma_f32_16x16x16_bf16 v[80:83], v[148:149], v[148:149], v[80:83]
  s_mov_b32 exec_lo, 0xff00ff
  s_mov_b32 exec_hi, 0xff00ff
  s_nop 3
  ds_write_b128 v10, v[72:75]
  ds_write_b128 v10, v[76:79] offset:64
  s_mov_b32 exec_lo, 0
  ds_write_b128 v10, v[80:83] offset:96
  s_mov_b64 exec, -1
  s_cmp_lg_u32 s24, 0
  s_waitcnt lgkmcnt(0)
  s_barrier
  s_cbranch_scc1 CQ_side0
  ds_read2_b64 v[32:35], v12 offset0:0 offset1:8
  ds_read2_b64 v[36:39], v12 offset0:160 offset1:168
  ds_read2st64_b32 v[48:49], v14 offset0:0 offset1:5
  ds_read2_b64 v[40:43], v13 offset0:0 offset1:8
  ds_read2_b64 v[44:47], v13 offset0:160 offset1:168
  ds_read2st64_b32 v[50:51], v14 offset0:10 offset1:15
  s_waitcnt lgkmcnt(3)
  v_pk_add_f32 v[32:33], v[32:33], v[36:37]
  v_pk_add_f32 v[34:35], v[34:35], v[38:39]
  v_add_f32 v48, v48, v49
  s_waitcnt lgkmcnt(0)
  v_pk_add_f32 v[40:41], v[40:41], v[44:45]
  v_pk_add_f32 v[42:43], v[42:43], v[46:47]
  v_add_f32 v50, v50, v51
  v_pk_add_f32 v[32:33], v[32:33], v[40:41]
  v_pk_add_f32 v[34:35], v[34:35], v[42:43]
  v_add_f32 v48, v48, v50
  v_max3_f32 v52, v32, v33, v34
  v_max3_f32 v52, v52, v35, v48
  v_pk_mul_f32 v[32:33], v[32:33], s[92:93]
  s_nop 0
  v_max_f32_dpp v52, v52, v52 quad_perm:[1,0,3,2] row_mask:0xf bank_mask:0xf
  v_pk_mul_f32 v[34:35], v[34:35], s[92:93]
  s_nop 0
  v_max_f32_dpp v52, v52, v52 quad_perm:[2,3,0,1] row_mask:0xf bank_mask:0xf
  v_mul_f32 v48, s92, v48
  s_nop 0
  v_max_f32_dpp v52, v52, v52 row_half_mirror row_mask:0xf bank_mask:0xf
  v_mul_f32 v52, s92, v52
  v_pk_add_f32 v[32:33], v[32:33], v[52:53] op_sel_hi:[1,0] neg_lo:[0,1] neg_hi:[0,1]
  v_pk_add_f32 v[34:35], v[34:35], v[52:53] op_sel_hi:[1,0] neg_lo:[0,1] neg_hi:[0,1]
  v_sub_f32 v48, v48, v52
  v_exp_f32 v32, v32
  v_exp_f32 v33, v33
  v_exp_f32 v34, v34
  v_exp_f32 v35, v35
  v_exp_f32 v48, v48
  v_pk_add_f32 v[52:53], v[32:33], v[34:35]
  v_add_f32 v52, v52, v53
  v_add_f32 v52, v52, v48
  s_nop 1
  v_add_f32_dpp v52, v52, v52 quad_perm:[1,0,3,2] row_mask:0xf bank_mask:0xf
  s_nop 1
  v_add_f32_dpp v52, v52, v52 quad_perm:[2,3,0,1] row_mask:0xf bank_mask:0xf
  s_nop 1
  v_add_f32_dpp v52, v52, v52 row_half_mirror row_mask:0xf bank_mask:0xf
  v_rcp_f32 v52, v52
  s_nop 0
  v_mul_f32 v48, v48, v52
  v_pk_mul_f32 v[32:33], v[32:33], v[52:53] op_sel_hi:[1,0]
  v_pk_mul_f32 v[34:35], v[34:35], v[52:53] op_sel_hi:[1,0]
  v_mov_b32_dpp v49, v48 quad_perm:[1,0,3,2] row_mask:0xf bank_mask:0xf
  v_cvt_pk_bf16_f32 v36, v32, v33
  v_cvt_pk_bf16_f32 v37, v34, v35
  v_cvt_pk_bf16_f32 v38, v48, v49
  v_and_or_b32 v36, v36, v27, s73
  v_and_or_b32 v37, v37, v27, s73
  buffer_store_dwordx2 v[36:37], v17, s[8:11], s72 offen
  v_and_or_b32 v38, v38, v27, s73
  s_mov_b32 exec_lo, 0x55555555
  s_mov_b32 exec_hi, 0x55555555
  buffer_store_dword v38, v18, s[8:11], s72 offen
  s_mov_b64 exec, -1
  s_waitcnt vmcnt(4)
  s_branch CQ_side
CQ_rem:
  buffer_load_dwordx4 v[56:59], v2, s[8:11], s90 offen sc1
  buffer_load_dwordx4 v[60:63], v2, s[8:11], s87 offen sc1
  buffer_load_dwordx4 v[64:67], v2, s[8:11], s67 offen sc1
  s_add_u32 s26, s26, 1
  s_mov_b32 s39, 67
  s_cmp_gt_u32 s26, 2097152
  s_cbranch_scc1 L_abort
  s_waitcnt vmcnt(1)
  v_bitop3_b32 v68, v56, v60, s79 bitop3:0x7e
  s_waitcnt vmcnt(0)
  v_bitop3_b32 v68, v68, v64, s79 bitop3:0xf6
  v_and_b32 v68, 1, v68
  v_cmp_ne_u32 vcc, 0, v68
  s_cbranch_vccnz CQ_rem
  s_branch CQ_got
CQ_side0:
  s_waitcnt vmcnt(2)
CQ_side:
  s_barrier
  s_mov_b32 exec_lo, 0xff00ff00
  s_mov_b32 exec_hi, 0xff00ff00
  buffer_store_dwordx4 v[144:147], v2, s[8:11], s36 offen sc1
  buffer_store_dwordx2 v[148:149], v11, s[8:11], s76 offen sc1
  s_mov_b64 exec, -1
  s_add_u32 s33, s80, 1
  s_cmp_eq_u32 s33, 63
  s_cselect_b32 s30, 3, 1
  v_cmp_ge_u32 vcc, s33, v22
  s_nop 0
  s_and_b32 s27, vcc_lo, s30
  s_cbranch_scc0 CQ_kq
  s_mov_b32 exec_lo, s30
  s_mov_b32 exec_hi, 0
wp_8:
  buffer_load_dword v22, v21, s[8:11], 0 offen sc1
  s_add_u32 s26, s26, 1
  s_mov_b32 s39, 68
  s_cmp_gt_u32 s26, 2097152
  s_cbranch_scc1 L_abort
  s_waitcnt vmcnt(0)
  v_cmp_ge_u32 vcc, s33, v22
  s_cbranch_vccnz wp_8
  s_mov_b64 exec, -1
CQ_kq:
  s_add_u32 s27, s35, 42467328
  buffer_load_dwordx4 v[120:123], v2, s[8:11], s27 offen offset:0 sc1
  buffer_load_dwordx4 v[124:127], v2, s[8:11], s27 offen offset:1024 sc1
  buffer_load_dwordx4 v[128:131], v2, s[8:11], s27 offen offset:2048 sc1
  s_add_u32 s35, s35, 393216
  s_mul_i32 s72, s88, 327680
  s_add_u32 s72, s72, s78
  s_add_u32 s72, s72, 262144
  v_and_b32 v24, 511, v2
  s_cmp_eq_u32 s80, 99
  s_cselect_b32 s27, 0, 131072
  s_cselect_b32 s30, 0, 65536
  s_add_u32 s36, s36, s27
  s_add_u32 s76, s76, s30
  s_mul_i32 s100, s80, 327680
  s_add_u32 s100, s100, s78
  s_add_u32 s100, s100, 21495808
  ds_read_b128 v[96:99], v7 offset:0
  ds_read_b128 v[100:103], v7 offset:1024
  ds_read_b128 v[104:107], v7 offset:2048
  ds_read_b128 v[108:111], v7 offset:3072
  ds_read_b128 v[112:115], v7 offset:4096
  ds_read_b128 v[116:119], v7 offset:5120
  v_mov_b64 v[72:73], 0
  v_mov_b64 v[74:75], 0
  v_mov_b64 v[76:77], 0
  v_mov_b64 v[78:79], 0
  v_mov_b64 v[80:81], 0
  v_mov_b64 v[82:83], 0
  v_mov_b64 v[84:85], 0
  v_mov_b64 v[86:87], 0
  v_mov_b64 v[88:89], 0
  v_mov_b64 v[90:91], 0
  v_mov_b64 v[92:93], 0
  v_mov_b64 v[94:95], 0
  s_waitcnt lgkmcnt(0)
  s_sleep 8
  buffer_load_dwordx4 v[132:135], v2, s[8:11], s72 offen offset:0 sc1
  buffer_load_dwordx4 v[136:139], v2, s[8:11], s72 offen offset:1024 sc1
  buffer_load_dwordx4 v[140:143], v24, s[8:11], s72 offen offset:2048 sc1
  s_waitcnt vmcnt(1)
  v_bitop3_b32 v32, v132, v136, s79 bitop3:0x7e
  s_waitcnt vmcnt(0)
  v_bitop3_b32 v32, v32, v140, s79 bitop3:0xf6
  v_and_b32 v32, 1, v32
  v_cmp_ne_u32 vcc, 0, v32
  s_cbranch_vccnz CQ_ucp
CQ_ucd:
  s_add_u32 s80, s80, 1
  s_branch CQ_step
CQ_last:
  v_and_b32 v41, 15, v1
  v_lshrrev_b32 v42, 4, v1
  v_lshrrev_b32 v43, 3, v1
  v_and_b32 v44, 7, v1
  v_mul_u32_u24 v11, 160, v41
  v_lshl_add_u32 v11, v42, 4, v11
  s_mul_i32 s27, s24, 5120
  s_add_u32 s27, s27, 139264
  v_add_u32 v11, s27, v11
  s_waitcnt vmcnt(0) lgkmcnt(0)
  v_mfma_f32_16x16x32_bf16 v[72:75], v[144:147], v[132:135], 0
  v_mfma_f32_16x16x32_bf16 v[76:79], v[120:123], v[132:135], 0
  v_mfma_f32_16x16x32_bf16 v[80:83], v[124:127], v[132:135], 0
  v_mfma_f32_16x16x32_bf16 v[84:87], v[144:147], v[136:139], 0
  v_mfma_f32_16x16x32_bf16 v[88:91], v[120:123], v[136:139], 0
  v_mfma_f32_16x16x32_bf16 v[92:95], v[124:127], v[136:139], 0
  v_mfma_f32_16x16x16_bf16 v[72:75], v[148:149], v[140:141], v[72:75]
  v_mfma_f32_16x16x16_bf16 v[76:79], v[128:129], v[140:141], v[76:79]
  v_mfma_f32_16x16x16_bf16 v[80:83], v[130:131], v[140:141], v[80:83]
  v_mfma_f32_16x16x16_bf16 v[84:87], v[148:149], v[142:143], v[84:87]
  v_mfma_f32_16x16x16_bf16 v[88:91], v[128:129], v[142:143], v[88:91]
  v_mfma_f32_16x16x16_bf16 v[92:95], v[130:131], v[142:143], v[92:95]
  v_and_b32 v45, 1, v1
  v_lshrrev_b32 v46, 1, v44
  v_mul_u32_u24 v47, 160, v43
  s_mul_i32 s27, s24, 1280
  s_add_u32 s27, s27, 139264
  v_add_u32 v47, s27, v47
  v_lshl_add_u32 v15, v45, 6, v47
  v_lshl_add_u32 v15, v46, 4, v15
  v_lshl_add_u32 v16, v44, 2, v47
  v_add_u32 v16, 128, v16
  s_and_b32 s30, s24, 1
  s_lshl_b32 s30, s30, 7
  s_lshr_b32 s31, s24, 1
  s_lshl_b32 s31, s31, 10
  s_add_u32 s30, s30, s31
  s_lshl_b32 s27, s25, 11
  s_add_u32 s27, s27, s30
  v_lshlrev_b32 v19, 8, v46
  v_lshl_add_u32 v19, v43, 4, v19
  v_lshl_add_u32 v19, v45, 3, v19
  v_add_u32 v19, s27, v19
  s_lshr_b32 s27, s25, 2
  s_lshl_b32 s27, s27, 11
  s_and_b32 s31, s25, 3
  s_lshl_b32 s31, s31, 8
  s_add_u32 s27, s27, s31
  s_add_u32 s27, s27, s30
  s_add_u32 s27, s27, 65536
  v_lshlrev_b32 v20, 4, v43
  v_lshl_add_u32 v20, v46, 2, v20
  v_add_u32 v20, s27, v20
  ds_write_b128 v11, v[76:79] offset:0
  ds_write_b128 v11, v[80:83] offset:64
  ds_write_b128 v11, v[88:91] offset:2560
  ds_write_b128 v11, v[92:95] offset:2624
  s_mov_b32 exec_lo, 0
  ds_write_b128 v11, v[72:75] offset:96
  ds_write_b128 v11, v[84:87] offset:2656
  s_mov_b64 exec, -1
  s_lshl_b32 s27, s24, 3
  v_add_u32 v41, s27, v43
  v_lshlrev_b32 v42, 4, v45
  v_lshl_add_u32 v42, v46, 2, v42
  v_add_u32 v47, 0, v42
  v_cmp_le_u32 s[94:95], v47, v41
  v_add_u32 v47, 1, v42
  v_cmp_le_u32 s[96:97], v47, v41
  v_add_u32 v47, 2, v42
  v_cmp_le_u32 s[98:99], v47, v41
  v_add_u32 v47, 3, v42
  v_cmp_le_u32 s[86:87], v47, v41
  s_mul_i32 s72, s88, 327680
  s_add_u32 s72, s72, s78
  s_add_u32 s72, s72, 262144
  s_mul_i32 s100, s80, 327680
  s_add_u32 s100, s100, s78
  s_add_u32 s100, s100, 21495808
  v_and_b32 v24, 511, v2
  s_waitcnt lgkmcnt(0)
  s_barrier
  buffer_load_dwordx4 v[132:135], v2, s[8:11], s72 offen offset:0 sc1
  buffer_load_dwordx4 v[136:139], v2, s[8:11], s72 offen offset:1024 sc1
  buffer_load_dwordx4 v[140:143], v24, s[8:11], s72 offen offset:2048 sc1
  ds_read_b128 v[32:35], v15 offset:0
  ds_read_b128 v[36:39], v15 offset:5120
  ds_read_b128 v[40:43], v15 offset:10240
  ds_read_b128 v[44:47], v15 offset:15360
  ds_read2st64_b32 v[48:49], v16 offset0:0 offset1:20
  ds_read2st64_b32 v[50:51], v16 offset0:40 offset1:60
  v_mov_b32 v54, 0xceabfb8f
  s_waitcnt lgkmcnt(0)
  v_pk_add_f32 v[32:33], v[32:33], v[36:37]
  v_pk_add_f32 v[40:41], v[40:41], v[44:45]
  v_pk_add_f32 v[34:35], v[34:35], v[38:39]
  v_pk_add_f32 v[42:43], v[42:43], v[46:47]
  v_pk_add_f32 v[32:33], v[32:33], v[40:41]
  v_pk_add_f32 v[34:35], v[34:35], v[42:43]
  v_add_f32 v48, v48, v49
  v_add_f32 v50, v50, v51
  v_add_f32 v48, v48, v50
  v_pk_mul_f32 v[32:33], v[32:33], s[92:93]
  v_pk_mul_f32 v[34:35], v[34:35], s[92:93]
  v_mul_f32 v48, s92, v48
  v_cndmask_b32 v32, v54, v32, s[94:95]
  v_cndmask_b32 v33, v54, v33, s[96:97]
  v_cndmask_b32 v34, v54, v34, s[98:99]
  v_cndmask_b32 v35, v54, v35, s[86:87]
  v_max3_f32 v52, v32, v33, v34
  v_max3_f32 v52, v52, v35, v48
  s_nop 1
  v_max_f32_dpp v52, v52, v52 quad_perm:[1,0,3,2] row_mask:0xf bank_mask:0xf
  s_nop 1
  v_max_f32_dpp v52, v52, v52 quad_perm:[2,3,0,1] row_mask:0xf bank_mask:0xf
  s_nop 1
  v_max_f32_dpp v52, v52, v52 row_half_mirror row_mask:0xf bank_mask:0xf
  v_pk_add_f32 v[32:33], v[32:33], v[52:53] op_sel_hi:[1,0] neg_lo:[0,1] neg_hi:[0,1]
  v_pk_add_f32 v[34:35], v[34:35], v[52:53] op_sel_hi:[1,0] neg_lo:[0,1] neg_hi:[0,1]
  v_sub_f32 v48, v48, v52
  v_exp_f32 v32, v32
  v_exp_f32 v33, v33
  v_exp_f32 v34, v34
  v_exp_f32 v35, v35
  v_exp_f32 v48, v48
  v_pk_add_f32 v[52:53], v[32:33], v[34:35]
  v_add_f32 v52, v52, v53
  v_add_f32 v52, v52, v48
  s_nop 1
  v_add_f32_dpp v52, v52, v52 quad_perm:[1,0,3,2] row_mask:0xf bank_mask:0xf
  s_nop 1
  v_add_f32_dpp v52, v52, v52 quad_perm:[2,3,0,1] row_mask:0xf bank_mask:0xf
  s_nop 1
  v_add_f32_dpp v52, v52, v52 row_half_mirror row_mask:0xf bank_mask:0xf
  v_rcp_f32 v52, v52
  s_nop 0
  v_mul_f32 v48, v48, v52
  v_pk_mul_f32 v[32:33], v[32:33], v[52:53] op_sel_hi:[1,0]
  v_pk_mul_f32 v[34:35], v[34:35], v[52:53] op_sel_hi:[1,0]
  v_mov_b32_dpp v49, v48 quad_perm:[1,0,3,2] row_mask:0xf bank_mask:0xf
  v_cvt_pk_bf16_f32 v36, v32, v33
  v_cvt_pk_bf16_f32 v37, v34, v35
  v_cvt_pk_bf16_f32 v38, v48, v49
  s_mov_b32 s27, 21413888
  buffer_store_dwordx2 v[36:37], v19, s[8:11], s27 offen sc1
  s_mov_b32 exec_lo, 0x55555555
  s_mov_b32 exec_hi, 0x55555555
  buffer_store_dword v38, v20, s[8:11], s27 offen sc1
  s_mov_b64 exec, -1
  s_waitcnt vmcnt(3)
  v_bitop3_b32 v40, v132, v136, s79 bitop3:0x7e
  s_waitcnt vmcnt(2)
  v_bitop3_b32 v40, v40, v140, s79 bitop3:0xf6
  v_and_b32 v40, 1, v40
  v_cmp_ne_u32 vcc, 0, v40
  s_cbranch_vccnz CQ_lu
  s_branch CQ_lu2
CQ_lu:
  buffer_load_dwordx4 v[132:135], v2, s[8:11], s72 offen offset:0 sc1
  buffer_load_dwordx4 v[136:139], v2, s[8:11], s72 offen offset:1024 sc1
  buffer_load_dwordx4 v[140:143], v24, s[8:11], s72 offen offset:2048 sc1
  s_add_u32 s26, s26, 1
  s_mov_b32 s39, 71
  s_cmp_gt_u32 s26, 2097152
  s_cbranch_scc1 L_abort
  s_waitcnt vmcnt(1)
  v_bitop3_b32 v40, v132, v136, s79 bitop3:0x7e
  s_waitcnt vmcnt(0)
  v_bitop3_b32 v40, v40, v140, s79 bitop3:0xf6
  v_and_b32 v40, 1, v40
  v_cmp_ne_u32 vcc, 0, v40
  s_cbranch_vccnz CQ_lu
CQ_lu2:
  buffer_store_dwordx4 v[132:135], v2, s[8:11], s100 offen offset:0 sc1
  buffer_store_dwordx4 v[136:139], v2, s[8:11], s100 offen offset:1024 sc1
  s_mov_b32 exec_hi, 0
  buffer_store_dwordx4 v[140:143], v2, s[8:11], s100 offen offset:2048 sc1
  s_mov_b32 exec_hi, -1
  v_mov_b32 v31, 65
  s_waitcnt vmcnt(0)
  s_mov_b64 exec, 1
  buffer_store_dword v31, off, s[8:11], s34 sc1
  s_mov_b64 exec, -1
  s_endpgm
CQ_ucp:
  buffer_load_dwordx4 v[132:135], v2, s[8:11], s72 offen offset:0 sc1
  buffer_load_dwordx4 v[136:139], v2, s[8:11], s72 offen offset:1024 sc1
  buffer_load_dwordx4 v[140:143], v24, s[8:11], s72 offen offset:2048 sc1
  s_add_u32 s26, s26, 1
  s_mov_b32 s39, 70
  s_cmp_gt_u32 s26, 2097152
  s_cbranch_scc1 L_abort
  s_waitcnt vmcnt(1)
  v_bitop3_b32 v32, v132, v136, s79 bitop3:0x7e
  s_waitcnt vmcnt(0)
  v_bitop3_b32 v32, v32, v140, s79 bitop3:0xf6
  v_and_b32 v32, 1, v32
  v_cmp_ne_u32 vcc, 0, v32
  s_cbranch_vccnz CQ_ucp
  s_branch CQ_ucd
CQS_step:
  s_and_b32 s88, s80, 1
  s_lshl_b32 s81, s88, 16
  s_bfe_u32 s82, s80, 0x10001
  s_sub_u32 s79, 0, s82
  s_add_u32 s89, s81, s86
  s_mul_i32 s27, s88, 0x18000
  s_add_u32 s90, s27, s64
  s_add_u32 s87, s27, s65
  s_add_u32 s67, s27, s66
CQS_can:
  buffer_load_dword v68, v28, s[8:11], 0 offen sc1
  s_add_u32 s26, s26, 1
  s_mov_b32 s39, 66
  s_cmp_gt_u32 s26, 2097152
  s_cbranch_scc1 L_abort
  s_waitcnt vmcnt(0)
  v_cmp_gt_u32 vcc, s80, v68
  s_cbranch_vccz CQS_can2
  s_sleep 1
  s_branch CQS_can
CQS_can2:
CQS_loc:
  buffer_load_dwordx4 v[32:35], v4, s[8:11], s89 offen offset:0 sc1
  buffer_load_dwordx4 v[36:39], v4, s[8:11], s89 offen offset:1024 sc1
  buffer_load_dwordx4 v[40:43], v4, s[8:11], s89 offen offset:2048 sc1
  s_add_u32 s26, s26, 1
  s_mov_b32 s39, 66
  s_cmp_gt_u32 s26, 2097152
  s_cbranch_scc1 L_abort
  s_waitcnt vmcnt(1)
  v_bitop3_b32 v68, v32, v36, s79 bitop3:0x7e
  s_waitcnt vmcnt(0)
  v_bitop3_b32 v68, v68, v40, s79 bitop3:0xf6
  v_and_b32 v68, 1, v68
  v_cmp_ne_u32 vcc, 0, v68
  s_cbranch_vccnz CQS_loc
  buffer_load_dwordx4 v[56:59], v2, s[8:11], s90 offen sc1
  buffer_load_dwordx4 v[60:63], v2, s[8:11], s87 offen sc1
  buffer_load_dwordx4 v[64:67], v2, s[8:11], s67 offen sc1
CQS_x0:
  s_lshl_b32 s72, s88, 1
  s_add_u32 s72, s72, s29
  s_lshl_b32 s72, s72, 14
  s_add_u32 s72, s72, 196608
  s_mul_i32 s73, s82, 0x80008000
  v_mov_b32 v31, s80
  s_add_u32 s30, s80, 1
  v_cmp_ge_i32 vcc, s30, v22
  s_nop 0
  s_and_b32 s30, vcc_lo, 0xf0
  s_cmp_eq_u32 s30, 0
  s_cselect_b32 s38, s37, 2097152
  s_add_u32 s37, s37, 1310720
  v_lshlrev_b32 v44, 16, v32
  v_and_b32 v32, 0xffff0000, v32
  v_lshlrev_b32 v45, 16, v33
  v_and_b32 v33, 0xffff0000, v33
  v_lshlrev_b32 v46, 16, v34
  v_and_b32 v34, 0xffff0000, v34
  v_lshlrev_b32 v47, 16, v35
  v_and_b32 v35, 0xffff0000, v35
  v_lshlrev_b32 v48, 16, v36
  v_and_b32 v36, 0xffff0000, v36
  v_lshlrev_b32 v49, 16, v37
  v_and_b32 v37, 0xffff0000, v37
  v_lshlrev_b32 v50, 16, v38
  v_and_b32 v38, 0xffff0000, v38
  v_lshlrev_b32 v51, 16, v39
  v_and_b32 v39, 0xffff0000, v39
  v_lshlrev_b32 v52, 16, v40
  v_and_b32 v40, 0xffff0000, v40
  v_lshlrev_b32 v53, 16, v41
  v_and_b32 v41, 0xffff0000, v41
  v_lshlrev_b32 v54, 16, v42
  v_and_b32 v42, 0xffff0000, v42
  v_lshlrev_b32 v55, 16, v43
  v_and_b32 v43, 0xffff0000, v43
  s_waitcnt vmcnt(1)
  v_bitop3_b32 v68, v56, v60, s79 bitop3:0x7e
  s_waitcnt vmcnt(0)
  v_bitop3_b32 v68, v68, v64, s79 bitop3:0xf6
  v_and_b32 v68, 1, v68
  v_cmp_ne_u32 vcc, 0, v68
  s_cbranch_vccnz CQS_rem
CQS_got:
  v_dot2_f32_bf16 v44, v56, s83, v44
  v_dot2_f32_bf16 v32, v56, s84, v32
  v_dot2_f32_bf16 v45, v57, s83, v45
  v_dot2_f32_bf16 v33, v57, s84, v33
  v_dot2_f32_bf16 v46, v58, s83, v46
  v_dot2_f32_bf16 v34, v58, s84, v34
  v_dot2_f32_bf16 v47, v59, s83, v47
  v_dot2_f32_bf16 v35, v59, s84, v35
  v_dot2_f32_bf16 v48, v60, s83, v48
  v_dot2_f32_bf16 v36, v60, s84, v36
  v_dot2_f32_bf16 v49, v61, s83, v49
  v_dot2_f32_bf16 v37, v61, s84, v37
  v_dot2_f32_bf16 v50, v62, s83, v50
  v_dot2_f32_bf16 v38, v62, s84, v38
  v_dot2_f32_bf16 v51, v63, s83, v51
  v_dot2_f32_bf16 v39, v63, s84, v39
  v_cvt_pk_bf16_f32 v32, v44, v32
  v_cvt_pk_bf16_f32 v33, v45, v33
  v_cvt_pk_bf16_f32 v34, v46, v34
  v_cvt_pk_bf16_f32 v35, v47, v35
  ds_write_b128 v5, v[32:35] offset:0
  v_dot2_f32_bf16 v52, v64, s83, v52
  v_dot2_f32_bf16 v40, v64, s84, v40
  v_dot2_f32_bf16 v53, v65, s83, v53
  v_dot2_f32_bf16 v41, v65, s84, v41
  v_dot2_f32_bf16 v54, v66, s83, v54
  v_dot2_f32_bf16 v42, v66, s84, v42
  v_dot2_f32_bf16 v55, v67, s83, v55
  v_dot2_f32_bf16 v43, v67, s84, v43
  v_cvt_pk_bf16_f32 v36, v48, v36
  v_cvt_pk_bf16_f32 v37, v49, v37
  v_cvt_pk_bf16_f32 v38, v50, v38
  v_cvt_pk_bf16_f32 v39, v51, v39
  ds_write_b128 v5, v[36:39] offset:1024
  v_smfmac_f32_16x16x64_bf16 v[72:75], v[32:35], a[0:7], v3
  s_nop 1
  v_cvt_pk_bf16_f32 v40, v52, v40
  v_cvt_pk_bf16_f32 v41, v53, v41
  v_cvt_pk_bf16_f32 v42, v54, v42
  v_cvt_pk_bf16_f32 v43, v55, v43
  ds_write_b128 v5, v[40:43] offset:2048
  v_smfmac_f32_16x16x64_bf16 v[76:79], v[32:35], a[120:127], v3
  v_smfmac_f32_16x16x64_bf16 v[80:83], v[32:35], a[8:15], v3
  v_smfmac_f32_16x16x64_bf16 v[84:87], v[32:35], a[128:135], v3
  s_waitcnt lgkmcnt(0)
  s_barrier
  ds_read_b128 v[44:47], v0 offset:3072
  ds_read_b128 v[48:51], v6 offset:4096
  ds_read_b128 v[52:55], v6 offset:5120
  ds_read_b128 v[56:59], v6 offset:6144
  ds_read_b128 v[60:63], v23 offset:7168
  ds_read_b128 v[64:67], v23 offset:8192
  ds_read_b128 v[68:71], v23 offset:9216
  v_smfmac_f32_16x16x64_bf16 v[88:91], v[32:35], a[16:23], v3
  s_mov_b64 exec, 1
  buffer_store_dword v31, off, s[8:11], s34 sc1
  s_mov_b64 exec, -1
  v_smfmac_f32_16x16x64_bf16 v[92:95], v[32:35], a[136:143], v3
  buffer_store_dwordx4 v[132:135], v2, s[8:11], s100 offen offset:0 sc1
  v_smfmac_f32_16x16x64_bf16 v[72:75], v[36:39], v[96:103], v3
  ds_read_b128 v[96:99], v7 offset:6144
  v_smfmac_f32_16x16x64_bf16 v[76:79], v[36:39], a[144:151], v3
  ds_read_b128 v[100:103], v7 offset:7168
  v_smfmac_f32_16x16x64_bf16 v[80:83], v[36:39], v[104:111], v3
  ds_read_b128 v[104:107], v7 offset:12288
  v_smfmac_f32_16x16x64_bf16 v[84:87], v[36:39], a[152:159], v3
  ds_read_b128 v[108:111], v7 offset:13312
  v_smfmac_f32_16x16x64_bf16 v[88:91], v[36:39], v[112:119], v3
  ds_read_b128 v[112:115], v7 offset:18432
  v_smfmac_f32_16x16x64_bf16 v[92:95], v[36:39], a[160:167], v3
  ds_read_b128 v[116:119], v7 offset:19456
  v_smfmac_f32_16x16x64_bf16 v[72:75], v[40:43], a[24:31], v3
  buffer_store_dwordx4 v[136:139], v2, s[8:11], s100 offen offset:1024 sc1
  v_smfmac_f32_16x16x64_bf16 v[76:79], v[40:43], a[168:175], v3
  s_mov_b32 exec_hi, 0
  buffer_store_dwordx4 v[140:143], v2, s[8:11], s100 offen offset:2048 sc1
  s_mov_b32 exec_hi, -1
  v_smfmac_f32_16x16x64_bf16 v[80:83], v[40:43], a[32:39], v3
  buffer_load_dword v22, v21, s[8:11], 0 offen sc1
  v_smfmac_f32_16x16x64_bf16 v[84:87], v[40:43], a[176:183], v3
  buffer_load_dword v26, v29, s[8:11], s38 offen sc1
  v_smfmac_f32_16x16x64_bf16 v[88:91], v[40:43], a[40:47], v3
  buffer_load_dword v26, v30, s[8:11], s38 offen sc1
  v_smfmac_f32_16x16x64_bf16 v[92:95], v[40:43], a[184:191], v3
  s_waitcnt lgkmcnt(12)
  s_waitcnt lgkmcnt(4)
  v_smfmac_f32_16x16x64_bf16 v[72:75], v[44:47], v[96:103], v3
  ds_read_b128 v[96:99], v7 offset:24576
  v_smfmac_f32_16x16x64_bf16 v[76:79], v[44:47], a[192:199], v3
  ds_read_b128 v[100:103], v7 offset:25600
  v_smfmac_f32_16x16x64_bf16 v[72:75], v[48:51], a[48:55], v3
  v_smfmac_f32_16x16x64_bf16 v[76:79], v[48:51], a[216:223], v3
  s_waitcnt lgkmcnt(4)
  v_smfmac_f32_16x16x64_bf16 v[72:75], v[52:55], v[104:111], v3
  ds_read_b128 v[104:107], v7 offset:8192
  v_smfmac_f32_16x16x64_bf16 v[76:79], v[52:55], a[240:247], v3
  ds_read_b128 v[108:111], v7 offset:9216
  v_smfmac_f32_16x16x64_bf16 v[72:75], v[56:59], a[72:79], v3
  s_cmp_lg_u32 s80, 63
  s_cbranch_scc1 q63_10
  s_add_u32 s27, s35, 67239936
  buffer_load_dwordx4 v[132:135], v2, s[8:11], s27 offen offset:0 sc1
  buffer_load_dwordx4 v[136:139], v2, s[8:11], s27 offen offset:1024 sc1
  buffer_load_dwordx4 v[140:143], v2, s[8:11], s27 offen offset:2048 sc1
q63_10:
  v_smfmac_f32_16x16x64_bf16 v[76:79], v[56:59], v[160:167], v3
  s_waitcnt lgkmcnt(4)
  v_smfmac_f32_16x16x64_bf16 v[72:75], v[60:63], v[112:119], v3
  ds_read_b128 v[112:115], v7 offset:14336
  v_smfmac_f32_16x16x64_bf16 v[76:79], v[60:63], v[184:191], v3
  ds_read_b128 v[116:119], v7 offset:15360
  v_smfmac_f32_16x16x64_bf16 v[72:75], v[64:67], a[96:103], v3
  v_smfmac_f32_16x16x64_bf16 v[76:79], v[64:67], v[208:215], v3
  s_waitcnt lgkmcnt(4)
  v_smfmac_f32_16x16x64_bf16 v[72:75], v[68:71], v[96:103], v3
  ds_read_b128 v[96:99], v7 offset:20480
  v_smfmac_f32_16x16x64_bf16 v[76:79], v[68:71], v[232:239], v3
  ds_read_b128 v[100:103], v7 offset:21504
  s_waitcnt lgkmcnt(4)
  v_smfmac_f32_16x16x64_bf16 v[80:83], v[44:47], v[104:111], v3
  ds_read_b128 v[104:107], v7 offset:26624
  v_smfmac_f32_16x16x64_bf16 v[84:87], v[44:47], a[200:207], v3
  ds_read_b128 v[108:111], v7 offset:27648
  v_smfmac_f32_16x16x64_bf16 v[80:83], v[48:51], a[56:63], v3
  v_smfmac_f32_16x16x64_bf16 v[84:87], v[48:51], a[224:231], v3
  s_waitcnt lgkmcnt(4)
  v_smfmac_f32_16x16x64_bf16 v[80:83], v[52:55], v[112:119], v3
  ds_read_b128 v[112:115], v7 offset:10240
  v_smfmac_f32_16x16x64_bf16 v[84:87], v[52:55], a[248:255], v3
  ds_read_b128 v[116:119], v7 offset:11264
  v_smfmac_f32_16x16x64_bf16 v[80:83], v[56:59], a[80:87], v3
  v_add_f32 v72, v72, v74
  v_smfmac_f32_16x16x64_bf16 v[84:87], v[56:59], v[168:175], v3
  v_add_f32 v73, v73, v75
  s_waitcnt lgkmcnt(4)
  v_smfmac_f32_16x16x64_bf16 v[80:83], v[60:63], v[96:103], v3
  ds_read_b128 v[96:99], v7 offset:16384
  v_smfmac_f32_16x16x64_bf16 v[84:87], v[60:63], v[192:199], v3
  ds_read_b128 v[100:103], v7 offset:17408
  v_smfmac_f32_16x16x64_bf16 v[80:83], v[64:67], a[104:111], v3
  v_add_f32 v76, v76, v78
  v_smfmac_f32_16x16x64_bf16 v[84:87], v[64:67], v[216:223], v3
  v_add_f32 v77, v77, v79
  s_waitcnt lgkmcnt(4)
  v_smfmac_f32_16x16x64_bf16 v[80:83], v[68:71], v[104:111], v3
  ds_read_b128 v[104:107], v7 offset:22528
  v_smfmac_f32_16x16x64_bf16 v[84:87], v[68:71], v[240:247], v3
  ds_read_b128 v[108:111], v7 offset:23552
  s_waitcnt lgkmcnt(4)
  v_smfmac_f32_16x16x64_bf16 v[88:91], v[44:47], v[112:119], v3
  ds_read_b128 v[112:115], v7 offset:28672
  v_smfmac_f32_16x16x64_bf16 v[92:95], v[44:47], a[208:215], v3
  ds_read_b128 v[116:119], v7 offset:29696
  v_smfmac_f32_16x16x64_bf16 v[88:91], v[48:51], a[64:71], v3
  v_cvt_pk_bf16_f32 v150, v72, v73
  v_smfmac_f32_16x16x64_bf16 v[92:95], v[48:51], a[232:239], v3
  ds_write_b32 v8, v150 offset:0
  s_waitcnt lgkmcnt(5)
  v_smfmac_f32_16x16x64_bf16 v[88:91], v[52:55], v[96:103], v3
  v_cvt_pk_bf16_f32 v151, v76, v77
  v_smfmac_f32_16x16x64_bf16 v[92:95], v[52:55], v[152:159], v3
  ds_write_b32 v8, v151 offset:16
  v_smfmac_f32_16x16x64_bf16 v[88:91], v[56:59], a[88:95], v3
  v_add_f32 v80, v80, v82
  v_smfmac_f32_16x16x64_bf16 v[92:95], v[56:59], v[176:183], v3
  v_add_f32 v81, v81, v83
  s_waitcnt lgkmcnt(4)
  v_smfmac_f32_16x16x64_bf16 v[88:91], v[60:63], v[104:111], v3
  v_add_f32 v84, v84, v86
  v_smfmac_f32_16x16x64_bf16 v[92:95], v[60:63], v[200:207], v3
  v_add_f32 v85, v85, v87
  v_smfmac_f32_16x16x64_bf16 v[88:91], v[64:67], a[112:119], v3
  v_cvt_pk_bf16_f32 v150, v80, v81
  v_smfmac_f32_16x16x64_bf16 v[92:95], v[64:67], v[224:231], v3
  ds_write_b32 v8, v150 offset:512
  s_waitcnt lgkmcnt(3)
  v_smfmac_f32_16x16x64_bf16 v[88:91], v[68:71], v[112:119], v3
  v_cvt_pk_bf16_f32 v151, v84, v85
  v_smfmac_f32_16x16x64_bf16 v[92:95], v[68:71], v[248:255], v3
  ds_write_b32 v8, v151 offset:528
  ds_read_b64_tr_b16 v[144:145], v9 offset:0
  ds_read_b64_tr_b16 v[146:147], v9 offset:512
  s_nop 2
  v_pk_add_f32 v[88:89], v[88:89], v[90:91]
  s_nop 0
  v_pk_add_f32 v[92:93], v[92:93], v[94:95]
  v_cvt_pk_bf16_f32 v150, v88, v89
  ds_write_b32 v8, v150 offset:1024
  v_cvt_pk_bf16_f32 v151, v92, v93
  ds_write_b32 v8, v151 offset:1040
  ds_read_b64_tr_b16 v[148:149], v9 offset:1024
  s_cmp_eq_u32 s80, 63
  s_cbranch_scc1 CQS_last
  s_waitcnt lgkmcnt(3)
  v_mfma_f32_16x16x32_bf16 v[72:75], v[120:123], v[144:147], 0
  v_mfma_f32_16x16x32_bf16 v[76:79], v[124:127], v[144:147], 0
  v_mfma_f32_16x16x32_bf16 v[80:83], v[144:147], v[144:147], 0
  s_waitcnt lgkmcnt(0)
  v_mfma_f32_16x16x16_bf16 v[72:75], v[128:129], v[148:149], v[72:75]
  v_mfma_f32_16x16x16_bf16 v[76:79], v[130:131], v[148:149], v[76:79]
  v_mfma_f32_16x16x16_bf16 v[80:83], v[148:149], v[148:149], v[80:83]
  s_mov_b32 exec_lo, 0xff00ff
  s_mov_b32 exec_hi, 0xff00ff
  s_nop 3
  ds_write_b128 v10, v[72:75]
  ds_write_b128 v10, v[76:79] offset:64
  s_mov_b32 exec_lo, 0
  ds_write_b128 v10, v[80:83] offset:96
  s_mov_b64 exec, -1
  s_cmp_lg_u32 s24, 0
  s_waitcnt lgkmcnt(0)
  s_barrier
  s_cbranch_scc1 CQS_side0
  ds_read2_b64 v[32:35], v12 offset0:0 offset1:8
  ds_read2_b64 v[36:39], v12 offset0:160 offset1:168
  ds_read2st64_b32 v[48:49], v14 offset0:0 offset1:5
  ds_read2_b64 v[40:43], v13 offset0:0 offset1:8
  ds_read2_b64 v[44:47], v13 offset0:160 offset1:168
  ds_read2st64_b32 v[50:51], v14 offset0:10 offset1:15
  s_waitcnt lgkmcnt(3)
  v_pk_add_f32 v[32:33], v[32:33], v[36:37]
  v_pk_add_f32 v[34:35], v[34:35], v[38:39]
  v_add_f32 v48, v48, v49
  s_waitcnt lgkmcnt(0)
  v_pk_add_f32 v[40:41], v[40:41], v[44:45]
  v_pk_add_f32 v[42:43], v[42:43], v[46:47]
  v_add_f32 v50, v50, v51
  v_pk_add_f32 v[32:33], v[32:33], v[40:41]
  v_pk_add_f32 v[34:35], v[34:35], v[42:43]
  v_add_f32 v48, v48, v50
  v_max3_f32 v52, v32, v33, v34
  v_max3_f32 v52, v52, v35, v48
  v_pk_mul_f32 v[32:33], v[32:33], s[92:93]
  s_nop 0
  v_max_f32_dpp v52, v52, v52 quad_perm:[1,0,3,2] row_mask:0xf bank_mask:0xf
  v_pk_mul_f32 v[34:35], v[34:35], s[92:93]
  s_nop 0
  v_max_f32_dpp v52, v52, v52 quad_perm:[2,3,0,1] row_mask:0xf bank_mask:0xf
  v_mul_f32 v48, s92, v48
  s_nop 0
  v_max_f32_dpp v52, v52, v52 row_half_mirror row_mask:0xf bank_mask:0xf
  v_mul_f32 v52, s92, v52
  v_pk_add_f32 v[32:33], v[32:33], v[52:53] op_sel_hi:[1,0] neg_lo:[0,1] neg_hi:[0,1]
  v_pk_add_f32 v[34:35], v[34:35], v[52:53] op_sel_hi:[1,0] neg_lo:[0,1] neg_hi:[0,1]
  v_sub_f32 v48, v48, v52
  v_exp_f32 v32, v32
  v_exp_f32 v33, v33
  v_exp_f32 v34, v34
  v_exp_f32 v35, v35
  v_exp_f32 v48, v48
  v_pk_add_f32 v[52:53], v[32:33], v[34:35]
  v_add_f32 v52, v52, v53
  v_add_f32 v52, v52, v48
  s_nop 1
  v_add_f32_dpp v52, v52, v52 quad_perm:[1,0,3,2] row_mask:0xf bank_mask:0xf
  s_nop 1
  v_add_f32_dpp v52, v52, v52 quad_perm:[2,3,0,1] row_mask:0xf bank_mask:0xf
  s_nop 1
  v_add_f32_dpp v52, v52, v52 row_half_mirror row_mask:0xf bank_mask:0xf
  v_rcp_f32 v52, v52
  s_nop 0
  v_mul_f32 v48, v48, v52
  v_pk_mul_f32 v[32:33], v[32:33], v[52:53] op_sel_hi:[1,0]
  v_pk_mul_f32 v[34:35], v[34:35], v[52:53] op_sel_hi:[1,0]
  v_mov_b32_dpp v49, v48 quad_perm:[1,0,3,2] row_mask:0xf bank_mask:0xf
  v_cvt_pk_bf16_f32 v36, v32, v33
  v_cvt_pk_bf16_f32 v37, v34, v35
  v_cvt_pk_bf16_f32 v38, v48, v49
  v_and_or_b32 v36, v36, v27, s73
  v_and_or_b32 v37, v37, v27, s73
  buffer_store_dwordx2 v[36:37], v17, s[8:11], s72 offen sc1
  v_and_or_b32 v38, v38, v27, s73
  s_mov_b32 exec_lo, 0x55555555
  s_mov_b32 exec_hi, 0x55555555
  buffer_store_dword v38, v18, s[8:11], s72 offen sc1
  s_mov_b64 exec, -1
  s_waitcnt vmcnt(4)
  s_branch CQS_side
CQS_rem:
  buffer_load_dwordx4 v[56:59], v2, s[8:11], s90 offen sc1
  buffer_load_dwordx4 v[60:63], v2, s[8:11], s87 offen sc1
  buffer_load_dwordx4 v[64:67], v2, s[8:11], s67 offen sc1
  s_add_u32 s26, s26, 1
  s_mov_b32 s39, 67
  s_cmp_gt_u32 s26, 2097152
  s_cbranch_scc1 L_abort
  s_waitcnt vmcnt(1)
  v_bitop3_b32 v68, v56, v60, s79 bitop3:0x7e
  s_waitcnt vmcnt(0)
  v_bitop3_b32 v68, v68, v64, s79 bitop3:0xf6
  v_and_b32 v68, 1, v68
  v_cmp_ne_u32 vcc, 0, v68
  s_cbranch_vccnz CQS_rem
  s_branch CQS_got
CQS_side0:
  s_waitcnt vmcnt(2)
CQS_side:
  s_barrier
  s_mov_b32 exec_lo, 0xff00ff00
  s_mov_b32 exec_hi, 0xff00ff00
  buffer_store_dwordx4 v[144:147], v2, s[8:11], s36 offen sc1
  buffer_store_dwordx2 v[148:149], v11, s[8:11], s76 offen sc1
  s_mov_b64 exec, -1
  s_add_u32 s33, s80, 1
  s_cmp_eq_u32 s33, 63
  s_cselect_b32 s30, 3, 1
  v_cmp_ge_u32 vcc, s33, v22
  s_nop 0
  s_and_b32 s27, vcc_lo, s30
  s_cbranch_scc0 CQS_kq
  s_mov_b32 exec_lo, s30
  s_mov_b32 exec_hi, 0
wp_11:
  buffer_load_dword v22, v21, s[8:11], 0 offen sc1
  s_add_u32 s26, s26, 1
  s_mov_b32 s39, 68
  s_cmp_gt_u32 s26, 2097152
  s_cbranch_scc1 L_abort
  s_waitcnt vmcnt(0)
  v_cmp_ge_u32 vcc, s33, v22
  s_cbranch_vccnz wp_11
  s_mov_b64 exec, -1
CQS_kq:
  s_add_u32 s27, s35, 42467328
  buffer_load_dwordx4 v[120:123], v2, s[8:11], s27 offen offset:0 sc1
  buffer_load_dwordx4 v[124:127], v2, s[8:11], s27 offen offset:1024 sc1
  buffer_load_dwordx4 v[128:131], v2, s[8:11], s27 offen offset:2048 sc1
  s_add_u32 s35, s35, 393216
  s_mul_i32 s72, s88, 327680
  s_add_u32 s72, s72, s78
  s_add_u32 s72, s72, 262144
  v_and_b32 v24, 511, v2
  s_cmp_eq_u32 s80, 99
  s_cselect_b32 s27, 0, 131072
  s_cselect_b32 s30, 0, 65536
  s_add_u32 s36, s36, s27
  s_add_u32 s76, s76, s30
  s_mul_i32 s100, s80, 327680
  s_add_u32 s100, s100, s78
  s_add_u32 s100, s100, 21495808
  ds_read_b128 v[96:99], v7 offset:0
  ds_read_b128 v[100:103], v7 offset:1024
  ds_read_b128 v[104:107], v7 offset:2048
  ds_read_b128 v[108:111], v7 offset:3072
  ds_read_b128 v[112:115], v7 offset:4096
  ds_read_b128 v[116:119], v7 offset:5120
  v_mov_b64 v[72:73], 0
  v_mov_b64 v[74:75], 0
  v_mov_b64 v[76:77], 0
  v_mov_b64 v[78:79], 0
  v_mov_b64 v[80:81], 0
  v_mov_b64 v[82:83], 0
  v_mov_b64 v[84:85], 0
  v_mov_b64 v[86:87], 0
  v_mov_b64 v[88:89], 0
  v_mov_b64 v[90:91], 0
  v_mov_b64 v[92:93], 0
  v_mov_b64 v[94:95], 0
  s_waitcnt lgkmcnt(0)
  s_sleep 8
  buffer_load_dwordx4 v[132:135], v2, s[8:11], s72 offen offset:0 sc1
  buffer_load_dwordx4 v[136:139], v2, s[8:11], s72 offen offset:1024 sc1
  buffer_load_dwordx4 v[140:143], v24, s[8:11], s72 offen offset:2048 sc1
  s_waitcnt vmcnt(1)
  v_bitop3_b32 v32, v132, v136, s79 bitop3:0x7e
  s_waitcnt vmcnt(0)
  v_bitop3_b32 v32, v32, v140, s79 bitop3:0xf6
  v_and_b32 v32, 1, v32
  v_cmp_ne_u32 vcc, 0, v32
  s_cbranch_vccnz CQS_ucp
CQS_ucd:
  s_add_u32 s80, s80, 1
  s_branch CQS_step
CQS_last:
  v_and_b32 v41, 15, v1
  v_lshrrev_b32 v42, 4, v1
  v_lshrrev_b32 v43, 3, v1
  v_and_b32 v44, 7, v1
  v_mul_u32_u24 v11, 160, v41
  v_lshl_add_u32 v11, v42, 4, v11
  s_mul_i32 s27, s24, 5120
  s_add_u32 s27, s27, 139264
  v_add_u32 v11, s27, v11
  s_waitcnt vmcnt(0) lgkmcnt(0)
  v_mfma_f32_16x16x32_bf16 v[72:75], v[144:147], v[132:135], 0
  v_mfma_f32_16x16x32_bf16 v[76:79], v[120:123], v[132:135], 0
  v_mfma_f32_16x16x32_bf16 v[80:83], v[124:127], v[132:135], 0
  v_mfma_f32_16x16x32_bf16 v[84:87], v[144:147], v[136:139], 0
  v_mfma_f32_16x16x32_bf16 v[88:91], v[120:123], v[136:139], 0
  v_mfma_f32_16x16x32_bf16 v[92:95], v[124:127], v[136:139], 0
  v_mfma_f32_16x16x16_bf16 v[72:75], v[148:149], v[140:141], v[72:75]
  v_mfma_f32_16x16x16_bf16 v[76:79], v[128:129], v[140:141], v[76:79]
  v_mfma_f32_16x16x16_bf16 v[80:83], v[130:131], v[140:141], v[80:83]
  v_mfma_f32_16x16x16_bf16 v[84:87], v[148:149], v[142:143], v[84:87]
  v_mfma_f32_16x16x16_bf16 v[88:91], v[128:129], v[142:143], v[88:91]
  v_mfma_f32_16x16x16_bf16 v[92:95], v[130:131], v[142:143], v[92:95]
  v_and_b32 v45, 1, v1
  v_lshrrev_b32 v46, 1, v44
  v_mul_u32_u24 v47, 160, v43
  s_mul_i32 s27, s24, 1280
  s_add_u32 s27, s27, 139264
  v_add_u32 v47, s27, v47
  v_lshl_add_u32 v15, v45, 6, v47
  v_lshl_add_u32 v15, v46, 4, v15
  v_lshl_add_u32 v16, v44, 2, v47
  v_add_u32 v16, 128, v16
  s_and_b32 s30, s24, 1
  s_lshl_b32 s30, s30, 7
  s_lshr_b32 s31, s24, 1
  s_lshl_b32 s31, s31, 10
  s_add_u32 s30, s30, s31
  s_lshl_b32 s27, s25, 11
  s_add_u32 s27, s27, s30
  v_lshlrev_b32 v19, 8, v46
  v_lshl_add_u32 v19, v43, 4, v19
  v_lshl_add_u32 v19, v45, 3, v19
  v_add_u32 v19, s27, v19
  s_lshr_b32 s27, s25, 2
  s_lshl_b32 s27, s27, 11
  s_and_b32 s31, s25, 3
  s_lshl_b32 s31, s31, 8
  s_add_u32 s27, s27, s31
  s_add_u32 s27, s27, s30
  s_add_u32 s27, s27, 65536
  v_lshlrev_b32 v20, 4, v43
  v_lshl_add_u32 v20, v46, 2, v20
  v_add_u32 v20, s27, v20
  ds_write_b128 v11, v[76:79] offset:0
  ds_write_b128 v11, v[80:83] offset:64
  ds_write_b128 v11, v[88:91] offset:2560
  ds_write_b128 v11, v[92:95] offset:2624
  s_mov_b32 exec_lo, 0
  ds_write_b128 v11, v[72:75] offset:96
  ds_write_b128 v11, v[84:87] offset:2656
  s_mov_b64 exec, -1
  s_lshl_b32 s27, s24, 3
  v_add_u32 v41, s27, v43
  v_lshlrev_b32 v42, 4, v45
  v_lshl_add_u32 v42, v46, 2, v42
  v_add_u32 v47, 0, v42
  v_cmp_le_u32 s[94:95], v47, v41
  v_add_u32 v47, 1, v42
  v_cmp_le_u32 s[96:97], v47, v41
  v_add_u32 v47, 2, v42
  v_cmp_le_u32 s[98:99], v47, v41
  v_add_u32 v47, 3, v42
  v_cmp_le_u32 s[86:87], v47, v41
  s_mul_i32 s72, s88, 327680
  s_add_u32 s72, s72, s78
  s_add_u32 s72, s72, 262144
  s_mul_i32 s100, s80, 327680
  s_add_u32 s100, s100, s78
  s_add_u32 s100, s100, 21495808
  v_and_b32 v24, 511, v2
  s_waitcnt lgkmcnt(0)
  s_barrier
  buffer_load_dwordx4 v[132:135], v2, s[8:11], s72 offen offset:0 sc1
  buffer_load_dwordx4 v[136:139], v2, s[8:11], s72 offen offset:1024 sc1
  buffer_load_dwordx4 v[140:143], v24, s[8:11], s72 offen offset:2048 sc1
  ds_read_b128 v[32:35], v15 offset:0
  ds_read_b128 v[36:39], v15 offset:5120
  ds_read_b128 v[40:43], v15 offset:10240
  ds_read_b128 v[44:47], v15 offset:15360
  ds_read2st64_b32 v[48:49], v16 offset0:0 offset1:20
  ds_read2st64_b32 v[50:51], v16 offset0:40 offset1:60
  v_mov_b32 v54, 0xceabfb8f
  s_waitcnt lgkmcnt(0)
  v_pk_add_f32 v[32:33], v[32:33], v[36:37]
  v_pk_add_f32 v[40:41], v[40:41], v[44:45]
  v_pk_add_f32 v[34:35], v[34:35], v[38:39]
  v_pk_add_f32 v[42:43], v[42:43], v[46:47]
  v_pk_add_f32 v[32:33], v[32:33], v[40:41]
  v_pk_add_f32 v[34:35], v[34:35], v[42:43]
  v_add_f32 v48, v48, v49
  v_add_f32 v50, v50, v51
  v_add_f32 v48, v48, v50
  v_pk_mul_f32 v[32:33], v[32:33], s[92:93]
  v_pk_mul_f32 v[34:35], v[34:35], s[92:93]
  v_mul_f32 v48, s92, v48
  v_cndmask_b32 v32, v54, v32, s[94:95]
  v_cndmask_b32 v33, v54, v33, s[96:97]
  v_cndmask_b32 v34, v54, v34, s[98:99]
  v_cndmask_b32 v35, v54, v35, s[86:87]
  v_max3_f32 v52, v32, v33, v34
  v_max3_f32 v52, v52, v35, v48
  s_nop 1
  v_max_f32_dpp v52, v52, v52 quad_perm:[1,0,3,2] row_mask:0xf bank_mask:0xf
  s_nop 1
  v_max_f32_dpp v52, v52, v52 quad_perm:[2,3,0,1] row_mask:0xf bank_mask:0xf
  s_nop 1
  v_max_f32_dpp v52, v52, v52 row_half_mirror row_mask:0xf bank_mask:0xf
  v_pk_add_f32 v[32:33], v[32:33], v[52:53] op_sel_hi:[1,0] neg_lo:[0,1] neg_hi:[0,1]
  v_pk_add_f32 v[34:35], v[34:35], v[52:53] op_sel_hi:[1,0] neg_lo:[0,1] neg_hi:[0,1]
  v_sub_f32 v48, v48, v52
  v_exp_f32 v32, v32
  v_exp_f32 v33, v33
  v_exp_f32 v34, v34
  v_exp_f32 v35, v35
  v_exp_f32 v48, v48
  v_pk_add_f32 v[52:53], v[32:33], v[34:35]
  v_add_f32 v52, v52, v53
  v_add_f32 v52, v52, v48
  s_nop 1
  v_add_f32_dpp v52, v52, v52 quad_perm:[1,0,3,2] row_mask:0xf bank_mask:0xf
  s_nop 1
  v_add_f32_dpp v52, v52, v52 quad_perm:[2,3,0,1] row_mask:0xf bank_mask:0xf
  s_nop 1
  v_add_f32_dpp v52, v52, v52 row_half_mirror row_mask:0xf bank_mask:0xf
  v_rcp_f32 v52, v52
  s_nop 0
  v_mul_f32 v48, v48, v52
  v_pk_mul_f32 v[32:33], v[32:33], v[52:53] op_sel_hi:[1,0]
  v_pk_mul_f32 v[34:35], v[34:35], v[52:53] op_sel_hi:[1,0]
  v_mov_b32_dpp v49, v48 quad_perm:[1,0,3,2] row_mask:0xf bank_mask:0xf
  v_cvt_pk_bf16_f32 v36, v32, v33
  v_cvt_pk_bf16_f32 v37, v34, v35
  v_cvt_pk_bf16_f32 v38, v48, v49
  s_mov_b32 s27, 21413888
  buffer_store_dwordx2 v[36:37], v19, s[8:11], s27 offen sc1
  s_mov_b32 exec_lo, 0x55555555
  s_mov_b32 exec_hi, 0x55555555
  buffer_store_dword v38, v20, s[8:11], s27 offen sc1
  s_mov_b64 exec, -1
  s_waitcnt vmcnt(3)
  v_bitop3_b32 v40, v132, v136, s79 bitop3:0x7e
  s_waitcnt vmcnt(2)
  v_bitop3_b32 v40, v40, v140, s79 bitop3:0xf6
  v_and_b32 v40, 1, v40
  v_cmp_ne_u32 vcc, 0, v40
  s_cbranch_vccnz CQS_lu
  s_branch CQS_lu2
CQS_lu:
  buffer_load_dwordx4 v[132:135], v2, s[8:11], s72 offen offset:0 sc1
  buffer_load_dwordx4 v[136:139], v2, s[8:11], s72 offen offset:1024 sc1
  buffer_load_dwordx4 v[140:143], v24, s[8:11], s72 offen offset:2048 sc1
  s_add_u32 s26, s26, 1
  s_mov_b32 s39, 71
  s_cmp_gt_u32 s26, 2097152
  s_cbranch_scc1 L_abort
  s_waitcnt vmcnt(1)
  v_bitop3_b32 v40, v132, v136, s79 bitop3:0x7e
  s_waitcnt vmcnt(0)
  v_bitop3_b32 v40, v40, v140, s79 bitop3:0xf6
  v_and_b32 v40, 1, v40
  v_cmp_ne_u32 vcc, 0, v40
  s_cbranch_vccnz CQS_lu
CQS_lu2:
  buffer_store_dwordx4 v[132:135], v2, s[8:11], s100 offen offset:0 sc1
  buffer_store_dwordx4 v[136:139], v2, s[8:11], s100 offen offset:1024 sc1
  s_mov_b32 exec_hi, 0
  buffer_store_dwordx4 v[140:143], v2, s[8:11], s100 offen offset:2048 sc1
  s_mov_b32 exec_hi, -1
  v_mov_b32 v31, 65
  s_waitcnt vmcnt(0)
  s_mov_b64 exec, 1
  buffer_store_dword v31, off, s[8:11], s34 sc1
  s_mov_b64 exec, -1
  s_endpgm
CQS_ucp:
  buffer_load_dwordx4 v[132:135], v2, s[8:11], s72 offen offset:0 sc1
  buffer_load_dwordx4 v[136:139], v2, s[8:11], s72 offen offset:1024 sc1
  buffer_load_dwordx4 v[140:143], v24, s[8:11], s72 offen offset:2048 sc1
  s_add_u32 s26, s26, 1
  s_mov_b32 s39, 70
  s_cmp_gt_u32 s26, 2097152
  s_cbranch_scc1 L_abort
  s_waitcnt vmcnt(1)
  v_bitop3_b32 v32, v132, v136, s79 bitop3:0x7e
  s_waitcnt vmcnt(0)
  v_bitop3_b32 v32, v32, v140, s79 bitop3:0xf6
  v_and_b32 v32, 1, v32
  v_cmp_ne_u32 vcc, 0, v32
  s_cbranch_vccnz CQS_ucp
  s_branch CQS_ucd
CV:
  s_cmp_lg_u32 s24, 0
  s_cbranch_scc1 an_13
  s_getreg_b32 s27, hwreg(HW_REG_XCC_ID, 0, 3)
  s_lshl_b32 s27, s27, 3
  s_lshl_b64 s[30:31], 1, s27
  v_mov_b32 v4, s30
  v_mov_b32 v5, s31
  s_lshl_b32 s30, s29, 3
  s_mov_b64 exec, 1
  buffer_atomic_add_x2 v[4:5], off, s[68:71], s30 offset:128 sc1
  s_mov_b64 exec, -1
an_13:
  s_mov_b32 s12, s48
  s_and_b32 s13, s49, 0xffff
  s_mov_b32 s14, 7864320
  s_mov_b32 s15, 0x20000
  s_mov_b32 s16, s50
  s_and_b32 s17, s51, 0xffff
  s_mov_b32 s18, 7864320
  s_mov_b32 s19, 0x20000
  s_mov_b32 s30, 12288
  v_add_u32 v64, 0, v1
  s_mov_b32 s27, 43691
  v_mul_lo_u32 v65, v64, s27
  v_lshrrev_b32 v65, 18, v65
  v_mul_u32_u24 v8, 6, v65
  v_sub_u32 v66, v64, v8
  v_mul_lo_u32 v65, v65, s30
  v_lshl_add_u32 v8, v66, 4, v65
  v_add_u32 v64, 64, v1
  s_mov_b32 s27, 43691
  v_mul_lo_u32 v65, v64, s27
  v_lshrrev_b32 v65, 18, v65
  v_mul_u32_u24 v9, 6, v65
  v_sub_u32 v66, v64, v9
  v_mul_lo_u32 v65, v65, s30
  v_lshl_add_u32 v9, v66, 4, v65
  v_add_u32 v64, 128, v1
  s_mov_b32 s27, 43691
  v_mul_lo_u32 v65, v64, s27
  v_lshrrev_b32 v65, 18, v65
  v_mul_u32_u24 v10, 6, v65
  v_sub_u32 v66, v64, v10
  v_mul_lo_u32 v65, v65, s30
  v_lshl_add_u32 v10, v66, 4, v65
  v_add_u32 v64, 192, v1
  s_mov_b32 s27, 43691
  v_mul_lo_u32 v65, v64, s27
  v_lshrrev_b32 v65, 18, v65
  v_mul_u32_u24 v11, 6, v65
  v_sub_u32 v66, v64, v11
  v_mul_lo_u32 v65, v65, s30
  v_lshl_add_u32 v11, v66, 4, v65
  v_add_u32 v64, 256, v1
  s_mov_b32 s27, 43691
  v_mul_lo_u32 v65, v64, s27
  v_lshrrev_b32 v65, 18, v65
  v_mul_u32_u24 v12, 6, v65
  v_sub_u32 v66, v64, v12
  v_mul_lo_u32 v65, v65, s30
  v_lshl_add_u32 v12, v66, 4, v65
  v_add_u32 v64, 320, v1
  s_mov_b32 s27, 43691
  v_mul_lo_u32 v65, v64, s27
  v_lshrrev_b32 v65, 18, v65
  v_mul_u32_u24 v13, 6, v65
  v_sub_u32 v66, v64, v13
  v_mul_lo_u32 v65, v65, s30
  v_lshl_add_u32 v13, v66, 4, v65
  s_mov_b32 s30, 1280
  v_add_u32 v64, 0, v1
  v_lshrrev_b32 v65, 2, v64
  v_and_b32 v66, 3, v64
  v_mul_lo_u32 v65, v65, s30
  v_lshl_add_u32 v14, v66, 4, v65
  v_add_u32 v64, 64, v1
  v_lshrrev_b32 v65, 2, v64
  v_and_b32 v66, 3, v64
  v_mul_lo_u32 v65, v65, s30
  v_lshl_add_u32 v15, v66, 4, v65
  v_add_u32 v64, 128, v1
  v_lshrrev_b32 v65, 2, v64
  v_and_b32 v66, 3, v64
  v_mul_lo_u32 v65, v65, s30
  v_lshl_add_u32 v16, v66, 4, v65
  v_add_u32 v64, 192, v1
  v_lshrrev_b32 v65, 2, v64
  v_and_b32 v66, 3, v64
  v_mul_lo_u32 v65, v65, s30
  v_lshl_add_u32 v17, v66, 4, v65
  v_add_u32 v64, 256, v1
  v_lshrrev_b32 v65, 2, v64
  v_and_b32 v66, 3, v64
  v_mul_lo_u32 v65, v65, s30
  v_lshl_add_u32 v18, v66, 4, v65
  v_add_u32 v64, 320, v1
  v_lshrrev_b32 v65, 2, v64
  v_and_b32 v66, 3, v64
  v_mul_lo_u32 v65, v65, s30
  v_lshl_add_u32 v19, v66, 4, v65
  v_bfe_u32 v64, v1, 5, 1
  v_mul_u32_u24 v3, 1536, v64
  v_bfe_u32 v64, v1, 4, 1
  v_mul_u32_u24 v64, 384, v64
  v_add_u32 v3, v3, v64
  v_bfe_u32 v64, v1, 2, 1
  v_mul_u32_u24 v64, 96, v64
  v_add_u32 v3, v3, v64
  v_bfe_u32 v64, v1, 3, 1
  v_mul_u32_u24 v64, 768, v64
  v_add_u32 v3, v3, v64
  v_and_b32 v64, 3, v1
  v_lshl_add_u32 v3, v64, 3, v3
  s_mul_i32 s27, s24, 30720
  v_add_u32 v3, s27, v3
  v_bfe_u32 v64, v1, 5, 1
  v_mul_u32_u24 v4, 512, v64
  v_bfe_u32 v64, v1, 4, 1
  v_mul_u32_u24 v64, 256, v64
  v_add_u32 v4, v4, v64
  v_bfe_u32 v64, v1, 2, 1
  v_mul_u32_u24 v64, 64, v64
  v_add_u32 v4, v4, v64
  v_bfe_u32 v64, v1, 3, 1
  v_mul_u32_u24 v64, 1024, v64
  v_add_u32 v4, v4, v64
  v_and_b32 v64, 3, v1
  v_lshl_add_u32 v4, v64, 3, v4
  s_mul_i32 s27, s24, 30720
  v_add_u32 v4, s27, v4
  v_bfe_u32 v64, v1, 5, 1
  v_mul_u32_u24 v5, 512, v64
  v_bfe_u32 v64, v1, 4, 1
  v_mul_u32_u24 v64, 256, v64
  v_add_u32 v5, v5, v64
  v_bfe_u32 v64, v1, 2, 1
  v_mul_u32_u24 v64, 64, v64
  v_add_u32 v5, v5, v64
  v_bfe_u32 v64, v1, 3, 1
  v_mul_u32_u24 v64, 3072, v64
  v_add_u32 v5, v5, v64
  v_and_b32 v64, 3, v1
  v_lshl_add_u32 v5, v64, 3, v5
  s_mul_i32 s27, s24, 30720
  v_add_u32 v5, s27, v5
  s_mul_i32 s27, s24, 30720
  v_add_u32 v7, s27, v2
  s_mul_i32 s32, s25, 384
  s_mul_i32 s27, s24, 96
  s_add_u32 s32, s32, s27
  s_mul_i32 s33, s25, 245760
  s_mul_i32 s27, s24, 320
  s_add_u32 s33, s33, s27
  s_mul_i32 s75, s24, 3
  s_min_u32 s75, s75, 7
  s_mul_i32 s27, s24, -24576
  s_add_u32 s27, s27, 122880
  v_add_u32 v20, s27, v3
  v_add_u32 v21, s27, v4
  v_add_u32 v22, s27, v5
CV_ld0:
  s_cmp_lg_u32 s24, 0
  s_cbranch_scc1 CV_ld1
  s_mov_b32 m0, 122880
  s_add_u32 s27, s33, 0
  buffer_load_dwordx4 v14, s[16:19], s27 offen  lds
  s_mov_b32 m0, 123904
  s_add_u32 s27, s33, 0
  buffer_load_dwordx4 v15, s[16:19], s27 offen  lds
  s_mov_b32 m0, 124928
  s_add_u32 s27, s33, 0
  buffer_load_dwordx4 v16, s[16:19], s27 offen  lds
  s_mov_b32 m0, 125952
  s_add_u32 s27, s33, 0
  buffer_load_dwordx4 v17, s[16:19], s27 offen  lds
  s_mov_b32 m0, 126976
  s_add_u32 s27, s33, 0
  buffer_load_dwordx4 v18, s[16:19], s27 offen  lds
  s_mov_b32 m0, 128000
  s_add_u32 s27, s33, 0
  buffer_load_dwordx4 v19, s[16:19], s27 offen  lds
  s_mov_b32 m0, 24576
  s_add_u32 s27, s33, 64
  buffer_load_dwordx4 v14, s[16:19], s27 offen  lds
  s_mov_b32 m0, 25600
  s_add_u32 s27, s33, 64
  buffer_load_dwordx4 v15, s[16:19], s27 offen  lds
  s_mov_b32 m0, 26624
  s_add_u32 s27, s33, 64
  buffer_load_dwordx4 v16, s[16:19], s27 offen  lds
  s_mov_b32 m0, 27648
  s_add_u32 s27, s33, 64
  buffer_load_dwordx4 v17, s[16:19], s27 offen  lds
  s_mov_b32 m0, 28672
  s_add_u32 s27, s33, 64
  buffer_load_dwordx4 v18, s[16:19], s27 offen  lds
  s_mov_b32 m0, 29696
  s_add_u32 s27, s33, 64
  buffer_load_dwordx4 v19, s[16:19], s27 offen  lds
  s_mov_b32 m0, 12288
  s_add_u32 s27, s33, 128
  buffer_load_dwordx4 v14, s[16:19], s27 offen  lds
  s_mov_b32 m0, 13312
  s_add_u32 s27, s33, 128
  buffer_load_dwordx4 v15, s[16:19], s27 offen  lds
  s_mov_b32 m0, 14336
  s_add_u32 s27, s33, 128
  buffer_load_dwordx4 v16, s[16:19], s27 offen  lds
  s_mov_b32 m0, 15360
  s_add_u32 s27, s33, 128
  buffer_load_dwordx4 v17, s[16:19], s27 offen  lds
  s_mov_b32 m0, 16384
  s_add_u32 s27, s33, 128
  buffer_load_dwordx4 v18, s[16:19], s27 offen  lds
  s_mov_b32 m0, 17408
  s_add_u32 s27, s33, 128
  buffer_load_dwordx4 v19, s[16:19], s27 offen  lds
  s_mov_b32 m0, 6144
  s_add_u32 s27, s33, 192
  buffer_load_dwordx4 v14, s[16:19], s27 offen  lds
  s_mov_b32 m0, 7168
  s_add_u32 s27, s33, 192
  buffer_load_dwordx4 v15, s[16:19], s27 offen  lds
  s_mov_b32 m0, 8192
  s_add_u32 s27, s33, 192
  buffer_load_dwordx4 v16, s[16:19], s27 offen  lds
  s_mov_b32 m0, 9216
  s_add_u32 s27, s33, 192
  buffer_load_dwordx4 v17, s[16:19], s27 offen  lds
  s_mov_b32 m0, 10240
  s_add_u32 s27, s33, 192
  buffer_load_dwordx4 v18, s[16:19], s27 offen  lds
  s_mov_b32 m0, 11264
  s_add_u32 s27, s33, 192
  buffer_load_dwordx4 v19, s[16:19], s27 offen  lds
  s_mov_b32 m0, 18432
  s_add_u32 s27, s33, 256
  buffer_load_dwordx4 v14, s[16:19], s27 offen  lds
  s_mov_b32 m0, 19456
  s_add_u32 s27, s33, 256
  buffer_load_dwordx4 v15, s[16:19], s27 offen  lds
  s_mov_b32 m0, 20480
  s_add_u32 s27, s33, 256
  buffer_load_dwordx4 v16, s[16:19], s27 offen  lds
  s_mov_b32 m0, 21504
  s_add_u32 s27, s33, 256
  buffer_load_dwordx4 v17, s[16:19], s27 offen  lds
  s_mov_b32 m0, 22528
  s_add_u32 s27, s33, 256
  buffer_load_dwordx4 v18, s[16:19], s27 offen  lds
  s_mov_b32 m0, 23552
  s_add_u32 s27, s33, 256
  buffer_load_dwordx4 v19, s[16:19], s27 offen  lds
  s_mov_b32 m0, 0
  s_add_u32 s27, s33, 122880
  buffer_load_dwordx4 v14, s[16:19], s27 offen  lds
  s_mov_b32 m0, 1024
  s_add_u32 s27, s33, 122880
  buffer_load_dwordx4 v15, s[16:19], s27 offen  lds
  s_mov_b32 m0, 2048
  s_add_u32 s27, s33, 122880
  buffer_load_dwordx4 v16, s[16:19], s27 offen  lds
  s_mov_b32 m0, 3072
  s_add_u32 s27, s33, 122880
  buffer_load_dwordx4 v17, s[16:19], s27 offen  lds
  s_mov_b32 m0, 4096
  s_add_u32 s27, s33, 122880
  buffer_load_dwordx4 v18, s[16:19], s27 offen  lds
  s_mov_b32 m0, 5120
  s_add_u32 s27, s33, 122880
  buffer_load_dwordx4 v19, s[16:19], s27 offen  lds
  s_waitcnt vmcnt(30)
  ds_read_b64_tr_b16 a[168:169], v21 offset:0
  ds_read_b64_tr_b16 a[170:171], v21 offset:128
  ds_read_b64_tr_b16 a[172:173], v21 offset:3072
  ds_read_b64_tr_b16 a[174:175], v21 offset:3200
  ds_read_b64_tr_b16 a[184:185], v22 offset:2048
  ds_read_b64_tr_b16 a[186:187], v22 offset:2176
  ds_read_b64_tr_b16 a[192:193], v21 offset:32
  ds_read_b64_tr_b16 a[194:195], v21 offset:160
  ds_read_b64_tr_b16 a[196:197], v21 offset:3104
  ds_read_b64_tr_b16 a[198:199], v21 offset:3232
  ds_read_b64_tr_b16 a[208:209], v22 offset:2080
  ds_read_b64_tr_b16 a[210:211], v22 offset:2208
  s_waitcnt lgkmcnt(0)
  s_mov_b32 m0, 122880
  s_add_u32 s27, s33, 122944
  buffer_load_dwordx4 v14, s[16:19], s27 offen  lds
  s_mov_b32 m0, 123904
  s_add_u32 s27, s33, 122944
  buffer_load_dwordx4 v15, s[16:19], s27 offen  lds
  s_mov_b32 m0, 124928
  s_add_u32 s27, s33, 122944
  buffer_load_dwordx4 v16, s[16:19], s27 offen  lds
  s_mov_b32 m0, 125952
  s_add_u32 s27, s33, 122944
  buffer_load_dwordx4 v17, s[16:19], s27 offen  lds
  s_mov_b32 m0, 126976
  s_add_u32 s27, s33, 122944
  buffer_load_dwordx4 v18, s[16:19], s27 offen  lds
  s_mov_b32 m0, 128000
  s_add_u32 s27, s33, 122944
  buffer_load_dwordx4 v19, s[16:19], s27 offen  lds
  s_waitcnt vmcnt(30)
  ds_read_b64_tr_b16 a[216:217], v4 offset:24576
  ds_read_b64_tr_b16 a[218:219], v4 offset:24704
  ds_read_b64_tr_b16 a[220:221], v4 offset:27648
  ds_read_b64_tr_b16 a[222:223], v4 offset:27776
  ds_read_b64_tr_b16 a[232:233], v5 offset:26624
  ds_read_b64_tr_b16 a[234:235], v5 offset:26752
  ds_read_b64_tr_b16 a[240:241], v4 offset:24608
  ds_read_b64_tr_b16 a[242:243], v4 offset:24736
  ds_read_b64_tr_b16 a[244:245], v4 offset:27680
  ds_read_b64_tr_b16 a[246:247], v4 offset:27808
  ds_read_b64_tr_b16 v[152:153], v5 offset:26656
  ds_read_b64_tr_b16 v[154:155], v5 offset:26784
  s_waitcnt lgkmcnt(0)
  s_mov_b32 m0, 24576
  s_add_u32 s27, s33, 123008
  buffer_load_dwordx4 v14, s[16:19], s27 offen  lds
  s_mov_b32 m0, 25600
  s_add_u32 s27, s33, 123008
  buffer_load_dwordx4 v15, s[16:19], s27 offen  lds
  s_mov_b32 m0, 26624
  s_add_u32 s27, s33, 123008
  buffer_load_dwordx4 v16, s[16:19], s27 offen  lds
  s_mov_b32 m0, 27648
  s_add_u32 s27, s33, 123008
  buffer_load_dwordx4 v17, s[16:19], s27 offen  lds
  s_mov_b32 m0, 28672
  s_add_u32 s27, s33, 123008
  buffer_load_dwordx4 v18, s[16:19], s27 offen  lds
  s_mov_b32 m0, 29696
  s_add_u32 s27, s33, 123008
  buffer_load_dwordx4 v19, s[16:19], s27 offen  lds
  s_waitcnt vmcnt(30)
  ds_read_b64_tr_b16 v[160:161], v4 offset:12288
  ds_read_b64_tr_b16 v[162:163], v4 offset:12416
  ds_read_b64_tr_b16 v[164:165], v4 offset:15360
  ds_read_b64_tr_b16 v[166:167], v4 offset:15488
  ds_read_b64_tr_b16 v[176:177], v5 offset:14336
  ds_read_b64_tr_b16 v[178:179], v5 offset:14464
  ds_read_b64_tr_b16 v[184:185], v4 offset:12320
  ds_read_b64_tr_b16 v[186:187], v4 offset:12448
  ds_read_b64_tr_b16 v[188:189], v4 offset:15392
  ds_read_b64_tr_b16 v[190:191], v4 offset:15520
  ds_read_b64_tr_b16 v[200:201], v5 offset:14368
  ds_read_b64_tr_b16 v[202:203], v5 offset:14496
  s_waitcnt lgkmcnt(0)
  s_mov_b32 m0, 12288
  s_add_u32 s27, s33, 123072
  buffer_load_dwordx4 v14, s[16:19], s27 offen  lds
  s_mov_b32 m0, 13312
  s_add_u32 s27, s33, 123072
  buffer_load_dwordx4 v15, s[16:19], s27 offen  lds
  s_mov_b32 m0, 14336
  s_add_u32 s27, s33, 123072
  buffer_load_dwordx4 v16, s[16:19], s27 offen  lds
  s_mov_b32 m0, 15360
  s_add_u32 s27, s33, 123072
  buffer_load_dwordx4 v17, s[16:19], s27 offen  lds
  s_mov_b32 m0, 16384
  s_add_u32 s27, s33, 123072
  buffer_load_dwordx4 v18, s[16:19], s27 offen  lds
  s_mov_b32 m0, 17408
  s_add_u32 s27, s33, 123072
  buffer_load_dwordx4 v19, s[16:19], s27 offen  lds
  s_waitcnt vmcnt(30)
  ds_read_b64_tr_b16 v[208:209], v4 offset:6144
  ds_read_b64_tr_b16 v[210:211], v4 offset:6272
  ds_read_b64_tr_b16 v[212:213], v4 offset:9216
  ds_read_b64_tr_b16 v[214:215], v4 offset:9344
  ds_read_b64_tr_b16 v[224:225], v5 offset:8192
  ds_read_b64_tr_b16 v[226:227], v5 offset:8320
  ds_read_b64_tr_b16 v[232:233], v4 offset:6176
  ds_read_b64_tr_b16 v[234:235], v4 offset:6304
  ds_read_b64_tr_b16 v[236:237], v4 offset:9248
  ds_read_b64_tr_b16 v[238:239], v4 offset:9376
  ds_read_b64_tr_b16 v[248:249], v5 offset:8224
  ds_read_b64_tr_b16 v[250:251], v5 offset:8352
  s_waitcnt lgkmcnt(0)
  s_mov_b32 m0, 6144
  s_add_u32 s27, s32, 0
  buffer_load_dwordx4 v8, s[12:15], s27 offen  lds
  s_mov_b32 m0, 7168
  s_add_u32 s27, s32, 0
  buffer_load_dwordx4 v9, s[12:15], s27 offen  lds
  s_mov_b32 m0, 8192
  s_add_u32 s27, s32, 0
  buffer_load_dwordx4 v10, s[12:15], s27 offen  lds
  s_mov_b32 m0, 9216
  s_add_u32 s27, s32, 0
  buffer_load_dwordx4 v11, s[12:15], s27 offen  lds
  s_mov_b32 m0, 10240
  s_add_u32 s27, s32, 0
  buffer_load_dwordx4 v12, s[12:15], s27 offen  lds
  s_mov_b32 m0, 11264
  s_add_u32 s27, s32, 0
  buffer_load_dwordx4 v13, s[12:15], s27 offen  lds
  s_waitcnt vmcnt(30)
  ds_read_b64_tr_b16 v[24:25], v4 offset:18432
  ds_read_b64_tr_b16 v[26:27], v4 offset:18560
  ds_read_b64_tr_b16 v[28:29], v4 offset:21504
  ds_read_b64_tr_b16 v[30:31], v4 offset:21632
  ds_read_b64_tr_b16 v[32:33], v5 offset:20480
  ds_read_b64_tr_b16 v[34:35], v5 offset:20608
  ds_read_b64_tr_b16 v[36:37], v4 offset:18464
  ds_read_b64_tr_b16 v[38:39], v4 offset:18592
  ds_read_b64_tr_b16 v[40:41], v4 offset:21536
  ds_read_b64_tr_b16 v[42:43], v4 offset:21664
  ds_read_b64_tr_b16 v[44:45], v5 offset:20512
  ds_read_b64_tr_b16 v[46:47], v5 offset:20640
  s_waitcnt lgkmcnt(0)
  ds_write_b128 v7, v[24:27] offset:18432
  ds_write_b128 v7, v[28:31] offset:19456
  ds_write_b128 v7, v[32:35] offset:22528
  ds_write_b128 v7, v[36:39] offset:20480
  ds_write_b128 v7, v[40:43] offset:21504
  ds_write_b128 v7, v[44:47] offset:23552
  s_waitcnt lgkmcnt(0)
  s_waitcnt vmcnt(24)
  ds_read_b64_tr_b16 a[176:177], v4 offset:0
  ds_read_b64_tr_b16 a[178:179], v4 offset:128
  ds_read_b64_tr_b16 a[180:181], v4 offset:3072
  ds_read_b64_tr_b16 a[182:183], v4 offset:3200
  ds_read_b64_tr_b16 a[188:189], v5 offset:2048
  ds_read_b64_tr_b16 a[190:191], v5 offset:2176
  ds_read_b64_tr_b16 a[200:201], v4 offset:32
  ds_read_b64_tr_b16 a[202:203], v4 offset:160
  ds_read_b64_tr_b16 a[204:205], v4 offset:3104
  ds_read_b64_tr_b16 a[206:207], v4 offset:3232
  ds_read_b64_tr_b16 a[212:213], v5 offset:2080
  ds_read_b64_tr_b16 a[214:215], v5 offset:2208
  s_waitcnt lgkmcnt(0)
  s_waitcnt vmcnt(18)
  ds_read_b64_tr_b16 a[224:225], v21 offset:0
  ds_read_b64_tr_b16 a[226:227], v21 offset:128
  ds_read_b64_tr_b16 a[228:229], v21 offset:3072
  ds_read_b64_tr_b16 a[230:231], v21 offset:3200
  ds_read_b64_tr_b16 a[236:237], v22 offset:2048
  ds_read_b64_tr_b16 a[238:239], v22 offset:2176
  ds_read_b64_tr_b16 a[248:249], v21 offset:32
  ds_read_b64_tr_b16 a[250:251], v21 offset:160
  ds_read_b64_tr_b16 a[252:253], v21 offset:3104
  ds_read_b64_tr_b16 a[254:255], v21 offset:3232
  ds_read_b64_tr_b16 v[156:157], v22 offset:2080
  ds_read_b64_tr_b16 v[158:159], v22 offset:2208
  s_waitcnt lgkmcnt(0)
  s_mov_b32 m0, 122880
  s_add_u32 s27, s32, 786432
  buffer_load_dwordx4 v8, s[12:15], s27 offen  lds
  s_mov_b32 m0, 123904
  s_add_u32 s27, s32, 786432
  buffer_load_dwordx4 v9, s[12:15], s27 offen  lds
  s_mov_b32 m0, 124928
  s_add_u32 s27, s32, 786432
  buffer_load_dwordx4 v10, s[12:15], s27 offen  lds
  s_mov_b32 m0, 125952
  s_add_u32 s27, s32, 786432
  buffer_load_dwordx4 v11, s[12:15], s27 offen  lds
  s_mov_b32 m0, 126976
  s_add_u32 s27, s32, 786432
  buffer_load_dwordx4 v12, s[12:15], s27 offen  lds
  s_mov_b32 m0, 128000
  s_add_u32 s27, s32, 786432
  buffer_load_dwordx4 v13, s[12:15], s27 offen  lds
  s_waitcnt vmcnt(18)
  ds_read_b64_tr_b16 v[168:169], v4 offset:24576
  ds_read_b64_tr_b16 v[170:171], v4 offset:24704
  ds_read_b64_tr_b16 v[172:173], v4 offset:27648
  ds_read_b64_tr_b16 v[174:175], v4 offset:27776
  ds_read_b64_tr_b16 v[180:181], v5 offset:26624
  ds_read_b64_tr_b16 v[182:183], v5 offset:26752
  ds_read_b64_tr_b16 v[192:193], v4 offset:24608
  ds_read_b64_tr_b16 v[194:195], v4 offset:24736
  ds_read_b64_tr_b16 v[196:197], v4 offset:27680
  ds_read_b64_tr_b16 v[198:199], v4 offset:27808
  ds_read_b64_tr_b16 v[204:205], v5 offset:26656
  ds_read_b64_tr_b16 v[206:207], v5 offset:26784
  s_waitcnt lgkmcnt(0)
  s_mov_b32 m0, 24576
  s_add_u32 s27, s32, 1572864
  buffer_load_dwordx4 v8, s[12:15], s27 offen  lds
  s_mov_b32 m0, 25600
  s_add_u32 s27, s32, 1572864
  buffer_load_dwordx4 v9, s[12:15], s27 offen  lds
  s_mov_b32 m0, 26624
  s_add_u32 s27, s32, 1572864
  buffer_load_dwordx4 v10, s[12:15], s27 offen  lds
  s_mov_b32 m0, 27648
  s_add_u32 s27, s32, 1572864
  buffer_load_dwordx4 v11, s[12:15], s27 offen  lds
  s_mov_b32 m0, 28672
  s_add_u32 s27, s32, 1572864
  buffer_load_dwordx4 v12, s[12:15], s27 offen  lds
  s_mov_b32 m0, 29696
  s_add_u32 s27, s32, 1572864
  buffer_load_dwordx4 v13, s[12:15], s27 offen  lds
  s_mov_b32 m0, 0
  s_add_u32 s27, s32, 2359296
  buffer_load_dwordx4 v8, s[12:15], s27 offen  lds
  s_mov_b32 m0, 1024
  s_add_u32 s27, s32, 2359296
  buffer_load_dwordx4 v9, s[12:15], s27 offen  lds
  s_mov_b32 m0, 2048
  s_add_u32 s27, s32, 2359296
  buffer_load_dwordx4 v10, s[12:15], s27 offen  lds
  s_mov_b32 m0, 3072
  s_add_u32 s27, s32, 2359296
  buffer_load_dwordx4 v11, s[12:15], s27 offen  lds
  s_mov_b32 m0, 4096
  s_add_u32 s27, s32, 2359296
  buffer_load_dwordx4 v12, s[12:15], s27 offen  lds
  s_mov_b32 m0, 5120
  s_add_u32 s27, s32, 2359296
  buffer_load_dwordx4 v13, s[12:15], s27 offen  lds
  s_waitcnt vmcnt(24)
  ds_read_b64_tr_b16 v[216:217], v4 offset:12288
  ds_read_b64_tr_b16 v[218:219], v4 offset:12416
  ds_read_b64_tr_b16 v[220:221], v4 offset:15360
  ds_read_b64_tr_b16 v[222:223], v4 offset:15488
  ds_read_b64_tr_b16 v[228:229], v5 offset:14336
  ds_read_b64_tr_b16 v[230:231], v5 offset:14464
  ds_read_b64_tr_b16 v[240:241], v4 offset:12320
  ds_read_b64_tr_b16 v[242:243], v4 offset:12448
  ds_read_b64_tr_b16 v[244:245], v4 offset:15392
  ds_read_b64_tr_b16 v[246:247], v4 offset:15520
  ds_read_b64_tr_b16 v[252:253], v5 offset:14368
  ds_read_b64_tr_b16 v[254:255], v5 offset:14496
  s_waitcnt lgkmcnt(0)
  s_mov_b32 m0, 12288
  s_add_u32 s27, s32, 3145728
  buffer_load_dwordx4 v8, s[12:15], s27 offen  lds
  s_mov_b32 m0, 13312
  s_add_u32 s27, s32, 3145728
  buffer_load_dwordx4 v9, s[12:15], s27 offen  lds
  s_mov_b32 m0, 14336
  s_add_u32 s27, s32, 3145728
  buffer_load_dwordx4 v10, s[12:15], s27 offen  lds
  s_mov_b32 m0, 15360
  s_add_u32 s27, s32, 3145728
  buffer_load_dwordx4 v11, s[12:15], s27 offen  lds
  s_mov_b32 m0, 16384
  s_add_u32 s27, s32, 3145728
  buffer_load_dwordx4 v12, s[12:15], s27 offen  lds
  s_mov_b32 m0, 17408
  s_add_u32 s27, s32, 3145728
  buffer_load_dwordx4 v13, s[12:15], s27 offen  lds
  s_waitcnt vmcnt(24)
  ds_read_b64_tr_b16 a[0:1], v3 offset:6144
  ds_read_b64_tr_b16 a[2:3], v3 offset:6336
  ds_read_b64_tr_b16 a[4:5], v3 offset:9216
  ds_read_b64_tr_b16 a[6:7], v3 offset:9408
  ds_read_b64_tr_b16 a[8:9], v3 offset:6176
  ds_read_b64_tr_b16 a[10:11], v3 offset:6368
  ds_read_b64_tr_b16 a[12:13], v3 offset:9248
  ds_read_b64_tr_b16 a[14:15], v3 offset:9440
  ds_read_b64_tr_b16 a[16:17], v3 offset:6208
  ds_read_b64_tr_b16 a[18:19], v3 offset:6400
  ds_read_b64_tr_b16 a[20:21], v3 offset:9280
  ds_read_b64_tr_b16 a[22:23], v3 offset:9472
  s_waitcnt lgkmcnt(0)
  s_waitcnt vmcnt(18)
  ds_read_b64_tr_b16 a[24:25], v20 offset:0
  ds_read_b64_tr_b16 a[26:27], v20 offset:192
  ds_read_b64_tr_b16 a[28:29], v20 offset:3072
  ds_read_b64_tr_b16 a[30:31], v20 offset:3264
  ds_read_b64_tr_b16 a[32:33], v20 offset:32
  ds_read_b64_tr_b16 a[34:35], v20 offset:224
  ds_read_b64_tr_b16 a[36:37], v20 offset:3104
  ds_read_b64_tr_b16 a[38:39], v20 offset:3296
  ds_read_b64_tr_b16 a[40:41], v20 offset:64
  ds_read_b64_tr_b16 a[42:43], v20 offset:256
  ds_read_b64_tr_b16 a[44:45], v20 offset:3136
  ds_read_b64_tr_b16 a[46:47], v20 offset:3328
  s_waitcnt lgkmcnt(0)
  s_mov_b32 m0, 122880
  s_add_u32 s27, s32, 3932160
  buffer_load_dwordx4 v8, s[12:15], s27 offen  lds
  s_mov_b32 m0, 123904
  s_add_u32 s27, s32, 3932160
  buffer_load_dwordx4 v9, s[12:15], s27 offen  lds
  s_mov_b32 m0, 124928
  s_add_u32 s27, s32, 3932160
  buffer_load_dwordx4 v10, s[12:15], s27 offen  lds
  s_mov_b32 m0, 125952
  s_add_u32 s27, s32, 3932160
  buffer_load_dwordx4 v11, s[12:15], s27 offen  lds
  s_mov_b32 m0, 126976
  s_add_u32 s27, s32, 3932160
  buffer_load_dwordx4 v12, s[12:15], s27 offen  lds
  s_mov_b32 m0, 128000
  s_add_u32 s27, s32, 3932160
  buffer_load_dwordx4 v13, s[12:15], s27 offen  lds
  s_mov_b32 m0, 6144
  s_add_u32 s27, s32, 4718592
  buffer_load_dwordx4 v8, s[12:15], s27 offen  lds
  s_mov_b32 m0, 7168
  s_add_u32 s27, s32, 4718592
  buffer_load_dwordx4 v9, s[12:15], s27 offen  lds
  s_mov_b32 m0, 8192
  s_add_u32 s27, s32, 4718592
  buffer_load_dwordx4 v10, s[12:15], s27 offen  lds
  s_mov_b32 m0, 9216
  s_add_u32 s27, s32, 4718592
  buffer_load_dwordx4 v11, s[12:15], s27 offen  lds
  s_mov_b32 m0, 10240
  s_add_u32 s27, s32, 4718592
  buffer_load_dwordx4 v12, s[12:15], s27 offen  lds
  s_mov_b32 m0, 11264
  s_add_u32 s27, s32, 4718592
  buffer_load_dwordx4 v13, s[12:15], s27 offen  lds
  s_waitcnt vmcnt(24)
  ds_read_b64_tr_b16 a[48:49], v3 offset:24576
  ds_read_b64_tr_b16 a[50:51], v3 offset:24768
  ds_read_b64_tr_b16 a[52:53], v3 offset:27648
  ds_read_b64_tr_b16 a[54:55], v3 offset:27840
  ds_read_b64_tr_b16 a[56:57], v3 offset:24608
  ds_read_b64_tr_b16 a[58:59], v3 offset:24800
  ds_read_b64_tr_b16 a[60:61], v3 offset:27680
  ds_read_b64_tr_b16 a[62:63], v3 offset:27872
  ds_read_b64_tr_b16 a[64:65], v3 offset:24640
  ds_read_b64_tr_b16 a[66:67], v3 offset:24832
  ds_read_b64_tr_b16 a[68:69], v3 offset:27712
  ds_read_b64_tr_b16 a[70:71], v3 offset:27904
  s_waitcnt lgkmcnt(0)
  s_waitcnt vmcnt(18)
  ds_read_b64_tr_b16 v[24:25], v3 offset:0
  ds_read_b64_tr_b16 v[26:27], v3 offset:192
  ds_read_b64_tr_b16 v[28:29], v3 offset:3072
  ds_read_b64_tr_b16 v[30:31], v3 offset:3264
  ds_read_b64_tr_b16 v[32:33], v3 offset:32
  ds_read_b64_tr_b16 v[34:35], v3 offset:224
  ds_read_b64_tr_b16 v[36:37], v3 offset:3104
  ds_read_b64_tr_b16 v[38:39], v3 offset:3296
  ds_read_b64_tr_b16 v[40:41], v3 offset:64
  ds_read_b64_tr_b16 v[42:43], v3 offset:256
  ds_read_b64_tr_b16 v[44:45], v3 offset:3136
  ds_read_b64_tr_b16 v[46:47], v3 offset:3328
  s_waitcnt lgkmcnt(0)
  ds_write_b128 v7, v[24:27] offset:0
  ds_write_b128 v7, v[28:31] offset:1024
  ds_write_b128 v7, v[32:35] offset:2048
  ds_write_b128 v7, v[36:39] offset:3072
  ds_write_b128 v7, v[40:43] offset:4096
  ds_write_b128 v7, v[44:47] offset:5120
  s_waitcnt lgkmcnt(0)
  s_waitcnt vmcnt(12)
  ds_read_b64_tr_b16 a[72:73], v3 offset:12288
  ds_read_b64_tr_b16 a[74:75], v3 offset:12480
  ds_read_b64_tr_b16 a[76:77], v3 offset:15360
  ds_read_b64_tr_b16 a[78:79], v3 offset:15552
  ds_read_b64_tr_b16 a[80:81], v3 offset:12320
  ds_read_b64_tr_b16 a[82:83], v3 offset:12512
  ds_read_b64_tr_b16 a[84:85], v3 offset:15392
  ds_read_b64_tr_b16 a[86:87], v3 offset:15584
  ds_read_b64_tr_b16 a[88:89], v3 offset:12352
  ds_read_b64_tr_b16 a[90:91], v3 offset:12544
  ds_read_b64_tr_b16 a[92:93], v3 offset:15424
  ds_read_b64_tr_b16 a[94:95], v3 offset:15616
  s_waitcnt lgkmcnt(0)
  s_mov_b32 m0, 24576
  s_add_u32 s27, s32, 5505024
  buffer_load_dwordx4 v8, s[12:15], s27 offen  lds
  s_mov_b32 m0, 25600
  s_add_u32 s27, s32, 5505024
  buffer_load_dwordx4 v9, s[12:15], s27 offen  lds
  s_mov_b32 m0, 26624
  s_add_u32 s27, s32, 5505024
  buffer_load_dwordx4 v10, s[12:15], s27 offen  lds
  s_mov_b32 m0, 27648
  s_add_u32 s27, s32, 5505024
  buffer_load_dwordx4 v11, s[12:15], s27 offen  lds
  s_mov_b32 m0, 28672
  s_add_u32 s27, s32, 5505024
  buffer_load_dwordx4 v12, s[12:15], s27 offen  lds
  s_mov_b32 m0, 29696
  s_add_u32 s27, s32, 5505024
  buffer_load_dwordx4 v13, s[12:15], s27 offen  lds
  s_waitcnt vmcnt(12)
  ds_read_b64_tr_b16 a[96:97], v20 offset:0
  ds_read_b64_tr_b16 a[98:99], v20 offset:192
  ds_read_b64_tr_b16 a[100:101], v20 offset:3072
  ds_read_b64_tr_b16 a[102:103], v20 offset:3264
  ds_read_b64_tr_b16 a[104:105], v20 offset:32
  ds_read_b64_tr_b16 a[106:107], v20 offset:224
  ds_read_b64_tr_b16 a[108:109], v20 offset:3104
  ds_read_b64_tr_b16 a[110:111], v20 offset:3296
  ds_read_b64_tr_b16 a[112:113], v20 offset:64
  ds_read_b64_tr_b16 a[114:115], v20 offset:256
  ds_read_b64_tr_b16 a[116:117], v20 offset:3136
  ds_read_b64_tr_b16 a[118:119], v20 offset:3328
  s_waitcnt lgkmcnt(0)
  s_mov_b32 m0, 122880
  s_add_u32 s27, s32, 6291456
  buffer_load_dwordx4 v8, s[12:15], s27 offen  lds
  s_mov_b32 m0, 123904
  s_add_u32 s27, s32, 6291456
  buffer_load_dwordx4 v9, s[12:15], s27 offen  lds
  s_mov_b32 m0, 124928
  s_add_u32 s27, s32, 6291456
  buffer_load_dwordx4 v10, s[12:15], s27 offen  lds
  s_mov_b32 m0, 125952
  s_add_u32 s27, s32, 6291456
  buffer_load_dwordx4 v11, s[12:15], s27 offen  lds
  s_mov_b32 m0, 126976
  s_add_u32 s27, s32, 6291456
  buffer_load_dwordx4 v12, s[12:15], s27 offen  lds
  s_mov_b32 m0, 128000
  s_add_u32 s27, s32, 6291456
  buffer_load_dwordx4 v13, s[12:15], s27 offen  lds
  s_mov_b32 m0, 12288
  s_add_u32 s27, s32, 7077888
  buffer_load_dwordx4 v8, s[12:15], s27 offen  lds
  s_mov_b32 m0, 13312
  s_add_u32 s27, s32, 7077888
  buffer_load_dwordx4 v9, s[12:15], s27 offen  lds
  s_mov_b32 m0, 14336
  s_add_u32 s27, s32, 7077888
  buffer_load_dwordx4 v10, s[12:15], s27 offen  lds
  s_mov_b32 m0, 15360
  s_add_u32 s27, s32, 7077888
  buffer_load_dwordx4 v11, s[12:15], s27 offen  lds
  s_mov_b32 m0, 16384
  s_add_u32 s27, s32, 7077888
  buffer_load_dwordx4 v12, s[12:15], s27 offen  lds
  s_mov_b32 m0, 17408
  s_add_u32 s27, s32, 7077888
  buffer_load_dwordx4 v13, s[12:15], s27 offen  lds
  s_waitcnt vmcnt(18)
  ds_read_b64_tr_b16 v[24:25], v3 offset:6144
  ds_read_b64_tr_b16 v[26:27], v3 offset:6336
  ds_read_b64_tr_b16 v[28:29], v3 offset:9216
  ds_read_b64_tr_b16 v[30:31], v3 offset:9408
  ds_read_b64_tr_b16 v[32:33], v3 offset:6176
  ds_read_b64_tr_b16 v[34:35], v3 offset:6368
  ds_read_b64_tr_b16 v[36:37], v3 offset:9248
  ds_read_b64_tr_b16 v[38:39], v3 offset:9440
  ds_read_b64_tr_b16 v[40:41], v3 offset:6208
  ds_read_b64_tr_b16 v[42:43], v3 offset:6400
  ds_read_b64_tr_b16 v[44:45], v3 offset:9280
  ds_read_b64_tr_b16 v[46:47], v3 offset:9472
  s_waitcnt lgkmcnt(0)
  ds_write_b128 v7, v[24:27] offset:6144
  ds_write_b128 v7, v[28:31] offset:7168
  ds_write_b128 v7, v[32:35] offset:8192
  ds_write_b128 v7, v[36:39] offset:9216
  ds_write_b128 v7, v[40:43] offset:10240
  ds_write_b128 v7, v[44:47] offset:11264
  s_waitcnt lgkmcnt(0)
  s_waitcnt vmcnt(12)
  ds_read_b64_tr_b16 a[120:121], v3 offset:24576
  ds_read_b64_tr_b16 a[122:123], v3 offset:24768
  ds_read_b64_tr_b16 a[124:125], v3 offset:27648
  ds_read_b64_tr_b16 a[126:127], v3 offset:27840
  ds_read_b64_tr_b16 a[128:129], v3 offset:24608
  ds_read_b64_tr_b16 a[130:131], v3 offset:24800
  ds_read_b64_tr_b16 a[132:133], v3 offset:27680
  ds_read_b64_tr_b16 a[134:135], v3 offset:27872
  ds_read_b64_tr_b16 a[136:137], v3 offset:24640
  ds_read_b64_tr_b16 a[138:139], v3 offset:24832
  ds_read_b64_tr_b16 a[140:141], v3 offset:27712
  ds_read_b64_tr_b16 a[142:143], v3 offset:27904
  s_waitcnt lgkmcnt(0)
  s_mov_b32 m0, 24576
  s_add_u32 s27, s33, 123136
  buffer_load_dwordx4 v14, s[16:19], s27 offen  lds
  s_mov_b32 m0, 25600
  s_add_u32 s27, s33, 123136
  buffer_load_dwordx4 v15, s[16:19], s27 offen  lds
  s_mov_b32 m0, 26624
  s_add_u32 s27, s33, 123136
  buffer_load_dwordx4 v16, s[16:19], s27 offen  lds
  s_mov_b32 m0, 27648
  s_add_u32 s27, s33, 123136
  buffer_load_dwordx4 v17, s[16:19], s27 offen  lds
  s_mov_b32 m0, 28672
  s_add_u32 s27, s33, 123136
  buffer_load_dwordx4 v18, s[16:19], s27 offen  lds
  s_mov_b32 m0, 29696
  s_add_u32 s27, s33, 123136
  buffer_load_dwordx4 v19, s[16:19], s27 offen  lds
  buffer_load_dwordx4 v[68:71], off, s[68:71], 0 offset:128 sc1
  buffer_load_dwordx2 v[72:73], off, s[68:71], 0 offset:64 sc1
  s_waitcnt vmcnt(14)
  ds_read_b64_tr_b16 a[144:145], v20 offset:0
  ds_read_b64_tr_b16 a[146:147], v20 offset:192
  ds_read_b64_tr_b16 a[148:149], v20 offset:3072
  ds_read_b64_tr_b16 a[150:151], v20 offset:3264
  ds_read_b64_tr_b16 a[152:153], v20 offset:32
  ds_read_b64_tr_b16 a[154:155], v20 offset:224
  ds_read_b64_tr_b16 a[156:157], v20 offset:3104
  ds_read_b64_tr_b16 a[158:159], v20 offset:3296
  ds_read_b64_tr_b16 a[160:161], v20 offset:64
  ds_read_b64_tr_b16 a[162:163], v20 offset:256
  ds_read_b64_tr_b16 a[164:165], v20 offset:3136
  ds_read_b64_tr_b16 a[166:167], v20 offset:3328
  s_waitcnt lgkmcnt(0)
  s_waitcnt vmcnt(8)
  ds_read_b64_tr_b16 v[24:25], v3 offset:12288
  ds_read_b64_tr_b16 v[26:27], v3 offset:12480
  ds_read_b64_tr_b16 v[28:29], v3 offset:15360
  ds_read_b64_tr_b16 v[30:31], v3 offset:15552
  ds_read_b64_tr_b16 v[32:33], v3 offset:12320
  ds_read_b64_tr_b16 v[34:35], v3 offset:12512
  ds_read_b64_tr_b16 v[36:37], v3 offset:15392
  ds_read_b64_tr_b16 v[38:39], v3 offset:15584
  ds_read_b64_tr_b16 v[40:41], v3 offset:12352
  ds_read_b64_tr_b16 v[42:43], v3 offset:12544
  ds_read_b64_tr_b16 v[44:45], v3 offset:15424
  ds_read_b64_tr_b16 v[46:47], v3 offset:15616
  s_waitcnt lgkmcnt(0)
  ds_write_b128 v7, v[24:27] offset:12288
  ds_write_b128 v7, v[28:31] offset:13312
  ds_write_b128 v7, v[32:35] offset:14336
  ds_write_b128 v7, v[36:39] offset:15360
  ds_write_b128 v7, v[40:43] offset:16384
  ds_write_b128 v7, v[44:47] offset:17408
  s_waitcnt lgkmcnt(0)
  s_waitcnt vmcnt(2)
  ds_read_b64_tr_b16 v[24:25], v4 offset:24576
  ds_read_b64_tr_b16 v[26:27], v4 offset:24704
  ds_read_b64_tr_b16 v[28:29], v4 offset:27648
  ds_read_b64_tr_b16 v[30:31], v4 offset:27776
  ds_read_b64_tr_b16 v[32:33], v5 offset:26624
  ds_read_b64_tr_b16 v[34:35], v5 offset:26752
  ds_read_b64_tr_b16 v[36:37], v4 offset:24608
  ds_read_b64_tr_b16 v[38:39], v4 offset:24736
  ds_read_b64_tr_b16 v[40:41], v4 offset:27680
  ds_read_b64_tr_b16 v[42:43], v4 offset:27808
  ds_read_b64_tr_b16 v[44:45], v5 offset:26656
  ds_read_b64_tr_b16 v[46:47], v5 offset:26784
  s_waitcnt lgkmcnt(0)
  ds_write_b128 v7, v[24:27] offset:24576
  ds_write_b128 v7, v[28:31] offset:25600
  ds_write_b128 v7, v[32:35] offset:28672
  ds_write_b128 v7, v[36:39] offset:26624
  ds_write_b128 v7, v[40:43] offset:27648
  ds_write_b128 v7, v[44:47] offset:29696
  s_waitcnt lgkmcnt(0)
  s_branch CV_ldd
CV_ld1:
  s_cmp_lg_u32 s24, 1
  s_cbranch_scc1 CV_ld2
  s_mov_b32 m0, 129024
  s_add_u32 s27, s33, 0
  buffer_load_dwordx4 v14, s[16:19], s27 offen  lds
  s_mov_b32 m0, 130048
  s_add_u32 s27, s33, 0
  buffer_load_dwordx4 v15, s[16:19], s27 offen  lds
  s_mov_b32 m0, 131072
  s_add_u32 s27, s33, 0
  buffer_load_dwordx4 v16, s[16:19], s27 offen  lds
  s_mov_b32 m0, 132096
  s_add_u32 s27, s33, 0
  buffer_load_dwordx4 v17, s[16:19], s27 offen  lds
  s_mov_b32 m0, 133120
  s_add_u32 s27, s33, 0
  buffer_load_dwordx4 v18, s[16:19], s27 offen  lds
  s_mov_b32 m0, 134144
  s_add_u32 s27, s33, 0
  buffer_load_dwordx4 v19, s[16:19], s27 offen  lds
  s_mov_b32 m0, 55296
  s_add_u32 s27, s33, 64
  buffer_load_dwordx4 v14, s[16:19], s27 offen  lds
  s_mov_b32 m0, 56320
  s_add_u32 s27, s33, 64
  buffer_load_dwordx4 v15, s[16:19], s27 offen  lds
  s_mov_b32 m0, 57344
  s_add_u32 s27, s33, 64
  buffer_load_dwordx4 v16, s[16:19], s27 offen  lds
  s_mov_b32 m0, 58368
  s_add_u32 s27, s33, 64
  buffer_load_dwordx4 v17, s[16:19], s27 offen  lds
  s_mov_b32 m0, 59392
  s_add_u32 s27, s33, 64
  buffer_load_dwordx4 v18, s[16:19], s27 offen  lds
  s_mov_b32 m0, 60416
  s_add_u32 s27, s33, 64
  buffer_load_dwordx4 v19, s[16:19], s27 offen  lds
  s_mov_b32 m0, 36864
  s_add_u32 s27, s33, 128
  buffer_load_dwordx4 v14, s[16:19], s27 offen  lds
  s_mov_b32 m0, 37888
  s_add_u32 s27, s33, 128
  buffer_load_dwordx4 v15, s[16:19], s27 offen  lds
  s_mov_b32 m0, 38912
  s_add_u32 s27, s33, 128
  buffer_load_dwordx4 v16, s[16:19], s27 offen  lds
  s_mov_b32 m0, 39936
  s_add_u32 s27, s33, 128
  buffer_load_dwordx4 v17, s[16:19], s27 offen  lds
  s_mov_b32 m0, 40960
  s_add_u32 s27, s33, 128
  buffer_load_dwordx4 v18, s[16:19], s27 offen  lds
  s_mov_b32 m0, 41984
  s_add_u32 s27, s33, 128
  buffer_load_dwordx4 v19, s[16:19], s27 offen  lds
  s_mov_b32 m0, 30720
  s_add_u32 s27, s33, 192
  buffer_load_dwordx4 v14, s[16:19], s27 offen  lds
  s_mov_b32 m0, 31744
  s_add_u32 s27, s33, 192
  buffer_load_dwordx4 v15, s[16:19], s27 offen  lds
  s_mov_b32 m0, 32768
  s_add_u32 s27, s33, 192
  buffer_load_dwordx4 v16, s[16:19], s27 offen  lds
  s_mov_b32 m0, 33792
  s_add_u32 s27, s33, 192
  buffer_load_dwordx4 v17, s[16:19], s27 offen  lds
  s_mov_b32 m0, 34816
  s_add_u32 s27, s33, 192
  buffer_load_dwordx4 v18, s[16:19], s27 offen  lds
  s_mov_b32 m0, 35840
  s_add_u32 s27, s33, 192
  buffer_load_dwordx4 v19, s[16:19], s27 offen  lds
  s_mov_b32 m0, 49152
  s_add_u32 s27, s33, 256
  buffer_load_dwordx4 v14, s[16:19], s27 offen  lds
  s_mov_b32 m0, 50176
  s_add_u32 s27, s33, 256
  buffer_load_dwordx4 v15, s[16:19], s27 offen  lds
  s_mov_b32 m0, 51200
  s_add_u32 s27, s33, 256
  buffer_load_dwordx4 v16, s[16:19], s27 offen  lds
  s_mov_b32 m0, 52224
  s_add_u32 s27, s33, 256
  buffer_load_dwordx4 v17, s[16:19], s27 offen  lds
  s_mov_b32 m0, 53248
  s_add_u32 s27, s33, 256
  buffer_load_dwordx4 v18, s[16:19], s27 offen  lds
  s_mov_b32 m0, 54272
  s_add_u32 s27, s33, 256
  buffer_load_dwordx4 v19, s[16:19], s27 offen  lds
  s_mov_b32 m0, 43008
  s_add_u32 s27, s33, 122880
  buffer_load_dwordx4 v14, s[16:19], s27 offen  lds
  s_mov_b32 m0, 44032
  s_add_u32 s27, s33, 122880
  buffer_load_dwordx4 v15, s[16:19], s27 offen  lds
  s_mov_b32 m0, 45056
  s_add_u32 s27, s33, 122880
  buffer_load_dwordx4 v16, s[16:19], s27 offen  lds
  s_mov_b32 m0, 46080
  s_add_u32 s27, s33, 122880
  buffer_load_dwordx4 v17, s[16:19], s27 offen  lds
  s_mov_b32 m0, 47104
  s_add_u32 s27, s33, 122880
  buffer_load_dwordx4 v18, s[16:19], s27 offen  lds
  s_mov_b32 m0, 48128
  s_add_u32 s27, s33, 122880
  buffer_load_dwordx4 v19, s[16:19], s27 offen  lds
  s_waitcnt vmcnt(30)
  ds_read_b64_tr_b16 a[168:169], v21 offset:0
  ds_read_b64_tr_b16 a[170:171], v21 offset:128
  ds_read_b64_tr_b16 a[172:173], v21 offset:3072
  ds_read_b64_tr_b16 a[174:175], v21 offset:3200
  ds_read_b64_tr_b16 a[184:185], v22 offset:2048
  ds_read_b64_tr_b16 a[186:187], v22 offset:2176
  ds_read_b64_tr_b16 a[192:193], v21 offset:32
  ds_read_b64_tr_b16 a[194:195], v21 offset:160
  ds_read_b64_tr_b16 a[196:197], v21 offset:3104
  ds_read_b64_tr_b16 a[198:199], v21 offset:3232
  ds_read_b64_tr_b16 a[208:209], v22 offset:2080
  ds_read_b64_tr_b16 a[210:211], v22 offset:2208
  s_waitcnt lgkmcnt(0)
  s_mov_b32 m0, 129024
  s_add_u32 s27, s33, 122944
  buffer_load_dwordx4 v14, s[16:19], s27 offen  lds
  s_mov_b32 m0, 130048
  s_add_u32 s27, s33, 122944
  buffer_load_dwordx4 v15, s[16:19], s27 offen  lds
  s_mov_b32 m0, 131072
  s_add_u32 s27, s33, 122944
  buffer_load_dwordx4 v16, s[16:19], s27 offen  lds
  s_mov_b32 m0, 132096
  s_add_u32 s27, s33, 122944
  buffer_load_dwordx4 v17, s[16:19], s27 offen  lds
  s_mov_b32 m0, 133120
  s_add_u32 s27, s33, 122944
  buffer_load_dwordx4 v18, s[16:19], s27 offen  lds
  s_mov_b32 m0, 134144
  s_add_u32 s27, s33, 122944
  buffer_load_dwordx4 v19, s[16:19], s27 offen  lds
  s_waitcnt vmcnt(30)
  ds_read_b64_tr_b16 a[216:217], v4 offset:24576
  ds_read_b64_tr_b16 a[218:219], v4 offset:24704
  ds_read_b64_tr_b16 a[220:221], v4 offset:27648
  ds_read_b64_tr_b16 a[222:223], v4 offset:27776
  ds_read_b64_tr_b16 a[232:233], v5 offset:26624
  ds_read_b64_tr_b16 a[234:235], v5 offset:26752
  ds_read_b64_tr_b16 a[240:241], v4 offset:24608
  ds_read_b64_tr_b16 a[242:243], v4 offset:24736
  ds_read_b64_tr_b16 a[244:245], v4 offset:27680
  ds_read_b64_tr_b16 a[246:247], v4 offset:27808
  ds_read_b64_tr_b16 v[152:153], v5 offset:26656
  ds_read_b64_tr_b16 v[154:155], v5 offset:26784
  s_waitcnt lgkmcnt(0)
  s_mov_b32 m0, 55296
  s_add_u32 s27, s33, 123008
  buffer_load_dwordx4 v14, s[16:19], s27 offen  lds
  s_mov_b32 m0, 56320
  s_add_u32 s27, s33, 123008
  buffer_load_dwordx4 v15, s[16:19], s27 offen  lds
  s_mov_b32 m0, 57344
  s_add_u32 s27, s33, 123008
  buffer_load_dwordx4 v16, s[16:19], s27 offen  lds
  s_mov_b32 m0, 58368
  s_add_u32 s27, s33, 123008
  buffer_load_dwordx4 v17, s[16:19], s27 offen  lds
  s_mov_b32 m0, 59392
  s_add_u32 s27, s33, 123008
  buffer_load_dwordx4 v18, s[16:19], s27 offen  lds
  s_mov_b32 m0, 60416
  s_add_u32 s27, s33, 123008
  buffer_load_dwordx4 v19, s[16:19], s27 offen  lds
  s_waitcnt vmcnt(30)
  ds_read_b64_tr_b16 v[160:161], v4 offset:6144
  ds_read_b64_tr_b16 v[162:163], v4 offset:6272
  ds_read_b64_tr_b16 v[164:165], v4 offset:9216
  ds_read_b64_tr_b16 v[166:167], v4 offset:9344
  ds_read_b64_tr_b16 v[176:177], v5 offset:8192
  ds_read_b64_tr_b16 v[178:179], v5 offset:8320
  ds_read_b64_tr_b16 v[184:185], v4 offset:6176
  ds_read_b64_tr_b16 v[186:187], v4 offset:6304
  ds_read_b64_tr_b16 v[188:189], v4 offset:9248
  ds_read_b64_tr_b16 v[190:191], v4 offset:9376
  ds_read_b64_tr_b16 v[200:201], v5 offset:8224
  ds_read_b64_tr_b16 v[202:203], v5 offset:8352
  s_waitcnt lgkmcnt(0)
  s_mov_b32 m0, 36864
  s_add_u32 s27, s33, 123072
  buffer_load_dwordx4 v14, s[16:19], s27 offen  lds
  s_mov_b32 m0, 37888
  s_add_u32 s27, s33, 123072
  buffer_load_dwordx4 v15, s[16:19], s27 offen  lds
  s_mov_b32 m0, 38912
  s_add_u32 s27, s33, 123072
  buffer_load_dwordx4 v16, s[16:19], s27 offen  lds
  s_mov_b32 m0, 39936
  s_add_u32 s27, s33, 123072
  buffer_load_dwordx4 v17, s[16:19], s27 offen  lds
  s_mov_b32 m0, 40960
  s_add_u32 s27, s33, 123072
  buffer_load_dwordx4 v18, s[16:19], s27 offen  lds
  s_mov_b32 m0, 41984
  s_add_u32 s27, s33, 123072
  buffer_load_dwordx4 v19, s[16:19], s27 offen  lds
  s_waitcnt vmcnt(30)
  ds_read_b64_tr_b16 v[208:209], v4 offset:0
  ds_read_b64_tr_b16 v[210:211], v4 offset:128
  ds_read_b64_tr_b16 v[212:213], v4 offset:3072
  ds_read_b64_tr_b16 v[214:215], v4 offset:3200
  ds_read_b64_tr_b16 v[224:225], v5 offset:2048
  ds_read_b64_tr_b16 v[226:227], v5 offset:2176
  ds_read_b64_tr_b16 v[232:233], v4 offset:32
  ds_read_b64_tr_b16 v[234:235], v4 offset:160
  ds_read_b64_tr_b16 v[236:237], v4 offset:3104
  ds_read_b64_tr_b16 v[238:239], v4 offset:3232
  ds_read_b64_tr_b16 v[248:249], v5 offset:2080
  ds_read_b64_tr_b16 v[250:251], v5 offset:2208
  s_waitcnt lgkmcnt(0)
  s_mov_b32 m0, 30720
  s_add_u32 s27, s32, 0
  buffer_load_dwordx4 v8, s[12:15], s27 offen  lds
  s_mov_b32 m0, 31744
  s_add_u32 s27, s32, 0
  buffer_load_dwordx4 v9, s[12:15], s27 offen  lds
  s_mov_b32 m0, 32768
  s_add_u32 s27, s32, 0
  buffer_load_dwordx4 v10, s[12:15], s27 offen  lds
  s_mov_b32 m0, 33792
  s_add_u32 s27, s32, 0
  buffer_load_dwordx4 v11, s[12:15], s27 offen  lds
  s_mov_b32 m0, 34816
  s_add_u32 s27, s32, 0
  buffer_load_dwordx4 v12, s[12:15], s27 offen  lds
  s_mov_b32 m0, 35840
  s_add_u32 s27, s32, 0
  buffer_load_dwordx4 v13, s[12:15], s27 offen  lds
  s_waitcnt vmcnt(30)
  ds_read_b64_tr_b16 v[24:25], v4 offset:18432
  ds_read_b64_tr_b16 v[26:27], v4 offset:18560
  ds_read_b64_tr_b16 v[28:29], v4 offset:21504
  ds_read_b64_tr_b16 v[30:31], v4 offset:21632
  ds_read_b64_tr_b16 v[32:33], v5 offset:20480
  ds_read_b64_tr_b16 v[34:35], v5 offset:20608
  ds_read_b64_tr_b16 v[36:37], v4 offset:18464
  ds_read_b64_tr_b16 v[38:39], v4 offset:18592
  ds_read_b64_tr_b16 v[40:41], v4 offset:21536
  ds_read_b64_tr_b16 v[42:43], v4 offset:21664
  ds_read_b64_tr_b16 v[44:45], v5 offset:20512
  ds_read_b64_tr_b16 v[46:47], v5 offset:20640
  s_waitcnt lgkmcnt(0)
  ds_write_b128 v7, v[24:27] offset:18432
  ds_write_b128 v7, v[28:31] offset:19456
  ds_write_b128 v7, v[32:35] offset:22528
  ds_write_b128 v7, v[36:39] offset:20480
  ds_write_b128 v7, v[40:43] offset:21504
  ds_write_b128 v7, v[44:47] offset:23552
  s_waitcnt lgkmcnt(0)
  s_waitcnt vmcnt(24)
  ds_read_b64_tr_b16 a[176:177], v4 offset:12288
  ds_read_b64_tr_b16 a[178:179], v4 offset:12416
  ds_read_b64_tr_b16 a[180:181], v4 offset:15360
  ds_read_b64_tr_b16 a[182:183], v4 offset:15488
  ds_read_b64_tr_b16 a[188:189], v5 offset:14336
  ds_read_b64_tr_b16 a[190:191], v5 offset:14464
  ds_read_b64_tr_b16 a[200:201], v4 offset:12320
  ds_read_b64_tr_b16 a[202:203], v4 offset:12448
  ds_read_b64_tr_b16 a[204:205], v4 offset:15392
  ds_read_b64_tr_b16 a[206:207], v4 offset:15520
  ds_read_b64_tr_b16 a[212:213], v5 offset:14368
  ds_read_b64_tr_b16 a[214:215], v5 offset:14496
  s_waitcnt lgkmcnt(0)
  s_waitcnt vmcnt(18)
  ds_read_b64_tr_b16 a[224:225], v21 offset:0
  ds_read_b64_tr_b16 a[226:227], v21 offset:128
  ds_read_b64_tr_b16 a[228:229], v21 offset:3072
  ds_read_b64_tr_b16 a[230:231], v21 offset:3200
  ds_read_b64_tr_b16 a[236:237], v22 offset:2048
  ds_read_b64_tr_b16 a[238:239], v22 offset:2176
  ds_read_b64_tr_b16 a[248:249], v21 offset:32
  ds_read_b64_tr_b16 a[250:251], v21 offset:160
  ds_read_b64_tr_b16 a[252:253], v21 offset:3104
  ds_read_b64_tr_b16 a[254:255], v21 offset:3232
  ds_read_b64_tr_b16 v[156:157], v22 offset:2080
  ds_read_b64_tr_b16 v[158:159], v22 offset:2208
  s_waitcnt lgkmcnt(0)
  s_mov_b32 m0, 129024
  s_add_u32 s27, s32, 786432
  buffer_load_dwordx4 v8, s[12:15], s27 offen  lds
  s_mov_b32 m0, 130048
  s_add_u32 s27, s32, 786432
  buffer_load_dwordx4 v9, s[12:15], s27 offen  lds
  s_mov_b32 m0, 131072
  s_add_u32 s27, s32, 786432
  buffer_load_dwordx4 v10, s[12:15], s27 offen  lds
  s_mov_b32 m0, 132096
  s_add_u32 s27, s32, 786432
  buffer_load_dwordx4 v11, s[12:15], s27 offen  lds
  s_mov_b32 m0, 133120
  s_add_u32 s27, s32, 786432
  buffer_load_dwordx4 v12, s[12:15], s27 offen  lds
  s_mov_b32 m0, 134144
  s_add_u32 s27, s32, 786432
  buffer_load_dwordx4 v13, s[12:15], s27 offen  lds
  s_mov_b32 m0, 43008
  s_add_u32 s27, s32, 1572864
  buffer_load_dwordx4 v8, s[12:15], s27 offen  lds
  s_mov_b32 m0, 44032
  s_add_u32 s27, s32, 1572864
  buffer_load_dwordx4 v9, s[12:15], s27 offen  lds
  s_mov_b32 m0, 45056
  s_add_u32 s27, s32, 1572864
  buffer_load_dwordx4 v10, s[12:15], s27 offen  lds
  s_mov_b32 m0, 46080
  s_add_u32 s27, s32, 1572864
  buffer_load_dwordx4 v11, s[12:15], s27 offen  lds
  s_mov_b32 m0, 47104
  s_add_u32 s27, s32, 1572864
  buffer_load_dwordx4 v12, s[12:15], s27 offen  lds
  s_mov_b32 m0, 48128
  s_add_u32 s27, s32, 1572864
  buffer_load_dwordx4 v13, s[12:15], s27 offen  lds
  s_waitcnt vmcnt(24)
  ds_read_b64_tr_b16 v[168:169], v4 offset:24576
  ds_read_b64_tr_b16 v[170:171], v4 offset:24704
  ds_read_b64_tr_b16 v[172:173], v4 offset:27648
  ds_read_b64_tr_b16 v[174:175], v4 offset:27776
  ds_read_b64_tr_b16 v[180:181], v5 offset:26624
  ds_read_b64_tr_b16 v[182:183], v5 offset:26752
  ds_read_b64_tr_b16 v[192:193], v4 offset:24608
  ds_read_b64_tr_b16 v[194:195], v4 offset:24736
  ds_read_b64_tr_b16 v[196:197], v4 offset:27680
  ds_read_b64_tr_b16 v[198:199], v4 offset:27808
  ds_read_b64_tr_b16 v[204:205], v5 offset:26656
  ds_read_b64_tr_b16 v[206:207], v5 offset:26784
  s_waitcnt lgkmcnt(0)
  s_mov_b32 m0, 55296
  s_add_u32 s27, s32, 2359296
  buffer_load_dwordx4 v8, s[12:15], s27 offen  lds
  s_mov_b32 m0, 56320
  s_add_u32 s27, s32, 2359296
  buffer_load_dwordx4 v9, s[12:15], s27 offen  lds
  s_mov_b32 m0, 57344
  s_add_u32 s27, s32, 2359296
  buffer_load_dwordx4 v10, s[12:15], s27 offen  lds
  s_mov_b32 m0, 58368
  s_add_u32 s27, s32, 2359296
  buffer_load_dwordx4 v11, s[12:15], s27 offen  lds
  s_mov_b32 m0, 59392
  s_add_u32 s27, s32, 2359296
  buffer_load_dwordx4 v12, s[12:15], s27 offen  lds
  s_mov_b32 m0, 60416
  s_add_u32 s27, s32, 2359296
  buffer_load_dwordx4 v13, s[12:15], s27 offen  lds
  s_waitcnt vmcnt(24)
  ds_read_b64_tr_b16 v[216:217], v4 offset:6144
  ds_read_b64_tr_b16 v[218:219], v4 offset:6272
  ds_read_b64_tr_b16 v[220:221], v4 offset:9216
  ds_read_b64_tr_b16 v[222:223], v4 offset:9344
  ds_read_b64_tr_b16 v[228:229], v5 offset:8192
  ds_read_b64_tr_b16 v[230:231], v5 offset:8320
  ds_read_b64_tr_b16 v[240:241], v4 offset:6176
  ds_read_b64_tr_b16 v[242:243], v4 offset:6304
  ds_read_b64_tr_b16 v[244:245], v4 offset:9248
  ds_read_b64_tr_b16 v[246:247], v4 offset:9376
  ds_read_b64_tr_b16 v[252:253], v5 offset:8224
  ds_read_b64_tr_b16 v[254:255], v5 offset:8352
  s_waitcnt lgkmcnt(0)
  s_mov_b32 m0, 36864
  s_add_u32 s27, s32, 3145728
  buffer_load_dwordx4 v8, s[12:15], s27 offen  lds
  s_mov_b32 m0, 37888
  s_add_u32 s27, s32, 3145728
  buffer_load_dwordx4 v9, s[12:15], s27 offen  lds
  s_mov_b32 m0, 38912
  s_add_u32 s27, s32, 3145728
  buffer_load_dwordx4 v10, s[12:15], s27 offen  lds
  s_mov_b32 m0, 39936
  s_add_u32 s27, s32, 3145728
  buffer_load_dwordx4 v11, s[12:15], s27 offen  lds
  s_mov_b32 m0, 40960
  s_add_u32 s27, s32, 3145728
  buffer_load_dwordx4 v12, s[12:15], s27 offen  lds
  s_mov_b32 m0, 41984
  s_add_u32 s27, s32, 3145728
  buffer_load_dwordx4 v13, s[12:15], s27 offen  lds
  s_waitcnt vmcnt(24)
  ds_read_b64_tr_b16 a[120:121], v3 offset:0
  ds_read_b64_tr_b16 a[122:123], v3 offset:192
  ds_read_b64_tr_b16 a[124:125], v3 offset:3072
  ds_read_b64_tr_b16 a[126:127], v3 offset:3264
  ds_read_b64_tr_b16 a[128:129], v3 offset:32
  ds_read_b64_tr_b16 a[130:131], v3 offset:224
  ds_read_b64_tr_b16 a[132:133], v3 offset:3104
  ds_read_b64_tr_b16 a[134:135], v3 offset:3296
  ds_read_b64_tr_b16 a[136:137], v3 offset:64
  ds_read_b64_tr_b16 a[138:139], v3 offset:256
  ds_read_b64_tr_b16 a[140:141], v3 offset:3136
  ds_read_b64_tr_b16 a[142:143], v3 offset:3328
  s_waitcnt lgkmcnt(0)
  s_waitcnt vmcnt(18)
  ds_read_b64_tr_b16 a[144:145], v20 offset:0
  ds_read_b64_tr_b16 a[146:147], v20 offset:192
  ds_read_b64_tr_b16 a[148:149], v20 offset:3072
  ds_read_b64_tr_b16 a[150:151], v20 offset:3264
  ds_read_b64_tr_b16 a[152:153], v20 offset:32
  ds_read_b64_tr_b16 a[154:155], v20 offset:224
  ds_read_b64_tr_b16 a[156:157], v20 offset:3104
  ds_read_b64_tr_b16 a[158:159], v20 offset:3296
  ds_read_b64_tr_b16 a[160:161], v20 offset:64
  ds_read_b64_tr_b16 a[162:163], v20 offset:256
  ds_read_b64_tr_b16 a[164:165], v20 offset:3136
  ds_read_b64_tr_b16 a[166:167], v20 offset:3328
  s_waitcnt lgkmcnt(0)
  s_mov_b32 m0, 129024
  s_add_u32 s27, s32, 3932160
  buffer_load_dwordx4 v8, s[12:15], s27 offen  lds
  s_mov_b32 m0, 130048
  s_add_u32 s27, s32, 3932160
  buffer_load_dwordx4 v9, s[12:15], s27 offen  lds
  s_mov_b32 m0, 131072
  s_add_u32 s27, s32, 3932160
  buffer_load_dwordx4 v10, s[12:15], s27 offen  lds
  s_mov_b32 m0, 132096
  s_add_u32 s27, s32, 3932160
  buffer_load_dwordx4 v11, s[12:15], s27 offen  lds
  s_mov_b32 m0, 133120
  s_add_u32 s27, s32, 3932160
  buffer_load_dwordx4 v12, s[12:15], s27 offen  lds
  s_mov_b32 m0, 134144
  s_add_u32 s27, s32, 3932160
  buffer_load_dwordx4 v13, s[12:15], s27 offen  lds
  s_mov_b32 m0, 30720
  s_add_u32 s27, s32, 4718592
  buffer_load_dwordx4 v8, s[12:15], s27 offen  lds
  s_mov_b32 m0, 31744
  s_add_u32 s27, s32, 4718592
  buffer_load_dwordx4 v9, s[12:15], s27 offen  lds
  s_mov_b32 m0, 32768
  s_add_u32 s27, s32, 4718592
  buffer_load_dwordx4 v10, s[12:15], s27 offen  lds
  s_mov_b32 m0, 33792
  s_add_u32 s27, s32, 4718592
  buffer_load_dwordx4 v11, s[12:15], s27 offen  lds
  s_mov_b32 m0, 34816
  s_add_u32 s27, s32, 4718592
  buffer_load_dwordx4 v12, s[12:15], s27 offen  lds
  s_mov_b32 m0, 35840
  s_add_u32 s27, s32, 4718592
  buffer_load_dwordx4 v13, s[12:15], s27 offen  lds
  s_waitcnt vmcnt(24)
  ds_read_b64_tr_b16 v[24:25], v3 offset:12288
  ds_read_b64_tr_b16 v[26:27], v3 offset:12480
  ds_read_b64_tr_b16 v[28:29], v3 offset:15360
  ds_read_b64_tr_b16 v[30:31], v3 offset:15552
  ds_read_b64_tr_b16 v[32:33], v3 offset:12320
  ds_read_b64_tr_b16 v[34:35], v3 offset:12512
  ds_read_b64_tr_b16 v[36:37], v3 offset:15392
  ds_read_b64_tr_b16 v[38:39], v3 offset:15584
  ds_read_b64_tr_b16 v[40:41], v3 offset:12352
  ds_read_b64_tr_b16 v[42:43], v3 offset:12544
  ds_read_b64_tr_b16 v[44:45], v3 offset:15424
  ds_read_b64_tr_b16 v[46:47], v3 offset:15616
  s_waitcnt lgkmcnt(0)
  ds_write_b128 v7, v[24:27] offset:12288
  ds_write_b128 v7, v[28:31] offset:13312
  ds_write_b128 v7, v[32:35] offset:14336
  ds_write_b128 v7, v[36:39] offset:15360
  ds_write_b128 v7, v[40:43] offset:16384
  ds_write_b128 v7, v[44:47] offset:17408
  s_waitcnt lgkmcnt(0)
  s_waitcnt vmcnt(18)
  ds_read_b64_tr_b16 a[0:1], v3 offset:24576
  ds_read_b64_tr_b16 a[2:3], v3 offset:24768
  ds_read_b64_tr_b16 a[4:5], v3 offset:27648
  ds_read_b64_tr_b16 a[6:7], v3 offset:27840
  ds_read_b64_tr_b16 a[8:9], v3 offset:24608
  ds_read_b64_tr_b16 a[10:11], v3 offset:24800
  ds_read_b64_tr_b16 a[12:13], v3 offset:27680
  ds_read_b64_tr_b16 a[14:15], v3 offset:27872
  ds_read_b64_tr_b16 a[16:17], v3 offset:24640
  ds_read_b64_tr_b16 a[18:19], v3 offset:24832
  ds_read_b64_tr_b16 a[20:21], v3 offset:27712
  ds_read_b64_tr_b16 a[22:23], v3 offset:27904
  s_waitcnt lgkmcnt(0)
  s_waitcnt vmcnt(12)
  ds_read_b64_tr_b16 a[24:25], v3 offset:6144
  ds_read_b64_tr_b16 a[26:27], v3 offset:6336
  ds_read_b64_tr_b16 a[28:29], v3 offset:9216
  ds_read_b64_tr_b16 a[30:31], v3 offset:9408
  ds_read_b64_tr_b16 a[32:33], v3 offset:6176
  ds_read_b64_tr_b16 a[34:35], v3 offset:6368
  ds_read_b64_tr_b16 a[36:37], v3 offset:9248
  ds_read_b64_tr_b16 a[38:39], v3 offset:9440
  ds_read_b64_tr_b16 a[40:41], v3 offset:6208
  ds_read_b64_tr_b16 a[42:43], v3 offset:6400
  ds_read_b64_tr_b16 a[44:45], v3 offset:9280
  ds_read_b64_tr_b16 a[46:47], v3 offset:9472
  s_waitcnt lgkmcnt(0)
  s_mov_b32 m0, 55296
  s_add_u32 s27, s32, 5505024
  buffer_load_dwordx4 v8, s[12:15], s27 offen  lds
  s_mov_b32 m0, 56320
  s_add_u32 s27, s32, 5505024
  buffer_load_dwordx4 v9, s[12:15], s27 offen  lds
  s_mov_b32 m0, 57344
  s_add_u32 s27, s32, 5505024
  buffer_load_dwordx4 v10, s[12:15], s27 offen  lds
  s_mov_b32 m0, 58368
  s_add_u32 s27, s32, 5505024
  buffer_load_dwordx4 v11, s[12:15], s27 offen  lds
  s_mov_b32 m0, 59392
  s_add_u32 s27, s32, 5505024
  buffer_load_dwordx4 v12, s[12:15], s27 offen  lds
  s_mov_b32 m0, 60416
  s_add_u32 s27, s32, 5505024
  buffer_load_dwordx4 v13, s[12:15], s27 offen  lds
  s_waitcnt vmcnt(12)
  ds_read_b64_tr_b16 a[48:49], v20 offset:0
  ds_read_b64_tr_b16 a[50:51], v20 offset:192
  ds_read_b64_tr_b16 a[52:53], v20 offset:3072
  ds_read_b64_tr_b16 a[54:55], v20 offset:3264
  ds_read_b64_tr_b16 a[56:57], v20 offset:32
  ds_read_b64_tr_b16 a[58:59], v20 offset:224
  ds_read_b64_tr_b16 a[60:61], v20 offset:3104
  ds_read_b64_tr_b16 a[62:63], v20 offset:3296
  ds_read_b64_tr_b16 a[64:65], v20 offset:64
  ds_read_b64_tr_b16 a[66:67], v20 offset:256
  ds_read_b64_tr_b16 a[68:69], v20 offset:3136
  ds_read_b64_tr_b16 a[70:71], v20 offset:3328
  s_waitcnt lgkmcnt(0)
  s_mov_b32 m0, 129024
  s_add_u32 s27, s32, 6291456
  buffer_load_dwordx4 v8, s[12:15], s27 offen  lds
  s_mov_b32 m0, 130048
  s_add_u32 s27, s32, 6291456
  buffer_load_dwordx4 v9, s[12:15], s27 offen  lds
  s_mov_b32 m0, 131072
  s_add_u32 s27, s32, 6291456
  buffer_load_dwordx4 v10, s[12:15], s27 offen  lds
  s_mov_b32 m0, 132096
  s_add_u32 s27, s32, 6291456
  buffer_load_dwordx4 v11, s[12:15], s27 offen  lds
  s_mov_b32 m0, 133120
  s_add_u32 s27, s32, 6291456
  buffer_load_dwordx4 v12, s[12:15], s27 offen  lds
  s_mov_b32 m0, 134144
  s_add_u32 s27, s32, 6291456
  buffer_load_dwordx4 v13, s[12:15], s27 offen  lds
  s_mov_b32 m0, 36864
  s_add_u32 s27, s32, 7077888
  buffer_load_dwordx4 v8, s[12:15], s27 offen  lds
  s_mov_b32 m0, 37888
  s_add_u32 s27, s32, 7077888
  buffer_load_dwordx4 v9, s[12:15], s27 offen  lds
  s_mov_b32 m0, 38912
  s_add_u32 s27, s32, 7077888
  buffer_load_dwordx4 v10, s[12:15], s27 offen  lds
  s_mov_b32 m0, 39936
  s_add_u32 s27, s32, 7077888
  buffer_load_dwordx4 v11, s[12:15], s27 offen  lds
  s_mov_b32 m0, 40960
  s_add_u32 s27, s32, 7077888
  buffer_load_dwordx4 v12, s[12:15], s27 offen  lds
  s_mov_b32 m0, 41984
  s_add_u32 s27, s32, 7077888
  buffer_load_dwordx4 v13, s[12:15], s27 offen  lds
  s_waitcnt vmcnt(18)
  ds_read_b64_tr_b16 v[24:25], v3 offset:0
  ds_read_b64_tr_b16 v[26:27], v3 offset:192
  ds_read_b64_tr_b16 v[28:29], v3 offset:3072
  ds_read_b64_tr_b16 v[30:31], v3 offset:3264
  ds_read_b64_tr_b16 v[32:33], v3 offset:32
  ds_read_b64_tr_b16 v[34:35], v3 offset:224
  ds_read_b64_tr_b16 v[36:37], v3 offset:3104
  ds_read_b64_tr_b16 v[38:39], v3 offset:3296
  ds_read_b64_tr_b16 v[40:41], v3 offset:64
  ds_read_b64_tr_b16 v[42:43], v3 offset:256
  ds_read_b64_tr_b16 v[44:45], v3 offset:3136
  ds_read_b64_tr_b16 v[46:47], v3 offset:3328
  s_waitcnt lgkmcnt(0)
  ds_write_b128 v7, v[24:27] offset:0
  ds_write_b128 v7, v[28:31] offset:1024
  ds_write_b128 v7, v[32:35] offset:2048
  ds_write_b128 v7, v[36:39] offset:3072
  ds_write_b128 v7, v[40:43] offset:4096
  ds_write_b128 v7, v[44:47] offset:5120
  s_waitcnt lgkmcnt(0)
  s_waitcnt vmcnt(12)
  ds_read_b64_tr_b16 a[72:73], v3 offset:24576
  ds_read_b64_tr_b16 a[74:75], v3 offset:24768
  ds_read_b64_tr_b16 a[76:77], v3 offset:27648
  ds_read_b64_tr_b16 a[78:79], v3 offset:27840
  ds_read_b64_tr_b16 a[80:81], v3 offset:24608
  ds_read_b64_tr_b16 a[82:83], v3 offset:24800
  ds_read_b64_tr_b16 a[84:85], v3 offset:27680
  ds_read_b64_tr_b16 a[86:87], v3 offset:27872
  ds_read_b64_tr_b16 a[88:89], v3 offset:24640
  ds_read_b64_tr_b16 a[90:91], v3 offset:24832
  ds_read_b64_tr_b16 a[92:93], v3 offset:27712
  ds_read_b64_tr_b16 a[94:95], v3 offset:27904
  s_waitcnt lgkmcnt(0)
  s_mov_b32 m0, 55296
  s_add_u32 s27, s33, 123136
  buffer_load_dwordx4 v14, s[16:19], s27 offen  lds
  s_mov_b32 m0, 56320
  s_add_u32 s27, s33, 123136
  buffer_load_dwordx4 v15, s[16:19], s27 offen  lds
  s_mov_b32 m0, 57344
  s_add_u32 s27, s33, 123136
  buffer_load_dwordx4 v16, s[16:19], s27 offen  lds
  s_mov_b32 m0, 58368
  s_add_u32 s27, s33, 123136
  buffer_load_dwordx4 v17, s[16:19], s27 offen  lds
  s_mov_b32 m0, 59392
  s_add_u32 s27, s33, 123136
  buffer_load_dwordx4 v18, s[16:19], s27 offen  lds
  s_mov_b32 m0, 60416
  s_add_u32 s27, s33, 123136
  buffer_load_dwordx4 v19, s[16:19], s27 offen  lds
  buffer_load_dwordx4 v[68:71], off, s[68:71], 0 offset:128 sc1
  buffer_load_dwordx2 v[72:73], off, s[68:71], 0 offset:64 sc1
  s_waitcnt vmcnt(14)
  ds_read_b64_tr_b16 a[96:97], v20 offset:0
  ds_read_b64_tr_b16 a[98:99], v20 offset:192
  ds_read_b64_tr_b16 a[100:101], v20 offset:3072
  ds_read_b64_tr_b16 a[102:103], v20 offset:3264
  ds_read_b64_tr_b16 a[104:105], v20 offset:32
  ds_read_b64_tr_b16 a[106:107], v20 offset:224
  ds_read_b64_tr_b16 a[108:109], v20 offset:3104
  ds_read_b64_tr_b16 a[110:111], v20 offset:3296
  ds_read_b64_tr_b16 a[112:113], v20 offset:64
  ds_read_b64_tr_b16 a[114:115], v20 offset:256
  ds_read_b64_tr_b16 a[116:117], v20 offset:3136
  ds_read_b64_tr_b16 a[118:119], v20 offset:3328
  s_waitcnt lgkmcnt(0)
  s_waitcnt vmcnt(8)
  ds_read_b64_tr_b16 v[24:25], v3 offset:6144
  ds_read_b64_tr_b16 v[26:27], v3 offset:6336
  ds_read_b64_tr_b16 v[28:29], v3 offset:9216
  ds_read_b64_tr_b16 v[30:31], v3 offset:9408
  ds_read_b64_tr_b16 v[32:33], v3 offset:6176
  ds_read_b64_tr_b16 v[34:35], v3 offset:6368
  ds_read_b64_tr_b16 v[36:37], v3 offset:9248
  ds_read_b64_tr_b16 v[38:39], v3 offset:9440
  ds_read_b64_tr_b16 v[40:41], v3 offset:6208
  ds_read_b64_tr_b16 v[42:43], v3 offset:6400
  ds_read_b64_tr_b16 v[44:45], v3 offset:9280
  ds_read_b64_tr_b16 v[46:47], v3 offset:9472
  s_waitcnt lgkmcnt(0)
  ds_write_b128 v7, v[24:27] offset:6144
  ds_write_b128 v7, v[28:31] offset:7168
  ds_write_b128 v7, v[32:35] offset:8192
  ds_write_b128 v7, v[36:39] offset:9216
  ds_write_b128 v7, v[40:43] offset:10240
  ds_write_b128 v7, v[44:47] offset:11264
  s_waitcnt lgkmcnt(0)
  s_waitcnt vmcnt(2)
  ds_read_b64_tr_b16 v[24:25], v4 offset:24576
  ds_read_b64_tr_b16 v[26:27], v4 offset:24704
  ds_read_b64_tr_b16 v[28:29], v4 offset:27648
  ds_read_b64_tr_b16 v[30:31], v4 offset:27776
  ds_read_b64_tr_b16 v[32:33], v5 offset:26624
  ds_read_b64_tr_b16 v[34:35], v5 offset:26752
  ds_read_b64_tr_b16 v[36:37], v4 offset:24608
  ds_read_b64_tr_b16 v[38:39], v4 offset:24736
  ds_read_b64_tr_b16 v[40:41], v4 offset:27680
  ds_read_b64_tr_b16 v[42:43], v4 offset:27808
  ds_read_b64_tr_b16 v[44:45], v5 offset:26656
  ds_read_b64_tr_b16 v[46:47], v5 offset:26784
  s_waitcnt lgkmcnt(0)
  ds_write_b128 v7, v[24:27] offset:24576
  ds_write_b128 v7, v[28:31] offset:25600
  ds_write_b128 v7, v[32:35] offset:28672
  ds_write_b128 v7, v[36:39] offset:26624
  ds_write_b128 v7, v[40:43] offset:27648
  ds_write_b128 v7, v[44:47] offset:29696
  s_waitcnt lgkmcnt(0)
  s_branch CV_ldd
CV_ld2:
  s_cmp_lg_u32 s24, 2
  s_cbranch_scc1 CV_ld3
  s_mov_b32 m0, 135168
  s_add_u32 s27, s33, 0
  buffer_load_dwordx4 v14, s[16:19], s27 offen  lds
  s_mov_b32 m0, 136192
  s_add_u32 s27, s33, 0
  buffer_load_dwordx4 v15, s[16:19], s27 offen  lds
  s_mov_b32 m0, 137216
  s_add_u32 s27, s33, 0
  buffer_load_dwordx4 v16, s[16:19], s27 offen  lds
  s_mov_b32 m0, 138240
  s_add_u32 s27, s33, 0
  buffer_load_dwordx4 v17, s[16:19], s27 offen  lds
  s_mov_b32 m0, 139264
  s_add_u32 s27, s33, 0
  buffer_load_dwordx4 v18, s[16:19], s27 offen  lds
  s_mov_b32 m0, 140288
  s_add_u32 s27, s33, 0
  buffer_load_dwordx4 v19, s[16:19], s27 offen  lds
  s_mov_b32 m0, 86016
  s_add_u32 s27, s33, 64
  buffer_load_dwordx4 v14, s[16:19], s27 offen  lds
  s_mov_b32 m0, 87040
  s_add_u32 s27, s33, 64
  buffer_load_dwordx4 v15, s[16:19], s27 offen  lds
  s_mov_b32 m0, 88064
  s_add_u32 s27, s33, 64
  buffer_load_dwordx4 v16, s[16:19], s27 offen  lds
  s_mov_b32 m0, 89088
  s_add_u32 s27, s33, 64
  buffer_load_dwordx4 v17, s[16:19], s27 offen  lds
  s_mov_b32 m0, 90112
  s_add_u32 s27, s33, 64
  buffer_load_dwordx4 v18, s[16:19], s27 offen  lds
  s_mov_b32 m0, 91136
  s_add_u32 s27, s33, 64
  buffer_load_dwordx4 v19, s[16:19], s27 offen  lds
  s_mov_b32 m0, 61440
  s_add_u32 s27, s33, 128
  buffer_load_dwordx4 v14, s[16:19], s27 offen  lds
  s_mov_b32 m0, 62464
  s_add_u32 s27, s33, 128
  buffer_load_dwordx4 v15, s[16:19], s27 offen  lds
  s_mov_b32 m0, 63488
  s_add_u32 s27, s33, 128
  buffer_load_dwordx4 v16, s[16:19], s27 offen  lds
  s_mov_b32 m0, 64512
  s_add_u32 s27, s33, 128
  buffer_load_dwordx4 v17, s[16:19], s27 offen  lds
  s_mov_b32 m0, 65536
  s_add_u32 s27, s33, 128
  buffer_load_dwordx4 v18, s[16:19], s27 offen  lds
  s_mov_b32 m0, 66560
  s_add_u32 s27, s33, 128
  buffer_load_dwordx4 v19, s[16:19], s27 offen  lds
  s_mov_b32 m0, 73728
  s_add_u32 s27, s33, 192
  buffer_load_dwordx4 v14, s[16:19], s27 offen  lds
  s_mov_b32 m0, 74752
  s_add_u32 s27, s33, 192
  buffer_load_dwordx4 v15, s[16:19], s27 offen  lds
  s_mov_b32 m0, 75776
  s_add_u32 s27, s33, 192
  buffer_load_dwordx4 v16, s[16:19], s27 offen  lds
  s_mov_b32 m0, 76800
  s_add_u32 s27, s33, 192
  buffer_load_dwordx4 v17, s[16:19], s27 offen  lds
  s_mov_b32 m0, 77824
  s_add_u32 s27, s33, 192
  buffer_load_dwordx4 v18, s[16:19], s27 offen  lds
  s_mov_b32 m0, 78848
  s_add_u32 s27, s33, 192
  buffer_load_dwordx4 v19, s[16:19], s27 offen  lds
  s_mov_b32 m0, 79872
  s_add_u32 s27, s33, 256
  buffer_load_dwordx4 v14, s[16:19], s27 offen  lds
  s_mov_b32 m0, 80896
  s_add_u32 s27, s33, 256
  buffer_load_dwordx4 v15, s[16:19], s27 offen  lds
  s_mov_b32 m0, 81920
  s_add_u32 s27, s33, 256
  buffer_load_dwordx4 v16, s[16:19], s27 offen  lds
  s_mov_b32 m0, 82944
  s_add_u32 s27, s33, 256
  buffer_load_dwordx4 v17, s[16:19], s27 offen  lds
  s_mov_b32 m0, 83968
  s_add_u32 s27, s33, 256
  buffer_load_dwordx4 v18, s[16:19], s27 offen  lds
  s_mov_b32 m0, 84992
  s_add_u32 s27, s33, 256
  buffer_load_dwordx4 v19, s[16:19], s27 offen  lds
  s_mov_b32 m0, 67584
  s_add_u32 s27, s33, 122880
  buffer_load_dwordx4 v14, s[16:19], s27 offen  lds
  s_mov_b32 m0, 68608
  s_add_u32 s27, s33, 122880
  buffer_load_dwordx4 v15, s[16:19], s27 offen  lds
  s_mov_b32 m0, 69632
  s_add_u32 s27, s33, 122880
  buffer_load_dwordx4 v16, s[16:19], s27 offen  lds
  s_mov_b32 m0, 70656
  s_add_u32 s27, s33, 122880
  buffer_load_dwordx4 v17, s[16:19], s27 offen  lds
  s_mov_b32 m0, 71680
  s_add_u32 s27, s33, 122880
  buffer_load_dwordx4 v18, s[16:19], s27 offen  lds
  s_mov_b32 m0, 72704
  s_add_u32 s27, s33, 122880
  buffer_load_dwordx4 v19, s[16:19], s27 offen  lds
  s_waitcnt vmcnt(30)
  ds_read_b64_tr_b16 a[168:169], v21 offset:0
  ds_read_b64_tr_b16 a[170:171], v21 offset:128
  ds_read_b64_tr_b16 a[172:173], v21 offset:3072
  ds_read_b64_tr_b16 a[174:175], v21 offset:3200
  ds_read_b64_tr_b16 a[184:185], v22 offset:2048
  ds_read_b64_tr_b16 a[186:187], v22 offset:2176
  ds_read_b64_tr_b16 a[192:193], v21 offset:32
  ds_read_b64_tr_b16 a[194:195], v21 offset:160
  ds_read_b64_tr_b16 a[196:197], v21 offset:3104
  ds_read_b64_tr_b16 a[198:199], v21 offset:3232
  ds_read_b64_tr_b16 a[208:209], v22 offset:2080
  ds_read_b64_tr_b16 a[210:211], v22 offset:2208
  s_waitcnt lgkmcnt(0)
  s_mov_b32 m0, 135168
  s_add_u32 s27, s33, 122944
  buffer_load_dwordx4 v14, s[16:19], s27 offen  lds
  s_mov_b32 m0, 136192
  s_add_u32 s27, s33, 122944
  buffer_load_dwordx4 v15, s[16:19], s27 offen  lds
  s_mov_b32 m0, 137216
  s_add_u32 s27, s33, 122944
  buffer_load_dwordx4 v16, s[16:19], s27 offen  lds
  s_mov_b32 m0, 138240
  s_add_u32 s27, s33, 122944
  buffer_load_dwordx4 v17, s[16:19], s27 offen  lds
  s_mov_b32 m0, 139264
  s_add_u32 s27, s33, 122944
  buffer_load_dwordx4 v18, s[16:19], s27 offen  lds
  s_mov_b32 m0, 140288
  s_add_u32 s27, s33, 122944
  buffer_load_dwordx4 v19, s[16:19], s27 offen  lds
  s_waitcnt vmcnt(30)
  ds_read_b64_tr_b16 a[216:217], v4 offset:24576
  ds_read_b64_tr_b16 a[218:219], v4 offset:24704
  ds_read_b64_tr_b16 a[220:221], v4 offset:27648
  ds_read_b64_tr_b16 a[222:223], v4 offset:27776
  ds_read_b64_tr_b16 a[232:233], v5 offset:26624
  ds_read_b64_tr_b16 a[234:235], v5 offset:26752
  ds_read_b64_tr_b16 a[240:241], v4 offset:24608
  ds_read_b64_tr_b16 a[242:243], v4 offset:24736
  ds_read_b64_tr_b16 a[244:245], v4 offset:27680
  ds_read_b64_tr_b16 a[246:247], v4 offset:27808
  ds_read_b64_tr_b16 v[152:153], v5 offset:26656
  ds_read_b64_tr_b16 v[154:155], v5 offset:26784
  s_waitcnt lgkmcnt(0)
  s_mov_b32 m0, 86016
  s_add_u32 s27, s33, 123008
  buffer_load_dwordx4 v14, s[16:19], s27 offen  lds
  s_mov_b32 m0, 87040
  s_add_u32 s27, s33, 123008
  buffer_load_dwordx4 v15, s[16:19], s27 offen  lds
  s_mov_b32 m0, 88064
  s_add_u32 s27, s33, 123008
  buffer_load_dwordx4 v16, s[16:19], s27 offen  lds
  s_mov_b32 m0, 89088
  s_add_u32 s27, s33, 123008
  buffer_load_dwordx4 v17, s[16:19], s27 offen  lds
  s_mov_b32 m0, 90112
  s_add_u32 s27, s33, 123008
  buffer_load_dwordx4 v18, s[16:19], s27 offen  lds
  s_mov_b32 m0, 91136
  s_add_u32 s27, s33, 123008
  buffer_load_dwordx4 v19, s[16:19], s27 offen  lds
  s_waitcnt vmcnt(30)
  ds_read_b64_tr_b16 v[160:161], v4 offset:0
  ds_read_b64_tr_b16 v[162:163], v4 offset:128
  ds_read_b64_tr_b16 v[164:165], v4 offset:3072
  ds_read_b64_tr_b16 v[166:167], v4 offset:3200
  ds_read_b64_tr_b16 v[176:177], v5 offset:2048
  ds_read_b64_tr_b16 v[178:179], v5 offset:2176
  ds_read_b64_tr_b16 v[184:185], v4 offset:32
  ds_read_b64_tr_b16 v[186:187], v4 offset:160
  ds_read_b64_tr_b16 v[188:189], v4 offset:3104
  ds_read_b64_tr_b16 v[190:191], v4 offset:3232
  ds_read_b64_tr_b16 v[200:201], v5 offset:2080
  ds_read_b64_tr_b16 v[202:203], v5 offset:2208
  s_waitcnt lgkmcnt(0)
  s_mov_b32 m0, 61440
  s_add_u32 s27, s33, 123072
  buffer_load_dwordx4 v14, s[16:19], s27 offen  lds
  s_mov_b32 m0, 62464
  s_add_u32 s27, s33, 123072
  buffer_load_dwordx4 v15, s[16:19], s27 offen  lds
  s_mov_b32 m0, 63488
  s_add_u32 s27, s33, 123072
  buffer_load_dwordx4 v16, s[16:19], s27 offen  lds
  s_mov_b32 m0, 64512
  s_add_u32 s27, s33, 123072
  buffer_load_dwordx4 v17, s[16:19], s27 offen  lds
  s_mov_b32 m0, 65536
  s_add_u32 s27, s33, 123072
  buffer_load_dwordx4 v18, s[16:19], s27 offen  lds
  s_mov_b32 m0, 66560
  s_add_u32 s27, s33, 123072
  buffer_load_dwordx4 v19, s[16:19], s27 offen  lds
  s_waitcnt vmcnt(30)
  ds_read_b64_tr_b16 v[208:209], v4 offset:12288
  ds_read_b64_tr_b16 v[210:211], v4 offset:12416
  ds_read_b64_tr_b16 v[212:213], v4 offset:15360
  ds_read_b64_tr_b16 v[214:215], v4 offset:15488
  ds_read_b64_tr_b16 v[224:225], v5 offset:14336
  ds_read_b64_tr_b16 v[226:227], v5 offset:14464
  ds_read_b64_tr_b16 v[232:233], v4 offset:12320
  ds_read_b64_tr_b16 v[234:235], v4 offset:12448
  ds_read_b64_tr_b16 v[236:237], v4 offset:15392
  ds_read_b64_tr_b16 v[238:239], v4 offset:15520
  ds_read_b64_tr_b16 v[248:249], v5 offset:14368
  ds_read_b64_tr_b16 v[250:251], v5 offset:14496
  s_waitcnt lgkmcnt(0)
  s_mov_b32 m0, 73728
  s_add_u32 s27, s32, 0
  buffer_load_dwordx4 v8, s[12:15], s27 offen  lds
  s_mov_b32 m0, 74752
  s_add_u32 s27, s32, 0
  buffer_load_dwordx4 v9, s[12:15], s27 offen  lds
  s_mov_b32 m0, 75776
  s_add_u32 s27, s32, 0
  buffer_load_dwordx4 v10, s[12:15], s27 offen  lds
  s_mov_b32 m0, 76800
  s_add_u32 s27, s32, 0
  buffer_load_dwordx4 v11, s[12:15], s27 offen  lds
  s_mov_b32 m0, 77824
  s_add_u32 s27, s32, 0
  buffer_load_dwordx4 v12, s[12:15], s27 offen  lds
  s_mov_b32 m0, 78848
  s_add_u32 s27, s32, 0
  buffer_load_dwordx4 v13, s[12:15], s27 offen  lds
  s_waitcnt vmcnt(30)
  ds_read_b64_tr_b16 v[24:25], v4 offset:18432
  ds_read_b64_tr_b16 v[26:27], v4 offset:18560
  ds_read_b64_tr_b16 v[28:29], v4 offset:21504
  ds_read_b64_tr_b16 v[30:31], v4 offset:21632
  ds_read_b64_tr_b16 v[32:33], v5 offset:20480
  ds_read_b64_tr_b16 v[34:35], v5 offset:20608
  ds_read_b64_tr_b16 v[36:37], v4 offset:18464
  ds_read_b64_tr_b16 v[38:39], v4 offset:18592
  ds_read_b64_tr_b16 v[40:41], v4 offset:21536
  ds_read_b64_tr_b16 v[42:43], v4 offset:21664
  ds_read_b64_tr_b16 v[44:45], v5 offset:20512
  ds_read_b64_tr_b16 v[46:47], v5 offset:20640
  s_waitcnt lgkmcnt(0)
  ds_write_b128 v7, v[24:27] offset:18432
  ds_write_b128 v7, v[28:31] offset:19456
  ds_write_b128 v7, v[32:35] offset:22528
  ds_write_b128 v7, v[36:39] offset:20480
  ds_write_b128 v7, v[40:43] offset:21504
  ds_write_b128 v7, v[44:47] offset:23552
  s_waitcnt lgkmcnt(0)
  s_waitcnt vmcnt(24)
  ds_read_b64_tr_b16 a[176:177], v4 offset:6144
  ds_read_b64_tr_b16 a[178:179], v4 offset:6272
  ds_read_b64_tr_b16 a[180:181], v4 offset:9216
  ds_read_b64_tr_b16 a[182:183], v4 offset:9344
  ds_read_b64_tr_b16 a[188:189], v5 offset:8192
  ds_read_b64_tr_b16 a[190:191], v5 offset:8320
  ds_read_b64_tr_b16 a[200:201], v4 offset:6176
  ds_read_b64_tr_b16 a[202:203], v4 offset:6304
  ds_read_b64_tr_b16 a[204:205], v4 offset:9248
  ds_read_b64_tr_b16 a[206:207], v4 offset:9376
  ds_read_b64_tr_b16 a[212:213], v5 offset:8224
  ds_read_b64_tr_b16 a[214:215], v5 offset:8352
  s_waitcnt lgkmcnt(0)
  s_waitcnt vmcnt(18)
  ds_read_b64_tr_b16 a[224:225], v21 offset:0
  ds_read_b64_tr_b16 a[226:227], v21 offset:128
  ds_read_b64_tr_b16 a[228:229], v21 offset:3072
  ds_read_b64_tr_b16 a[230:231], v21 offset:3200
  ds_read_b64_tr_b16 a[236:237], v22 offset:2048
  ds_read_b64_tr_b16 a[238:239], v22 offset:2176
  ds_read_b64_tr_b16 a[248:249], v21 offset:32
  ds_read_b64_tr_b16 a[250:251], v21 offset:160
  ds_read_b64_tr_b16 a[252:253], v21 offset:3104
  ds_read_b64_tr_b16 a[254:255], v21 offset:3232
  ds_read_b64_tr_b16 v[156:157], v22 offset:2080
  ds_read_b64_tr_b16 v[158:159], v22 offset:2208
  s_waitcnt lgkmcnt(0)
  s_mov_b32 m0, 135168
  s_add_u32 s27, s32, 786432
  buffer_load_dwordx4 v8, s[12:15], s27 offen  lds
  s_mov_b32 m0, 136192
  s_add_u32 s27, s32, 786432
  buffer_load_dwordx4 v9, s[12:15], s27 offen  lds
  s_mov_b32 m0, 137216
  s_add_u32 s27, s32, 786432
  buffer_load_dwordx4 v10, s[12:15], s27 offen  lds
  s_mov_b32 m0, 138240
  s_add_u32 s27, s32, 786432
  buffer_load_dwordx4 v11, s[12:15], s27 offen  lds
  s_mov_b32 m0, 139264
  s_add_u32 s27, s32, 786432
  buffer_load_dwordx4 v12, s[12:15], s27 offen  lds
  s_mov_b32 m0, 140288
  s_add_u32 s27, s32, 786432
  buffer_load_dwordx4 v13, s[12:15], s27 offen  lds
  s_mov_b32 m0, 67584
  s_add_u32 s27, s32, 1572864
  buffer_load_dwordx4 v8, s[12:15], s27 offen  lds
  s_mov_b32 m0, 68608
  s_add_u32 s27, s32, 1572864
  buffer_load_dwordx4 v9, s[12:15], s27 offen  lds
  s_mov_b32 m0, 69632
  s_add_u32 s27, s32, 1572864
  buffer_load_dwordx4 v10, s[12:15], s27 offen  lds
  s_mov_b32 m0, 70656
  s_add_u32 s27, s32, 1572864
  buffer_load_dwordx4 v11, s[12:15], s27 offen  lds
  s_mov_b32 m0, 71680
  s_add_u32 s27, s32, 1572864
  buffer_load_dwordx4 v12, s[12:15], s27 offen  lds
  s_mov_b32 m0, 72704
  s_add_u32 s27, s32, 1572864
  buffer_load_dwordx4 v13, s[12:15], s27 offen  lds
  s_waitcnt vmcnt(24)
  ds_read_b64_tr_b16 v[168:169], v4 offset:24576
  ds_read_b64_tr_b16 v[170:171], v4 offset:24704
  ds_read_b64_tr_b16 v[172:173], v4 offset:27648
  ds_read_b64_tr_b16 v[174:175], v4 offset:27776
  ds_read_b64_tr_b16 v[180:181], v5 offset:26624
  ds_read_b64_tr_b16 v[182:183], v5 offset:26752
  ds_read_b64_tr_b16 v[192:193], v4 offset:24608
  ds_read_b64_tr_b16 v[194:195], v4 offset:24736
  ds_read_b64_tr_b16 v[196:197], v4 offset:27680
  ds_read_b64_tr_b16 v[198:199], v4 offset:27808
  ds_read_b64_tr_b16 v[204:205], v5 offset:26656
  ds_read_b64_tr_b16 v[206:207], v5 offset:26784
  s_waitcnt lgkmcnt(0)
  s_mov_b32 m0, 86016
  s_add_u32 s27, s32, 2359296
  buffer_load_dwordx4 v8, s[12:15], s27 offen  lds
  s_mov_b32 m0, 87040
  s_add_u32 s27, s32, 2359296
  buffer_load_dwordx4 v9, s[12:15], s27 offen  lds
  s_mov_b32 m0, 88064
  s_add_u32 s27, s32, 2359296
  buffer_load_dwordx4 v10, s[12:15], s27 offen  lds
  s_mov_b32 m0, 89088
  s_add_u32 s27, s32, 2359296
  buffer_load_dwordx4 v11, s[12:15], s27 offen  lds
  s_mov_b32 m0, 90112
  s_add_u32 s27, s32, 2359296
  buffer_load_dwordx4 v12, s[12:15], s27 offen  lds
  s_mov_b32 m0, 91136
  s_add_u32 s27, s32, 2359296
  buffer_load_dwordx4 v13, s[12:15], s27 offen  lds
  s_waitcnt vmcnt(24)
  ds_read_b64_tr_b16 v[216:217], v4 offset:0
  ds_read_b64_tr_b16 v[218:219], v4 offset:128
  ds_read_b64_tr_b16 v[220:221], v4 offset:3072
  ds_read_b64_tr_b16 v[222:223], v4 offset:3200
  ds_read_b64_tr_b16 v[228:229], v5 offset:2048
  ds_read_b64_tr_b16 v[230:231], v5 offset:2176
  ds_read_b64_tr_b16 v[240:241], v4 offset:32
  ds_read_b64_tr_b16 v[242:243], v4 offset:160
  ds_read_b64_tr_b16 v[244:245], v4 offset:3104
  ds_read_b64_tr_b16 v[246:247], v4 offset:3232
  ds_read_b64_tr_b16 v[252:253], v5 offset:2080
  ds_read_b64_tr_b16 v[254:255], v5 offset:2208
  s_waitcnt lgkmcnt(0)
  s_mov_b32 m0, 61440
  s_add_u32 s27, s32, 3145728
  buffer_load_dwordx4 v8, s[12:15], s27 offen  lds
  s_mov_b32 m0, 62464
  s_add_u32 s27, s32, 3145728
  buffer_load_dwordx4 v9, s[12:15], s27 offen  lds
  s_mov_b32 m0, 63488
  s_add_u32 s27, s32, 3145728
  buffer_load_dwordx4 v10, s[12:15], s27 offen  lds
  s_mov_b32 m0, 64512
  s_add_u32 s27, s32, 3145728
  buffer_load_dwordx4 v11, s[12:15], s27 offen  lds
  s_mov_b32 m0, 65536
  s_add_u32 s27, s32, 3145728
  buffer_load_dwordx4 v12, s[12:15], s27 offen  lds
  s_mov_b32 m0, 66560
  s_add_u32 s27, s32, 3145728
  buffer_load_dwordx4 v13, s[12:15], s27 offen  lds
  s_waitcnt vmcnt(24)
  ds_read_b64_tr_b16 a[72:73], v3 offset:12288
  ds_read_b64_tr_b16 a[74:75], v3 offset:12480
  ds_read_b64_tr_b16 a[76:77], v3 offset:15360
  ds_read_b64_tr_b16 a[78:79], v3 offset:15552
  ds_read_b64_tr_b16 a[80:81], v3 offset:12320
  ds_read_b64_tr_b16 a[82:83], v3 offset:12512
  ds_read_b64_tr_b16 a[84:85], v3 offset:15392
  ds_read_b64_tr_b16 a[86:87], v3 offset:15584
  ds_read_b64_tr_b16 a[88:89], v3 offset:12352
  ds_read_b64_tr_b16 a[90:91], v3 offset:12544
  ds_read_b64_tr_b16 a[92:93], v3 offset:15424
  ds_read_b64_tr_b16 a[94:95], v3 offset:15616
  s_waitcnt lgkmcnt(0)
  s_mov_b32 m0, 73728
  s_add_u32 s27, s32, 3932160
  buffer_load_dwordx4 v8, s[12:15], s27 offen  lds
  s_mov_b32 m0, 74752
  s_add_u32 s27, s32, 3932160
  buffer_load_dwordx4 v9, s[12:15], s27 offen  lds
  s_mov_b32 m0, 75776
  s_add_u32 s27, s32, 3932160
  buffer_load_dwordx4 v10, s[12:15], s27 offen  lds
  s_mov_b32 m0, 76800
  s_add_u32 s27, s32, 3932160
  buffer_load_dwordx4 v11, s[12:15], s27 offen  lds
  s_mov_b32 m0, 77824
  s_add_u32 s27, s32, 3932160
  buffer_load_dwordx4 v12, s[12:15], s27 offen  lds
  s_mov_b32 m0, 78848
  s_add_u32 s27, s32, 3932160
  buffer_load_dwordx4 v13, s[12:15], s27 offen  lds
  s_waitcnt vmcnt(24)
  ds_read_b64_tr_b16 a[96:97], v20 offset:0
  ds_read_b64_tr_b16 a[98:99], v20 offset:192
  ds_read_b64_tr_b16 a[100:101], v20 offset:3072
  ds_read_b64_tr_b16 a[102:103], v20 offset:3264
  ds_read_b64_tr_b16 a[104:105], v20 offset:32
  ds_read_b64_tr_b16 a[106:107], v20 offset:224
  ds_read_b64_tr_b16 a[108:109], v20 offset:3104
  ds_read_b64_tr_b16 a[110:111], v20 offset:3296
  ds_read_b64_tr_b16 a[112:113], v20 offset:64
  ds_read_b64_tr_b16 a[114:115], v20 offset:256
  ds_read_b64_tr_b16 a[116:117], v20 offset:3136
  ds_read_b64_tr_b16 a[118:119], v20 offset:3328
  s_waitcnt lgkmcnt(0)
  s_mov_b32 m0, 135168
  s_add_u32 s27, s32, 4718592
  buffer_load_dwordx4 v8, s[12:15], s27 offen  lds
  s_mov_b32 m0, 136192
  s_add_u32 s27, s32, 4718592
  buffer_load_dwordx4 v9, s[12:15], s27 offen  lds
  s_mov_b32 m0, 137216
  s_add_u32 s27, s32, 4718592
  buffer_load_dwordx4 v10, s[12:15], s27 offen  lds
  s_mov_b32 m0, 138240
  s_add_u32 s27, s32, 4718592
  buffer_load_dwordx4 v11, s[12:15], s27 offen  lds
  s_mov_b32 m0, 139264
  s_add_u32 s27, s32, 4718592
  buffer_load_dwordx4 v12, s[12:15], s27 offen  lds
  s_mov_b32 m0, 140288
  s_add_u32 s27, s32, 4718592
  buffer_load_dwordx4 v13, s[12:15], s27 offen  lds
  s_waitcnt vmcnt(24)
  ds_read_b64_tr_b16 v[24:25], v3 offset:6144
  ds_read_b64_tr_b16 v[26:27], v3 offset:6336
  ds_read_b64_tr_b16 v[28:29], v3 offset:9216
  ds_read_b64_tr_b16 v[30:31], v3 offset:9408
  ds_read_b64_tr_b16 v[32:33], v3 offset:6176
  ds_read_b64_tr_b16 v[34:35], v3 offset:6368
  ds_read_b64_tr_b16 v[36:37], v3 offset:9248
  ds_read_b64_tr_b16 v[38:39], v3 offset:9440
  ds_read_b64_tr_b16 v[40:41], v3 offset:6208
  ds_read_b64_tr_b16 v[42:43], v3 offset:6400
  ds_read_b64_tr_b16 v[44:45], v3 offset:9280
  ds_read_b64_tr_b16 v[46:47], v3 offset:9472
  s_waitcnt lgkmcnt(0)
  ds_write_b128 v7, v[24:27] offset:6144
  ds_write_b128 v7, v[28:31] offset:7168
  ds_write_b128 v7, v[32:35] offset:8192
  ds_write_b128 v7, v[36:39] offset:9216
  ds_write_b128 v7, v[40:43] offset:10240
  ds_write_b128 v7, v[44:47] offset:11264
  s_waitcnt lgkmcnt(0)
  s_waitcnt vmcnt(18)
  ds_read_b64_tr_b16 a[120:121], v3 offset:24576
  ds_read_b64_tr_b16 a[122:123], v3 offset:24768
  ds_read_b64_tr_b16 a[124:125], v3 offset:27648
  ds_read_b64_tr_b16 a[126:127], v3 offset:27840
  ds_read_b64_tr_b16 a[128:129], v3 offset:24608
  ds_read_b64_tr_b16 a[130:131], v3 offset:24800
  ds_read_b64_tr_b16 a[132:133], v3 offset:27680
  ds_read_b64_tr_b16 a[134:135], v3 offset:27872
  ds_read_b64_tr_b16 a[136:137], v3 offset:24640
  ds_read_b64_tr_b16 a[138:139], v3 offset:24832
  ds_read_b64_tr_b16 a[140:141], v3 offset:27712
  ds_read_b64_tr_b16 a[142:143], v3 offset:27904
  s_waitcnt lgkmcnt(0)
  s_waitcnt vmcnt(12)
  ds_read_b64_tr_b16 a[144:145], v3 offset:0
  ds_read_b64_tr_b16 a[146:147], v3 offset:192
  ds_read_b64_tr_b16 a[148:149], v3 offset:3072
  ds_read_b64_tr_b16 a[150:151], v3 offset:3264
  ds_read_b64_tr_b16 a[152:153], v3 offset:32
  ds_read_b64_tr_b16 a[154:155], v3 offset:224
  ds_read_b64_tr_b16 a[156:157], v3 offset:3104
  ds_read_b64_tr_b16 a[158:159], v3 offset:3296
  ds_read_b64_tr_b16 a[160:161], v3 offset:64
  ds_read_b64_tr_b16 a[162:163], v3 offset:256
  ds_read_b64_tr_b16 a[164:165], v3 offset:3136
  ds_read_b64_tr_b16 a[166:167], v3 offset:3328
  s_waitcnt lgkmcnt(0)
  s_mov_b32 m0, 86016
  s_add_u32 s27, s32, 5505024
  buffer_load_dwordx4 v8, s[12:15], s27 offen  lds
  s_mov_b32 m0, 87040
  s_add_u32 s27, s32, 5505024
  buffer_load_dwordx4 v9, s[12:15], s27 offen  lds
  s_mov_b32 m0, 88064
  s_add_u32 s27, s32, 5505024
  buffer_load_dwordx4 v10, s[12:15], s27 offen  lds
  s_mov_b32 m0, 89088
  s_add_u32 s27, s32, 5505024
  buffer_load_dwordx4 v11, s[12:15], s27 offen  lds
  s_mov_b32 m0, 90112
  s_add_u32 s27, s32, 5505024
  buffer_load_dwordx4 v12, s[12:15], s27 offen  lds
  s_mov_b32 m0, 91136
  s_add_u32 s27, s32, 5505024
  buffer_load_dwordx4 v13, s[12:15], s27 offen  lds
  s_waitcnt vmcnt(12)
  ds_read_b64_tr_b16 v[24:25], v3 offset:12288
  ds_read_b64_tr_b16 v[26:27], v3 offset:12480
  ds_read_b64_tr_b16 v[28:29], v3 offset:15360
  ds_read_b64_tr_b16 v[30:31], v3 offset:15552
  ds_read_b64_tr_b16 v[32:33], v3 offset:12320
  ds_read_b64_tr_b16 v[34:35], v3 offset:12512
  ds_read_b64_tr_b16 v[36:37], v3 offset:15392
  ds_read_b64_tr_b16 v[38:39], v3 offset:15584
  ds_read_b64_tr_b16 v[40:41], v3 offset:12352
  ds_read_b64_tr_b16 v[42:43], v3 offset:12544
  ds_read_b64_tr_b16 v[44:45], v3 offset:15424
  ds_read_b64_tr_b16 v[46:47], v3 offset:15616
  s_waitcnt lgkmcnt(0)
  ds_write_b128 v7, v[24:27] offset:12288
  ds_write_b128 v7, v[28:31] offset:13312
  ds_write_b128 v7, v[32:35] offset:14336
  ds_write_b128 v7, v[36:39] offset:15360
  ds_write_b128 v7, v[40:43] offset:16384
  ds_write_b128 v7, v[44:47] offset:17408
  s_waitcnt lgkmcnt(0)
  s_waitcnt vmcnt(6)
  ds_read_b64_tr_b16 a[0:1], v20 offset:0
  ds_read_b64_tr_b16 a[2:3], v20 offset:192
  ds_read_b64_tr_b16 a[4:5], v20 offset:3072
  ds_read_b64_tr_b16 a[6:7], v20 offset:3264
  ds_read_b64_tr_b16 a[8:9], v20 offset:32
  ds_read_b64_tr_b16 a[10:11], v20 offset:224
  ds_read_b64_tr_b16 a[12:13], v20 offset:3104
  ds_read_b64_tr_b16 a[14:15], v20 offset:3296
  ds_read_b64_tr_b16 a[16:17], v20 offset:64
  ds_read_b64_tr_b16 a[18:19], v20 offset:256
  ds_read_b64_tr_b16 a[20:21], v20 offset:3136
  ds_read_b64_tr_b16 a[22:23], v20 offset:3328
  s_waitcnt lgkmcnt(0)
  s_mov_b32 m0, 135168
  s_add_u32 s27, s32, 6291456
  buffer_load_dwordx4 v8, s[12:15], s27 offen  lds
  s_mov_b32 m0, 136192
  s_add_u32 s27, s32, 6291456
  buffer_load_dwordx4 v9, s[12:15], s27 offen  lds
  s_mov_b32 m0, 137216
  s_add_u32 s27, s32, 6291456
  buffer_load_dwordx4 v10, s[12:15], s27 offen  lds
  s_mov_b32 m0, 138240
  s_add_u32 s27, s32, 6291456
  buffer_load_dwordx4 v11, s[12:15], s27 offen  lds
  s_mov_b32 m0, 139264
  s_add_u32 s27, s32, 6291456
  buffer_load_dwordx4 v12, s[12:15], s27 offen  lds
  s_mov_b32 m0, 140288
  s_add_u32 s27, s32, 6291456
  buffer_load_dwordx4 v13, s[12:15], s27 offen  lds
  s_mov_b32 m0, 61440
  s_add_u32 s27, s32, 7077888
  buffer_load_dwordx4 v8, s[12:15], s27 offen  lds
  s_mov_b32 m0, 62464
  s_add_u32 s27, s32, 7077888
  buffer_load_dwordx4 v9, s[12:15], s27 offen  lds
  s_mov_b32 m0, 63488
  s_add_u32 s27, s32, 7077888
  buffer_load_dwordx4 v10, s[12:15], s27 offen  lds
  s_mov_b32 m0, 64512
  s_add_u32 s27, s32, 7077888
  buffer_load_dwordx4 v11, s[12:15], s27 offen  lds
  s_mov_b32 m0, 65536
  s_add_u32 s27, s32, 7077888
  buffer_load_dwordx4 v12, s[12:15], s27 offen  lds
  s_mov_b32 m0, 66560
  s_add_u32 s27, s32, 7077888
  buffer_load_dwordx4 v13, s[12:15], s27 offen  lds
  s_waitcnt vmcnt(12)
  ds_read_b64_tr_b16 a[24:25], v3 offset:24576
  ds_read_b64_tr_b16 a[26:27], v3 offset:24768
  ds_read_b64_tr_b16 a[28:29], v3 offset:27648
  ds_read_b64_tr_b16 a[30:31], v3 offset:27840
  ds_read_b64_tr_b16 a[32:33], v3 offset:24608
  ds_read_b64_tr_b16 a[34:35], v3 offset:24800
  ds_read_b64_tr_b16 a[36:37], v3 offset:27680
  ds_read_b64_tr_b16 a[38:39], v3 offset:27872
  ds_read_b64_tr_b16 a[40:41], v3 offset:24640
  ds_read_b64_tr_b16 a[42:43], v3 offset:24832
  ds_read_b64_tr_b16 a[44:45], v3 offset:27712
  ds_read_b64_tr_b16 a[46:47], v3 offset:27904
  s_waitcnt lgkmcnt(0)
  s_mov_b32 m0, 86016
  s_add_u32 s27, s33, 123136
  buffer_load_dwordx4 v14, s[16:19], s27 offen  lds
  s_mov_b32 m0, 87040
  s_add_u32 s27, s33, 123136
  buffer_load_dwordx4 v15, s[16:19], s27 offen  lds
  s_mov_b32 m0, 88064
  s_add_u32 s27, s33, 123136
  buffer_load_dwordx4 v16, s[16:19], s27 offen  lds
  s_mov_b32 m0, 89088
  s_add_u32 s27, s33, 123136
  buffer_load_dwordx4 v17, s[16:19], s27 offen  lds
  s_mov_b32 m0, 90112
  s_add_u32 s27, s33, 123136
  buffer_load_dwordx4 v18, s[16:19], s27 offen  lds
  s_mov_b32 m0, 91136
  s_add_u32 s27, s33, 123136
  buffer_load_dwordx4 v19, s[16:19], s27 offen  lds
  buffer_load_dwordx4 v[68:71], off, s[68:71], 0 offset:128 sc1
  buffer_load_dwordx2 v[72:73], off, s[68:71], 0 offset:64 sc1
  s_waitcnt vmcnt(14)
  ds_read_b64_tr_b16 a[48:49], v20 offset:0
  ds_read_b64_tr_b16 a[50:51], v20 offset:192
  ds_read_b64_tr_b16 a[52:53], v20 offset:3072
  ds_read_b64_tr_b16 a[54:55], v20 offset:3264
  ds_read_b64_tr_b16 a[56:57], v20 offset:32
  ds_read_b64_tr_b16 a[58:59], v20 offset:224
  ds_read_b64_tr_b16 a[60:61], v20 offset:3104
  ds_read_b64_tr_b16 a[62:63], v20 offset:3296
  ds_read_b64_tr_b16 a[64:65], v20 offset:64
  ds_read_b64_tr_b16 a[66:67], v20 offset:256
  ds_read_b64_tr_b16 a[68:69], v20 offset:3136
  ds_read_b64_tr_b16 a[70:71], v20 offset:3328
  s_waitcnt lgkmcnt(0)
  s_waitcnt vmcnt(8)
  ds_read_b64_tr_b16 v[24:25], v3 offset:0
  ds_read_b64_tr_b16 v[26:27], v3 offset:192
  ds_read_b64_tr_b16 v[28:29], v3 offset:3072
  ds_read_b64_tr_b16 v[30:31], v3 offset:3264
  ds_read_b64_tr_b16 v[32:33], v3 offset:32
  ds_read_b64_tr_b16 v[34:35], v3 offset:224
  ds_read_b64_tr_b16 v[36:37], v3 offset:3104
  ds_read_b64_tr_b16 v[38:39], v3 offset:3296
  ds_read_b64_tr_b16 v[40:41], v3 offset:64
  ds_read_b64_tr_b16 v[42:43], v3 offset:256
  ds_read_b64_tr_b16 v[44:45], v3 offset:3136
  ds_read_b64_tr_b16 v[46:47], v3 offset:3328
  s_waitcnt lgkmcnt(0)
  ds_write_b128 v7, v[24:27] offset:0
  ds_write_b128 v7, v[28:31] offset:1024
  ds_write_b128 v7, v[32:35] offset:2048
  ds_write_b128 v7, v[36:39] offset:3072
  ds_write_b128 v7, v[40:43] offset:4096
  ds_write_b128 v7, v[44:47] offset:5120
  s_waitcnt lgkmcnt(0)
  s_waitcnt vmcnt(2)
  ds_read_b64_tr_b16 v[24:25], v4 offset:24576
  ds_read_b64_tr_b16 v[26:27], v4 offset:24704
  ds_read_b64_tr_b16 v[28:29], v4 offset:27648
  ds_read_b64_tr_b16 v[30:31], v4 offset:27776
  ds_read_b64_tr_b16 v[32:33], v5 offset:26624
  ds_read_b64_tr_b16 v[34:35], v5 offset:26752
  ds_read_b64_tr_b16 v[36:37], v4 offset:24608
  ds_read_b64_tr_b16 v[38:39], v4 offset:24736
  ds_read_b64_tr_b16 v[40:41], v4 offset:27680
  ds_read_b64_tr_b16 v[42:43], v4 offset:27808
  ds_read_b64_tr_b16 v[44:45], v5 offset:26656
  ds_read_b64_tr_b16 v[46:47], v5 offset:26784
  s_waitcnt lgkmcnt(0)
  ds_write_b128 v7, v[24:27] offset:24576
  ds_write_b128 v7, v[28:31] offset:25600
  ds_write_b128 v7, v[32:35] offset:28672
  ds_write_b128 v7, v[36:39] offset:26624
  ds_write_b128 v7, v[40:43] offset:27648
  ds_write_b128 v7, v[44:47] offset:29696
  s_waitcnt lgkmcnt(0)
  s_branch CV_ldd
CV_ld3:
  s_mov_b32 m0, 141312
  s_add_u32 s27, s33, 0
  buffer_load_dwordx4 v14, s[16:19], s27 offen  lds
  s_mov_b32 m0, 142336
  s_add_u32 s27, s33, 0
  buffer_load_dwordx4 v15, s[16:19], s27 offen  lds
  s_mov_b32 m0, 143360
  s_add_u32 s27, s33, 0
  buffer_load_dwordx4 v16, s[16:19], s27 offen  lds
  s_mov_b32 m0, 144384
  s_add_u32 s27, s33, 0
  buffer_load_dwordx4 v17, s[16:19], s27 offen  lds
  s_mov_b32 m0, 145408
  s_add_u32 s27, s33, 0
  buffer_load_dwordx4 v18, s[16:19], s27 offen  lds
  s_mov_b32 m0, 146432
  s_add_u32 s27, s33, 0
  buffer_load_dwordx4 v19, s[16:19], s27 offen  lds
  s_mov_b32 m0, 116736
  s_add_u32 s27, s33, 64
  buffer_load_dwordx4 v14, s[16:19], s27 offen  lds
  s_mov_b32 m0, 117760
  s_add_u32 s27, s33, 64
  buffer_load_dwordx4 v15, s[16:19], s27 offen  lds
  s_mov_b32 m0, 118784
  s_add_u32 s27, s33, 64
  buffer_load_dwordx4 v16, s[16:19], s27 offen  lds
  s_mov_b32 m0, 119808
  s_add_u32 s27, s33, 64
  buffer_load_dwordx4 v17, s[16:19], s27 offen  lds
  s_mov_b32 m0, 120832
  s_add_u32 s27, s33, 64
  buffer_load_dwordx4 v18, s[16:19], s27 offen  lds
  s_mov_b32 m0, 121856
  s_add_u32 s27, s33, 64
  buffer_load_dwordx4 v19, s[16:19], s27 offen  lds
  s_mov_b32 m0, 104448
  s_add_u32 s27, s33, 128
  buffer_load_dwordx4 v14, s[16:19], s27 offen  lds
  s_mov_b32 m0, 105472
  s_add_u32 s27, s33, 128
  buffer_load_dwordx4 v15, s[16:19], s27 offen  lds
  s_mov_b32 m0, 106496
  s_add_u32 s27, s33, 128
  buffer_load_dwordx4 v16, s[16:19], s27 offen  lds
  s_mov_b32 m0, 107520
  s_add_u32 s27, s33, 128
  buffer_load_dwordx4 v17, s[16:19], s27 offen  lds
  s_mov_b32 m0, 108544
  s_add_u32 s27, s33, 128
  buffer_load_dwordx4 v18, s[16:19], s27 offen  lds
  s_mov_b32 m0, 109568
  s_add_u32 s27, s33, 128
  buffer_load_dwordx4 v19, s[16:19], s27 offen  lds
  s_mov_b32 m0, 98304
  s_add_u32 s27, s33, 192
  buffer_load_dwordx4 v14, s[16:19], s27 offen  lds
  s_mov_b32 m0, 99328
  s_add_u32 s27, s33, 192
  buffer_load_dwordx4 v15, s[16:19], s27 offen  lds
  s_mov_b32 m0, 100352
  s_add_u32 s27, s33, 192
  buffer_load_dwordx4 v16, s[16:19], s27 offen  lds
  s_mov_b32 m0, 101376
  s_add_u32 s27, s33, 192
  buffer_load_dwordx4 v17, s[16:19], s27 offen  lds
  s_mov_b32 m0, 102400
  s_add_u32 s27, s33, 192
  buffer_load_dwordx4 v18, s[16:19], s27 offen  lds
  s_mov_b32 m0, 103424
  s_add_u32 s27, s33, 192
  buffer_load_dwordx4 v19, s[16:19], s27 offen  lds
  s_mov_b32 m0, 110592
  s_add_u32 s27, s33, 256
  buffer_load_dwordx4 v14, s[16:19], s27 offen  lds
  s_mov_b32 m0, 111616
  s_add_u32 s27, s33, 256
  buffer_load_dwordx4 v15, s[16:19], s27 offen  lds
  s_mov_b32 m0, 112640
  s_add_u32 s27, s33, 256
  buffer_load_dwordx4 v16, s[16:19], s27 offen  lds
  s_mov_b32 m0, 113664
  s_add_u32 s27, s33, 256
  buffer_load_dwordx4 v17, s[16:19], s27 offen  lds
  s_mov_b32 m0, 114688
  s_add_u32 s27, s33, 256
  buffer_load_dwordx4 v18, s[16:19], s27 offen  lds
  s_mov_b32 m0, 115712
  s_add_u32 s27, s33, 256
  buffer_load_dwordx4 v19, s[16:19], s27 offen  lds
  s_mov_b32 m0, 92160
  s_add_u32 s27, s33, 122880
  buffer_load_dwordx4 v14, s[16:19], s27 offen  lds
  s_mov_b32 m0, 93184
  s_add_u32 s27, s33, 122880
  buffer_load_dwordx4 v15, s[16:19], s27 offen  lds
  s_mov_b32 m0, 94208
  s_add_u32 s27, s33, 122880
  buffer_load_dwordx4 v16, s[16:19], s27 offen  lds
  s_mov_b32 m0, 95232
  s_add_u32 s27, s33, 122880
  buffer_load_dwordx4 v17, s[16:19], s27 offen  lds
  s_mov_b32 m0, 96256
  s_add_u32 s27, s33, 122880
  buffer_load_dwordx4 v18, s[16:19], s27 offen  lds
  s_mov_b32 m0, 97280
  s_add_u32 s27, s33, 122880
  buffer_load_dwordx4 v19, s[16:19], s27 offen  lds
  s_waitcnt vmcnt(30)
  ds_read_b64_tr_b16 a[168:169], v21 offset:0
  ds_read_b64_tr_b16 a[170:171], v21 offset:128
  ds_read_b64_tr_b16 a[172:173], v21 offset:3072
  ds_read_b64_tr_b16 a[174:175], v21 offset:3200
  ds_read_b64_tr_b16 a[184:185], v22 offset:2048
  ds_read_b64_tr_b16 a[186:187], v22 offset:2176
  ds_read_b64_tr_b16 a[192:193], v21 offset:32
  ds_read_b64_tr_b16 a[194:195], v21 offset:160
  ds_read_b64_tr_b16 a[196:197], v21 offset:3104
  ds_read_b64_tr_b16 a[198:199], v21 offset:3232
  ds_read_b64_tr_b16 a[208:209], v22 offset:2080
  ds_read_b64_tr_b16 a[210:211], v22 offset:2208
  s_waitcnt lgkmcnt(0)
  s_mov_b32 m0, 141312
  s_add_u32 s27, s33, 122944
  buffer_load_dwordx4 v14, s[16:19], s27 offen  lds
  s_mov_b32 m0, 142336
  s_add_u32 s27, s33, 122944
  buffer_load_dwordx4 v15, s[16:19], s27 offen  lds
  s_mov_b32 m0, 143360
  s_add_u32 s27, s33, 122944
  buffer_load_dwordx4 v16, s[16:19], s27 offen  lds
  s_mov_b32 m0, 144384
  s_add_u32 s27, s33, 122944
  buffer_load_dwordx4 v17, s[16:19], s27 offen  lds
  s_mov_b32 m0, 145408
  s_add_u32 s27, s33, 122944
  buffer_load_dwordx4 v18, s[16:19], s27 offen  lds
  s_mov_b32 m0, 146432
  s_add_u32 s27, s33, 122944
  buffer_load_dwordx4 v19, s[16:19], s27 offen  lds
  s_waitcnt vmcnt(30)
  ds_read_b64_tr_b16 a[216:217], v4 offset:24576
  ds_read_b64_tr_b16 a[218:219], v4 offset:24704
  ds_read_b64_tr_b16 a[220:221], v4 offset:27648
  ds_read_b64_tr_b16 a[222:223], v4 offset:27776
  ds_read_b64_tr_b16 a[232:233], v5 offset:26624
  ds_read_b64_tr_b16 a[234:235], v5 offset:26752
  ds_read_b64_tr_b16 a[240:241], v4 offset:24608
  ds_read_b64_tr_b16 a[242:243], v4 offset:24736
  ds_read_b64_tr_b16 a[244:245], v4 offset:27680
  ds_read_b64_tr_b16 a[246:247], v4 offset:27808
  ds_read_b64_tr_b16 v[152:153], v5 offset:26656
  ds_read_b64_tr_b16 v[154:155], v5 offset:26784
  s_waitcnt lgkmcnt(0)
  s_mov_b32 m0, 116736
  s_add_u32 s27, s33, 123008
  buffer_load_dwordx4 v14, s[16:19], s27 offen  lds
  s_mov_b32 m0, 117760
  s_add_u32 s27, s33, 123008
  buffer_load_dwordx4 v15, s[16:19], s27 offen  lds
  s_mov_b32 m0, 118784
  s_add_u32 s27, s33, 123008
  buffer_load_dwordx4 v16, s[16:19], s27 offen  lds
  s_mov_b32 m0, 119808
  s_add_u32 s27, s33, 123008
  buffer_load_dwordx4 v17, s[16:19], s27 offen  lds
  s_mov_b32 m0, 120832
  s_add_u32 s27, s33, 123008
  buffer_load_dwordx4 v18, s[16:19], s27 offen  lds
  s_mov_b32 m0, 121856
  s_add_u32 s27, s33, 123008
  buffer_load_dwordx4 v19, s[16:19], s27 offen  lds
  s_waitcnt vmcnt(30)
  ds_read_b64_tr_b16 v[160:161], v4 offset:12288
  ds_read_b64_tr_b16 v[162:163], v4 offset:12416
  ds_read_b64_tr_b16 v[164:165], v4 offset:15360
  ds_read_b64_tr_b16 v[166:167], v4 offset:15488
  ds_read_b64_tr_b16 v[176:177], v5 offset:14336
  ds_read_b64_tr_b16 v[178:179], v5 offset:14464
  ds_read_b64_tr_b16 v[184:185], v4 offset:12320
  ds_read_b64_tr_b16 v[186:187], v4 offset:12448
  ds_read_b64_tr_b16 v[188:189], v4 offset:15392
  ds_read_b64_tr_b16 v[190:191], v4 offset:15520
  ds_read_b64_tr_b16 v[200:201], v5 offset:14368
  ds_read_b64_tr_b16 v[202:203], v5 offset:14496
  s_waitcnt lgkmcnt(0)
  s_mov_b32 m0, 104448
  s_add_u32 s27, s33, 123072
  buffer_load_dwordx4 v14, s[16:19], s27 offen  lds
  s_mov_b32 m0, 105472
  s_add_u32 s27, s33, 123072
  buffer_load_dwordx4 v15, s[16:19], s27 offen  lds
  s_mov_b32 m0, 106496
  s_add_u32 s27, s33, 123072
  buffer_load_dwordx4 v16, s[16:19], s27 offen  lds
  s_mov_b32 m0, 107520
  s_add_u32 s27, s33, 123072
  buffer_load_dwordx4 v17, s[16:19], s27 offen  lds
  s_mov_b32 m0, 108544
  s_add_u32 s27, s33, 123072
  buffer_load_dwordx4 v18, s[16:19], s27 offen  lds
  s_mov_b32 m0, 109568
  s_add_u32 s27, s33, 123072
  buffer_load_dwordx4 v19, s[16:19], s27 offen  lds
  s_waitcnt vmcnt(30)
  ds_read_b64_tr_b16 v[208:209], v4 offset:6144
  ds_read_b64_tr_b16 v[210:211], v4 offset:6272
  ds_read_b64_tr_b16 v[212:213], v4 offset:9216
  ds_read_b64_tr_b16 v[214:215], v4 offset:9344
  ds_read_b64_tr_b16 v[224:225], v5 offset:8192
  ds_read_b64_tr_b16 v[226:227], v5 offset:8320
  ds_read_b64_tr_b16 v[232:233], v4 offset:6176
  ds_read_b64_tr_b16 v[234:235], v4 offset:6304
  ds_read_b64_tr_b16 v[236:237], v4 offset:9248
  ds_read_b64_tr_b16 v[238:239], v4 offset:9376
  ds_read_b64_tr_b16 v[248:249], v5 offset:8224
  ds_read_b64_tr_b16 v[250:251], v5 offset:8352
  s_waitcnt lgkmcnt(0)
  s_waitcnt vmcnt(24)
  ds_read_b64_tr_b16 v[24:25], v4 offset:18432
  ds_read_b64_tr_b16 v[26:27], v4 offset:18560
  ds_read_b64_tr_b16 v[28:29], v4 offset:21504
  ds_read_b64_tr_b16 v[30:31], v4 offset:21632
  ds_read_b64_tr_b16 v[32:33], v5 offset:20480
  ds_read_b64_tr_b16 v[34:35], v5 offset:20608
  ds_read_b64_tr_b16 v[36:37], v4 offset:18464
  ds_read_b64_tr_b16 v[38:39], v4 offset:18592
  ds_read_b64_tr_b16 v[40:41], v4 offset:21536
  ds_read_b64_tr_b16 v[42:43], v4 offset:21664
  ds_read_b64_tr_b16 v[44:45], v5 offset:20512
  ds_read_b64_tr_b16 v[46:47], v5 offset:20640
  s_waitcnt lgkmcnt(0)
  ds_write_b128 v7, v[24:27] offset:18432
  ds_write_b128 v7, v[28:31] offset:19456
  ds_write_b128 v7, v[32:35] offset:22528
  ds_write_b128 v7, v[36:39] offset:20480
  ds_write_b128 v7, v[40:43] offset:21504
  ds_write_b128 v7, v[44:47] offset:23552
  s_waitcnt lgkmcnt(0)
  s_waitcnt vmcnt(18)
  ds_read_b64_tr_b16 a[176:177], v4 offset:0
  ds_read_b64_tr_b16 a[178:179], v4 offset:128
  ds_read_b64_tr_b16 a[180:181], v4 offset:3072
  ds_read_b64_tr_b16 a[182:183], v4 offset:3200
  ds_read_b64_tr_b16 a[188:189], v5 offset:2048
  ds_read_b64_tr_b16 a[190:191], v5 offset:2176
  ds_read_b64_tr_b16 a[200:201], v4 offset:32
  ds_read_b64_tr_b16 a[202:203], v4 offset:160
  ds_read_b64_tr_b16 a[204:205], v4 offset:3104
  ds_read_b64_tr_b16 a[206:207], v4 offset:3232
  ds_read_b64_tr_b16 a[212:213], v5 offset:2080
  ds_read_b64_tr_b16 a[214:215], v5 offset:2208
  s_waitcnt lgkmcnt(0)
  s_mov_b32 m0, 92160
  s_add_u32 s27, s32, 0
  buffer_load_dwordx4 v8, s[12:15], s27 offen  lds
  s_mov_b32 m0, 93184
  s_add_u32 s27, s32, 0
  buffer_load_dwordx4 v9, s[12:15], s27 offen  lds
  s_mov_b32 m0, 94208
  s_add_u32 s27, s32, 0
  buffer_load_dwordx4 v10, s[12:15], s27 offen  lds
  s_mov_b32 m0, 95232
  s_add_u32 s27, s32, 0
  buffer_load_dwordx4 v11, s[12:15], s27 offen  lds
  s_mov_b32 m0, 96256
  s_add_u32 s27, s32, 0
  buffer_load_dwordx4 v12, s[12:15], s27 offen  lds
  s_mov_b32 m0, 97280
  s_add_u32 s27, s32, 0
  buffer_load_dwordx4 v13, s[12:15], s27 offen  lds
  s_waitcnt vmcnt(18)
  ds_read_b64_tr_b16 a[224:225], v21 offset:0
  ds_read_b64_tr_b16 a[226:227], v21 offset:128
  ds_read_b64_tr_b16 a[228:229], v21 offset:3072
  ds_read_b64_tr_b16 a[230:231], v21 offset:3200
  ds_read_b64_tr_b16 a[236:237], v22 offset:2048
  ds_read_b64_tr_b16 a[238:239], v22 offset:2176
  ds_read_b64_tr_b16 a[248:249], v21 offset:32
  ds_read_b64_tr_b16 a[250:251], v21 offset:160
  ds_read_b64_tr_b16 a[252:253], v21 offset:3104
  ds_read_b64_tr_b16 a[254:255], v21 offset:3232
  ds_read_b64_tr_b16 v[156:157], v22 offset:2080
  ds_read_b64_tr_b16 v[158:159], v22 offset:2208
  s_waitcnt lgkmcnt(0)
  s_mov_b32 m0, 141312
  s_add_u32 s27, s32, 786432
  buffer_load_dwordx4 v8, s[12:15], s27 offen  lds
  s_mov_b32 m0, 142336
  s_add_u32 s27, s32, 786432
  buffer_load_dwordx4 v9, s[12:15], s27 offen  lds
  s_mov_b32 m0, 143360
  s_add_u32 s27, s32, 786432
  buffer_load_dwordx4 v10, s[12:15], s27 offen  lds
  s_mov_b32 m0, 144384
  s_add_u32 s27, s32, 786432
  buffer_load_dwordx4 v11, s[12:15], s27 offen  lds
  s_mov_b32 m0, 145408
  s_add_u32 s27, s32, 786432
  buffer_load_dwordx4 v12, s[12:15], s27 offen  lds
  s_mov_b32 m0, 146432
  s_add_u32 s27, s32, 786432
  buffer_load_dwordx4 v13, s[12:15], s27 offen  lds
  s_waitcnt vmcnt(18)
  ds_read_b64_tr_b16 v[168:169], v4 offset:24576
  ds_read_b64_tr_b16 v[170:171], v4 offset:24704
  ds_read_b64_tr_b16 v[172:173], v4 offset:27648
  ds_read_b64_tr_b16 v[174:175], v4 offset:27776
  ds_read_b64_tr_b16 v[180:181], v5 offset:26624
  ds_read_b64_tr_b16 v[182:183], v5 offset:26752
  ds_read_b64_tr_b16 v[192:193], v4 offset:24608
  ds_read_b64_tr_b16 v[194:195], v4 offset:24736
  ds_read_b64_tr_b16 v[196:197], v4 offset:27680
  ds_read_b64_tr_b16 v[198:199], v4 offset:27808
  ds_read_b64_tr_b16 v[204:205], v5 offset:26656
  ds_read_b64_tr_b16 v[206:207], v5 offset:26784
  s_waitcnt lgkmcnt(0)
  s_mov_b32 m0, 116736
  s_add_u32 s27, s32, 1572864
  buffer_load_dwordx4 v8, s[12:15], s27 offen  lds
  s_mov_b32 m0, 117760
  s_add_u32 s27, s32, 1572864
  buffer_load_dwordx4 v9, s[12:15], s27 offen  lds
  s_mov_b32 m0, 118784
  s_add_u32 s27, s32, 1572864
  buffer_load_dwordx4 v10, s[12:15], s27 offen  lds
  s_mov_b32 m0, 119808
  s_add_u32 s27, s32, 1572864
  buffer_load_dwordx4 v11, s[12:15], s27 offen  lds
  s_mov_b32 m0, 120832
  s_add_u32 s27, s32, 1572864
  buffer_load_dwordx4 v12, s[12:15], s27 offen  lds
  s_mov_b32 m0, 121856
  s_add_u32 s27, s32, 1572864
  buffer_load_dwordx4 v13, s[12:15], s27 offen  lds
  s_mov_b32 m0, 98304
  s_add_u32 s27, s32, 2359296
  buffer_load_dwordx4 v8, s[12:15], s27 offen  lds
  s_mov_b32 m0, 99328
  s_add_u32 s27, s32, 2359296
  buffer_load_dwordx4 v9, s[12:15], s27 offen  lds
  s_mov_b32 m0, 100352
  s_add_u32 s27, s32, 2359296
  buffer_load_dwordx4 v10, s[12:15], s27 offen  lds
  s_mov_b32 m0, 101376
  s_add_u32 s27, s32, 2359296
  buffer_load_dwordx4 v11, s[12:15], s27 offen  lds
  s_mov_b32 m0, 102400
  s_add_u32 s27, s32, 2359296
  buffer_load_dwordx4 v12, s[12:15], s27 offen  lds
  s_mov_b32 m0, 103424
  s_add_u32 s27, s32, 2359296
  buffer_load_dwordx4 v13, s[12:15], s27 offen  lds
  s_waitcnt vmcnt(24)
  ds_read_b64_tr_b16 v[216:217], v4 offset:12288
  ds_read_b64_tr_b16 v[218:219], v4 offset:12416
  ds_read_b64_tr_b16 v[220:221], v4 offset:15360
  ds_read_b64_tr_b16 v[222:223], v4 offset:15488
  ds_read_b64_tr_b16 v[228:229], v5 offset:14336
  ds_read_b64_tr_b16 v[230:231], v5 offset:14464
  ds_read_b64_tr_b16 v[240:241], v4 offset:12320
  ds_read_b64_tr_b16 v[242:243], v4 offset:12448
  ds_read_b64_tr_b16 v[244:245], v4 offset:15392
  ds_read_b64_tr_b16 v[246:247], v4 offset:15520
  ds_read_b64_tr_b16 v[252:253], v5 offset:14368
  ds_read_b64_tr_b16 v[254:255], v5 offset:14496
  s_waitcnt lgkmcnt(0)
  s_waitcnt vmcnt(18)
  ds_read_b64_tr_b16 v[24:25], v3 offset:0
  ds_read_b64_tr_b16 v[26:27], v3 offset:192
  ds_read_b64_tr_b16 v[28:29], v3 offset:3072
  ds_read_b64_tr_b16 v[30:31], v3 offset:3264
  ds_read_b64_tr_b16 v[32:33], v3 offset:32
  ds_read_b64_tr_b16 v[34:35], v3 offset:224
  ds_read_b64_tr_b16 v[36:37], v3 offset:3104
  ds_read_b64_tr_b16 v[38:39], v3 offset:3296
  ds_read_b64_tr_b16 v[40:41], v3 offset:64
  ds_read_b64_tr_b16 v[42:43], v3 offset:256
  ds_read_b64_tr_b16 v[44:45], v3 offset:3136
  ds_read_b64_tr_b16 v[46:47], v3 offset:3328
  s_waitcnt lgkmcnt(0)
  ds_write_b128 v7, v[24:27] offset:0
  ds_write_b128 v7, v[28:31] offset:1024
  ds_write_b128 v7, v[32:35] offset:2048
  ds_write_b128 v7, v[36:39] offset:3072
  ds_write_b128 v7, v[40:43] offset:4096
  ds_write_b128 v7, v[44:47] offset:5120
  s_waitcnt lgkmcnt(0)
  s_waitcnt vmcnt(12)
  ds_read_b64_tr_b16 a[72:73], v20 offset:0
  ds_read_b64_tr_b16 a[74:75], v20 offset:192
  ds_read_b64_tr_b16 a[76:77], v20 offset:3072
  ds_read_b64_tr_b16 a[78:79], v20 offset:3264
  ds_read_b64_tr_b16 a[80:81], v20 offset:32
  ds_read_b64_tr_b16 a[82:83], v20 offset:224
  ds_read_b64_tr_b16 a[84:85], v20 offset:3104
  ds_read_b64_tr_b16 a[86:87], v20 offset:3296
  ds_read_b64_tr_b16 a[88:89], v20 offset:64
  ds_read_b64_tr_b16 a[90:91], v20 offset:256
  ds_read_b64_tr_b16 a[92:93], v20 offset:3136
  ds_read_b64_tr_b16 a[94:95], v20 offset:3328
  s_waitcnt lgkmcnt(0)
  s_mov_b32 m0, 141312
  s_add_u32 s27, s32, 3145728
  buffer_load_dwordx4 v8, s[12:15], s27 offen  lds
  s_mov_b32 m0, 142336
  s_add_u32 s27, s32, 3145728
  buffer_load_dwordx4 v9, s[12:15], s27 offen  lds
  s_mov_b32 m0, 143360
  s_add_u32 s27, s32, 3145728
  buffer_load_dwordx4 v10, s[12:15], s27 offen  lds
  s_mov_b32 m0, 144384
  s_add_u32 s27, s32, 3145728
  buffer_load_dwordx4 v11, s[12:15], s27 offen  lds
  s_mov_b32 m0, 145408
  s_add_u32 s27, s32, 3145728
  buffer_load_dwordx4 v12, s[12:15], s27 offen  lds
  s_mov_b32 m0, 146432
  s_add_u32 s27, s32, 3145728
  buffer_load_dwordx4 v13, s[12:15], s27 offen  lds
  s_waitcnt vmcnt(12)
  ds_read_b64_tr_b16 a[96:97], v3 offset:24576
  ds_read_b64_tr_b16 a[98:99], v3 offset:24768
  ds_read_b64_tr_b16 a[100:101], v3 offset:27648
  ds_read_b64_tr_b16 a[102:103], v3 offset:27840
  ds_read_b64_tr_b16 a[104:105], v3 offset:24608
  ds_read_b64_tr_b16 a[106:107], v3 offset:24800
  ds_read_b64_tr_b16 a[108:109], v3 offset:27680
  ds_read_b64_tr_b16 a[110:111], v3 offset:27872
  ds_read_b64_tr_b16 a[112:113], v3 offset:24640
  ds_read_b64_tr_b16 a[114:115], v3 offset:24832
  ds_read_b64_tr_b16 a[116:117], v3 offset:27712
  ds_read_b64_tr_b16 a[118:119], v3 offset:27904
  s_waitcnt lgkmcnt(0)
  s_mov_b32 m0, 116736
  s_add_u32 s27, s32, 3932160
  buffer_load_dwordx4 v8, s[12:15], s27 offen  lds
  s_mov_b32 m0, 117760
  s_add_u32 s27, s32, 3932160
  buffer_load_dwordx4 v9, s[12:15], s27 offen  lds
  s_mov_b32 m0, 118784
  s_add_u32 s27, s32, 3932160
  buffer_load_dwordx4 v10, s[12:15], s27 offen  lds
  s_mov_b32 m0, 119808
  s_add_u32 s27, s32, 3932160
  buffer_load_dwordx4 v11, s[12:15], s27 offen  lds
  s_mov_b32 m0, 120832
  s_add_u32 s27, s32, 3932160
  buffer_load_dwordx4 v12, s[12:15], s27 offen  lds
  s_mov_b32 m0, 121856
  s_add_u32 s27, s32, 3932160
  buffer_load_dwordx4 v13, s[12:15], s27 offen  lds
  s_mov_b32 m0, 104448
  s_add_u32 s27, s32, 4718592
  buffer_load_dwordx4 v8, s[12:15], s27 offen  lds
  s_mov_b32 m0, 105472
  s_add_u32 s27, s32, 4718592
  buffer_load_dwordx4 v9, s[12:15], s27 offen  lds
  s_mov_b32 m0, 106496
  s_add_u32 s27, s32, 4718592
  buffer_load_dwordx4 v10, s[12:15], s27 offen  lds
  s_mov_b32 m0, 107520
  s_add_u32 s27, s32, 4718592
  buffer_load_dwordx4 v11, s[12:15], s27 offen  lds
  s_mov_b32 m0, 108544
  s_add_u32 s27, s32, 4718592
  buffer_load_dwordx4 v12, s[12:15], s27 offen  lds
  s_mov_b32 m0, 109568
  s_add_u32 s27, s32, 4718592
  buffer_load_dwordx4 v13, s[12:15], s27 offen  lds
  s_waitcnt vmcnt(18)
  ds_read_b64_tr_b16 v[24:25], v3 offset:6144
  ds_read_b64_tr_b16 v[26:27], v3 offset:6336
  ds_read_b64_tr_b16 v[28:29], v3 offset:9216
  ds_read_b64_tr_b16 v[30:31], v3 offset:9408
  ds_read_b64_tr_b16 v[32:33], v3 offset:6176
  ds_read_b64_tr_b16 v[34:35], v3 offset:6368
  ds_read_b64_tr_b16 v[36:37], v3 offset:9248
  ds_read_b64_tr_b16 v[38:39], v3 offset:9440
  ds_read_b64_tr_b16 v[40:41], v3 offset:6208
  ds_read_b64_tr_b16 v[42:43], v3 offset:6400
  ds_read_b64_tr_b16 v[44:45], v3 offset:9280
  ds_read_b64_tr_b16 v[46:47], v3 offset:9472
  s_waitcnt lgkmcnt(0)
  ds_write_b128 v7, v[24:27] offset:6144
  ds_write_b128 v7, v[28:31] offset:7168
  ds_write_b128 v7, v[32:35] offset:8192
  ds_write_b128 v7, v[36:39] offset:9216
  ds_write_b128 v7, v[40:43] offset:10240
  ds_write_b128 v7, v[44:47] offset:11264
  s_waitcnt lgkmcnt(0)
  s_waitcnt vmcnt(12)
  ds_read_b64_tr_b16 a[120:121], v20 offset:0
  ds_read_b64_tr_b16 a[122:123], v20 offset:192
  ds_read_b64_tr_b16 a[124:125], v20 offset:3072
  ds_read_b64_tr_b16 a[126:127], v20 offset:3264
  ds_read_b64_tr_b16 a[128:129], v20 offset:32
  ds_read_b64_tr_b16 a[130:131], v20 offset:224
  ds_read_b64_tr_b16 a[132:133], v20 offset:3104
  ds_read_b64_tr_b16 a[134:135], v20 offset:3296
  ds_read_b64_tr_b16 a[136:137], v20 offset:64
  ds_read_b64_tr_b16 a[138:139], v20 offset:256
  ds_read_b64_tr_b16 a[140:141], v20 offset:3136
  ds_read_b64_tr_b16 a[142:143], v20 offset:3328
  s_waitcnt lgkmcnt(0)
  s_mov_b32 m0, 141312
  s_add_u32 s27, s32, 5505024
  buffer_load_dwordx4 v8, s[12:15], s27 offen  lds
  s_mov_b32 m0, 142336
  s_add_u32 s27, s32, 5505024
  buffer_load_dwordx4 v9, s[12:15], s27 offen  lds
  s_mov_b32 m0, 143360
  s_add_u32 s27, s32, 5505024
  buffer_load_dwordx4 v10, s[12:15], s27 offen  lds
  s_mov_b32 m0, 144384
  s_add_u32 s27, s32, 5505024
  buffer_load_dwordx4 v11, s[12:15], s27 offen  lds
  s_mov_b32 m0, 145408
  s_add_u32 s27, s32, 5505024
  buffer_load_dwordx4 v12, s[12:15], s27 offen  lds
  s_mov_b32 m0, 146432
  s_add_u32 s27, s32, 5505024
  buffer_load_dwordx4 v13, s[12:15], s27 offen  lds
  s_waitcnt vmcnt(12)
  ds_read_b64_tr_b16 a[144:145], v3 offset:24576
  ds_read_b64_tr_b16 a[146:147], v3 offset:24768
  ds_read_b64_tr_b16 a[148:149], v3 offset:27648
  ds_read_b64_tr_b16 a[150:151], v3 offset:27840
  ds_read_b64_tr_b16 a[152:153], v3 offset:24608
  ds_read_b64_tr_b16 a[154:155], v3 offset:24800
  ds_read_b64_tr_b16 a[156:157], v3 offset:27680
  ds_read_b64_tr_b16 a[158:159], v3 offset:27872
  ds_read_b64_tr_b16 a[160:161], v3 offset:24640
  ds_read_b64_tr_b16 a[162:163], v3 offset:24832
  ds_read_b64_tr_b16 a[164:165], v3 offset:27712
  ds_read_b64_tr_b16 a[166:167], v3 offset:27904
  s_waitcnt lgkmcnt(0)
  s_mov_b32 m0, 116736
  s_add_u32 s27, s32, 6291456
  buffer_load_dwordx4 v8, s[12:15], s27 offen  lds
  s_mov_b32 m0, 117760
  s_add_u32 s27, s32, 6291456
  buffer_load_dwordx4 v9, s[12:15], s27 offen  lds
  s_mov_b32 m0, 118784
  s_add_u32 s27, s32, 6291456
  buffer_load_dwordx4 v10, s[12:15], s27 offen  lds
  s_mov_b32 m0, 119808
  s_add_u32 s27, s32, 6291456
  buffer_load_dwordx4 v11, s[12:15], s27 offen  lds
  s_mov_b32 m0, 120832
  s_add_u32 s27, s32, 6291456
  buffer_load_dwordx4 v12, s[12:15], s27 offen  lds
  s_mov_b32 m0, 121856
  s_add_u32 s27, s32, 6291456
  buffer_load_dwordx4 v13, s[12:15], s27 offen  lds
  s_waitcnt vmcnt(12)
  ds_read_b64_tr_b16 v[24:25], v3 offset:12288
  ds_read_b64_tr_b16 v[26:27], v3 offset:12480
  ds_read_b64_tr_b16 v[28:29], v3 offset:15360
  ds_read_b64_tr_b16 v[30:31], v3 offset:15552
  ds_read_b64_tr_b16 v[32:33], v3 offset:12320
  ds_read_b64_tr_b16 v[34:35], v3 offset:12512
  ds_read_b64_tr_b16 v[36:37], v3 offset:15392
  ds_read_b64_tr_b16 v[38:39], v3 offset:15584
  ds_read_b64_tr_b16 v[40:41], v3 offset:12352
  ds_read_b64_tr_b16 v[42:43], v3 offset:12544
  ds_read_b64_tr_b16 v[44:45], v3 offset:15424
  ds_read_b64_tr_b16 v[46:47], v3 offset:15616
  s_waitcnt lgkmcnt(0)
  ds_write_b128 v7, v[24:27] offset:12288
  ds_write_b128 v7, v[28:31] offset:13312
  ds_write_b128 v7, v[32:35] offset:14336
  ds_write_b128 v7, v[36:39] offset:15360
  ds_write_b128 v7, v[40:43] offset:16384
  ds_write_b128 v7, v[44:47] offset:17408
  s_waitcnt lgkmcnt(0)
  s_waitcnt vmcnt(6)
  ds_read_b64_tr_b16 a[0:1], v20 offset:0
  ds_read_b64_tr_b16 a[2:3], v20 offset:192
  ds_read_b64_tr_b16 a[4:5], v20 offset:3072
  ds_read_b64_tr_b16 a[6:7], v20 offset:3264
  ds_read_b64_tr_b16 a[8:9], v20 offset:32
  ds_read_b64_tr_b16 a[10:11], v20 offset:224
  ds_read_b64_tr_b16 a[12:13], v20 offset:3104
  ds_read_b64_tr_b16 a[14:15], v20 offset:3296
  ds_read_b64_tr_b16 a[16:17], v20 offset:64
  ds_read_b64_tr_b16 a[18:19], v20 offset:256
  ds_read_b64_tr_b16 a[20:21], v20 offset:3136
  ds_read_b64_tr_b16 a[22:23], v20 offset:3328
  s_waitcnt lgkmcnt(0)
  s_mov_b32 m0, 141312
  s_add_u32 s27, s32, 7077888
  buffer_load_dwordx4 v8, s[12:15], s27 offen  lds
  s_mov_b32 m0, 142336
  s_add_u32 s27, s32, 7077888
  buffer_load_dwordx4 v9, s[12:15], s27 offen  lds
  s_mov_b32 m0, 143360
  s_add_u32 s27, s32, 7077888
  buffer_load_dwordx4 v10, s[12:15], s27 offen  lds
  s_mov_b32 m0, 144384
  s_add_u32 s27, s32, 7077888
  buffer_load_dwordx4 v11, s[12:15], s27 offen  lds
  s_mov_b32 m0, 145408
  s_add_u32 s27, s32, 7077888
  buffer_load_dwordx4 v12, s[12:15], s27 offen  lds
  s_mov_b32 m0, 146432
  s_add_u32 s27, s32, 7077888
  buffer_load_dwordx4 v13, s[12:15], s27 offen  lds
  s_waitcnt vmcnt(6)
  ds_read_b64_tr_b16 a[24:25], v3 offset:24576
  ds_read_b64_tr_b16 a[26:27], v3 offset:24768
  ds_read_b64_tr_b16 a[28:29], v3 offset:27648
  ds_read_b64_tr_b16 a[30:31], v3 offset:27840
  ds_read_b64_tr_b16 a[32:33], v3 offset:24608
  ds_read_b64_tr_b16 a[34:35], v3 offset:24800
  ds_read_b64_tr_b16 a[36:37], v3 offset:27680
  ds_read_b64_tr_b16 a[38:39], v3 offset:27872
  ds_read_b64_tr_b16 a[40:41], v3 offset:24640
  ds_read_b64_tr_b16 a[42:43], v3 offset:24832
  ds_read_b64_tr_b16 a[44:45], v3 offset:27712
  ds_read_b64_tr_b16 a[46:47], v3 offset:27904
  s_waitcnt lgkmcnt(0)
  s_mov_b32 m0, 116736
  s_add_u32 s27, s33, 123136
  buffer_load_dwordx4 v14, s[16:19], s27 offen  lds
  s_mov_b32 m0, 117760
  s_add_u32 s27, s33, 123136
  buffer_load_dwordx4 v15, s[16:19], s27 offen  lds
  s_mov_b32 m0, 118784
  s_add_u32 s27, s33, 123136
  buffer_load_dwordx4 v16, s[16:19], s27 offen  lds
  s_mov_b32 m0, 119808
  s_add_u32 s27, s33, 123136
  buffer_load_dwordx4 v17, s[16:19], s27 offen  lds
  s_mov_b32 m0, 120832
  s_add_u32 s27, s33, 123136
  buffer_load_dwordx4 v18, s[16:19], s27 offen  lds
  s_mov_b32 m0, 121856
  s_add_u32 s27, s33, 123136
  buffer_load_dwordx4 v19, s[16:19], s27 offen  lds
  buffer_load_dwordx4 v[68:71], off, s[68:71], 0 offset:128 sc1
  buffer_load_dwordx2 v[72:73], off, s[68:71], 0 offset:64 sc1
  s_getpc_b64 s[4:5]
pc_14:
  s_add_u32 s4, s4, CV_ldd-pc_14
  s_addc_u32 s5, s5, 0
  v_lshlrev_b32 v74, 7, v1
  global_load_dword v75, v74, s[4:5]
  s_waitcnt vmcnt(9)
  ds_read_b64_tr_b16 a[48:49], v20 offset:0
  ds_read_b64_tr_b16 a[50:51], v20 offset:192
  ds_read_b64_tr_b16 a[52:53], v20 offset:3072
  ds_read_b64_tr_b16 a[54:55], v20 offset:3264
  ds_read_b64_tr_b16 a[56:57], v20 offset:32
  ds_read_b64_tr_b16 a[58:59], v20 offset:224
  ds_read_b64_tr_b16 a[60:61], v20 offset:3104
  ds_read_b64_tr_b16 a[62:63], v20 offset:3296
  ds_read_b64_tr_b16 a[64:65], v20 offset:64
  ds_read_b64_tr_b16 a[66:67], v20 offset:256
  ds_read_b64_tr_b16 a[68:69], v20 offset:3136
  ds_read_b64_tr_b16 a[70:71], v20 offset:3328
  s_waitcnt lgkmcnt(0)
  s_waitcnt vmcnt(3)
  ds_read_b64_tr_b16 v[24:25], v4 offset:24576
  ds_read_b64_tr_b16 v[26:27], v4 offset:24704
  ds_read_b64_tr_b16 v[28:29], v4 offset:27648
  ds_read_b64_tr_b16 v[30:31], v4 offset:27776
  ds_read_b64_tr_b16 v[32:33], v5 offset:26624
  ds_read_b64_tr_b16 v[34:35], v5 offset:26752
  ds_read_b64_tr_b16 v[36:37], v4 offset:24608
  ds_read_b64_tr_b16 v[38:39], v4 offset:24736
  ds_read_b64_tr_b16 v[40:41], v4 offset:27680
  ds_read_b64_tr_b16 v[42:43], v4 offset:27808
  ds_read_b64_tr_b16 v[44:45], v5 offset:26656
  ds_read_b64_tr_b16 v[46:47], v5 offset:26784
  s_waitcnt lgkmcnt(0)
  ds_write_b128 v7, v[24:27] offset:24576
  ds_write_b128 v7, v[28:31] offset:25600
  ds_write_b128 v7, v[32:35] offset:28672
  ds_write_b128 v7, v[36:39] offset:26624
  ds_write_b128 v7, v[40:43] offset:27648
  ds_write_b128 v7, v[44:47] offset:29696
  s_waitcnt lgkmcnt(0)
CV_ldd:
  s_branch cg_16
cg_15:
  s_sleep 4
  buffer_load_dwordx4 v[68:71], off, s[68:71], 0 offset:128 sc1
  buffer_load_dwordx2 v[72:73], off, s[68:71], 0 offset:64 sc1
  s_add_u32 s26, s26, 1
  s_mov_b32 s39, 97
  s_cmp_gt_u32 s26, 2097152
  s_cbranch_scc1 L_abort
cg_16:
  s_waitcnt vmcnt(0)
  v_readfirstlane_b32 s32, v68
  v_readfirstlane_b32 s33, v69
  v_readfirstlane_b32 s34, v70
  v_readfirstlane_b32 s35, v71
  v_readfirstlane_b32 s31, v72
  v_readfirstlane_b32 s74, v73
  s_add_u32 s27, s32, s33
  s_add_u32 s30, s34, s35
  s_add_u32 s27, s27, s30
  s_mul_i32 s27, s27, 0x01010101
  s_lshr_b32 s27, s27, 24
  s_cmp_lt_u32 s27, 64
  s_cbranch_scc1 cg_15
  s_cmp_lt_u32 s31, 64
  s_cbranch_scc1 cg_15
  s_cmp_eq_u32 s74, 0
  s_cbranch_scc1 cg_15
  s_and_b32 s74, s74, 6
  s_lshl_b32 s74, s74, 12
  s_xor_b32 s74, s74, 0x4000
  s_or_b32 s27, s32, s33
  s_or_b32 s27, s27, s34
  s_or_b32 s27, s27, s35
  s_and_b32 s3, s27, 0x1f1f1f1f
  s_and_b32 s85, s25, 15
  v_bfe_u32 v3, v1, 1, 1
  v_mul_u32_u24 v3, 0xaaaa, v3
  v_add_u32 v3, 0x4444, v3
  s_lshl_b32 s27, s75, 10
  v_add_u32 v4, s27, v2
  s_mov_b32 s83, 0x3f80
  s_mov_b32 s84, 0x3f800000
  s_mov_b32 s77, 0x80008000
  s_mul_i32 s86, s29, 10240
  s_add_u32 s86, s86, 65536
  s_xor_b32 s27, s29, 1
  s_mul_i32 s27, s27, 10
  s_add_u32 s27, s27, s75
  s_add_u32 s30, s27, 0
  s_lshr_b32 s31, s30, 3
  s_mul_i32 s31, s31, 24
  s_add_u32 s30, s30, s31
  s_lshl_b32 s30, s30, 10
  s_add_u32 s30, s30, s74
  s_add_u32 s64, s30, 917504
  s_add_u32 s30, s27, 1
  s_lshr_b32 s31, s30, 3
  s_mul_i32 s31, s31, 24
  s_add_u32 s30, s30, s31
  s_lshl_b32 s30, s30, 10
  s_add_u32 s30, s30, s74
  s_add_u32 s65, s30, 917504
  s_add_u32 s30, s27, 2
  s_lshr_b32 s31, s30, 3
  s_mul_i32 s31, s31, 24
  s_add_u32 s30, s30, s31
  s_lshl_b32 s30, s30, 10
  s_add_u32 s30, s30, s74
  s_add_u32 s66, s30, 917504
  v_add_u32 v5, 122880, v4
  s_cmp_ge_u32 s24, 3
  s_cselect_b32 s27, 10, 0
  s_sub_u32 s27, s75, s27
  s_lshl_b32 s27, s27, 10
  s_add_u32 s27, s27, 122880
  v_add_u32 v11, s27, v2
  s_cmp_ge_u32 s24, 2
  s_cselect_b32 s27, 10, 0
  s_sub_u32 s27, s75, s27
  s_lshl_b32 s27, s27, 10
  s_add_u32 s27, s27, 122880
  v_add_u32 v12, s27, v2
  s_cmp_ge_u32 s24, 1
  s_cselect_b32 s27, 10, 0
  s_sub_u32 s27, s75, s27
  s_lshl_b32 s27, s27, 10
  s_add_u32 s27, s27, 122880
  v_add_u32 v13, s27, v2
  v_and_b32 v67, 15, v1
  v_lshlrev_b32 v21, 2, v67
  s_lshl_b32 s27, s29, 11
  s_add_u32 s27, s27, 40960
  v_add_u32 v21, s27, v21
  s_mov_b32 s80, 0
  v_and_b32 v64, 15, v1
  v_lshrrev_b32 v65, 4, v1
  v_lshlrev_b32 v66, 5, v64
  v_lshl_add_u32 v66, v65, 3, v66
  s_lshl_b32 s27, s24, 9
  s_add_u32 s27, s27, 133120
  v_add_u32 v8, s27, v66
  s_lshr_b32 s27, s24, 1
  s_lshl_b32 s27, s27, 9
  s_and_b32 s30, s24, 1
  s_lshl_b32 s30, s30, 2
  s_add_u32 s27, s27, s30
  s_add_u32 s27, s27, 135168
  v_add_u32 v9, s27, v66
  v_bfe_u32 v67, v1, 2, 2
  v_lshl_add_u32 v67, v65, 3, v67
  v_lshlrev_b32 v10, 5, v67
  v_and_b32 v67, 3, v1
  v_lshl_add_u32 v10, v67, 3, v10
  v_add_u32 v10, 133120, v10
  s_mul_i32 s37, s25, 10240
  s_mul_i32 s27, s24, 2560
  s_add_u32 s37, s37, s27
  s_mul_i32 s38, s85, 5
  s_lshr_b32 s38, s38, 1
  s_lshl_b32 s27, s29, 4
  s_lshl_b32 s30, s24, 2
  s_add_u32 s31, s27, s30
  v_add_u32 v14, s31, v65
  v_mul_u32_u24 v14, 10240, v14
  v_lshl_add_u32 v14, v64, 4, v14
  s_lshl_b32 s27, s38, 8
  v_add_u32 v14, s27, v14
  s_lshl_b32 s27, s24, 11
  v_add_u32 v15, s27, v2
  s_lshl_b32 s27, s24, 10
  s_add_u32 s27, s27, 8192
  v_add_u32 v16, s27, v2
  s_mul_i32 s35, s31, 40960
  s_lshl_b32 s27, s38, 10
  s_add_u32 s35, s35, s27
  s_add_u32 s35, s35, 117964800
  s_mul_i32 s27, s24, 1536
  s_add_u32 s27, s27, 136192
  v_mul_u32_u24 v17, 384, v65
  v_lshl_add_u32 v17, v64, 2, v17
  v_add_u32 v17, s27, v17
  v_min_u32 v67, 2, v65
  v_lshlrev_b32 v18, 6, v67
  v_bfe_u32 v67, v1, 1, 1
  v_lshl_add_u32 v18, v67, 5, v18
  v_bfe_u32 v67, v1, 2, 2
  v_mul_u32_u24 v67, 384, v67
  v_add_u32 v18, v18, v67
  v_and_b32 v67, 1, v1
  v_mul_u32_u24 v67, 192, v67
  v_add_u32 v18, v18, v67
  v_add_u32 v18, 136192, v18
  s_lshl_b32 s27, s29, 4
  s_add_u32 s27, s27, 64
  v_lshrrev_b32 v67, 2, v1
  v_min_u32 v67, 15, v67
  v_add_u32 v67, s27, v67
  v_lshlrev_b32 v67, 7, v67
  v_and_b32 v19, 3, v1
  v_lshl_add_u32 v19, v19, 2, v67
  v_add_u32 v19, 4096, v19
  s_add_u32 s34, s25, 224
  s_lshl_b32 s34, s34, 7
  s_lshl_b32 s30, s24, 2
  s_add_u32 s34, s34, s30
  s_add_u32 s34, s34, 4096
  v_bfe_u32 v22, v1, 1, 1
  v_add_u32 v22, -1, v22
  s_mul_i32 s72, s29, 10240
  s_lshl_b32 s27, s38, 8
  s_add_u32 s72, s72, s27
  v_add_u32 v6, s72, v2
  v_lshrrev_b32 v67, 13, v6
  v_mul_u32_u24 v67, 0x6000, v67
  v_add_u32 v6, v6, v67
  s_bitcmp1_b32 s85, 0
  s_cselect_b32 s73, 0xffff0000, -1
  s_lshl_b32 s91, s29, 11
  s_lshl_b32 s27, s85, 2
  s_add_u32 s91, s91, s27
  s_add_u32 s91, s91, 40960
  s_cmp_eq_u32 s24, 0
  s_cselect_b32 s96, 1, 0
  s_mov_b32 s97, 0
  s_add_u32 s36, s37, 21495808
  v_mov_b32 v20, 0
  s_barrier
  ds_read_b128 v[76:79], v7 offset:0
  ds_read_b128 v[80:83], v7 offset:1024
  ds_read_b128 v[84:87], v7 offset:4096
  ds_read_b128 v[88:91], v7 offset:5120
  ds_read_b128 v[116:119], v7 offset:2048
  ds_read_b128 v[120:123], v7 offset:3072
  ds_read_b128 v[124:127], v7 offset:6144
  ds_read_b128 v[128:131], v7 offset:7168
  ds_read_b128 v[132:135], v7 offset:10240
  ds_read_b128 v[136:139], v7 offset:11264
  v_mov_b64 v[64:65], 0
  v_mov_b64 v[66:67], 0
  v_mov_b64 v[68:69], 0
  v_mov_b64 v[70:71], 0
  v_mov_b64 v[72:73], 0
  v_mov_b64 v[74:75], 0
  s_waitcnt lgkmcnt(0)
  s_cmp_lg_u32 s3, 0
  s_cbranch_scc1 CVS_step
CV_step:
  s_and_b32 s88, s80, 1
  s_lshl_b32 s81, s88, 16
  s_bfe_u32 s82, s80, 0x10001
  s_sub_u32 s79, 0, s82
  s_add_u32 s89, s81, s86
  s_mul_i32 s27, s88, 0x18000
  s_add_u32 s90, s27, s64
  s_add_u32 s87, s27, s65
  s_add_u32 s67, s27, s66
  s_cmp_lg_u32 s24, 0
  s_cbranch_scc1 CV_loc
  buffer_load_dwordx4 v[24:27], v4, s[8:11], s89 offen offset:0 sc1
  buffer_load_dwordx4 v[28:31], v4, s[8:11], s89 offen offset:1024 sc1
  buffer_load_dwordx4 v[32:35], v4, s[8:11], s89 offen offset:2048 sc1
  buffer_load_dwordx4 v[48:51], v2, s[8:11], s90 offen sc1
  buffer_load_dwordx4 v[52:55], v2, s[8:11], s87 offen sc1
  buffer_load_dwordx4 v[56:59], v2, s[8:11], s67 offen sc1
  s_waitcnt vmcnt(4)
  v_bitop3_b32 v60, v24, v28, s79 bitop3:0x7e
  s_waitcnt vmcnt(3)
  v_bitop3_b32 v60, v60, v32, s79 bitop3:0xf6
  v_and_b32 v60, 1, v60
  v_cmp_ne_u32 vcc, 0, v60
  s_cbranch_vccnz CV_loc
  s_branch CV_x0
CV_loc:
  buffer_load_dwordx4 v[24:27], v4, s[8:11], s89 offen offset:0 sc1
  buffer_load_dwordx4 v[28:31], v4, s[8:11], s89 offen offset:1024 sc1
  buffer_load_dwordx4 v[32:35], v4, s[8:11], s89 offen offset:2048 sc1
  s_add_u32 s26, s26, 1
  s_mov_b32 s39, 82
  s_cmp_gt_u32 s26, 2097152
  s_cbranch_scc1 L_abort
  s_waitcnt vmcnt(1)
  v_bitop3_b32 v60, v24, v28, s79 bitop3:0x7e
  s_waitcnt vmcnt(0)
  v_bitop3_b32 v60, v60, v32, s79 bitop3:0xf6
  v_and_b32 v60, 1, v60
  v_cmp_ne_u32 vcc, 0, v60
  s_cbranch_vccnz CV_loc
  buffer_load_dwordx4 v[48:51], v2, s[8:11], s90 offen sc1
  buffer_load_dwordx4 v[52:55], v2, s[8:11], s87 offen sc1
  buffer_load_dwordx4 v[56:59], v2, s[8:11], s67 offen sc1
CV_x0:
  v_cmp_ge_u32 vcc, s80, v20
  s_cbranch_vccz CV_vo
wp_17:
  buffer_load_dword v20, v19, s[8:11], 0 offen sc1
  s_add_u32 s26, s26, 1
  s_mov_b32 s39, 80
  s_cmp_gt_u32 s26, 2097152
  s_cbranch_scc1 L_abort
  s_waitcnt vmcnt(0)
  v_cmp_ge_u32 vcc, s80, v20
  s_cbranch_vccnz wp_17
CV_vo:
  s_add_u32 s92, s35, 0
  s_add_u32 s93, s35, 40960
  s_add_u32 s94, s35, 81920
  s_add_u32 s95, s35, 122880
  s_add_u32 s35, s35, 1310720
  s_add_u32 s33, s80, 2
  v_cmp_ge_u32 s[98:99], s33, v20
  buffer_load_dwordx4 v[92:95], v2, s[8:11], s92 offen offset:0 sc1
  buffer_load_dwordx4 v[100:103], v2, s[8:11], s92 offen offset:1024 sc1
  buffer_load_dwordx4 v[108:111], v2, s[8:11], s92 offen offset:2048 sc1
  buffer_load_dwordx4 v[96:99], v2, s[8:11], s93 offen offset:0 sc1
  buffer_load_dwordx4 v[104:107], v2, s[8:11], s93 offen offset:1024 sc1
  buffer_load_dwordx4 v[112:115], v2, s[8:11], s93 offen offset:2048 sc1
  v_lshlrev_b32 v36, 16, v24
  v_and_b32 v24, 0xffff0000, v24
  v_lshlrev_b32 v37, 16, v25
  v_and_b32 v25, 0xffff0000, v25
  v_lshlrev_b32 v38, 16, v26
  v_and_b32 v26, 0xffff0000, v26
  v_lshlrev_b32 v39, 16, v27
  v_and_b32 v27, 0xffff0000, v27
  v_lshlrev_b32 v40, 16, v28
  v_and_b32 v28, 0xffff0000, v28
  v_lshlrev_b32 v41, 16, v29
  v_and_b32 v29, 0xffff0000, v29
  v_lshlrev_b32 v42, 16, v30
  v_and_b32 v30, 0xffff0000, v30
  v_lshlrev_b32 v43, 16, v31
  v_and_b32 v31, 0xffff0000, v31
  v_lshlrev_b32 v44, 16, v32
  v_and_b32 v32, 0xffff0000, v32
  v_lshlrev_b32 v45, 16, v33
  v_and_b32 v33, 0xffff0000, v33
  v_lshlrev_b32 v46, 16, v34
  v_and_b32 v34, 0xffff0000, v34
  v_lshlrev_b32 v47, 16, v35
  v_and_b32 v35, 0xffff0000, v35
  s_waitcnt vmcnt(7)
  v_bitop3_b32 v60, v48, v52, s79 bitop3:0x7e
  s_waitcnt vmcnt(6)
  v_bitop3_b32 v60, v60, v56, s79 bitop3:0xf6
  v_and_b32 v60, 1, v60
  v_cmp_ne_u32 vcc, 0, v60
  s_cbranch_vccnz CV_rem
CV_got:
  v_dot2_f32_bf16 v36, v48, s83, v36
  v_dot2_f32_bf16 v24, v48, s84, v24
  v_dot2_f32_bf16 v37, v49, s83, v37
  v_dot2_f32_bf16 v25, v49, s84, v25
  v_dot2_f32_bf16 v38, v50, s83, v38
  v_dot2_f32_bf16 v26, v50, s84, v26
  v_dot2_f32_bf16 v39, v51, s83, v39
  v_dot2_f32_bf16 v27, v51, s84, v27
  v_dot2_f32_bf16 v40, v52, s83, v40
  v_dot2_f32_bf16 v28, v52, s84, v28
  v_dot2_f32_bf16 v41, v53, s83, v41
  v_dot2_f32_bf16 v29, v53, s84, v29
  v_dot2_f32_bf16 v42, v54, s83, v42
  v_dot2_f32_bf16 v30, v54, s84, v30
  v_dot2_f32_bf16 v43, v55, s83, v43
  v_dot2_f32_bf16 v31, v55, s84, v31
  v_cvt_pk_bf16_f32 v24, v36, v24
  v_cvt_pk_bf16_f32 v25, v37, v25
  v_cvt_pk_bf16_f32 v26, v38, v26
  v_cvt_pk_bf16_f32 v27, v39, v27
  ds_write_b128 v5, v[24:27] offset:0
  v_dot2_f32_bf16 v44, v56, s83, v44
  v_dot2_f32_bf16 v32, v56, s84, v32
  v_dot2_f32_bf16 v45, v57, s83, v45
  v_dot2_f32_bf16 v33, v57, s84, v33
  v_dot2_f32_bf16 v46, v58, s83, v46
  v_dot2_f32_bf16 v34, v58, s84, v34
  v_dot2_f32_bf16 v47, v59, s83, v47
  v_dot2_f32_bf16 v35, v59, s84, v35
  v_cvt_pk_bf16_f32 v28, v40, v28
  v_cvt_pk_bf16_f32 v29, v41, v29
  v_cvt_pk_bf16_f32 v30, v42, v30
  v_cvt_pk_bf16_f32 v31, v43, v31
  ds_write_b128 v5, v[28:31] offset:1024
  v_smfmac_f32_16x16x64_bf16 v[64:67], v[24:27], a[0:7], v3
  s_nop 1
  v_cvt_pk_bf16_f32 v32, v44, v32
  v_cvt_pk_bf16_f32 v33, v45, v33
  v_cvt_pk_bf16_f32 v34, v46, v34
  v_cvt_pk_bf16_f32 v35, v47, v35
  ds_write_b128 v5, v[32:35] offset:2048
  v_smfmac_f32_16x16x64_bf16 v[68:71], v[24:27], a[8:15], v3
  v_smfmac_f32_16x16x64_bf16 v[72:75], v[24:27], a[16:23], v3
  s_waitcnt lgkmcnt(0)
  s_barrier
  ds_read_b128 v[36:39], v11 offset:3072
  ds_read_b128 v[40:43], v12 offset:4096
  ds_read_b128 v[44:47], v12 offset:5120
  ds_read_b128 v[48:51], v12 offset:6144
  ds_read_b128 v[52:55], v13 offset:7168
  ds_read_b128 v[56:59], v13 offset:8192
  ds_read_b128 v[60:63], v13 offset:9216
  v_smfmac_f32_16x16x64_bf16 v[64:67], v[28:31], a[24:31], v3
  v_smfmac_f32_16x16x64_bf16 v[68:71], v[28:31], a[32:39], v3
  v_smfmac_f32_16x16x64_bf16 v[72:75], v[28:31], a[40:47], v3
  v_smfmac_f32_16x16x64_bf16 v[64:67], v[32:35], a[48:55], v3
  v_smfmac_f32_16x16x64_bf16 v[68:71], v[32:35], a[56:63], v3
  v_smfmac_f32_16x16x64_bf16 v[72:75], v[32:35], a[64:71], v3
  s_waitcnt lgkmcnt(6)
  v_smfmac_f32_16x16x64_bf16 v[64:67], v[36:39], v[76:83], v3
  ds_read_b128 v[76:79], v7 offset:8192
  v_smfmac_f32_16x16x64_bf16 v[72:75], v[36:39], v[84:91], v3
  ds_read_b128 v[80:83], v7 offset:9216
  v_smfmac_f32_16x16x64_bf16 v[68:71], v[36:39], v[116:123], v3
  ds_read_b128 v[84:87], v7 offset:12288
  s_waitcnt lgkmcnt(6)
  v_smfmac_f32_16x16x64_bf16 v[64:67], v[48:51], v[124:131], v3
  ds_read_b128 v[88:91], v7 offset:13312
  v_smfmac_f32_16x16x64_bf16 v[72:75], v[48:51], v[132:139], v3
  s_mov_b64 exec, s[98:99]
  buffer_load_dword v20, v19, s[8:11], 0 offen sc1
  s_mov_b64 exec, -1
  v_smfmac_f32_16x16x64_bf16 v[64:67], v[40:43], a[72:79], v3
  v_smfmac_f32_16x16x64_bf16 v[68:71], v[40:43], a[80:87], v3
  v_smfmac_f32_16x16x64_bf16 v[72:75], v[40:43], a[88:95], v3
  buffer_load_dwordx4 v[116:119], v2, s[8:11], s94 offen offset:0 sc1
  s_waitcnt lgkmcnt(2)
  v_smfmac_f32_16x16x64_bf16 v[68:71], v[48:51], v[76:83], v3
  ds_read_b128 v[76:79], v7 offset:16384
  s_waitcnt lgkmcnt(1)
  v_smfmac_f32_16x16x64_bf16 v[64:67], v[60:63], v[84:91], v3
  ds_read_b128 v[80:83], v7 offset:17408
  v_smfmac_f32_16x16x64_bf16 v[64:67], v[44:47], a[96:103], v3
  ds_read_b128 v[84:87], v7 offset:14336
  v_smfmac_f32_16x16x64_bf16 v[68:71], v[44:47], a[104:111], v3
  ds_read_b128 v[88:91], v7 offset:15360
  v_smfmac_f32_16x16x64_bf16 v[72:75], v[44:47], a[112:119], v3
  buffer_load_dwordx4 v[124:127], v2, s[8:11], s94 offen offset:1024 sc1
  v_smfmac_f32_16x16x64_bf16 v[64:67], v[52:55], a[120:127], v3
  v_smfmac_f32_16x16x64_bf16 v[68:71], v[52:55], a[128:135], v3
  v_smfmac_f32_16x16x64_bf16 v[72:75], v[52:55], a[136:143], v3
  buffer_load_dwordx4 v[132:135], v2, s[8:11], s94 offen offset:2048 sc1
  v_smfmac_f32_16x16x64_bf16 v[64:67], v[56:59], a[144:151], v3
  s_waitcnt lgkmcnt(2)
  v_smfmac_f32_16x16x64_bf16 v[72:75], v[60:63], v[76:83], v3
  ds_read_b128 v[76:79], v7 offset:18432
  s_waitcnt lgkmcnt(1)
  v_smfmac_f32_16x16x64_bf16 v[68:71], v[60:63], v[84:91], v3
  ds_read_b128 v[80:83], v7 offset:19456
  v_smfmac_f32_16x16x64_bf16 v[68:71], v[56:59], a[152:159], v3
  ds_read_b128 v[84:87], v7 offset:20480
  v_smfmac_f32_16x16x64_bf16 v[72:75], v[56:59], a[160:167], v3
  ds_read_b128 v[88:91], v7 offset:21504
  v_pk_add_f32 v[64:65], v[64:65], v[66:67]
  s_nop 3
  v_pk_add_f32 v[68:69], v[68:69], v[70:71]
  s_nop 0
  v_pk_add_f32 v[72:73], v[72:73], v[74:75]
  v_cvt_pk_bf16_f32 v140, v64, v65
  v_cvt_pk_bf16_f32 v141, v68, v69
  v_cvt_pk_bf16_f32 v142, v72, v73
  ds_write_b64 v8, v[140:141]
  ds_write_b32 v9, v142
  v_mov_b64 v[24:25], 0
  v_mov_b64 v[26:27], 0
  v_mov_b64 v[28:29], 0
  v_mov_b64 v[30:31], 0
  v_mov_b64 v[32:33], 0
  v_mov_b64 v[34:35], 0
  v_mov_b64 v[36:37], 0
  v_mov_b64 v[38:39], 0
  v_mov_b64 v[40:41], 0
  v_mov_b64 v[42:43], 0
  v_mov_b64 v[44:45], 0
  v_mov_b64 v[46:47], 0
  v_mov_b64 v[48:49], 0
  v_mov_b64 v[50:51], 0
  v_mov_b64 v[52:53], 0
  v_mov_b64 v[54:55], 0
  v_mov_b64 v[56:57], 0
  v_mov_b64 v[58:59], 0
  v_mov_b64 v[60:61], 0
  v_mov_b64 v[62:63], 0
  s_waitcnt lgkmcnt(0)
  s_barrier
  ds_read_b64_tr_b16 v[64:65], v10 offset:0
  ds_read_b64_tr_b16 v[66:67], v10 offset:128
  ds_read_b64_tr_b16 v[68:69], v10 offset:1024
  ds_read_b64_tr_b16 v[70:71], v10 offset:1152
  ds_read_b64_tr_b16 v[72:73], v10 offset:2048
  ds_read_b64_tr_b16 v[74:75], v10 offset:2176
  s_mul_i32 s89, s88, 327680
  s_add_u32 s89, s89, 262144
  s_add_u32 s90, s89, s37
  s_lshl_b32 s100, s88, 1
  s_add_u32 s100, s100, s29
  s_lshl_b32 s100, s100, 14
  s_add_u32 s100, s100, 196608
  s_waitcnt lgkmcnt(4)
  v_smfmac_f32_16x16x64_bf16 v[24:27], v[64:67], a[168:175], v3
  buffer_load_dwordx4 v[120:123], v2, s[8:11], s95 offen offset:0 sc1
  v_smfmac_f32_16x16x64_bf16 v[28:31], v[64:67], a[192:199], v3
  s_waitcnt lgkmcnt(2)
  v_smfmac_f32_16x16x64_bf16 v[24:27], v[68:71], a[176:183], v3
  v_smfmac_f32_16x16x64_bf16 v[56:59], v[64:67], v[76:83], v3
  ds_read_b128 v[76:79], v7 offset:24576
  v_smfmac_f32_16x16x64_bf16 v[28:31], v[68:71], a[200:207], v3
  ds_read_b128 v[80:83], v7 offset:25600
  s_waitcnt lgkmcnt(2)
  v_smfmac_f32_16x16x64_bf16 v[24:27], v[72:75], a[184:191], v3
  v_smfmac_f32_16x16x64_bf16 v[28:31], v[72:75], a[208:215], v3
  buffer_load_dwordx4 v[128:131], v2, s[8:11], s95 offen offset:1024 sc1
  v_smfmac_f32_16x16x64_bf16 v[60:63], v[64:67], v[84:91], v3
  ds_read_b128 v[84:87], v7 offset:26624
  v_smfmac_f32_16x16x64_bf16 v[32:35], v[64:67], a[216:223], v3
  ds_read_b128 v[88:91], v7 offset:27648
  v_smfmac_f32_16x16x64_bf16 v[36:39], v[64:67], a[240:247], v3
  buffer_load_dwordx4 v[136:139], v2, s[8:11], s95 offen offset:2048 sc1
  v_smfmac_f32_16x16x64_bf16 v[32:35], v[68:71], a[224:231], v3
  v_add_f32 v24, v24, v26
  v_add_f32 v25, v25, v27
  s_waitcnt lgkmcnt(2)
  v_smfmac_f32_16x16x64_bf16 v[56:59], v[68:71], v[76:83], v3
  ds_read_b128 v[76:79], v7 offset:22528
  v_cvt_pk_bf16_f32 v140, v24, v25
  v_smfmac_f32_16x16x64_bf16 v[36:39], v[68:71], a[248:255], v3
  ds_read_b128 v[80:83], v7 offset:28672
  v_add_f32 v28, v28, v30
  v_smfmac_f32_16x16x64_bf16 v[32:35], v[72:75], a[232:239], v3
  v_add_f32 v29, v29, v31
  v_cvt_pk_bf16_f32 v141, v28, v29
  v_smfmac_f32_16x16x64_bf16 v[36:39], v[72:75], v[152:159], v3
  s_waitcnt lgkmcnt(2)
  v_smfmac_f32_16x16x64_bf16 v[60:63], v[68:71], v[84:91], v3
  ds_read_b128 v[84:87], v7 offset:23552
  v_smfmac_f32_16x16x64_bf16 v[40:43], v[64:67], v[160:167], v3
  ds_read_b128 v[88:91], v7 offset:29696
  v_smfmac_f32_16x16x64_bf16 v[44:47], v[64:67], v[184:191], v3
  v_smfmac_f32_16x16x64_bf16 v[40:43], v[68:71], v[168:175], v3
  v_add_f32 v32, v32, v34
  v_add_f32 v33, v33, v35
  s_waitcnt lgkmcnt(2)
  v_smfmac_f32_16x16x64_bf16 v[56:59], v[72:75], v[76:83], v3
  v_cvt_pk_bf16_f32 v142, v32, v33
  v_add_f32 v36, v36, v38
  v_smfmac_f32_16x16x64_bf16 v[44:47], v[68:71], v[192:199], v3
  v_add_f32 v37, v37, v39
  v_cvt_pk_bf16_f32 v143, v36, v37
  v_smfmac_f32_16x16x64_bf16 v[40:43], v[72:75], v[176:183], v3
  v_permlane32_swap_b32 v140, v142
  v_permlane32_swap_b32 v141, v143
  v_smfmac_f32_16x16x64_bf16 v[44:47], v[72:75], v[200:207], v3
  s_nop 0
  v_permlane16_swap_b32 v140, v141
  v_permlane16_swap_b32 v142, v143
  s_waitcnt lgkmcnt(0)
  v_smfmac_f32_16x16x64_bf16 v[60:63], v[72:75], v[84:91], v3
  v_and_or_b32 v140, v140, -2, s82
  buffer_store_dwordx4 v[140:143], v2, s[8:11], s90 offen offset:0
  v_smfmac_f32_16x16x64_bf16 v[48:51], v[64:67], v[208:215], v3
  v_add_f32 v56, v56, v58
  v_add_f32 v57, v57, v59
  v_smfmac_f32_16x16x64_bf16 v[52:55], v[64:67], v[232:239], v3
  v_cvt_pk_bf16_f32 v148, v56, v57
  v_smfmac_f32_16x16x64_bf16 v[48:51], v[68:71], v[216:223], v3
  v_add_f32 v40, v40, v42
  v_add_f32 v41, v41, v43
  v_smfmac_f32_16x16x64_bf16 v[52:55], v[68:71], v[240:247], v3
  v_cvt_pk_bf16_f32 v144, v40, v41
  v_add_f32 v44, v44, v46
  v_smfmac_f32_16x16x64_bf16 v[48:51], v[72:75], v[224:231], v3
  v_add_f32 v45, v45, v47
  v_cvt_pk_bf16_f32 v145, v44, v45
  v_smfmac_f32_16x16x64_bf16 v[52:55], v[72:75], v[248:255], v3
  v_pk_add_f32 v[60:61], v[60:61], v[62:63]
  v_cvt_pk_bf16_f32 v149, v60, v61
  v_permlane32_swap_b32 v148, v150
  s_nop 0
  v_permlane32_swap_b32 v149, v151
  s_nop 1
  v_permlane16_swap_b32 v148, v149
  v_permlane16_swap_b32 v150, v151
  v_and_or_b32 v148, v148, -2, s82
  s_mov_b32 exec_hi, 0
  buffer_store_dwordx4 v[148:151], v2, s[8:11], s90 offen offset:2048
  s_mov_b32 exec_hi, -1
  v_pk_add_f32 v[48:49], v[48:49], v[50:51]
  v_cvt_pk_bf16_f32 v146, v48, v49
  v_pk_add_f32 v[52:53], v[52:53], v[54:55]
  v_cvt_pk_bf16_f32 v147, v52, v53
  v_permlane32_swap_b32 v144, v146
  s_nop 0
  v_permlane32_swap_b32 v145, v147
  s_nop 1
  v_permlane16_swap_b32 v144, v145
  v_permlane16_swap_b32 v146, v147
  v_and_or_b32 v144, v144, -2, s82
  buffer_store_dwordx4 v[144:147], v2, s[8:11], s90 offen offset:1024
  s_cmp_eq_u32 s80, 63
  s_cbranch_scc1 CV_fin
  v_mov_b64 v[44:45], 0
  v_mov_b64 v[46:47], 0
  buffer_load_dwordx4 v[24:27], v14, s[8:11], s89 offen offset:0 sc1
  buffer_load_dwordx4 v[28:31], v14, s[8:11], s89 offen offset:256 sc1
  buffer_load_dwordx4 v[32:35], v14, s[8:11], s89 offen offset:512 sc1
  s_mov_b32 exec_lo, 0x33333333
  s_mov_b32 exec_hi, 0x33333333
  buffer_load_dwordx4 v[44:47], v16, s[8:11], s100 offen sc1
  s_mov_b64 exec, -1
  buffer_load_dwordx4 v[36:39], v15, s[8:11], s100 offen offset:0 sc1
  buffer_load_dwordx4 v[40:43], v15, s[8:11], s100 offen offset:1024 sc1
  v_mov_b64 v[48:49], 0
  v_mov_b64 v[50:51], 0
  v_mov_b64 v[52:53], 0
  v_mov_b64 v[54:55], 0
  v_mov_b64 v[56:57], 0
  v_mov_b64 v[58:59], 0
  s_add_u32 s33, s80, 1
  s_and_b32 s27, s33, 1
  s_mul_i32 s30, s27, 0x18000
  s_lshl_b32 s27, s27, 16
  s_add_u32 s30, s30, 917504
  s_add_u32 s30, s30, s74
  s_add_u32 s27, s27, s72
  s_add_u32 s27, s27, 65536
  s_bfe_u32 s31, s33, 0x10001
  s_mul_i32 s32, s82, 0x80008000
  s_or_b32 s31, s32, s31
  v_mov_b32 v23, s33
  v_and_b32 v0, s79, v22
CV_pu2:
  s_waitcnt vmcnt(4)
  v_bitop3_b32 v60, v24, v28, s79 bitop3:0x7e
  s_waitcnt vmcnt(3)
  v_bitop3_b32 v60, v60, v32, s79 bitop3:0xf6
  v_and_b32 v60, 1, v60
  v_cmp_ne_u32 vcc, 0, v60
  s_cbranch_vccnz CV_pu
CV_pp2:
  s_waitcnt vmcnt(2)
  v_bitop3_b32 v60, v44, v45, v0 bitop3:0x7e
  v_bitop3_b32 v61, v46, v47, v0 bitop3:0x7e
  s_waitcnt vmcnt(1)
  v_bitop3_b32 v62, v36, v38, s79 bitop3:0x7e
  v_or3_b32 v60, v60, v61, v62
  s_waitcnt vmcnt(0)
  v_bitop3_b32 v61, v40, v42, s79 bitop3:0x7e
  v_bitop3_b32 v60, v60, v61, s77 bitop3:0xa8
  v_cmp_ne_u32 vcc, 0, v60
  s_cbranch_vccnz CV_pp
CV_go:
  v_mfma_f32_16x16x32_bf16 v[48:51], v[44:47], v[24:27], v[48:51]
  v_mfma_f32_16x16x32_bf16 v[52:55], v[44:47], v[28:31], v[52:55]
  v_mfma_f32_16x16x32_bf16 v[56:59], v[44:47], v[32:35], v[56:59]
  v_smfmac_f32_16x16x64_bf16 v[48:51], v[36:39], v[92:99], v3
  v_smfmac_f32_16x16x64_bf16 v[52:55], v[36:39], v[100:107], v3
  v_smfmac_f32_16x16x64_bf16 v[56:59], v[36:39], v[108:115], v3
  v_smfmac_f32_16x16x64_bf16 v[48:51], v[40:43], v[116:123], v3
  v_smfmac_f32_16x16x64_bf16 v[52:55], v[40:43], v[124:131], v3
  v_smfmac_f32_16x16x64_bf16 v[56:59], v[40:43], v[132:139], v3
  s_mov_b64 exec, s[96:97]
  buffer_store_dword v23, off, s[8:11], s91
  s_mov_b64 exec, -1
  s_nop 2
  v_pk_add_f32 v[48:49], v[48:49], v[50:51]
  ds_write2_b32 v17, v48, v49 offset0:0 offset1:48
  v_pk_add_f32 v[52:53], v[52:53], v[54:55]
  ds_write2_b32 v17, v52, v53 offset0:16 offset1:64
  v_pk_add_f32 v[56:57], v[56:57], v[58:59]
  ds_write2_b32 v17, v56, v57 offset0:32 offset1:80
  s_cmp_lg_u32 s24, 0
  s_waitcnt lgkmcnt(0)
  s_barrier
  s_cbranch_scc1 CV_post
  ds_read_b128 v[24:27], v18 offset:0
  ds_read_b128 v[28:31], v18 offset:16
  ds_read_b128 v[32:35], v18 offset:1536
  ds_read_b128 v[36:39], v18 offset:1552
  ds_read_b128 v[40:43], v18 offset:3072
  ds_read_b128 v[44:47], v18 offset:3088
  ds_read_b128 v[48:51], v18 offset:4608
  ds_read_b128 v[52:55], v18 offset:4624
  s_waitcnt lgkmcnt(4)
  v_pk_add_f32 v[24:25], v[24:25], v[32:33]
  v_pk_add_f32 v[26:27], v[26:27], v[34:35]
  v_pk_add_f32 v[28:29], v[28:29], v[36:37]
  v_pk_add_f32 v[30:31], v[30:31], v[38:39]
  s_waitcnt lgkmcnt(2)
  v_pk_add_f32 v[24:25], v[24:25], v[40:41]
  v_pk_add_f32 v[26:27], v[26:27], v[42:43]
  v_pk_add_f32 v[28:29], v[28:29], v[44:45]
  v_pk_add_f32 v[30:31], v[30:31], v[46:47]
  s_waitcnt lgkmcnt(0)
  v_pk_add_f32 v[24:25], v[24:25], v[48:49]
  v_pk_add_f32 v[26:27], v[26:27], v[50:51]
  v_pk_add_f32 v[28:29], v[28:29], v[52:53]
  v_pk_add_f32 v[30:31], v[30:31], v[54:55]
  v_cvt_pk_bf16_f32 v32, v24, v25
  v_cvt_pk_bf16_f32 v33, v26, v27
  v_cvt_pk_bf16_f32 v34, v28, v29
  v_cvt_pk_bf16_f32 v35, v30, v31
  v_bitop3_b32 v32, v32, s31, 1 bitop3:0x9c
  v_xor_b32 v33, s32, v33
  v_xor_b32 v34, s32, v34
  v_xor_b32 v35, s32, v35
  s_mov_b32 exec_lo, s73
  s_mov_b32 exec_hi, 0xffff
  buffer_store_dwordx4 v[32:35], v2, s[8:11], s27 offen
  buffer_store_dwordx4 v[32:35], v6, s[8:11], s30 offen sc1
  s_mov_b64 exec, -1
CV_post:
  ds_read_b128 v[76:79], v7 offset:0
  ds_read_b128 v[80:83], v7 offset:1024
  ds_read_b128 v[84:87], v7 offset:4096
  ds_read_b128 v[88:91], v7 offset:5120
  ds_read_b128 v[116:119], v7 offset:2048
  ds_read_b128 v[120:123], v7 offset:3072
  ds_read_b128 v[124:127], v7 offset:6144
  ds_read_b128 v[128:131], v7 offset:7168
  ds_read_b128 v[132:135], v7 offset:10240
  ds_read_b128 v[136:139], v7 offset:11264
  v_mov_b64 v[64:65], 0
  v_mov_b64 v[66:67], 0
  v_mov_b64 v[68:69], 0
  v_mov_b64 v[70:71], 0
  v_mov_b64 v[72:73], 0
  v_mov_b64 v[74:75], 0
  s_waitcnt lgkmcnt(0)
  s_add_u32 s80, s80, 1
  s_branch CV_step
CV_rem:
  buffer_load_dwordx4 v[48:51], v2, s[8:11], s90 offen sc1
  buffer_load_dwordx4 v[52:55], v2, s[8:11], s87 offen sc1
  buffer_load_dwordx4 v[56:59], v2, s[8:11], s67 offen sc1
  s_add_u32 s26, s26, 1
  s_mov_b32 s39, 83
  s_cmp_gt_u32 s26, 2097152
  s_cbranch_scc1 L_abort
  s_waitcnt vmcnt(1)
  v_bitop3_b32 v60, v48, v52, s79 bitop3:0x7e
  s_waitcnt vmcnt(0)
  v_bitop3_b32 v60, v60, v56, s79 bitop3:0xf6
  v_and_b32 v60, 1, v60
  v_cmp_ne_u32 vcc, 0, v60
  s_cbranch_vccnz CV_rem
  s_branch CV_got
CV_pu:
  buffer_load_dwordx4 v[24:27], v14, s[8:11], s89 offen offset:0 sc1
  buffer_load_dwordx4 v[28:31], v14, s[8:11], s89 offen offset:256 sc1
  buffer_load_dwordx4 v[32:35], v14, s[8:11], s89 offen offset:512 sc1
  s_mov_b32 exec_lo, 0x33333333
  s_mov_b32 exec_hi, 0x33333333
  buffer_load_dwordx4 v[44:47], v16, s[8:11], s100 offen sc1
  s_mov_b64 exec, -1
  buffer_load_dwordx4 v[36:39], v15, s[8:11], s100 offen offset:0 sc1
  buffer_load_dwordx4 v[40:43], v15, s[8:11], s100 offen offset:1024 sc1
  s_add_u32 s26, s26, 1
  s_mov_b32 s39, 84
  s_cmp_gt_u32 s26, 2097152
  s_cbranch_scc1 L_abort
  s_branch CV_pu2
CV_uu:
  buffer_load_dwordx4 v[24:27], v14, s[8:11], s89 offen offset:0 sc1
  buffer_load_dwordx4 v[28:31], v14, s[8:11], s89 offen offset:256 sc1
  buffer_load_dwordx4 v[32:35], v14, s[8:11], s89 offen offset:512 sc1
  s_add_u32 s26, s26, 1
  s_mov_b32 s39, 86
  s_cmp_gt_u32 s26, 2097152
  s_cbranch_scc1 L_abort
  s_branch CV_pu
CV_pp:
  s_mov_b32 exec_lo, 0x33333333
  s_mov_b32 exec_hi, 0x33333333
  buffer_load_dwordx4 v[44:47], v16, s[8:11], s100 offen sc1
  s_mov_b64 exec, -1
  buffer_load_dwordx4 v[36:39], v15, s[8:11], s100 offen offset:0 sc1
  buffer_load_dwordx4 v[40:43], v15, s[8:11], s100 offen offset:1024 sc1
  s_add_u32 s26, s26, 1
  s_mov_b32 s39, 85
  s_cmp_gt_u32 s26, 2097152
  s_cbranch_scc1 L_abort
  s_branch CV_pp2
CV_fin:
  s_endpgm
CVS_step:
  s_and_b32 s88, s80, 1
  s_lshl_b32 s81, s88, 16
  s_bfe_u32 s82, s80, 0x10001
  s_sub_u32 s79, 0, s82
  s_add_u32 s89, s81, s86
  s_mul_i32 s27, s88, 0x18000
  s_add_u32 s90, s27, s64
  s_add_u32 s87, s27, s65
  s_add_u32 s67, s27, s66
  s_cmp_lg_u32 s24, 0
  s_cbranch_scc1 CVS_loc
  buffer_load_dwordx4 v[24:27], v4, s[8:11], s89 offen offset:0 sc1
  buffer_load_dwordx4 v[28:31], v4, s[8:11], s89 offen offset:1024 sc1
  buffer_load_dwordx4 v[32:35], v4, s[8:11], s89 offen offset:2048 sc1
  buffer_load_dwordx4 v[48:51], v2, s[8:11], s90 offen sc1
  buffer_load_dwordx4 v[52:55], v2, s[8:11], s87 offen sc1
  buffer_load_dwordx4 v[56:59], v2, s[8:11], s67 offen sc1
  s_waitcnt vmcnt(4)
  v_bitop3_b32 v60, v24, v28, s79 bitop3:0x7e
  s_waitcnt vmcnt(3)
  v_bitop3_b32 v60, v60, v32, s79 bitop3:0xf6
  v_and_b32 v60, 1, v60
  v_cmp_ne_u32 vcc, 0, v60
  s_cbranch_vccnz CVS_loc
  s_branch CVS_x0
CVS_loc:
  buffer_load_dwordx4 v[24:27], v4, s[8:11], s89 offen offset:0 sc1
  buffer_load_dwordx4 v[28:31], v4, s[8:11], s89 offen offset:1024 sc1
  buffer_load_dwordx4 v[32:35], v4, s[8:11], s89 offen offset:2048 sc1
  s_add_u32 s26, s26, 1
  s_mov_b32 s39, 82
  s_cmp_gt_u32 s26, 2097152
  s_cbranch_scc1 L_abort
  s_waitcnt vmcnt(1)
  v_bitop3_b32 v60, v24, v28, s79 bitop3:0x7e
  s_waitcnt vmcnt(0)
  v_bitop3_b32 v60, v60, v32, s79 bitop3:0xf6
  v_and_b32 v60, 1, v60
  v_cmp_ne_u32 vcc, 0, v60
  s_cbranch_vccnz CVS_loc
  buffer_load_dwordx4 v[48:51], v2, s[8:11], s90 offen sc1
  buffer_load_dwordx4 v[52:55], v2, s[8:11], s87 offen sc1
  buffer_load_dwordx4 v[56:59], v2, s[8:11], s67 offen sc1
CVS_x0:
  v_cmp_ge_u32 vcc, s80, v20
  s_cbranch_vccz CVS_vo
wp_19:
  buffer_load_dword v20, v19, s[8:11], 0 offen sc1
  s_add_u32 s26, s26, 1
  s_mov_b32 s39, 80
  s_cmp_gt_u32 s26, 2097152
  s_cbranch_scc1 L_abort
  s_waitcnt vmcnt(0)
  v_cmp_ge_u32 vcc, s80, v20
  s_cbranch_vccnz wp_19
CVS_vo:
  s_add_u32 s92, s35, 0
  s_add_u32 s93, s35, 40960
  s_add_u32 s94, s35, 81920
  s_add_u32 s95, s35, 122880
  s_add_u32 s35, s35, 1310720
  s_add_u32 s33, s80, 2
  v_cmp_ge_u32 s[98:99], s33, v20
  buffer_load_dwordx4 v[92:95], v2, s[8:11], s92 offen offset:0 sc1
  buffer_load_dwordx4 v[100:103], v2, s[8:11], s92 offen offset:1024 sc1
  buffer_load_dwordx4 v[108:111], v2, s[8:11], s92 offen offset:2048 sc1
  buffer_load_dwordx4 v[96:99], v2, s[8:11], s93 offen offset:0 sc1
  buffer_load_dwordx4 v[104:107], v2, s[8:11], s93 offen offset:1024 sc1
  buffer_load_dwordx4 v[112:115], v2, s[8:11], s93 offen offset:2048 sc1
  v_lshlrev_b32 v36, 16, v24
  v_and_b32 v24, 0xffff0000, v24
  v_lshlrev_b32 v37, 16, v25
  v_and_b32 v25, 0xffff0000, v25
  v_lshlrev_b32 v38, 16, v26
  v_and_b32 v26, 0xffff0000, v26
  v_lshlrev_b32 v39, 16, v27
  v_and_b32 v27, 0xffff0000, v27
  v_lshlrev_b32 v40, 16, v28
  v_and_b32 v28, 0xffff0000, v28
  v_lshlrev_b32 v41, 16, v29
  v_and_b32 v29, 0xffff0000, v29
  v_lshlrev_b32 v42, 16, v30
  v_and_b32 v30, 0xffff0000, v30
  v_lshlrev_b32 v43, 16, v31
  v_and_b32 v31, 0xffff0000, v31
  v_lshlrev_b32 v44, 16, v32
  v_and_b32 v32, 0xffff0000, v32
  v_lshlrev_b32 v45, 16, v33
  v_and_b32 v33, 0xffff0000, v33
  v_lshlrev_b32 v46, 16, v34
  v_and_b32 v34, 0xffff0000, v34
  v_lshlrev_b32 v47, 16, v35
  v_and_b32 v35, 0xffff0000, v35
  s_waitcnt vmcnt(7)
  v_bitop3_b32 v60, v48, v52, s79 bitop3:0x7e
  s_waitcnt vmcnt(6)
  v_bitop3_b32 v60, v60, v56, s79 bitop3:0xf6
  v_and_b32 v60, 1, v60
  v_cmp_ne_u32 vcc, 0, v60
  s_cbranch_vccnz CVS_rem
CVS_got:
  v_dot2_f32_bf16 v36, v48, s83, v36
  v_dot2_f32_bf16 v24, v48, s84, v24
  v_dot2_f32_bf16 v37, v49, s83, v37
  v_dot2_f32_bf16 v25, v49, s84, v25
  v_dot2_f32_bf16 v38, v50, s83, v38
  v_dot2_f32_bf16 v26, v50, s84, v26
  v_dot2_f32_bf16 v39, v51, s83, v39
  v_dot2_f32_bf16 v27, v51, s84, v27
  v_dot2_f32_bf16 v40, v52, s83, v40
  v_dot2_f32_bf16 v28, v52, s84, v28
  v_dot2_f32_bf16 v41, v53, s83, v41
  v_dot2_f32_bf16 v29, v53, s84, v29
  v_dot2_f32_bf16 v42, v54, s83, v42
  v_dot2_f32_bf16 v30, v54, s84, v30
  v_dot2_f32_bf16 v43, v55, s83, v43
  v_dot2_f32_bf16 v31, v55, s84, v31
  v_cvt_pk_bf16_f32 v24, v36, v24
  v_cvt_pk_bf16_f32 v25, v37, v25
  v_cvt_pk_bf16_f32 v26, v38, v26
  v_cvt_pk_bf16_f32 v27, v39, v27
  ds_write_b128 v5, v[24:27] offset:0
  v_dot2_f32_bf16 v44, v56, s83, v44
  v_dot2_f32_bf16 v32, v56, s84, v32
  v_dot2_f32_bf16 v45, v57, s83, v45
  v_dot2_f32_bf16 v33, v57, s84, v33
  v_dot2_f32_bf16 v46, v58, s83, v46
  v_dot2_f32_bf16 v34, v58, s84, v34
  v_dot2_f32_bf16 v47, v59, s83, v47
  v_dot2_f32_bf16 v35, v59, s84, v35
  v_cvt_pk_bf16_f32 v28, v40, v28
  v_cvt_pk_bf16_f32 v29, v41, v29
  v_cvt_pk_bf16_f32 v30, v42, v30
  v_cvt_pk_bf16_f32 v31, v43, v31
  ds_write_b128 v5, v[28:31] offset:1024
  v_smfmac_f32_16x16x64_bf16 v[64:67], v[24:27], a[0:7], v3
  s_nop 1
  v_cvt_pk_bf16_f32 v32, v44, v32
  v_cvt_pk_bf16_f32 v33, v45, v33
  v_cvt_pk_bf16_f32 v34, v46, v34
  v_cvt_pk_bf16_f32 v35, v47, v35
  ds_write_b128 v5, v[32:35] offset:2048
  v_smfmac_f32_16x16x64_bf16 v[68:71], v[24:27], a[8:15], v3
  v_smfmac_f32_16x16x64_bf16 v[72:75], v[24:27], a[16:23], v3
  s_waitcnt lgkmcnt(0)
  s_barrier
  ds_read_b128 v[36:39], v11 offset:3072
  ds_read_b128 v[40:43], v12 offset:4096
  ds_read_b128 v[44:47], v12 offset:5120
  ds_read_b128 v[48:51], v12 offset:6144
  ds_read_b128 v[52:55], v13 offset:7168
  ds_read_b128 v[56:59], v13 offset:8192
  ds_read_b128 v[60:63], v13 offset:9216
  v_smfmac_f32_16x16x64_bf16 v[64:67], v[28:31], a[24:31], v3
  v_smfmac_f32_16x16x64_bf16 v[68:71], v[28:31], a[32:39], v3
  v_smfmac_f32_16x16x64_bf16 v[72:75], v[28:31], a[40:47], v3
  v_smfmac_f32_16x16x64_bf16 v[64:67], v[32:35], a[48:55], v3
  v_smfmac_f32_16x16x64_bf16 v[68:71], v[32:35], a[56:63], v3
  v_smfmac_f32_16x16x64_bf16 v[72:75], v[32:35], a[64:71], v3
  s_waitcnt lgkmcnt(6)
  v_smfmac_f32_16x16x64_bf16 v[64:67], v[36:39], v[76:83], v3
  ds_read_b128 v[76:79], v7 offset:8192
  v_smfmac_f32_16x16x64_bf16 v[72:75], v[36:39], v[84:91], v3
  ds_read_b128 v[80:83], v7 offset:9216
  v_smfmac_f32_16x16x64_bf16 v[68:71], v[36:39], v[116:123], v3
  ds_read_b128 v[84:87], v7 offset:12288
  s_waitcnt lgkmcnt(6)
  v_smfmac_f32_16x16x64_bf16 v[64:67], v[48:51], v[124:131], v3
  ds_read_b128 v[88:91], v7 offset:13312
  v_smfmac_f32_16x16x64_bf16 v[72:75], v[48:51], v[132:139], v3
  s_mov_b64 exec, s[98:99]
  buffer_load_dword v20, v19, s[8:11], 0 offen sc1
  s_mov_b64 exec, -1
  v_smfmac_f32_16x16x64_bf16 v[64:67], v[40:43], a[72:79], v3
  v_smfmac_f32_16x16x64_bf16 v[68:71], v[40:43], a[80:87], v3
  v_smfmac_f32_16x16x64_bf16 v[72:75], v[40:43], a[88:95], v3
  buffer_load_dwordx4 v[116:119], v2, s[8:11], s94 offen offset:0 sc1
  s_waitcnt lgkmcnt(2)
  v_smfmac_f32_16x16x64_bf16 v[68:71], v[48:51], v[76:83], v3
  ds_read_b128 v[76:79], v7 offset:16384
  s_waitcnt lgkmcnt(1)
  v_smfmac_f32_16x16x64_bf16 v[64:67], v[60:63], v[84:91], v3
  ds_read_b128 v[80:83], v7 offset:17408
  v_smfmac_f32_16x16x64_bf16 v[64:67], v[44:47], a[96:103], v3
  ds_read_b128 v[84:87], v7 offset:14336
  v_smfmac_f32_16x16x64_bf16 v[68:71], v[44:47], a[104:111], v3
  ds_read_b128 v[88:91], v7 offset:15360
  v_smfmac_f32_16x16x64_bf16 v[72:75], v[44:47], a[112:119], v3
  buffer_load_dwordx4 v[124:127], v2, s[8:11], s94 offen offset:1024 sc1
  v_smfmac_f32_16x16x64_bf16 v[64:67], v[52:55], a[120:127], v3
  v_smfmac_f32_16x16x64_bf16 v[68:71], v[52:55], a[128:135], v3
  v_smfmac_f32_16x16x64_bf16 v[72:75], v[52:55], a[136:143], v3
  buffer_load_dwordx4 v[132:135], v2, s[8:11], s94 offen offset:2048 sc1
  v_smfmac_f32_16x16x64_bf16 v[64:67], v[56:59], a[144:151], v3
  s_waitcnt lgkmcnt(2)
  v_smfmac_f32_16x16x64_bf16 v[72:75], v[60:63], v[76:83], v3
  ds_read_b128 v[76:79], v7 offset:18432
  s_waitcnt lgkmcnt(1)
  v_smfmac_f32_16x16x64_bf16 v[68:71], v[60:63], v[84:91], v3
  ds_read_b128 v[80:83], v7 offset:19456
  v_smfmac_f32_16x16x64_bf16 v[68:71], v[56:59], a[152:159], v3
  ds_read_b128 v[84:87], v7 offset:20480
  v_smfmac_f32_16x16x64_bf16 v[72:75], v[56:59], a[160:167], v3
  ds_read_b128 v[88:91], v7 offset:21504
  v_pk_add_f32 v[64:65], v[64:65], v[66:67]
  s_nop 3
  v_pk_add_f32 v[68:69], v[68:69], v[70:71]
  s_nop 0
  v_pk_add_f32 v[72:73], v[72:73], v[74:75]
  v_cvt_pk_bf16_f32 v140, v64, v65
  v_cvt_pk_bf16_f32 v141, v68, v69
  v_cvt_pk_bf16_f32 v142, v72, v73
  ds_write_b64 v8, v[140:141]
  ds_write_b32 v9, v142
  v_mov_b64 v[24:25], 0
  v_mov_b64 v[26:27], 0
  v_mov_b64 v[28:29], 0
  v_mov_b64 v[30:31], 0
  v_mov_b64 v[32:33], 0
  v_mov_b64 v[34:35], 0
  v_mov_b64 v[36:37], 0
  v_mov_b64 v[38:39], 0
  v_mov_b64 v[40:41], 0
  v_mov_b64 v[42:43], 0
  v_mov_b64 v[44:45], 0
  v_mov_b64 v[46:47], 0
  v_mov_b64 v[48:49], 0
  v_mov_b64 v[50:51], 0
  v_mov_b64 v[52:53], 0
  v_mov_b64 v[54:55], 0
  v_mov_b64 v[56:57], 0
  v_mov_b64 v[58:59], 0
  v_mov_b64 v[60:61], 0
  v_mov_b64 v[62:63], 0
  s_waitcnt lgkmcnt(0)
  s_barrier
  ds_read_b64_tr_b16 v[64:65], v10 offset:0
  ds_read_b64_tr_b16 v[66:67], v10 offset:128
  ds_read_b64_tr_b16 v[68:69], v10 offset:1024
  ds_read_b64_tr_b16 v[70:71], v10 offset:1152
  ds_read_b64_tr_b16 v[72:73], v10 offset:2048
  ds_read_b64_tr_b16 v[74:75], v10 offset:2176
  s_mul_i32 s89, s88, 327680
  s_add_u32 s89, s89, 262144
  s_add_u32 s90, s89, s37
  s_lshl_b32 s100, s88, 1
  s_add_u32 s100, s100, s29
  s_lshl_b32 s100, s100, 14
  s_add_u32 s100, s100, 196608
  s_waitcnt lgkmcnt(4)
  v_smfmac_f32_16x16x64_bf16 v[24:27], v[64:67], a[168:175], v3
  buffer_load_dwordx4 v[120:123], v2, s[8:11], s95 offen offset:0 sc1
  v_smfmac_f32_16x16x64_bf16 v[28:31], v[64:67], a[192:199], v3
  s_waitcnt lgkmcnt(2)
  v_smfmac_f32_16x16x64_bf16 v[24:27], v[68:71], a[176:183], v3
  v_smfmac_f32_16x16x64_bf16 v[56:59], v[64:67], v[76:83], v3
  ds_read_b128 v[76:79], v7 offset:24576
  v_smfmac_f32_16x16x64_bf16 v[28:31], v[68:71], a[200:207], v3
  ds_read_b128 v[80:83], v7 offset:25600
  s_waitcnt lgkmcnt(2)
  v_smfmac_f32_16x16x64_bf16 v[24:27], v[72:75], a[184:191], v3
  v_smfmac_f32_16x16x64_bf16 v[28:31], v[72:75], a[208:215], v3
  buffer_load_dwordx4 v[128:131], v2, s[8:11], s95 offen offset:1024 sc1
  v_smfmac_f32_16x16x64_bf16 v[60:63], v[64:67], v[84:91], v3
  ds_read_b128 v[84:87], v7 offset:26624
  v_smfmac_f32_16x16x64_bf16 v[32:35], v[64:67], a[216:223], v3
  ds_read_b128 v[88:91], v7 offset:27648
  v_smfmac_f32_16x16x64_bf16 v[36:39], v[64:67], a[240:247], v3
  buffer_load_dwordx4 v[136:139], v2, s[8:11], s95 offen offset:2048 sc1
  v_smfmac_f32_16x16x64_bf16 v[32:35], v[68:71], a[224:231], v3
  v_add_f32 v24, v24, v26
  v_add_f32 v25, v25, v27
  s_waitcnt lgkmcnt(2)
  v_smfmac_f32_16x16x64_bf16 v[56:59], v[68:71], v[76:83], v3
  ds_read_b128 v[76:79], v7 offset:22528
  v_cvt_pk_bf16_f32 v140, v24, v25
  v_smfmac_f32_16x16x64_bf16 v[36:39], v[68:71], a[248:255], v3
  ds_read_b128 v[80:83], v7 offset:28672
  v_add_f32 v28, v28, v30
  v_smfmac_f32_16x16x64_bf16 v[32:35], v[72:75], a[232:239], v3
  v_add_f32 v29, v29, v31
  v_cvt_pk_bf16_f32 v141, v28, v29
  v_smfmac_f32_16x16x64_bf16 v[36:39], v[72:75], v[152:159], v3
  s_waitcnt lgkmcnt(2)
  v_smfmac_f32_16x16x64_bf16 v[60:63], v[68:71], v[84:91], v3
  ds_read_b128 v[84:87], v7 offset:23552
  v_smfmac_f32_16x16x64_bf16 v[40:43], v[64:67], v[160:167], v3
  ds_read_b128 v[88:91], v7 offset:29696
  v_smfmac_f32_16x16x64_bf16 v[44:47], v[64:67], v[184:191], v3
  v_smfmac_f32_16x16x64_bf16 v[40:43], v[68:71], v[168:175], v3
  v_add_f32 v32, v32, v34
  v_add_f32 v33, v33, v35
  s_waitcnt lgkmcnt(2)
  v_smfmac_f32_16x16x64_bf16 v[56:59], v[72:75], v[76:83], v3
  v_cvt_pk_bf16_f32 v142, v32, v33
  v_add_f32 v36, v36, v38
  v_smfmac_f32_16x16x64_bf16 v[44:47], v[68:71], v[192:199], v3
  v_add_f32 v37, v37, v39
  v_cvt_pk_bf16_f32 v143, v36, v37
  v_smfmac_f32_16x16x64_bf16 v[40:43], v[72:75], v[176:183], v3
  v_permlane32_swap_b32 v140, v142
  v_permlane32_swap_b32 v141, v143
  v_smfmac_f32_16x16x64_bf16 v[44:47], v[72:75], v[200:207], v3
  s_nop 0
  v_permlane16_swap_b32 v140, v141
  v_permlane16_swap_b32 v142, v143
  s_waitcnt lgkmcnt(0)
  v_smfmac_f32_16x16x64_bf16 v[60:63], v[72:75], v[84:91], v3
  v_and_or_b32 v140, v140, -2, s82
  buffer_store_dwordx4 v[140:143], v2, s[8:11], s90 offen offset:0 sc1
  v_smfmac_f32_16x16x64_bf16 v[48:51], v[64:67], v[208:215], v3
  v_add_f32 v56, v56, v58
  v_add_f32 v57, v57, v59
  v_smfmac_f32_16x16x64_bf16 v[52:55], v[64:67], v[232:239], v3
  v_cvt_pk_bf16_f32 v148, v56, v57
  v_smfmac_f32_16x16x64_bf16 v[48:51], v[68:71], v[216:223], v3
  v_add_f32 v40, v40, v42
  v_add_f32 v41, v41, v43
  v_smfmac_f32_16x16x64_bf16 v[52:55], v[68:71], v[240:247], v3
  v_cvt_pk_bf16_f32 v144, v40, v41
  v_add_f32 v44, v44, v46
  v_smfmac_f32_16x16x64_bf16 v[48:51], v[72:75], v[224:231], v3
  v_add_f32 v45, v45, v47
  v_cvt_pk_bf16_f32 v145, v44, v45
  v_smfmac_f32_16x16x64_bf16 v[52:55], v[72:75], v[248:255], v3
  v_pk_add_f32 v[60:61], v[60:61], v[62:63]
  v_cvt_pk_bf16_f32 v149, v60, v61
  v_permlane32_swap_b32 v148, v150
  s_nop 0
  v_permlane32_swap_b32 v149, v151
  s_nop 1
  v_permlane16_swap_b32 v148, v149
  v_permlane16_swap_b32 v150, v151
  v_and_or_b32 v148, v148, -2, s82
  s_mov_b32 exec_hi, 0
  buffer_store_dwordx4 v[148:151], v2, s[8:11], s90 offen offset:2048 sc1
  s_mov_b32 exec_hi, -1
  v_pk_add_f32 v[48:49], v[48:49], v[50:51]
  v_cvt_pk_bf16_f32 v146, v48, v49
  v_pk_add_f32 v[52:53], v[52:53], v[54:55]
  v_cvt_pk_bf16_f32 v147, v52, v53
  v_permlane32_swap_b32 v144, v146
  s_nop 0
  v_permlane32_swap_b32 v145, v147
  s_nop 1
  v_permlane16_swap_b32 v144, v145
  v_permlane16_swap_b32 v146, v147
  v_and_or_b32 v144, v144, -2, s82
  buffer_store_dwordx4 v[144:147], v2, s[8:11], s90 offen offset:1024 sc1
  s_cmp_eq_u32 s80, 63
  s_cbranch_scc1 CVS_fin
  v_mov_b64 v[44:45], 0
  v_mov_b64 v[46:47], 0
  buffer_load_dwordx4 v[24:27], v14, s[8:11], s89 offen offset:0 sc1
  buffer_load_dwordx4 v[28:31], v14, s[8:11], s89 offen offset:256 sc1
  buffer_load_dwordx4 v[32:35], v14, s[8:11], s89 offen offset:512 sc1
  s_mov_b32 exec_lo, 0x33333333
  s_mov_b32 exec_hi, 0x33333333
  buffer_load_dwordx4 v[44:47], v16, s[8:11], s100 offen sc1
  s_mov_b64 exec, -1
  buffer_load_dwordx4 v[36:39], v15, s[8:11], s100 offen offset:0 sc1
  buffer_load_dwordx4 v[40:43], v15, s[8:11], s100 offen offset:1024 sc1
  v_mov_b64 v[48:49], 0
  v_mov_b64 v[50:51], 0
  v_mov_b64 v[52:53], 0
  v_mov_b64 v[54:55], 0
  v_mov_b64 v[56:57], 0
  v_mov_b64 v[58:59], 0
  s_add_u32 s33, s80, 1
  s_and_b32 s27, s33, 1
  s_mul_i32 s30, s27, 0x18000
  s_lshl_b32 s27, s27, 16
  s_add_u32 s30, s30, 917504
  s_add_u32 s30, s30, s74
  s_add_u32 s27, s27, s72
  s_add_u32 s27, s27, 65536
  s_bfe_u32 s31, s33, 0x10001
  s_mul_i32 s32, s82, 0x80008000
  s_or_b32 s31, s32, s31
  v_mov_b32 v23, s33
  v_and_b32 v0, s79, v22
CVS_pu2:
  s_waitcnt vmcnt(4)
  v_bitop3_b32 v60, v24, v28, s79 bitop3:0x7e
  s_waitcnt vmcnt(3)
  v_bitop3_b32 v60, v60, v32, s79 bitop3:0xf6
  v_and_b32 v60, 1, v60
  v_cmp_ne_u32 vcc, 0, v60
  s_cbranch_vccnz CVS_pu
CVS_pp2:
  s_waitcnt vmcnt(2)
  v_bitop3_b32 v60, v44, v45, v0 bitop3:0x7e
  v_bitop3_b32 v61, v46, v47, v0 bitop3:0x7e
  s_waitcnt vmcnt(1)
  v_bitop3_b32 v62, v36, v38, s79 bitop3:0x7e
  v_or3_b32 v60, v60, v61, v62
  s_waitcnt vmcnt(0)
  v_bitop3_b32 v61, v40, v42, s79 bitop3:0x7e
  v_bitop3_b32 v60, v60, v61, s77 bitop3:0xa8
  v_cmp_ne_u32 vcc, 0, v60
  s_cbranch_vccnz CVS_pp
CVS_go:
  v_mfma_f32_16x16x32_bf16 v[48:51], v[44:47], v[24:27], v[48:51]
  v_mfma_f32_16x16x32_bf16 v[52:55], v[44:47], v[28:31], v[52:55]
  v_mfma_f32_16x16x32_bf16 v[56:59], v[44:47], v[32:35], v[56:59]
  v_smfmac_f32_16x16x64_bf16 v[48:51], v[36:39], v[92:99], v3
  v_smfmac_f32_16x16x64_bf16 v[52:55], v[36:39], v[100:107], v3
  v_smfmac_f32_16x16x64_bf16 v[56:59], v[36:39], v[108:115], v3
  v_smfmac_f32_16x16x64_bf16 v[48:51], v[40:43], v[116:123], v3
  v_smfmac_f32_16x16x64_bf16 v[52:55], v[40:43], v[124:131], v3
  v_smfmac_f32_16x16x64_bf16 v[56:59], v[40:43], v[132:139], v3
  s_mov_b64 exec, s[96:97]
  buffer_store_dword v23, off, s[8:11], s91 sc1
  s_mov_b64 exec, -1
  s_nop 2
  v_pk_add_f32 v[48:49], v[48:49], v[50:51]
  ds_write2_b32 v17, v48, v49 offset0:0 offset1:48
  v_pk_add_f32 v[52:53], v[52:53], v[54:55]
  ds_write2_b32 v17, v52, v53 offset0:16 offset1:64
  v_pk_add_f32 v[56:57], v[56:57], v[58:59]
  ds_write2_b32 v17, v56, v57 offset0:32 offset1:80
  s_cmp_lg_u32 s24, 0
  s_waitcnt lgkmcnt(0)
  s_barrier
  s_cbranch_scc1 CVS_post
  ds_read_b128 v[24:27], v18 offset:0
  ds_read_b128 v[28:31], v18 offset:16
  ds_read_b128 v[32:35], v18 offset:1536
  ds_read_b128 v[36:39], v18 offset:1552
  ds_read_b128 v[40:43], v18 offset:3072
  ds_read_b128 v[44:47], v18 offset:3088
  ds_read_b128 v[48:51], v18 offset:4608
  ds_read_b128 v[52:55], v18 offset:4624
  s_waitcnt lgkmcnt(4)
  v_pk_add_f32 v[24:25], v[24:25], v[32:33]
  v_pk_add_f32 v[26:27], v[26:27], v[34:35]
  v_pk_add_f32 v[28:29], v[28:29], v[36:37]
  v_pk_add_f32 v[30:31], v[30:31], v[38:39]
  s_waitcnt lgkmcnt(2)
  v_pk_add_f32 v[24:25], v[24:25], v[40:41]
  v_pk_add_f32 v[26:27], v[26:27], v[42:43]
  v_pk_add_f32 v[28:29], v[28:29], v[44:45]
  v_pk_add_f32 v[30:31], v[30:31], v[46:47]
  s_waitcnt lgkmcnt(0)
  v_pk_add_f32 v[24:25], v[24:25], v[48:49]
  v_pk_add_f32 v[26:27], v[26:27], v[50:51]
  v_pk_add_f32 v[28:29], v[28:29], v[52:53]
  v_pk_add_f32 v[30:31], v[30:31], v[54:55]
  v_cvt_pk_bf16_f32 v32, v24, v25
  v_cvt_pk_bf16_f32 v33, v26, v27
  v_cvt_pk_bf16_f32 v34, v28, v29
  v_cvt_pk_bf16_f32 v35, v30, v31
  v_bitop3_b32 v32, v32, s31, 1 bitop3:0x9c
  v_xor_b32 v33, s32, v33
  v_xor_b32 v34, s32, v34
  v_xor_b32 v35, s32, v35
  s_mov_b32 exec_lo, s73
  s_mov_b32 exec_hi, 0xffff
  buffer_store_dwordx4 v[32:35], v2, s[8:11], s27 offen sc1
  buffer_store_dwordx4 v[32:35], v6, s[8:11], s30 offen sc1
  s_mov_b64 exec, -1
CVS_post:
  ds_read_b128 v[76:79], v7 offset:0
  ds_read_b128 v[80:83], v7 offset:1024
  ds_read_b128 v[84:87], v7 offset:4096
  ds_read_b128 v[88:91], v7 offset:5120
  ds_read_b128 v[116:119], v7 offset:2048
  ds_read_b128 v[120:123], v7 offset:3072
  ds_read_b128 v[124:127], v7 offset:6144
  ds_read_b128 v[128:131], v7 offset:7168
  ds_read_b128 v[132:135], v7 offset:10240
  ds_read_b128 v[136:139], v7 offset:11264
  v_mov_b64 v[64:65], 0
  v_mov_b64 v[66:67], 0
  v_mov_b64 v[68:69], 0
  v_mov_b64 v[70:71], 0
  v_mov_b64 v[72:73], 0
  v_mov_b64 v[74:75], 0
  s_waitcnt lgkmcnt(0)
  s_add_u32 s80, s80, 1
  s_branch CVS_step
CVS_rem:
  buffer_load_dwordx4 v[48:51], v2, s[8:11], s90 offen sc1
  buffer_load_dwordx4 v[52:55], v2, s[8:11], s87 offen sc1
  buffer_load_dwordx4 v[56:59], v2, s[8:11], s67 offen sc1
  s_add_u32 s26, s26, 1
  s_mov_b32 s39, 83
  s_cmp_gt_u32 s26, 2097152
  s_cbranch_scc1 L_abort
  s_waitcnt vmcnt(1)
  v_bitop3_b32 v60, v48, v52, s79 bitop3:0x7e
  s_waitcnt vmcnt(0)
  v_bitop3_b32 v60, v60, v56, s79 bitop3:0xf6
  v_and_b32 v60, 1, v60
  v_cmp_ne_u32 vcc, 0, v60
  s_cbranch_vccnz CVS_rem
  s_branch CVS_got
CVS_pu:
  buffer_load_dwordx4 v[24:27], v14, s[8:11], s89 offen offset:0 sc1
  buffer_load_dwordx4 v[28:31], v14, s[8:11], s89 offen offset:256 sc1
  buffer_load_dwordx4 v[32:35], v14, s[8:11], s89 offen offset:512 sc1
  s_mov_b32 exec_lo, 0x33333333
  s_mov_b32 exec_hi, 0x33333333
  buffer_load_dwordx4 v[44:47], v16, s[8:11], s100 offen sc1
  s_mov_b64 exec, -1
  buffer_load_dwordx4 v[36:39], v15, s[8:11], s100 offen offset:0 sc1
  buffer_load_dwordx4 v[40:43], v15, s[8:11], s100 offen offset:1024 sc1
  s_add_u32 s26, s26, 1
  s_mov_b32 s39, 84
  s_cmp_gt_u32 s26, 2097152
  s_cbranch_scc1 L_abort
  s_branch CVS_pu2
CVS_uu:
  buffer_load_dwordx4 v[24:27], v14, s[8:11], s89 offen offset:0 sc1
  buffer_load_dwordx4 v[28:31], v14, s[8:11], s89 offen offset:256 sc1
  buffer_load_dwordx4 v[32:35], v14, s[8:11], s89 offen offset:512 sc1
  s_add_u32 s26, s26, 1
  s_mov_b32 s39, 86
  s_cmp_gt_u32 s26, 2097152
  s_cbranch_scc1 L_abort
  s_branch CVS_pu
CVS_pp:
  s_mov_b32 exec_lo, 0x33333333
  s_mov_b32 exec_hi, 0x33333333
  buffer_load_dwordx4 v[44:47], v16, s[8:11], s100 offen sc1
  s_mov_b64 exec, -1
  buffer_load_dwordx4 v[36:39], v15, s[8:11], s100 offen offset:0 sc1
  buffer_load_dwordx4 v[40:43], v15, s[8:11], s100 offen offset:1024 sc1
  s_add_u32 s26, s26, 1
  s_mov_b32 s39, 85
  s_cmp_gt_u32 s26, 2097152
  s_cbranch_scc1 L_abort
  s_branch CVS_pp2
CVS_fin:
  s_endpgm
L_exit2:
  s_endpgm
WK:
  s_mov_b32 s12, s46
  s_and_b32 s13, s47, 0xffff
  s_mov_b32 s14, 7864320
  s_mov_b32 s15, 0x20000
  s_mov_b32 s30, 12288
  v_add_u32 v68, 0, v1
  s_mov_b32 s27, 43691
  v_mul_lo_u32 v69, v68, s27
  v_lshrrev_b32 v69, 18, v69
  v_mul_u32_u24 v4, 6, v69
  v_sub_u32 v70, v68, v4
  v_mul_lo_u32 v69, v69, s30
  v_lshl_add_u32 v4, v70, 4, v69
  v_add_u32 v68, 64, v1
  s_mov_b32 s27, 43691
  v_mul_lo_u32 v69, v68, s27
  v_lshrrev_b32 v69, 18, v69
  v_mul_u32_u24 v5, 6, v69
  v_sub_u32 v70, v68, v5
  v_mul_lo_u32 v69, v69, s30
  v_lshl_add_u32 v5, v70, 4, v69
  v_add_u32 v68, 128, v1
  s_mov_b32 s27, 43691
  v_mul_lo_u32 v69, v68, s27
  v_lshrrev_b32 v69, 18, v69
  v_mul_u32_u24 v6, 6, v69
  v_sub_u32 v70, v68, v6
  v_mul_lo_u32 v69, v69, s30
  v_lshl_add_u32 v6, v70, 4, v69
  v_add_u32 v68, 192, v1
  s_mov_b32 s27, 43691
  v_mul_lo_u32 v69, v68, s27
  v_lshrrev_b32 v69, 18, v69
  v_mul_u32_u24 v7, 6, v69
  v_sub_u32 v70, v68, v7
  v_mul_lo_u32 v69, v69, s30
  v_lshl_add_u32 v7, v70, 4, v69
  v_add_u32 v68, 256, v1
  s_mov_b32 s27, 43691
  v_mul_lo_u32 v69, v68, s27
  v_lshrrev_b32 v69, 18, v69
  v_mul_u32_u24 v8, 6, v69
  v_sub_u32 v70, v68, v8
  v_mul_lo_u32 v69, v69, s30
  v_lshl_add_u32 v8, v70, 4, v69
  v_add_u32 v68, 320, v1
  s_mov_b32 s27, 43691
  v_mul_lo_u32 v69, v68, s27
  v_lshrrev_b32 v69, 18, v69
  v_mul_u32_u24 v9, 6, v69
  v_sub_u32 v70, v68, v9
  v_mul_lo_u32 v69, v69, s30
  v_lshl_add_u32 v9, v70, 4, v69
  v_bfe_u32 v68, v1, 5, 1
  v_mul_u32_u24 v3, 1536, v68
  v_bfe_u32 v68, v1, 4, 1
  v_mul_u32_u24 v68, 768, v68
  v_add_u32 v3, v3, v68
  v_bfe_u32 v68, v1, 2, 1
  v_mul_u32_u24 v68, 96, v68
  v_add_u32 v3, v3, v68
  v_bfe_u32 v68, v1, 3, 1
  v_mul_u32_u24 v68, 192, v68
  v_add_u32 v3, v3, v68
  v_and_b32 v68, 3, v1
  v_lshl_add_u32 v3, v68, 3, v3
  s_mul_i32 s27, s24, 30720
  v_add_u32 v3, s27, v3
  s_mul_i32 s32, s25, 384
  s_mul_i32 s27, s24, 96
  s_add_u32 s32, s32, s27
  s_mul_i32 s31, s24, 30720
  s_add_u32 m0, s31, 0
  s_add_u32 s27, s32, 0
  buffer_load_dwordx4 v4, s[12:15], s27 offen  lds
  s_add_u32 m0, s31, 1024
  s_add_u32 s27, s32, 0
  buffer_load_dwordx4 v5, s[12:15], s27 offen  lds
  s_add_u32 m0, s31, 2048
  s_add_u32 s27, s32, 0
  buffer_load_dwordx4 v6, s[12:15], s27 offen  lds
  s_add_u32 m0, s31, 3072
  s_add_u32 s27, s32, 0
  buffer_load_dwordx4 v7, s[12:15], s27 offen  lds
  s_add_u32 m0, s31, 4096
  s_add_u32 s27, s32, 0
  buffer_load_dwordx4 v8, s[12:15], s27 offen  lds
  s_add_u32 m0, s31, 5120
  s_add_u32 s27, s32, 0
  buffer_load_dwordx4 v9, s[12:15], s27 offen  lds
  s_add_u32 m0, s31, 6144
  s_add_u32 s27, s32, 786432
  buffer_load_dwordx4 v4, s[12:15], s27 offen  lds
  s_add_u32 m0, s31, 7168
  s_add_u32 s27, s32, 786432
  buffer_load_dwordx4 v5, s[12:15], s27 offen  lds
  s_add_u32 m0, s31, 8192
  s_add_u32 s27, s32, 786432
  buffer_load_dwordx4 v6, s[12:15], s27 offen  lds
  s_add_u32 m0, s31, 9216
  s_add_u32 s27, s32, 786432
  buffer_load_dwordx4 v7, s[12:15], s27 offen  lds
  s_add_u32 m0, s31, 10240
  s_add_u32 s27, s32, 786432
  buffer_load_dwordx4 v8, s[12:15], s27 offen  lds
  s_add_u32 m0, s31, 11264
  s_add_u32 s27, s32, 786432
  buffer_load_dwordx4 v9, s[12:15], s27 offen  lds
  s_add_u32 m0, s31, 12288
  s_add_u32 s27, s32, 1572864
  buffer_load_dwordx4 v4, s[12:15], s27 offen  lds
  s_add_u32 m0, s31, 13312
  s_add_u32 s27, s32, 1572864
  buffer_load_dwordx4 v5, s[12:15], s27 offen  lds
  s_add_u32 m0, s31, 14336
  s_add_u32 s27, s32, 1572864
  buffer_load_dwordx4 v6, s[12:15], s27 offen  lds
  s_add_u32 m0, s31, 15360
  s_add_u32 s27, s32, 1572864
  buffer_load_dwordx4 v7, s[12:15], s27 offen  lds
  s_add_u32 m0, s31, 16384
  s_add_u32 s27, s32, 1572864
  buffer_load_dwordx4 v8, s[12:15], s27 offen  lds
  s_add_u32 m0, s31, 17408
  s_add_u32 s27, s32, 1572864
  buffer_load_dwordx4 v9, s[12:15], s27 offen  lds
  s_add_u32 m0, s31, 18432
  s_add_u32 s27, s32, 2359296
  buffer_load_dwordx4 v4, s[12:15], s27 offen  lds
  s_add_u32 m0, s31, 19456
  s_add_u32 s27, s32, 2359296
  buffer_load_dwordx4 v5, s[12:15], s27 offen  lds
  s_add_u32 m0, s31, 20480
  s_add_u32 s27, s32, 2359296
  buffer_load_dwordx4 v6, s[12:15], s27 offen  lds
  s_add_u32 m0, s31, 21504
  s_add_u32 s27, s32, 2359296
  buffer_load_dwordx4 v7, s[12:15], s27 offen  lds
  s_add_u32 m0, s31, 22528
  s_add_u32 s27, s32, 2359296
  buffer_load_dwordx4 v8, s[12:15], s27 offen  lds
  s_add_u32 m0, s31, 23552
  s_add_u32 s27, s32, 2359296
  buffer_load_dwordx4 v9, s[12:15], s27 offen  lds
  s_add_u32 m0, s31, 24576
  s_add_u32 s27, s32, 3145728
  buffer_load_dwordx4 v4, s[12:15], s27 offen  lds
  s_add_u32 m0, s31, 25600
  s_add_u32 s27, s32, 3145728
  buffer_load_dwordx4 v5, s[12:15], s27 offen  lds
  s_add_u32 m0, s31, 26624
  s_add_u32 s27, s32, 3145728
  buffer_load_dwordx4 v6, s[12:15], s27 offen  lds
  s_add_u32 m0, s31, 27648
  s_add_u32 s27, s32, 3145728
  buffer_load_dwordx4 v7, s[12:15], s27 offen  lds
  s_add_u32 m0, s31, 28672
  s_add_u32 s27, s32, 3145728
  buffer_load_dwordx4 v8, s[12:15], s27 offen  lds
  s_add_u32 m0, s31, 29696
  s_add_u32 s27, s32, 3145728
  buffer_load_dwordx4 v9, s[12:15], s27 offen  lds
  s_waitcnt vmcnt(24)
  ds_read_b64_tr_b16 a[0:1], v3 offset:0
  ds_read_b64_tr_b16 a[2:3], v3 offset:384
  ds_read_b64_tr_b16 a[4:5], v3 offset:3072
  ds_read_b64_tr_b16 a[6:7], v3 offset:3456
  ds_read_b64_tr_b16 a[80:81], v3 offset:32
  ds_read_b64_tr_b16 a[82:83], v3 offset:416
  ds_read_b64_tr_b16 a[84:85], v3 offset:3104
  ds_read_b64_tr_b16 a[86:87], v3 offset:3488
  ds_read_b64_tr_b16 a[160:161], v3 offset:64
  ds_read_b64_tr_b16 a[162:163], v3 offset:448
  ds_read_b64_tr_b16 a[164:165], v3 offset:3136
  ds_read_b64_tr_b16 a[166:167], v3 offset:3520
  s_waitcnt lgkmcnt(0)
  s_add_u32 m0, s31, 0
  s_add_u32 s27, s32, 3932160
  buffer_load_dwordx4 v4, s[12:15], s27 offen  lds
  s_add_u32 m0, s31, 1024
  s_add_u32 s27, s32, 3932160
  buffer_load_dwordx4 v5, s[12:15], s27 offen  lds
  s_add_u32 m0, s31, 2048
  s_add_u32 s27, s32, 3932160
  buffer_load_dwordx4 v6, s[12:15], s27 offen  lds
  s_add_u32 m0, s31, 3072
  s_add_u32 s27, s32, 3932160
  buffer_load_dwordx4 v7, s[12:15], s27 offen  lds
  s_add_u32 m0, s31, 4096
  s_add_u32 s27, s32, 3932160
  buffer_load_dwordx4 v8, s[12:15], s27 offen  lds
  s_add_u32 m0, s31, 5120
  s_add_u32 s27, s32, 3932160
  buffer_load_dwordx4 v9, s[12:15], s27 offen  lds
  s_waitcnt vmcnt(24)
  ds_read_b64_tr_b16 a[8:9], v3 offset:6144
  ds_read_b64_tr_b16 a[10:11], v3 offset:6528
  ds_read_b64_tr_b16 a[12:13], v3 offset:9216
  ds_read_b64_tr_b16 a[14:15], v3 offset:9600
  ds_read_b64_tr_b16 a[88:89], v3 offset:6176
  ds_read_b64_tr_b16 a[90:91], v3 offset:6560
  ds_read_b64_tr_b16 a[92:93], v3 offset:9248
  ds_read_b64_tr_b16 a[94:95], v3 offset:9632
  ds_read_b64_tr_b16 a[168:169], v3 offset:6208
  ds_read_b64_tr_b16 a[170:171], v3 offset:6592
  ds_read_b64_tr_b16 a[172:173], v3 offset:9280
  ds_read_b64_tr_b16 a[174:175], v3 offset:9664
  s_waitcnt lgkmcnt(0)
  s_add_u32 m0, s31, 6144
  s_add_u32 s27, s32, 4718592
  buffer_load_dwordx4 v4, s[12:15], s27 offen  lds
  s_add_u32 m0, s31, 7168
  s_add_u32 s27, s32, 4718592
  buffer_load_dwordx4 v5, s[12:15], s27 offen  lds
  s_add_u32 m0, s31, 8192
  s_add_u32 s27, s32, 4718592
  buffer_load_dwordx4 v6, s[12:15], s27 offen  lds
  s_add_u32 m0, s31, 9216
  s_add_u32 s27, s32, 4718592
  buffer_load_dwordx4 v7, s[12:15], s27 offen  lds
  s_add_u32 m0, s31, 10240
  s_add_u32 s27, s32, 4718592
  buffer_load_dwordx4 v8, s[12:15], s27 offen  lds
  s_add_u32 m0, s31, 11264
  s_add_u32 s27, s32, 4718592
  buffer_load_dwordx4 v9, s[12:15], s27 offen  lds
  s_waitcnt vmcnt(24)
  ds_read_b64_tr_b16 a[16:17], v3 offset:12288
  ds_read_b64_tr_b16 a[18:19], v3 offset:12672
  ds_read_b64_tr_b16 a[20:21], v3 offset:15360
  ds_read_b64_tr_b16 a[22:23], v3 offset:15744
  ds_read_b64_tr_b16 a[96:97], v3 offset:12320
  ds_read_b64_tr_b16 a[98:99], v3 offset:12704
  ds_read_b64_tr_b16 a[100:101], v3 offset:15392
  ds_read_b64_tr_b16 a[102:103], v3 offset:15776
  ds_read_b64_tr_b16 a[176:177], v3 offset:12352
  ds_read_b64_tr_b16 a[178:179], v3 offset:12736
  ds_read_b64_tr_b16 a[180:181], v3 offset:15424
  ds_read_b64_tr_b16 a[182:183], v3 offset:15808
  s_waitcnt lgkmcnt(0)
  s_add_u32 m0, s31, 12288
  s_add_u32 s27, s32, 5505024
  buffer_load_dwordx4 v4, s[12:15], s27 offen  lds
  s_add_u32 m0, s31, 13312
  s_add_u32 s27, s32, 5505024
  buffer_load_dwordx4 v5, s[12:15], s27 offen  lds
  s_add_u32 m0, s31, 14336
  s_add_u32 s27, s32, 5505024
  buffer_load_dwordx4 v6, s[12:15], s27 offen  lds
  s_add_u32 m0, s31, 15360
  s_add_u32 s27, s32, 5505024
  buffer_load_dwordx4 v7, s[12:15], s27 offen  lds
  s_add_u32 m0, s31, 16384
  s_add_u32 s27, s32, 5505024
  buffer_load_dwordx4 v8, s[12:15], s27 offen  lds
  s_add_u32 m0, s31, 17408
  s_add_u32 s27, s32, 5505024
  buffer_load_dwordx4 v9, s[12:15], s27 offen  lds
  s_waitcnt vmcnt(24)
  ds_read_b64_tr_b16 a[24:25], v3 offset:18432
  ds_read_b64_tr_b16 a[26:27], v3 offset:18816
  ds_read_b64_tr_b16 a[28:29], v3 offset:21504
  ds_read_b64_tr_b16 a[30:31], v3 offset:21888
  ds_read_b64_tr_b16 a[104:105], v3 offset:18464
  ds_read_b64_tr_b16 a[106:107], v3 offset:18848
  ds_read_b64_tr_b16 a[108:109], v3 offset:21536
  ds_read_b64_tr_b16 a[110:111], v3 offset:21920
  ds_read_b64_tr_b16 a[184:185], v3 offset:18496
  ds_read_b64_tr_b16 a[186:187], v3 offset:18880
  ds_read_b64_tr_b16 a[188:189], v3 offset:21568
  ds_read_b64_tr_b16 a[190:191], v3 offset:21952
  s_waitcnt lgkmcnt(0)
  s_add_u32 m0, s31, 18432
  s_add_u32 s27, s32, 6291456
  buffer_load_dwordx4 v4, s[12:15], s27 offen  lds
  s_add_u32 m0, s31, 19456
  s_add_u32 s27, s32, 6291456
  buffer_load_dwordx4 v5, s[12:15], s27 offen  lds
  s_add_u32 m0, s31, 20480
  s_add_u32 s27, s32, 6291456
  buffer_load_dwordx4 v6, s[12:15], s27 offen  lds
  s_add_u32 m0, s31, 21504
  s_add_u32 s27, s32, 6291456
  buffer_load_dwordx4 v7, s[12:15], s27 offen  lds
  s_add_u32 m0, s31, 22528
  s_add_u32 s27, s32, 6291456
  buffer_load_dwordx4 v8, s[12:15], s27 offen  lds
  s_add_u32 m0, s31, 23552
  s_add_u32 s27, s32, 6291456
  buffer_load_dwordx4 v9, s[12:15], s27 offen  lds
  s_waitcnt vmcnt(24)
  ds_read_b64_tr_b16 a[32:33], v3 offset:24576
  ds_read_b64_tr_b16 a[34:35], v3 offset:24960
  ds_read_b64_tr_b16 a[36:37], v3 offset:27648
  ds_read_b64_tr_b16 a[38:39], v3 offset:28032
  ds_read_b64_tr_b16 a[112:113], v3 offset:24608
  ds_read_b64_tr_b16 a[114:115], v3 offset:24992
  ds_read_b64_tr_b16 a[116:117], v3 offset:27680
  ds_read_b64_tr_b16 a[118:119], v3 offset:28064
  ds_read_b64_tr_b16 a[192:193], v3 offset:24640
  ds_read_b64_tr_b16 a[194:195], v3 offset:25024
  ds_read_b64_tr_b16 a[196:197], v3 offset:27712
  ds_read_b64_tr_b16 a[198:199], v3 offset:28096
  s_waitcnt lgkmcnt(0)
  s_add_u32 m0, s31, 24576
  s_add_u32 s27, s32, 7077888
  buffer_load_dwordx4 v4, s[12:15], s27 offen  lds
  s_add_u32 m0, s31, 25600
  s_add_u32 s27, s32, 7077888
  buffer_load_dwordx4 v5, s[12:15], s27 offen  lds
  s_add_u32 m0, s31, 26624
  s_add_u32 s27, s32, 7077888
  buffer_load_dwordx4 v6, s[12:15], s27 offen  lds
  s_add_u32 m0, s31, 27648
  s_add_u32 s27, s32, 7077888
  buffer_load_dwordx4 v7, s[12:15], s27 offen  lds
  s_add_u32 m0, s31, 28672
  s_add_u32 s27, s32, 7077888
  buffer_load_dwordx4 v8, s[12:15], s27 offen  lds
  s_add_u32 m0, s31, 29696
  s_add_u32 s27, s32, 7077888
  buffer_load_dwordx4 v9, s[12:15], s27 offen  lds
  s_waitcnt vmcnt(24)
  ds_read_b64_tr_b16 a[40:41], v3 offset:0
  ds_read_b64_tr_b16 a[42:43], v3 offset:384
  ds_read_b64_tr_b16 a[44:45], v3 offset:3072
  ds_read_b64_tr_b16 a[46:47], v3 offset:3456
  ds_read_b64_tr_b16 a[120:121], v3 offset:32
  ds_read_b64_tr_b16 a[122:123], v3 offset:416
  ds_read_b64_tr_b16 a[124:125], v3 offset:3104
  ds_read_b64_tr_b16 a[126:127], v3 offset:3488
  ds_read_b64_tr_b16 a[200:201], v3 offset:64
  ds_read_b64_tr_b16 a[202:203], v3 offset:448
  ds_read_b64_tr_b16 a[204:205], v3 offset:3136
  ds_read_b64_tr_b16 a[206:207], v3 offset:3520
  s_waitcnt lgkmcnt(0)
  s_waitcnt vmcnt(18)
  ds_read_b64_tr_b16 a[48:49], v3 offset:6144
  ds_read_b64_tr_b16 a[50:51], v3 offset:6528
  ds_read_b64_tr_b16 a[52:53], v3 offset:9216
  ds_read_b64_tr_b16 a[54:55], v3 offset:9600
  ds_read_b64_tr_b16 a[128:129], v3 offset:6176
  ds_read_b64_tr_b16 a[130:131], v3 offset:6560
  ds_read_b64_tr_b16 a[132:133], v3 offset:9248
  ds_read_b64_tr_b16 a[134:135], v3 offset:9632
  ds_read_b64_tr_b16 a[208:209], v3 offset:6208
  ds_read_b64_tr_b16 a[210:211], v3 offset:6592
  ds_read_b64_tr_b16 a[212:213], v3 offset:9280
  ds_read_b64_tr_b16 a[214:215], v3 offset:9664
  s_waitcnt lgkmcnt(0)
  s_waitcnt vmcnt(12)
  ds_read_b64_tr_b16 a[56:57], v3 offset:12288
  ds_read_b64_tr_b16 a[58:59], v3 offset:12672
  ds_read_b64_tr_b16 a[60:61], v3 offset:15360
  ds_read_b64_tr_b16 a[62:63], v3 offset:15744
  ds_read_b64_tr_b16 a[136:137], v3 offset:12320
  ds_read_b64_tr_b16 a[138:139], v3 offset:12704
  ds_read_b64_tr_b16 a[140:141], v3 offset:15392
  ds_read_b64_tr_b16 a[142:143], v3 offset:15776
  ds_read_b64_tr_b16 a[216:217], v3 offset:12352
  ds_read_b64_tr_b16 a[218:219], v3 offset:12736
  ds_read_b64_tr_b16 a[220:221], v3 offset:15424
  ds_read_b64_tr_b16 a[222:223], v3 offset:15808
  s_waitcnt lgkmcnt(0)
  s_waitcnt vmcnt(6)
  ds_read_b64_tr_b16 a[64:65], v3 offset:18432
  ds_read_b64_tr_b16 a[66:67], v3 offset:18816
  ds_read_b64_tr_b16 a[68:69], v3 offset:21504
  ds_read_b64_tr_b16 a[70:71], v3 offset:21888
  ds_read_b64_tr_b16 a[144:145], v3 offset:18464
  ds_read_b64_tr_b16 a[146:147], v3 offset:18848
  ds_read_b64_tr_b16 a[148:149], v3 offset:21536
  ds_read_b64_tr_b16 a[150:151], v3 offset:21920
  ds_read_b64_tr_b16 a[224:225], v3 offset:18496
  ds_read_b64_tr_b16 a[226:227], v3 offset:18880
  ds_read_b64_tr_b16 a[228:229], v3 offset:21568
  ds_read_b64_tr_b16 a[230:231], v3 offset:21952
  s_waitcnt lgkmcnt(0)
  s_waitcnt vmcnt(0)
  ds_read_b64_tr_b16 a[72:73], v3 offset:24576
  ds_read_b64_tr_b16 a[74:75], v3 offset:24960
  ds_read_b64_tr_b16 a[76:77], v3 offset:27648
  ds_read_b64_tr_b16 a[78:79], v3 offset:28032
  ds_read_b64_tr_b16 a[152:153], v3 offset:24608
  ds_read_b64_tr_b16 a[154:155], v3 offset:24992
  ds_read_b64_tr_b16 a[156:157], v3 offset:27680
  ds_read_b64_tr_b16 a[158:159], v3 offset:28064
  ds_read_b64_tr_b16 a[232:233], v3 offset:24640
  ds_read_b64_tr_b16 a[234:235], v3 offset:25024
  ds_read_b64_tr_b16 a[236:237], v3 offset:27712
  ds_read_b64_tr_b16 a[238:239], v3 offset:28096
  s_waitcnt lgkmcnt(0)
  s_cmp_lg_u32 s24, 0
  s_cbranch_scc1 wwd_22
ww_21:
  buffer_load_dword v8, off, s[68:71], 0 offset:72 sc1
  s_add_u32 s26, s26, 1
  s_mov_b32 s39, 113
  s_cmp_gt_u32 s26, 2097152
  s_cbranch_scc1 L_abort
  s_waitcnt vmcnt(0)
  v_cmp_gt_u32 vcc, 4, v8
  s_cbranch_vccz wwd_22
  s_sleep 4
  s_branch ww_21
wwd_22:
  s_barrier
  s_barrier
  s_mul_i32 s33, s24, 10240
  v_mov_b32 v14, 0
  s_add_u32 s34, s25, 0
  s_lshl_b32 s34, s34, 7
  s_lshl_b32 s27, s24, 2
  s_add_u32 s34, s34, s27
  s_add_u32 s34, s34, 4096
  s_lshl_b32 s35, s25, 2
  s_add_u32 s35, s35, s24
  s_mul_i32 s35, s35, 3072
  s_add_u32 s35, s35, 42467328
  s_mov_b32 s36, 0
  s_add_u32 s37, s33, 2097152
  s_mov_b32 s38, 0
  s_mov_b32 s73, s33
  s_add_u32 m0, s73, 0
  s_add_u32 s27, s37, 0
  buffer_load_dwordx4 v2, s[8:11], s27 offen offset:0 lds
  buffer_load_dwordx4 v2, s[8:11], s27 offen offset:1024 lds
  buffer_load_dwordx4 v2, s[8:11], s27 offen offset:2048 lds
  buffer_load_dwordx4 v2, s[8:11], s27 offen offset:3072 lds
  s_add_u32 m0, s73, 4096
  s_add_u32 s27, s37, 4096
  buffer_load_dwordx4 v2, s[8:11], s27 offen offset:0 lds
  buffer_load_dwordx4 v2, s[8:11], s27 offen offset:1024 lds
  buffer_load_dwordx4 v2, s[8:11], s27 offen offset:2048 lds
  buffer_load_dwordx4 v2, s[8:11], s27 offen offset:3072 lds
  s_add_u32 m0, s73, 8192
  s_add_u32 s27, s37, 8192
  buffer_load_dwordx4 v2, s[8:11], s27 offen offset:0 lds
  buffer_load_dwordx4 v2, s[8:11], s27 offen offset:1024 lds
  s_add_u32 s37, s37, 40960
  s_add_u32 s73, s33, 40960
  s_add_u32 m0, s73, 0
  s_add_u32 s27, s37, 0
  buffer_load_dwordx4 v2, s[8:11], s27 offen offset:0 lds
  buffer_load_dwordx4 v2, s[8:11], s27 offen offset:1024 lds
  buffer_load_dwordx4 v2, s[8:11], s27 offen offset:2048 lds
  buffer_load_dwordx4 v2, s[8:11], s27 offen offset:3072 lds
  s_add_u32 m0, s73, 4096
  s_add_u32 s27, s37, 4096
  buffer_load_dwordx4 v2, s[8:11], s27 offen offset:0 lds
  buffer_load_dwordx4 v2, s[8:11], s27 offen offset:1024 lds
  buffer_load_dwordx4 v2, s[8:11], s27 offen offset:2048 lds
  buffer_load_dwordx4 v2, s[8:11], s27 offen offset:3072 lds
  s_add_u32 m0, s73, 8192
  s_add_u32 s27, s37, 8192
  buffer_load_dwordx4 v2, s[8:11], s27 offen offset:0 lds
  buffer_load_dwordx4 v2, s[8:11], s27 offen offset:1024 lds
  s_add_u32 s37, s37, 40960
  s_mov_b32 s72, 81920
  s_waitcnt vmcnt(10)
WK_loop:
  s_cmp_lg_u32 s36, 2
  s_cbranch_scc1 g2_23
  s_cmp_lg_u32 s24, 0
  s_cbranch_scc1 wwd_25
ww_24:
  buffer_load_dword v8, off, s[68:71], 0 offset:64 sc1
  s_add_u32 s26, s26, 1
  s_mov_b32 s39, 121
  s_cmp_gt_u32 s26, 2097152
  s_cbranch_scc1 L_abort
  s_waitcnt vmcnt(0)
  v_cmp_gt_u32 vcc, 64, v8
  s_cbranch_vccz wwd_25
  s_sleep 8
  s_branch ww_24
wwd_25:
  s_barrier
g2_23:
  s_barrier
  v_add_u32 v11, s38, v2
  s_min_u32 s74, s37, 4708352
  s_add_u32 s73, s72, s33
  s_add_u32 s37, s37, 40960
  ds_read_b128 v[76:79], v11 offset:0
  ds_read_b128 v[80:83], v11 offset:20480
  ds_read_b128 v[84:87], v11 offset:1024
  ds_read_b128 v[88:91], v11 offset:21504
  s_waitcnt lgkmcnt(2)
  v_mfma_f32_16x16x32_bf16 v[32:35], a[0:3], v[76:79], 0
  ds_read_b128 v[92:95], v11 offset:2048
  v_mfma_f32_16x16x32_bf16 v[40:43], a[80:83], v[76:79], 0
  ds_read_b128 v[96:99], v11 offset:22528
  v_mfma_f32_16x16x32_bf16 v[48:51], a[160:163], v[76:79], 0
  s_add_u32 m0, s73, 0
  s_add_u32 s27, s74, 0
  v_mfma_f32_16x16x32_bf16 v[36:39], a[0:3], v[80:83], 0
  buffer_load_dwordx4 v2, s[8:11], s27 offen offset:0 lds
  v_mfma_f32_16x16x32_bf16 v[44:47], a[80:83], v[80:83], 0
  v_mfma_f32_16x16x32_bf16 v[52:55], a[160:163], v[80:83], 0
  s_waitcnt lgkmcnt(2)
  v_mfma_f32_16x16x32_bf16 v[32:35], a[4:7], v[84:87], v[32:35]
  ds_read_b128 v[76:79], v11 offset:3072
  v_mfma_f32_16x16x32_bf16 v[40:43], a[84:87], v[84:87], v[40:43]
  ds_read_b128 v[80:83], v11 offset:23552
  v_mfma_f32_16x16x32_bf16 v[48:51], a[164:167], v[84:87], v[48:51]
  v_mfma_f32_16x16x32_bf16 v[36:39], a[4:7], v[88:91], v[36:39]
  buffer_load_dwordx4 v2, s[8:11], s27 offen offset:1024 lds
  v_mfma_f32_16x16x32_bf16 v[44:47], a[84:87], v[88:91], v[44:47]
  v_mfma_f32_16x16x32_bf16 v[52:55], a[164:167], v[88:91], v[52:55]
  s_waitcnt lgkmcnt(2)
  v_mfma_f32_16x16x32_bf16 v[32:35], a[8:11], v[92:95], v[32:35]
  ds_read_b128 v[84:87], v11 offset:4096
  v_mfma_f32_16x16x32_bf16 v[40:43], a[88:91], v[92:95], v[40:43]
  ds_read_b128 v[88:91], v11 offset:24576
  v_mfma_f32_16x16x32_bf16 v[48:51], a[168:171], v[92:95], v[48:51]
  v_mfma_f32_16x16x32_bf16 v[36:39], a[8:11], v[96:99], v[36:39]
  buffer_load_dwordx4 v2, s[8:11], s27 offen offset:2048 lds
  v_mfma_f32_16x16x32_bf16 v[44:47], a[88:91], v[96:99], v[44:47]
  v_mfma_f32_16x16x32_bf16 v[52:55], a[168:171], v[96:99], v[52:55]
  s_waitcnt lgkmcnt(2)
  v_mfma_f32_16x16x32_bf16 v[32:35], a[12:15], v[76:79], v[32:35]
  ds_read_b128 v[92:95], v11 offset:5120
  v_mfma_f32_16x16x32_bf16 v[40:43], a[92:95], v[76:79], v[40:43]
  ds_read_b128 v[96:99], v11 offset:25600
  v_mfma_f32_16x16x32_bf16 v[48:51], a[172:175], v[76:79], v[48:51]
  v_mfma_f32_16x16x32_bf16 v[36:39], a[12:15], v[80:83], v[36:39]
  buffer_load_dwordx4 v2, s[8:11], s27 offen offset:3072 lds
  v_mfma_f32_16x16x32_bf16 v[44:47], a[92:95], v[80:83], v[44:47]
  v_mfma_f32_16x16x32_bf16 v[52:55], a[172:175], v[80:83], v[52:55]
  s_waitcnt lgkmcnt(2)
  v_mfma_f32_16x16x32_bf16 v[32:35], a[16:19], v[84:87], v[32:35]
  ds_read_b128 v[76:79], v11 offset:6144
  v_mfma_f32_16x16x32_bf16 v[40:43], a[96:99], v[84:87], v[40:43]
  ds_read_b128 v[80:83], v11 offset:26624
  v_mfma_f32_16x16x32_bf16 v[48:51], a[176:179], v[84:87], v[48:51]
  s_add_u32 m0, s73, 4096
  s_add_u32 s27, s74, 4096
  v_mfma_f32_16x16x32_bf16 v[36:39], a[16:19], v[88:91], v[36:39]
  buffer_load_dwordx4 v2, s[8:11], s27 offen offset:0 lds
  v_mfma_f32_16x16x32_bf16 v[44:47], a[96:99], v[88:91], v[44:47]
  v_mfma_f32_16x16x32_bf16 v[52:55], a[176:179], v[88:91], v[52:55]
  s_waitcnt lgkmcnt(2)
  v_mfma_f32_16x16x32_bf16 v[32:35], a[20:23], v[92:95], v[32:35]
  ds_read_b128 v[84:87], v11 offset:7168
  v_mfma_f32_16x16x32_bf16 v[40:43], a[100:103], v[92:95], v[40:43]
  ds_read_b128 v[88:91], v11 offset:27648
  v_mfma_f32_16x16x32_bf16 v[48:51], a[180:183], v[92:95], v[48:51]
  v_mfma_f32_16x16x32_bf16 v[36:39], a[20:23], v[96:99], v[36:39]
  buffer_load_dwordx4 v2, s[8:11], s27 offen offset:1024 lds
  v_mfma_f32_16x16x32_bf16 v[44:47], a[100:103], v[96:99], v[44:47]
  v_mfma_f32_16x16x32_bf16 v[52:55], a[180:183], v[96:99], v[52:55]
  s_waitcnt lgkmcnt(2)
  v_mfma_f32_16x16x32_bf16 v[32:35], a[24:27], v[76:79], v[32:35]
  ds_read_b128 v[92:95], v11 offset:8192
  v_mfma_f32_16x16x32_bf16 v[40:43], a[104:107], v[76:79], v[40:43]
  ds_read_b128 v[96:99], v11 offset:28672
  v_mfma_f32_16x16x32_bf16 v[48:51], a[184:187], v[76:79], v[48:51]
  v_mfma_f32_16x16x32_bf16 v[36:39], a[24:27], v[80:83], v[36:39]
  buffer_load_dwordx4 v2, s[8:11], s27 offen offset:2048 lds
  v_mfma_f32_16x16x32_bf16 v[44:47], a[104:107], v[80:83], v[44:47]
  v_mfma_f32_16x16x32_bf16 v[52:55], a[184:187], v[80:83], v[52:55]
  s_waitcnt lgkmcnt(2)
  v_mfma_f32_16x16x32_bf16 v[32:35], a[28:31], v[84:87], v[32:35]
  ds_read_b128 v[76:79], v11 offset:9216
  v_mfma_f32_16x16x32_bf16 v[40:43], a[108:111], v[84:87], v[40:43]
  ds_read_b128 v[80:83], v11 offset:29696
  v_mfma_f32_16x16x32_bf16 v[48:51], a[188:191], v[84:87], v[48:51]
  v_mfma_f32_16x16x32_bf16 v[36:39], a[28:31], v[88:91], v[36:39]
  buffer_load_dwordx4 v2, s[8:11], s27 offen offset:3072 lds
  v_mfma_f32_16x16x32_bf16 v[44:47], a[108:111], v[88:91], v[44:47]
  v_mfma_f32_16x16x32_bf16 v[52:55], a[188:191], v[88:91], v[52:55]
  s_waitcnt lgkmcnt(2)
  v_mfma_f32_16x16x32_bf16 v[32:35], a[32:35], v[92:95], v[32:35]
  ds_read_b128 v[84:87], v11 offset:10240
  v_mfma_f32_16x16x32_bf16 v[40:43], a[112:115], v[92:95], v[40:43]
  ds_read_b128 v[88:91], v11 offset:30720
  v_mfma_f32_16x16x32_bf16 v[48:51], a[192:195], v[92:95], v[48:51]
  s_add_u32 m0, s73, 8192
  s_add_u32 s27, s74, 8192
  v_mfma_f32_16x16x32_bf16 v[36:39], a[32:35], v[96:99], v[36:39]
  buffer_load_dwordx4 v2, s[8:11], s27 offen offset:0 lds
  v_mfma_f32_16x16x32_bf16 v[44:47], a[112:115], v[96:99], v[44:47]
  v_mfma_f32_16x16x32_bf16 v[52:55], a[192:195], v[96:99], v[52:55]
  s_waitcnt lgkmcnt(2)
  v_mfma_f32_16x16x32_bf16 v[32:35], a[36:39], v[76:79], v[32:35]
  ds_read_b128 v[92:95], v11 offset:11264
  v_mfma_f32_16x16x32_bf16 v[40:43], a[116:119], v[76:79], v[40:43]
  ds_read_b128 v[96:99], v11 offset:31744
  v_mfma_f32_16x16x32_bf16 v[48:51], a[196:199], v[76:79], v[48:51]
  v_mfma_f32_16x16x32_bf16 v[36:39], a[36:39], v[80:83], v[36:39]
  buffer_load_dwordx4 v2, s[8:11], s27 offen offset:1024 lds
  v_mfma_f32_16x16x32_bf16 v[44:47], a[116:119], v[80:83], v[44:47]
  v_mfma_f32_16x16x32_bf16 v[52:55], a[196:199], v[80:83], v[52:55]
  s_waitcnt lgkmcnt(2)
  v_mfma_f32_16x16x32_bf16 v[32:35], a[40:43], v[84:87], v[32:35]
  ds_read_b128 v[76:79], v11 offset:12288
  v_mfma_f32_16x16x32_bf16 v[40:43], a[120:123], v[84:87], v[40:43]
  ds_read_b128 v[80:83], v11 offset:32768
  v_mfma_f32_16x16x32_bf16 v[48:51], a[200:203], v[84:87], v[48:51]
  v_mfma_f32_16x16x32_bf16 v[36:39], a[40:43], v[88:91], v[36:39]
  v_mfma_f32_16x16x32_bf16 v[44:47], a[120:123], v[88:91], v[44:47]
  v_mfma_f32_16x16x32_bf16 v[52:55], a[200:203], v[88:91], v[52:55]
  s_waitcnt lgkmcnt(2)
  v_mfma_f32_16x16x32_bf16 v[32:35], a[44:47], v[92:95], v[32:35]
  ds_read_b128 v[84:87], v11 offset:13312
  v_mfma_f32_16x16x32_bf16 v[40:43], a[124:127], v[92:95], v[40:43]
  ds_read_b128 v[88:91], v11 offset:33792
  v_mfma_f32_16x16x32_bf16 v[48:51], a[204:207], v[92:95], v[48:51]
  v_mfma_f32_16x16x32_bf16 v[36:39], a[44:47], v[96:99], v[36:39]
  v_mfma_f32_16x16x32_bf16 v[44:47], a[124:127], v[96:99], v[44:47]
  v_mfma_f32_16x16x32_bf16 v[52:55], a[204:207], v[96:99], v[52:55]
  s_cmp_lt_u32 s36, 4
  s_cbranch_scc1 wa_26
  s_waitcnt vmcnt(14)
  s_sub_u32 s30, s36, 1
  s_branch wb_27
wa_26:
  s_waitcnt vmcnt(10)
  s_mov_b32 s30, s36
wb_27:
  v_mov_b32 v15, s30
  s_mov_b64 exec, 1
  buffer_store_dword v15, off, s[8:11], s34 sc1
  s_mov_b64 exec, -1
  s_waitcnt lgkmcnt(2)
  v_mfma_f32_16x16x32_bf16 v[32:35], a[48:51], v[76:79], v[32:35]
  ds_read_b128 v[92:95], v11 offset:14336
  v_mfma_f32_16x16x32_bf16 v[40:43], a[128:131], v[76:79], v[40:43]
  ds_read_b128 v[96:99], v11 offset:34816
  v_mfma_f32_16x16x32_bf16 v[48:51], a[208:211], v[76:79], v[48:51]
  v_mfma_f32_16x16x32_bf16 v[36:39], a[48:51], v[80:83], v[36:39]
  v_mfma_f32_16x16x32_bf16 v[44:47], a[128:131], v[80:83], v[44:47]
  v_mfma_f32_16x16x32_bf16 v[52:55], a[208:211], v[80:83], v[52:55]
  s_waitcnt lgkmcnt(2)
  v_mfma_f32_16x16x32_bf16 v[32:35], a[52:55], v[84:87], v[32:35]
  ds_read_b128 v[76:79], v11 offset:15360
  v_mfma_f32_16x16x32_bf16 v[40:43], a[132:135], v[84:87], v[40:43]
  ds_read_b128 v[80:83], v11 offset:35840
  v_mfma_f32_16x16x32_bf16 v[48:51], a[212:215], v[84:87], v[48:51]
  v_mfma_f32_16x16x32_bf16 v[36:39], a[52:55], v[88:91], v[36:39]
  v_mfma_f32_16x16x32_bf16 v[44:47], a[132:135], v[88:91], v[44:47]
  v_mfma_f32_16x16x32_bf16 v[52:55], a[212:215], v[88:91], v[52:55]
  s_waitcnt lgkmcnt(2)
  v_mfma_f32_16x16x32_bf16 v[32:35], a[56:59], v[92:95], v[32:35]
  ds_read_b128 v[84:87], v11 offset:16384
  v_mfma_f32_16x16x32_bf16 v[40:43], a[136:139], v[92:95], v[40:43]
  ds_read_b128 v[88:91], v11 offset:36864
  v_mfma_f32_16x16x32_bf16 v[48:51], a[216:219], v[92:95], v[48:51]
  v_mfma_f32_16x16x32_bf16 v[36:39], a[56:59], v[96:99], v[36:39]
  v_mfma_f32_16x16x32_bf16 v[44:47], a[136:139], v[96:99], v[44:47]
  v_mfma_f32_16x16x32_bf16 v[52:55], a[216:219], v[96:99], v[52:55]
  s_waitcnt lgkmcnt(2)
  v_mfma_f32_16x16x32_bf16 v[32:35], a[60:63], v[76:79], v[32:35]
  ds_read_b128 v[92:95], v11 offset:17408
  v_mfma_f32_16x16x32_bf16 v[40:43], a[140:143], v[76:79], v[40:43]
  ds_read_b128 v[96:99], v11 offset:37888
  v_mfma_f32_16x16x32_bf16 v[48:51], a[220:223], v[76:79], v[48:51]
  v_mfma_f32_16x16x32_bf16 v[36:39], a[60:63], v[80:83], v[36:39]
  v_mfma_f32_16x16x32_bf16 v[44:47], a[140:143], v[80:83], v[44:47]
  v_mfma_f32_16x16x32_bf16 v[52:55], a[220:223], v[80:83], v[52:55]
  s_waitcnt lgkmcnt(2)
  v_mfma_f32_16x16x32_bf16 v[32:35], a[64:67], v[84:87], v[32:35]
  ds_read_b128 v[76:79], v11 offset:18432
  v_mfma_f32_16x16x32_bf16 v[40:43], a[144:147], v[84:87], v[40:43]
  ds_read_b128 v[80:83], v11 offset:38912
  v_mfma_f32_16x16x32_bf16 v[48:51], a[224:227], v[84:87], v[48:51]
  v_mfma_f32_16x16x32_bf16 v[36:39], a[64:67], v[88:91], v[36:39]
  v_mfma_f32_16x16x32_bf16 v[44:47], a[144:147], v[88:91], v[44:47]
  v_mfma_f32_16x16x32_bf16 v[52:55], a[224:227], v[88:91], v[52:55]
  s_waitcnt lgkmcnt(2)
  v_mfma_f32_16x16x32_bf16 v[32:35], a[68:71], v[92:95], v[32:35]
  ds_read_b128 v[84:87], v11 offset:19456
  v_mfma_f32_16x16x32_bf16 v[40:43], a[148:151], v[92:95], v[40:43]
  ds_read_b128 v[88:91], v11 offset:39936
  v_mfma_f32_16x16x32_bf16 v[48:51], a[228:231], v[92:95], v[48:51]
  v_mfma_f32_16x16x32_bf16 v[36:39], a[68:71], v[96:99], v[36:39]
  v_mfma_f32_16x16x32_bf16 v[44:47], a[148:151], v[96:99], v[44:47]
  v_mfma_f32_16x16x32_bf16 v[52:55], a[228:231], v[96:99], v[52:55]
  s_waitcnt lgkmcnt(2)
  v_mfma_f32_16x16x32_bf16 v[32:35], a[72:75], v[76:79], v[32:35]
  v_mfma_f32_16x16x32_bf16 v[40:43], a[152:155], v[76:79], v[40:43]
  v_mfma_f32_16x16x32_bf16 v[48:51], a[232:235], v[76:79], v[48:51]
  v_mfma_f32_16x16x32_bf16 v[36:39], a[72:75], v[80:83], v[36:39]
  v_mfma_f32_16x16x32_bf16 v[44:47], a[152:155], v[80:83], v[44:47]
  v_mfma_f32_16x16x32_bf16 v[52:55], a[232:235], v[80:83], v[52:55]
  s_waitcnt lgkmcnt(0)
  v_mfma_f32_16x16x32_bf16 v[32:35], a[76:79], v[84:87], v[32:35]
  v_mfma_f32_16x16x32_bf16 v[40:43], a[156:159], v[84:87], v[40:43]
  v_mfma_f32_16x16x32_bf16 v[48:51], a[236:239], v[84:87], v[48:51]
  v_mfma_f32_16x16x32_bf16 v[36:39], a[76:79], v[88:91], v[36:39]
  v_mfma_f32_16x16x32_bf16 v[44:47], a[156:159], v[88:91], v[44:47]
  v_mfma_f32_16x16x32_bf16 v[52:55], a[236:239], v[88:91], v[52:55]
  s_nop 2
  v_cvt_pk_bf16_f32 v56, v32, v33
  v_cvt_pk_bf16_f32 v57, v34, v35
  v_cvt_pk_bf16_f32 v58, v40, v41
  v_cvt_pk_bf16_f32 v59, v42, v43
  v_cvt_pk_bf16_f32 v64, v48, v49
  v_cvt_pk_bf16_f32 v65, v50, v51
  v_cvt_pk_bf16_f32 v60, v36, v37
  v_cvt_pk_bf16_f32 v61, v38, v39
  v_cvt_pk_bf16_f32 v62, v44, v45
  v_cvt_pk_bf16_f32 v63, v46, v47
  v_cvt_pk_bf16_f32 v66, v52, v53
  v_cvt_pk_bf16_f32 v67, v54, v55
  buffer_store_dwordx4 v[56:59], v2, s[8:11], s35 offen offset:0 sc1
  buffer_store_dwordx4 v[60:63], v2, s[8:11], s35 offen offset:1024 sc1
  buffer_store_dwordx4 v[64:67], v2, s[8:11], s35 offen offset:2048 sc1
  s_cmp_ge_u32 s36, 2
  s_cbranch_scc1 we_28
  s_waitcnt vmcnt(0)
  s_add_u32 s30, s36, 1
  v_mov_b32 v15, s30
  s_mov_b64 exec, 1
  buffer_store_dword v15, off, s[8:11], s34 sc1
  s_mov_b64 exec, -1
we_28:
  s_add_u32 s35, s35, 393216
  s_add_u32 s38, s38, 40960
  s_cmp_eq_u32 s38, 122880
  s_cselect_b32 s38, 0, s38
  s_add_u32 s72, s72, 40960
  s_cmp_eq_u32 s72, 122880
  s_cselect_b32 s72, 0, s72
  s_add_u32 s36, s36, 1
  s_cmp_lt_u32 s36, 64
  s_cbranch_scc1 WK_loop
  s_waitcnt vmcnt(0)
  v_mov_b32 v15, s36
  s_mov_b64 exec, 1
  buffer_store_dword v15, off, s[8:11], s34 sc1
  s_mov_b64 exec, -1
  s_branch PY
WV:
  s_mov_b32 s12, s48
  s_and_b32 s13, s49, 0xffff
  s_mov_b32 s14, 7864320
  s_mov_b32 s15, 0x20000
  s_mov_b32 s30, 12288
  v_add_u32 v68, 0, v1
  s_mov_b32 s27, 43691
  v_mul_lo_u32 v69, v68, s27
  v_lshrrev_b32 v69, 18, v69
  v_mul_u32_u24 v4, 6, v69
  v_sub_u32 v70, v68, v4
  v_mul_lo_u32 v69, v69, s30
  v_lshl_add_u32 v4, v70, 4, v69
  v_add_u32 v68, 64, v1
  s_mov_b32 s27, 43691
  v_mul_lo_u32 v69, v68, s27
  v_lshrrev_b32 v69, 18, v69
  v_mul_u32_u24 v5, 6, v69
  v_sub_u32 v70, v68, v5
  v_mul_lo_u32 v69, v69, s30
  v_lshl_add_u32 v5, v70, 4, v69
  v_add_u32 v68, 128, v1
  s_mov_b32 s27, 43691
  v_mul_lo_u32 v69, v68, s27
  v_lshrrev_b32 v69, 18, v69
  v_mul_u32_u24 v6, 6, v69
  v_sub_u32 v70, v68, v6
  v_mul_lo_u32 v69, v69, s30
  v_lshl_add_u32 v6, v70, 4, v69
  v_add_u32 v68, 192, v1
  s_mov_b32 s27, 43691
  v_mul_lo_u32 v69, v68, s27
  v_lshrrev_b32 v69, 18, v69
  v_mul_u32_u24 v7, 6, v69
  v_sub_u32 v70, v68, v7
  v_mul_lo_u32 v69, v69, s30
  v_lshl_add_u32 v7, v70, 4, v69
  v_add_u32 v68, 256, v1
  s_mov_b32 s27, 43691
  v_mul_lo_u32 v69, v68, s27
  v_lshrrev_b32 v69, 18, v69
  v_mul_u32_u24 v8, 6, v69
  v_sub_u32 v70, v68, v8
  v_mul_lo_u32 v69, v69, s30
  v_lshl_add_u32 v8, v70, 4, v69
  v_add_u32 v68, 320, v1
  s_mov_b32 s27, 43691
  v_mul_lo_u32 v69, v68, s27
  v_lshrrev_b32 v69, 18, v69
  v_mul_u32_u24 v9, 6, v69
  v_sub_u32 v70, v68, v9
  v_mul_lo_u32 v69, v69, s30
  v_lshl_add_u32 v9, v70, 4, v69
  v_bfe_u32 v68, v1, 5, 1
  v_mul_u32_u24 v3, 1536, v68
  v_bfe_u32 v68, v1, 4, 1
  v_mul_u32_u24 v68, 768, v68
  v_add_u32 v3, v3, v68
  v_bfe_u32 v68, v1, 2, 1
  v_mul_u32_u24 v68, 96, v68
  v_add_u32 v3, v3, v68
  v_bfe_u32 v68, v1, 3, 1
  v_mul_u32_u24 v68, 192, v68
  v_add_u32 v3, v3, v68
  v_and_b32 v68, 3, v1
  v_lshl_add_u32 v3, v68, 3, v3
  s_mul_i32 s27, s24, 30720
  v_add_u32 v3, s27, v3
  s_mul_i32 s32, s25, 384
  s_mul_i32 s27, s24, 96
  s_add_u32 s32, s32, s27
  s_mul_i32 s31, s24, 30720
  s_add_u32 m0, s31, 0
  s_add_u32 s27, s32, 0
  buffer_load_dwordx4 v4, s[12:15], s27 offen  lds
  s_add_u32 m0, s31, 1024
  s_add_u32 s27, s32, 0
  buffer_load_dwordx4 v5, s[12:15], s27 offen  lds
  s_add_u32 m0, s31, 2048
  s_add_u32 s27, s32, 0
  buffer_load_dwordx4 v6, s[12:15], s27 offen  lds
  s_add_u32 m0, s31, 3072
  s_add_u32 s27, s32, 0
  buffer_load_dwordx4 v7, s[12:15], s27 offen  lds
  s_add_u32 m0, s31, 4096
  s_add_u32 s27, s32, 0
  buffer_load_dwordx4 v8, s[12:15], s27 offen  lds
  s_add_u32 m0, s31, 5120
  s_add_u32 s27, s32, 0
  buffer_load_dwordx4 v9, s[12:15], s27 offen  lds
  s_add_u32 m0, s31, 6144
  s_add_u32 s27, s32, 786432
  buffer_load_dwordx4 v4, s[12:15], s27 offen  lds
  s_add_u32 m0, s31, 7168
  s_add_u32 s27, s32, 786432
  buffer_load_dwordx4 v5, s[12:15], s27 offen  lds
  s_add_u32 m0, s31, 8192
  s_add_u32 s27, s32, 786432
  buffer_load_dwordx4 v6, s[12:15], s27 offen  lds
  s_add_u32 m0, s31, 9216
  s_add_u32 s27, s32, 786432
  buffer_load_dwordx4 v7, s[12:15], s27 offen  lds
  s_add_u32 m0, s31, 10240
  s_add_u32 s27, s32, 786432
  buffer_load_dwordx4 v8, s[12:15], s27 offen  lds
  s_add_u32 m0, s31, 11264
  s_add_u32 s27, s32, 786432
  buffer_load_dwordx4 v9, s[12:15], s27 offen  lds
  s_add_u32 m0, s31, 12288
  s_add_u32 s27, s32, 1572864
  buffer_load_dwordx4 v4, s[12:15], s27 offen  lds
  s_add_u32 m0, s31, 13312
  s_add_u32 s27, s32, 1572864
  buffer_load_dwordx4 v5, s[12:15], s27 offen  lds
  s_add_u32 m0, s31, 14336
  s_add_u32 s27, s32, 1572864
  buffer_load_dwordx4 v6, s[12:15], s27 offen  lds
  s_add_u32 m0, s31, 15360
  s_add_u32 s27, s32, 1572864
  buffer_load_dwordx4 v7, s[12:15], s27 offen  lds
  s_add_u32 m0, s31, 16384
  s_add_u32 s27, s32, 1572864
  buffer_load_dwordx4 v8, s[12:15], s27 offen  lds
  s_add_u32 m0, s31, 17408
  s_add_u32 s27, s32, 1572864
  buffer_load_dwordx4 v9, s[12:15], s27 offen  lds
  s_add_u32 m0, s31, 18432
  s_add_u32 s27, s32, 2359296
  buffer_load_dwordx4 v4, s[12:15], s27 offen  lds
  s_add_u32 m0, s31, 19456
  s_add_u32 s27, s32, 2359296
  buffer_load_dwordx4 v5, s[12:15], s27 offen  lds
  s_add_u32 m0, s31, 20480
  s_add_u32 s27, s32, 2359296
  buffer_load_dwordx4 v6, s[12:15], s27 offen  lds
  s_add_u32 m0, s31, 21504
  s_add_u32 s27, s32, 2359296
  buffer_load_dwordx4 v7, s[12:15], s27 offen  lds
  s_add_u32 m0, s31, 22528
  s_add_u32 s27, s32, 2359296
  buffer_load_dwordx4 v8, s[12:15], s27 offen  lds
  s_add_u32 m0, s31, 23552
  s_add_u32 s27, s32, 2359296
  buffer_load_dwordx4 v9, s[12:15], s27 offen  lds
  s_add_u32 m0, s31, 24576
  s_add_u32 s27, s32, 3145728
  buffer_load_dwordx4 v4, s[12:15], s27 offen  lds
  s_add_u32 m0, s31, 25600
  s_add_u32 s27, s32, 3145728
  buffer_load_dwordx4 v5, s[12:15], s27 offen  lds
  s_add_u32 m0, s31, 26624
  s_add_u32 s27, s32, 3145728
  buffer_load_dwordx4 v6, s[12:15], s27 offen  lds
  s_add_u32 m0, s31, 27648
  s_add_u32 s27, s32, 3145728
  buffer_load_dwordx4 v7, s[12:15], s27 offen  lds
  s_add_u32 m0, s31, 28672
  s_add_u32 s27, s32, 3145728
  buffer_load_dwordx4 v8, s[12:15], s27 offen  lds
  s_add_u32 m0, s31, 29696
  s_add_u32 s27, s32, 3145728
  buffer_load_dwordx4 v9, s[12:15], s27 offen  lds
  s_waitcnt vmcnt(24)
  ds_read_b64_tr_b16 a[0:1], v3 offset:0
  ds_read_b64_tr_b16 a[2:3], v3 offset:384
  ds_read_b64_tr_b16 a[4:5], v3 offset:3072
  ds_read_b64_tr_b16 a[6:7], v3 offset:3456
  ds_read_b64_tr_b16 a[80:81], v3 offset:32
  ds_read_b64_tr_b16 a[82:83], v3 offset:416
  ds_read_b64_tr_b16 a[84:85], v3 offset:3104
  ds_read_b64_tr_b16 a[86:87], v3 offset:3488
  ds_read_b64_tr_b16 a[160:161], v3 offset:64
  ds_read_b64_tr_b16 a[162:163], v3 offset:448
  ds_read_b64_tr_b16 a[164:165], v3 offset:3136
  ds_read_b64_tr_b16 a[166:167], v3 offset:3520
  s_waitcnt lgkmcnt(0)
  s_add_u32 m0, s31, 0
  s_add_u32 s27, s32, 3932160
  buffer_load_dwordx4 v4, s[12:15], s27 offen  lds
  s_add_u32 m0, s31, 1024
  s_add_u32 s27, s32, 3932160
  buffer_load_dwordx4 v5, s[12:15], s27 offen  lds
  s_add_u32 m0, s31, 2048
  s_add_u32 s27, s32, 3932160
  buffer_load_dwordx4 v6, s[12:15], s27 offen  lds
  s_add_u32 m0, s31, 3072
  s_add_u32 s27, s32, 3932160
  buffer_load_dwordx4 v7, s[12:15], s27 offen  lds
  s_add_u32 m0, s31, 4096
  s_add_u32 s27, s32, 3932160
  buffer_load_dwordx4 v8, s[12:15], s27 offen  lds
  s_add_u32 m0, s31, 5120
  s_add_u32 s27, s32, 3932160
  buffer_load_dwordx4 v9, s[12:15], s27 offen  lds
  s_waitcnt vmcnt(24)
  ds_read_b64_tr_b16 a[8:9], v3 offset:6144
  ds_read_b64_tr_b16 a[10:11], v3 offset:6528
  ds_read_b64_tr_b16 a[12:13], v3 offset:9216
  ds_read_b64_tr_b16 a[14:15], v3 offset:9600
  ds_read_b64_tr_b16 a[88:89], v3 offset:6176
  ds_read_b64_tr_b16 a[90:91], v3 offset:6560
  ds_read_b64_tr_b16 a[92:93], v3 offset:9248
  ds_read_b64_tr_b16 a[94:95], v3 offset:9632
  ds_read_b64_tr_b16 a[168:169], v3 offset:6208
  ds_read_b64_tr_b16 a[170:171], v3 offset:6592
  ds_read_b64_tr_b16 a[172:173], v3 offset:9280
  ds_read_b64_tr_b16 a[174:175], v3 offset:9664
  s_waitcnt lgkmcnt(0)
  s_add_u32 m0, s31, 6144
  s_add_u32 s27, s32, 4718592
  buffer_load_dwordx4 v4, s[12:15], s27 offen  lds
  s_add_u32 m0, s31, 7168
  s_add_u32 s27, s32, 4718592
  buffer_load_dwordx4 v5, s[12:15], s27 offen  lds
  s_add_u32 m0, s31, 8192
  s_add_u32 s27, s32, 4718592
  buffer_load_dwordx4 v6, s[12:15], s27 offen  lds
  s_add_u32 m0, s31, 9216
  s_add_u32 s27, s32, 4718592
  buffer_load_dwordx4 v7, s[12:15], s27 offen  lds
  s_add_u32 m0, s31, 10240
  s_add_u32 s27, s32, 4718592
  buffer_load_dwordx4 v8, s[12:15], s27 offen  lds
  s_add_u32 m0, s31, 11264
  s_add_u32 s27, s32, 4718592
  buffer_load_dwordx4 v9, s[12:15], s27 offen  lds
  s_waitcnt vmcnt(24)
  ds_read_b64_tr_b16 a[16:17], v3 offset:12288
  ds_read_b64_tr_b16 a[18:19], v3 offset:12672
  ds_read_b64_tr_b16 a[20:21], v3 offset:15360
  ds_read_b64_tr_b16 a[22:23], v3 offset:15744
  ds_read_b64_tr_b16 a[96:97], v3 offset:12320
  ds_read_b64_tr_b16 a[98:99], v3 offset:12704
  ds_read_b64_tr_b16 a[100:101], v3 offset:15392
  ds_read_b64_tr_b16 a[102:103], v3 offset:15776
  ds_read_b64_tr_b16 a[176:177], v3 offset:12352
  ds_read_b64_tr_b16 a[178:179], v3 offset:12736
  ds_read_b64_tr_b16 a[180:181], v3 offset:15424
  ds_read_b64_tr_b16 a[182:183], v3 offset:15808
  s_waitcnt lgkmcnt(0)
  s_add_u32 m0, s31, 12288
  s_add_u32 s27, s32, 5505024
  buffer_load_dwordx4 v4, s[12:15], s27 offen  lds
  s_add_u32 m0, s31, 13312
  s_add_u32 s27, s32, 5505024
  buffer_load_dwordx4 v5, s[12:15], s27 offen  lds
  s_add_u32 m0, s31, 14336
  s_add_u32 s27, s32, 5505024
  buffer_load_dwordx4 v6, s[12:15], s27 offen  lds
  s_add_u32 m0, s31, 15360
  s_add_u32 s27, s32, 5505024
  buffer_load_dwordx4 v7, s[12:15], s27 offen  lds
  s_add_u32 m0, s31, 16384
  s_add_u32 s27, s32, 5505024
  buffer_load_dwordx4 v8, s[12:15], s27 offen  lds
  s_add_u32 m0, s31, 17408
  s_add_u32 s27, s32, 5505024
  buffer_load_dwordx4 v9, s[12:15], s27 offen  lds
  s_waitcnt vmcnt(24)
  ds_read_b64_tr_b16 a[24:25], v3 offset:18432
  ds_read_b64_tr_b16 a[26:27], v3 offset:18816
  ds_read_b64_tr_b16 a[28:29], v3 offset:21504
  ds_read_b64_tr_b16 a[30:31], v3 offset:21888
  ds_read_b64_tr_b16 a[104:105], v3 offset:18464
  ds_read_b64_tr_b16 a[106:107], v3 offset:18848
  ds_read_b64_tr_b16 a[108:109], v3 offset:21536
  ds_read_b64_tr_b16 a[110:111], v3 offset:21920
  ds_read_b64_tr_b16 a[184:185], v3 offset:18496
  ds_read_b64_tr_b16 a[186:187], v3 offset:18880
  ds_read_b64_tr_b16 a[188:189], v3 offset:21568
  ds_read_b64_tr_b16 a[190:191], v3 offset:21952
  s_waitcnt lgkmcnt(0)
  s_add_u32 m0, s31, 18432
  s_add_u32 s27, s32, 6291456
  buffer_load_dwordx4 v4, s[12:15], s27 offen  lds
  s_add_u32 m0, s31, 19456
  s_add_u32 s27, s32, 6291456
  buffer_load_dwordx4 v5, s[12:15], s27 offen  lds
  s_add_u32 m0, s31, 20480
  s_add_u32 s27, s32, 6291456
  buffer_load_dwordx4 v6, s[12:15], s27 offen  lds
  s_add_u32 m0, s31, 21504
  s_add_u32 s27, s32, 6291456
  buffer_load_dwordx4 v7, s[12:15], s27 offen  lds
  s_add_u32 m0, s31, 22528
  s_add_u32 s27, s32, 6291456
  buffer_load_dwordx4 v8, s[12:15], s27 offen  lds
  s_add_u32 m0, s31, 23552
  s_add_u32 s27, s32, 6291456
  buffer_load_dwordx4 v9, s[12:15], s27 offen  lds
  s_waitcnt vmcnt(24)
  ds_read_b64_tr_b16 a[32:33], v3 offset:24576
  ds_read_b64_tr_b16 a[34:35], v3 offset:24960
  ds_read_b64_tr_b16 a[36:37], v3 offset:27648
  ds_read_b64_tr_b16 a[38:39], v3 offset:28032
  ds_read_b64_tr_b16 a[112:113], v3 offset:24608
  ds_read_b64_tr_b16 a[114:115], v3 offset:24992
  ds_read_b64_tr_b16 a[116:117], v3 offset:27680
  ds_read_b64_tr_b16 a[118:119], v3 offset:28064
  ds_read_b64_tr_b16 a[192:193], v3 offset:24640
  ds_read_b64_tr_b16 a[194:195], v3 offset:25024
  ds_read_b64_tr_b16 a[196:197], v3 offset:27712
  ds_read_b64_tr_b16 a[198:199], v3 offset:28096
  s_waitcnt lgkmcnt(0)
  s_add_u32 m0, s31, 24576
  s_add_u32 s27, s32, 7077888
  buffer_load_dwordx4 v4, s[12:15], s27 offen  lds
  s_add_u32 m0, s31, 25600
  s_add_u32 s27, s32, 7077888
  buffer_load_dwordx4 v5, s[12:15], s27 offen  lds
  s_add_u32 m0, s31, 26624
  s_add_u32 s27, s32, 7077888
  buffer_load_dwordx4 v6, s[12:15], s27 offen  lds
  s_add_u32 m0, s31, 27648
  s_add_u32 s27, s32, 7077888
  buffer_load_dwordx4 v7, s[12:15], s27 offen  lds
  s_add_u32 m0, s31, 28672
  s_add_u32 s27, s32, 7077888
  buffer_load_dwordx4 v8, s[12:15], s27 offen  lds
  s_add_u32 m0, s31, 29696
  s_add_u32 s27, s32, 7077888
  buffer_load_dwordx4 v9, s[12:15], s27 offen  lds
  s_waitcnt vmcnt(24)
  ds_read_b64_tr_b16 a[40:41], v3 offset:0
  ds_read_b64_tr_b16 a[42:43], v3 offset:384
  ds_read_b64_tr_b16 a[44:45], v3 offset:3072
  ds_read_b64_tr_b16 a[46:47], v3 offset:3456
  ds_read_b64_tr_b16 a[120:121], v3 offset:32
  ds_read_b64_tr_b16 a[122:123], v3 offset:416
  ds_read_b64_tr_b16 a[124:125], v3 offset:3104
  ds_read_b64_tr_b16 a[126:127], v3 offset:3488
  ds_read_b64_tr_b16 a[200:201], v3 offset:64
  ds_read_b64_tr_b16 a[202:203], v3 offset:448
  ds_read_b64_tr_b16 a[204:205], v3 offset:3136
  ds_read_b64_tr_b16 a[206:207], v3 offset:3520
  s_waitcnt lgkmcnt(0)
  s_waitcnt vmcnt(18)
  ds_read_b64_tr_b16 a[48:49], v3 offset:6144
  ds_read_b64_tr_b16 a[50:51], v3 offset:6528
  ds_read_b64_tr_b16 a[52:53], v3 offset:9216
  ds_read_b64_tr_b16 a[54:55], v3 offset:9600
  ds_read_b64_tr_b16 a[128:129], v3 offset:6176
  ds_read_b64_tr_b16 a[130:131], v3 offset:6560
  ds_read_b64_tr_b16 a[132:133], v3 offset:9248
  ds_read_b64_tr_b16 a[134:135], v3 offset:9632
  ds_read_b64_tr_b16 a[208:209], v3 offset:6208
  ds_read_b64_tr_b16 a[210:211], v3 offset:6592
  ds_read_b64_tr_b16 a[212:213], v3 offset:9280
  ds_read_b64_tr_b16 a[214:215], v3 offset:9664
  s_waitcnt lgkmcnt(0)
  s_waitcnt vmcnt(12)
  ds_read_b64_tr_b16 a[56:57], v3 offset:12288
  ds_read_b64_tr_b16 a[58:59], v3 offset:12672
  ds_read_b64_tr_b16 a[60:61], v3 offset:15360
  ds_read_b64_tr_b16 a[62:63], v3 offset:15744
  ds_read_b64_tr_b16 a[136:137], v3 offset:12320
  ds_read_b64_tr_b16 a[138:139], v3 offset:12704
  ds_read_b64_tr_b16 a[140:141], v3 offset:15392
  ds_read_b64_tr_b16 a[142:143], v3 offset:15776
  ds_read_b64_tr_b16 a[216:217], v3 offset:12352
  ds_read_b64_tr_b16 a[218:219], v3 offset:12736
  ds_read_b64_tr_b16 a[220:221], v3 offset:15424
  ds_read_b64_tr_b16 a[222:223], v3 offset:15808
  s_waitcnt lgkmcnt(0)
  s_waitcnt vmcnt(6)
  ds_read_b64_tr_b16 a[64:65], v3 offset:18432
  ds_read_b64_tr_b16 a[66:67], v3 offset:18816
  ds_read_b64_tr_b16 a[68:69], v3 offset:21504
  ds_read_b64_tr_b16 a[70:71], v3 offset:21888
  ds_read_b64_tr_b16 a[144:145], v3 offset:18464
  ds_read_b64_tr_b16 a[146:147], v3 offset:18848
  ds_read_b64_tr_b16 a[148:149], v3 offset:21536
  ds_read_b64_tr_b16 a[150:151], v3 offset:21920
  ds_read_b64_tr_b16 a[224:225], v3 offset:18496
  ds_read_b64_tr_b16 a[226:227], v3 offset:18880
  ds_read_b64_tr_b16 a[228:229], v3 offset:21568
  ds_read_b64_tr_b16 a[230:231], v3 offset:21952
  s_waitcnt lgkmcnt(0)
  s_waitcnt vmcnt(0)
  ds_read_b64_tr_b16 a[72:73], v3 offset:24576
  ds_read_b64_tr_b16 a[74:75], v3 offset:24960
  ds_read_b64_tr_b16 a[76:77], v3 offset:27648
  ds_read_b64_tr_b16 a[78:79], v3 offset:28032
  ds_read_b64_tr_b16 a[152:153], v3 offset:24608
  ds_read_b64_tr_b16 a[154:155], v3 offset:24992
  ds_read_b64_tr_b16 a[156:157], v3 offset:27680
  ds_read_b64_tr_b16 a[158:159], v3 offset:28064
  ds_read_b64_tr_b16 a[232:233], v3 offset:24640
  ds_read_b64_tr_b16 a[234:235], v3 offset:25024
  ds_read_b64_tr_b16 a[236:237], v3 offset:27712
  ds_read_b64_tr_b16 a[238:239], v3 offset:28096
  s_waitcnt lgkmcnt(0)
  s_cmp_lg_u32 s24, 0
  s_cbranch_scc1 wwd_30
ww_29:
  buffer_load_dword v8, off, s[68:71], 0 offset:72 sc1
  s_add_u32 s26, s26, 1
  s_mov_b32 s39, 113
  s_cmp_gt_u32 s26, 2097152
  s_cbranch_scc1 L_abort
  s_waitcnt vmcnt(0)
  v_cmp_gt_u32 vcc, 4, v8
  s_cbranch_vccz wwd_30
  s_sleep 4
  s_branch ww_29
wwd_30:
  s_barrier
  s_barrier
  s_mul_i32 s33, s24, 10240
  v_mov_b32 v14, 0
  s_add_u32 s34, s25, 32
  s_lshl_b32 s34, s34, 7
  s_lshl_b32 s27, s24, 2
  s_add_u32 s34, s34, s27
  s_add_u32 s34, s34, 4096
  s_mul_i32 s35, s25, 12288
  s_add_u32 s35, s35, 92798976
  s_lshl_b32 s27, s24, 11
  v_add_u32 v12, s27, v2
  s_lshr_b32 s27, s24, 1
  s_lshl_b32 s27, s27, 11
  s_add_u32 s27, s27, 8192
  s_and_b32 s30, s24, 1
  s_lshl_b32 s30, s30, 3
  s_add_u32 s27, s27, s30
  v_add_u32 v13, s27, v2
  s_mov_b32 s36, 0
  s_add_u32 s37, s33, 2097152
  s_mov_b32 s38, 0
  s_mov_b32 s73, s33
  s_add_u32 m0, s73, 0
  s_add_u32 s27, s37, 0
  buffer_load_dwordx4 v2, s[8:11], s27 offen offset:0 lds
  buffer_load_dwordx4 v2, s[8:11], s27 offen offset:1024 lds
  buffer_load_dwordx4 v2, s[8:11], s27 offen offset:2048 lds
  buffer_load_dwordx4 v2, s[8:11], s27 offen offset:3072 lds
  s_add_u32 m0, s73, 4096
  s_add_u32 s27, s37, 4096
  buffer_load_dwordx4 v2, s[8:11], s27 offen offset:0 lds
  buffer_load_dwordx4 v2, s[8:11], s27 offen offset:1024 lds
  buffer_load_dwordx4 v2, s[8:11], s27 offen offset:2048 lds
  buffer_load_dwordx4 v2, s[8:11], s27 offen offset:3072 lds
  s_add_u32 m0, s73, 8192
  s_add_u32 s27, s37, 8192
  buffer_load_dwordx4 v2, s[8:11], s27 offen offset:0 lds
  buffer_load_dwordx4 v2, s[8:11], s27 offen offset:1024 lds
  s_add_u32 s37, s37, 40960
  s_add_u32 s73, s33, 40960
  s_add_u32 m0, s73, 0
  s_add_u32 s27, s37, 0
  buffer_load_dwordx4 v2, s[8:11], s27 offen offset:0 lds
  buffer_load_dwordx4 v2, s[8:11], s27 offen offset:1024 lds
  buffer_load_dwordx4 v2, s[8:11], s27 offen offset:2048 lds
  buffer_load_dwordx4 v2, s[8:11], s27 offen offset:3072 lds
  s_add_u32 m0, s73, 4096
  s_add_u32 s27, s37, 4096
  buffer_load_dwordx4 v2, s[8:11], s27 offen offset:0 lds
  buffer_load_dwordx4 v2, s[8:11], s27 offen offset:1024 lds
  buffer_load_dwordx4 v2, s[8:11], s27 offen offset:2048 lds
  buffer_load_dwordx4 v2, s[8:11], s27 offen offset:3072 lds
  s_add_u32 m0, s73, 8192
  s_add_u32 s27, s37, 8192
  buffer_load_dwordx4 v2, s[8:11], s27 offen offset:0 lds
  buffer_load_dwordx4 v2, s[8:11], s27 offen offset:1024 lds
  s_add_u32 s37, s37, 40960
  s_mov_b32 s72, 81920
  s_waitcnt vmcnt(10)
WV_loop:
  s_cmp_lg_u32 s36, 2
  s_cbranch_scc1 g2_31
  s_cmp_lg_u32 s24, 0
  s_cbranch_scc1 wwd_33
ww_32:
  buffer_load_dword v8, off, s[68:71], 0 offset:64 sc1
  s_add_u32 s26, s26, 1
  s_mov_b32 s39, 121
  s_cmp_gt_u32 s26, 2097152
  s_cbranch_scc1 L_abort
  s_waitcnt vmcnt(0)
  v_cmp_gt_u32 vcc, 64, v8
  s_cbranch_vccz wwd_33
  s_sleep 8
  s_branch ww_32
wwd_33:
  s_barrier
g2_31:
  s_barrier
  v_add_u32 v11, s38, v2
  s_min_u32 s74, s37, 4708352
  s_add_u32 s73, s72, s33
  s_add_u32 s37, s37, 40960
  ds_read_b128 v[76:79], v11 offset:0
  ds_read_b128 v[80:83], v11 offset:20480
  ds_read_b128 v[84:87], v11 offset:1024
  ds_read_b128 v[88:91], v11 offset:21504
  s_waitcnt lgkmcnt(2)
  v_mfma_f32_16x16x32_bf16 v[32:35], a[0:3], v[76:79], 0
  ds_read_b128 v[92:95], v11 offset:2048
  v_mfma_f32_16x16x32_bf16 v[40:43], a[80:83], v[76:79], 0
  ds_read_b128 v[96:99], v11 offset:22528
  v_mfma_f32_16x16x32_bf16 v[48:51], a[160:163], v[76:79], 0
  s_add_u32 m0, s73, 0
  s_add_u32 s27, s74, 0
  v_mfma_f32_16x16x32_bf16 v[36:39], a[0:3], v[80:83], 0
  buffer_load_dwordx4 v2, s[8:11], s27 offen offset:0 lds
  v_mfma_f32_16x16x32_bf16 v[44:47], a[80:83], v[80:83], 0
  v_mfma_f32_16x16x32_bf16 v[52:55], a[160:163], v[80:83], 0
  s_waitcnt lgkmcnt(2)
  v_mfma_f32_16x16x32_bf16 v[32:35], a[4:7], v[84:87], v[32:35]
  ds_read_b128 v[76:79], v11 offset:3072
  v_mfma_f32_16x16x32_bf16 v[40:43], a[84:87], v[84:87], v[40:43]
  ds_read_b128 v[80:83], v11 offset:23552
  v_mfma_f32_16x16x32_bf16 v[48:51], a[164:167], v[84:87], v[48:51]
  v_mfma_f32_16x16x32_bf16 v[36:39], a[4:7], v[88:91], v[36:39]
  buffer_load_dwordx4 v2, s[8:11], s27 offen offset:1024 lds
  v_mfma_f32_16x16x32_bf16 v[44:47], a[84:87], v[88:91], v[44:47]
  v_mfma_f32_16x16x32_bf16 v[52:55], a[164:167], v[88:91], v[52:55]
  s_waitcnt lgkmcnt(2)
  v_mfma_f32_16x16x32_bf16 v[32:35], a[8:11], v[92:95], v[32:35]
  ds_read_b128 v[84:87], v11 offset:4096
  v_mfma_f32_16x16x32_bf16 v[40:43], a[88:91], v[92:95], v[40:43]
  ds_read_b128 v[88:91], v11 offset:24576
  v_mfma_f32_16x16x32_bf16 v[48:51], a[168:171], v[92:95], v[48:51]
  v_mfma_f32_16x16x32_bf16 v[36:39], a[8:11], v[96:99], v[36:39]
  buffer_load_dwordx4 v2, s[8:11], s27 offen offset:2048 lds
  v_mfma_f32_16x16x32_bf16 v[44:47], a[88:91], v[96:99], v[44:47]
  v_mfma_f32_16x16x32_bf16 v[52:55], a[168:171], v[96:99], v[52:55]
  s_waitcnt lgkmcnt(2)
  v_mfma_f32_16x16x32_bf16 v[32:35], a[12:15], v[76:79], v[32:35]
  ds_read_b128 v[92:95], v11 offset:5120
  v_mfma_f32_16x16x32_bf16 v[40:43], a[92:95], v[76:79], v[40:43]
  ds_read_b128 v[96:99], v11 offset:25600
  v_mfma_f32_16x16x32_bf16 v[48:51], a[172:175], v[76:79], v[48:51]
  v_mfma_f32_16x16x32_bf16 v[36:39], a[12:15], v[80:83], v[36:39]
  buffer_load_dwordx4 v2, s[8:11], s27 offen offset:3072 lds
  v_mfma_f32_16x16x32_bf16 v[44:47], a[92:95], v[80:83], v[44:47]
  v_mfma_f32_16x16x32_bf16 v[52:55], a[172:175], v[80:83], v[52:55]
  s_waitcnt lgkmcnt(2)
  v_mfma_f32_16x16x32_bf16 v[32:35], a[16:19], v[84:87], v[32:35]
  ds_read_b128 v[76:79], v11 offset:6144
  v_mfma_f32_16x16x32_bf16 v[40:43], a[96:99], v[84:87], v[40:43]
  ds_read_b128 v[80:83], v11 offset:26624
  v_mfma_f32_16x16x32_bf16 v[48:51], a[176:179], v[84:87], v[48:51]
  s_add_u32 m0, s73, 4096
  s_add_u32 s27, s74, 4096
  v_mfma_f32_16x16x32_bf16 v[36:39], a[16:19], v[88:91], v[36:39]
  buffer_load_dwordx4 v2, s[8:11], s27 offen offset:0 lds
  v_mfma_f32_16x16x32_bf16 v[44:47], a[96:99], v[88:91], v[44:47]
  v_mfma_f32_16x16x32_bf16 v[52:55], a[176:179], v[88:91], v[52:55]
  s_waitcnt lgkmcnt(2)
  v_mfma_f32_16x16x32_bf16 v[32:35], a[20:23], v[92:95], v[32:35]
  ds_read_b128 v[84:87], v11 offset:7168
  v_mfma_f32_16x16x32_bf16 v[40:43], a[100:103], v[92:95], v[40:43]
  ds_read_b128 v[88:91], v11 offset:27648
  v_mfma_f32_16x16x32_bf16 v[48:51], a[180:183], v[92:95], v[48:51]
  v_mfma_f32_16x16x32_bf16 v[36:39], a[20:23], v[96:99], v[36:39]
  buffer_load_dwordx4 v2, s[8:11], s27 offen offset:1024 lds
  v_mfma_f32_16x16x32_bf16 v[44:47], a[100:103], v[96:99], v[44:47]
  v_mfma_f32_16x16x32_bf16 v[52:55], a[180:183], v[96:99], v[52:55]
  s_waitcnt lgkmcnt(2)
  v_mfma_f32_16x16x32_bf16 v[32:35], a[24:27], v[76:79], v[32:35]
  ds_read_b128 v[92:95], v11 offset:8192
  v_mfma_f32_16x16x32_bf16 v[40:43], a[104:107], v[76:79], v[40:43]
  ds_read_b128 v[96:99], v11 offset:28672
  v_mfma_f32_16x16x32_bf16 v[48:51], a[184:187], v[76:79], v[48:51]
  v_mfma_f32_16x16x32_bf16 v[36:39], a[24:27], v[80:83], v[36:39]
  buffer_load_dwordx4 v2, s[8:11], s27 offen offset:2048 lds
  v_mfma_f32_16x16x32_bf16 v[44:47], a[104:107], v[80:83], v[44:47]
  v_mfma_f32_16x16x32_bf16 v[52:55], a[184:187], v[80:83], v[52:55]
  s_waitcnt lgkmcnt(2)
  v_mfma_f32_16x16x32_bf16 v[32:35], a[28:31], v[84:87], v[32:35]
  ds_read_b128 v[76:79], v11 offset:9216
  v_mfma_f32_16x16x32_bf16 v[40:43], a[108:111], v[84:87], v[40:43]
  ds_read_b128 v[80:83], v11 offset:29696
  v_mfma_f32_16x16x32_bf16 v[48:51], a[188:191], v[84:87], v[48:51]
  v_mfma_f32_16x16x32_bf16 v[36:39], a[28:31], v[88:91], v[36:39]
  buffer_load_dwordx4 v2, s[8:11], s27 offen offset:3072 lds
  v_mfma_f32_16x16x32_bf16 v[44:47], a[108:111], v[88:91], v[44:47]
  v_mfma_f32_16x16x32_bf16 v[52:55], a[188:191], v[88:91], v[52:55]
  s_waitcnt lgkmcnt(2)
  v_mfma_f32_16x16x32_bf16 v[32:35], a[32:35], v[92:95], v[32:35]
  ds_read_b128 v[84:87], v11 offset:10240
  v_mfma_f32_16x16x32_bf16 v[40:43], a[112:115], v[92:95], v[40:43]
  ds_read_b128 v[88:91], v11 offset:30720
  v_mfma_f32_16x16x32_bf16 v[48:51], a[192:195], v[92:95], v[48:51]
  s_add_u32 m0, s73, 8192
  s_add_u32 s27, s74, 8192
  v_mfma_f32_16x16x32_bf16 v[36:39], a[32:35], v[96:99], v[36:39]
  buffer_load_dwordx4 v2, s[8:11], s27 offen offset:0 lds
  v_mfma_f32_16x16x32_bf16 v[44:47], a[112:115], v[96:99], v[44:47]
  v_mfma_f32_16x16x32_bf16 v[52:55], a[192:195], v[96:99], v[52:55]
  s_waitcnt lgkmcnt(2)
  v_mfma_f32_16x16x32_bf16 v[32:35], a[36:39], v[76:79], v[32:35]
  ds_read_b128 v[92:95], v11 offset:11264
  v_mfma_f32_16x16x32_bf16 v[40:43], a[116:119], v[76:79], v[40:43]
  ds_read_b128 v[96:99], v11 offset:31744
  v_mfma_f32_16x16x32_bf16 v[48:51], a[196:199], v[76:79], v[48:51]
  v_mfma_f32_16x16x32_bf16 v[36:39], a[36:39], v[80:83], v[36:39]
  buffer_load_dwordx4 v2, s[8:11], s27 offen offset:1024 lds
  v_mfma_f32_16x16x32_bf16 v[44:47], a[116:119], v[80:83], v[44:47]
  v_mfma_f32_16x16x32_bf16 v[52:55], a[196:199], v[80:83], v[52:55]
  s_waitcnt lgkmcnt(2)
  v_mfma_f32_16x16x32_bf16 v[32:35], a[40:43], v[84:87], v[32:35]
  ds_read_b128 v[76:79], v11 offset:12288
  v_mfma_f32_16x16x32_bf16 v[40:43], a[120:123], v[84:87], v[40:43]
  ds_read_b128 v[80:83], v11 offset:32768
  v_mfma_f32_16x16x32_bf16 v[48:51], a[200:203], v[84:87], v[48:51]
  v_mfma_f32_16x16x32_bf16 v[36:39], a[40:43], v[88:91], v[36:39]
  v_mfma_f32_16x16x32_bf16 v[44:47], a[120:123], v[88:91], v[44:47]
  v_mfma_f32_16x16x32_bf16 v[52:55], a[200:203], v[88:91], v[52:55]
  s_waitcnt lgkmcnt(2)
  v_mfma_f32_16x16x32_bf16 v[32:35], a[44:47], v[92:95], v[32:35]
  ds_read_b128 v[84:87], v11 offset:13312
  v_mfma_f32_16x16x32_bf16 v[40:43], a[124:127], v[92:95], v[40:43]
  ds_read_b128 v[88:91], v11 offset:33792
  v_mfma_f32_16x16x32_bf16 v[48:51], a[204:207], v[92:95], v[48:51]
  v_mfma_f32_16x16x32_bf16 v[36:39], a[44:47], v[96:99], v[36:39]
  v_mfma_f32_16x16x32_bf16 v[44:47], a[124:127], v[96:99], v[44:47]
  v_mfma_f32_16x16x32_bf16 v[52:55], a[204:207], v[96:99], v[52:55]
  s_cmp_lt_u32 s36, 4
  s_cbranch_scc1 wa_34
  s_waitcnt vmcnt(15)
  s_sub_u32 s30, s36, 1
  s_branch wb_35
wa_34:
  s_waitcnt vmcnt(10)
  s_mov_b32 s30, s36
wb_35:
  v_mov_b32 v15, s30
  s_mov_b64 exec, 1
  buffer_store_dword v15, off, s[8:11], s34 sc1
  s_mov_b64 exec, -1
  s_waitcnt lgkmcnt(2)
  v_mfma_f32_16x16x32_bf16 v[32:35], a[48:51], v[76:79], v[32:35]
  ds_read_b128 v[92:95], v11 offset:14336
  v_mfma_f32_16x16x32_bf16 v[40:43], a[128:131], v[76:79], v[40:43]
  ds_read_b128 v[96:99], v11 offset:34816
  v_mfma_f32_16x16x32_bf16 v[48:51], a[208:211], v[76:79], v[48:51]
  v_mfma_f32_16x16x32_bf16 v[36:39], a[48:51], v[80:83], v[36:39]
  v_mfma_f32_16x16x32_bf16 v[44:47], a[128:131], v[80:83], v[44:47]
  v_mfma_f32_16x16x32_bf16 v[52:55], a[208:211], v[80:83], v[52:55]
  s_waitcnt lgkmcnt(2)
  v_mfma_f32_16x16x32_bf16 v[32:35], a[52:55], v[84:87], v[32:35]
  ds_read_b128 v[76:79], v11 offset:15360
  v_mfma_f32_16x16x32_bf16 v[40:43], a[132:135], v[84:87], v[40:43]
  ds_read_b128 v[80:83], v11 offset:35840
  v_mfma_f32_16x16x32_bf16 v[48:51], a[212:215], v[84:87], v[48:51]
  v_mfma_f32_16x16x32_bf16 v[36:39], a[52:55], v[88:91], v[36:39]
  v_mfma_f32_16x16x32_bf16 v[44:47], a[132:135], v[88:91], v[44:47]
  v_mfma_f32_16x16x32_bf16 v[52:55], a[212:215], v[88:91], v[52:55]
  s_waitcnt lgkmcnt(2)
  v_mfma_f32_16x16x32_bf16 v[32:35], a[56:59], v[92:95], v[32:35]
  ds_read_b128 v[84:87], v11 offset:16384
  v_mfma_f32_16x16x32_bf16 v[40:43], a[136:139], v[92:95], v[40:43]
  ds_read_b128 v[88:91], v11 offset:36864
  v_mfma_f32_16x16x32_bf16 v[48:51], a[216:219], v[92:95], v[48:51]
  v_mfma_f32_16x16x32_bf16 v[36:39], a[56:59], v[96:99], v[36:39]
  v_mfma_f32_16x16x32_bf16 v[44:47], a[136:139], v[96:99], v[44:47]
  v_mfma_f32_16x16x32_bf16 v[52:55], a[216:219], v[96:99], v[52:55]
  s_waitcnt lgkmcnt(2)
  v_mfma_f32_16x16x32_bf16 v[32:35], a[60:63], v[76:79], v[32:35]
  ds_read_b128 v[92:95], v11 offset:17408
  v_mfma_f32_16x16x32_bf16 v[40:43], a[140:143], v[76:79], v[40:43]
  ds_read_b128 v[96:99], v11 offset:37888
  v_mfma_f32_16x16x32_bf16 v[48:51], a[220:223], v[76:79], v[48:51]
  v_mfma_f32_16x16x32_bf16 v[36:39], a[60:63], v[80:83], v[36:39]
  v_mfma_f32_16x16x32_bf16 v[44:47], a[140:143], v[80:83], v[44:47]
  v_mfma_f32_16x16x32_bf16 v[52:55], a[220:223], v[80:83], v[52:55]
  s_waitcnt lgkmcnt(2)
  v_mfma_f32_16x16x32_bf16 v[32:35], a[64:67], v[84:87], v[32:35]
  ds_read_b128 v[76:79], v11 offset:18432
  v_mfma_f32_16x16x32_bf16 v[40:43], a[144:147], v[84:87], v[40:43]
  ds_read_b128 v[80:83], v11 offset:38912
  v_mfma_f32_16x16x32_bf16 v[48:51], a[224:227], v[84:87], v[48:51]
  v_mfma_f32_16x16x32_bf16 v[36:39], a[64:67], v[88:91], v[36:39]
  v_mfma_f32_16x16x32_bf16 v[44:47], a[144:147], v[88:91], v[44:47]
  v_mfma_f32_16x16x32_bf16 v[52:55], a[224:227], v[88:91], v[52:55]
  s_waitcnt lgkmcnt(2)
  v_mfma_f32_16x16x32_bf16 v[32:35], a[68:71], v[92:95], v[32:35]
  ds_read_b128 v[84:87], v11 offset:19456
  v_mfma_f32_16x16x32_bf16 v[40:43], a[148:151], v[92:95], v[40:43]
  ds_read_b128 v[88:91], v11 offset:39936
  v_mfma_f32_16x16x32_bf16 v[48:51], a[228:231], v[92:95], v[48:51]
  v_mfma_f32_16x16x32_bf16 v[36:39], a[68:71], v[96:99], v[36:39]
  v_mfma_f32_16x16x32_bf16 v[44:47], a[148:151], v[96:99], v[44:47]
  v_mfma_f32_16x16x32_bf16 v[52:55], a[228:231], v[96:99], v[52:55]
  s_waitcnt lgkmcnt(2)
  v_mfma_f32_16x16x32_bf16 v[32:35], a[72:75], v[76:79], v[32:35]
  v_mfma_f32_16x16x32_bf16 v[40:43], a[152:155], v[76:79], v[40:43]
  v_mfma_f32_16x16x32_bf16 v[48:51], a[232:235], v[76:79], v[48:51]
  v_mfma_f32_16x16x32_bf16 v[36:39], a[72:75], v[80:83], v[36:39]
  v_mfma_f32_16x16x32_bf16 v[44:47], a[152:155], v[80:83], v[44:47]
  v_mfma_f32_16x16x32_bf16 v[52:55], a[232:235], v[80:83], v[52:55]
  s_waitcnt lgkmcnt(0)
  v_mfma_f32_16x16x32_bf16 v[32:35], a[76:79], v[84:87], v[32:35]
  v_mfma_f32_16x16x32_bf16 v[40:43], a[156:159], v[84:87], v[40:43]
  v_mfma_f32_16x16x32_bf16 v[48:51], a[236:239], v[84:87], v[48:51]
  v_mfma_f32_16x16x32_bf16 v[36:39], a[76:79], v[88:91], v[36:39]
  v_mfma_f32_16x16x32_bf16 v[44:47], a[156:159], v[88:91], v[44:47]
  v_mfma_f32_16x16x32_bf16 v[52:55], a[236:239], v[88:91], v[52:55]
  s_nop 2
  v_cvt_pk_bf16_f32 v56, v32, v33
  v_cvt_pk_bf16_f32 v57, v34, v35
  v_cvt_pk_bf16_f32 v58, v40, v41
  v_cvt_pk_bf16_f32 v59, v42, v43
  v_cvt_pk_bf16_f32 v64, v48, v49
  v_cvt_pk_bf16_f32 v65, v50, v51
  v_cvt_pk_bf16_f32 v60, v36, v37
  v_cvt_pk_bf16_f32 v61, v38, v39
  v_cvt_pk_bf16_f32 v62, v44, v45
  v_cvt_pk_bf16_f32 v63, v46, v47
  v_cvt_pk_bf16_f32 v66, v52, v53
  v_cvt_pk_bf16_f32 v67, v54, v55
  buffer_store_dwordx4 v[56:59], v12, s[8:11], s35 offen offset:0 sc1
  buffer_store_dwordx4 v[60:63], v12, s[8:11], s35 offen offset:1024 sc1
  buffer_store_dwordx2 v[64:65], v13, s[8:11], s35 offen offset:0 sc1
  buffer_store_dwordx2 v[66:67], v13, s[8:11], s35 offen offset:1024 sc1
  s_cmp_ge_u32 s36, 2
  s_cbranch_scc1 we_36
  s_waitcnt vmcnt(0)
  s_add_u32 s30, s36, 1
  v_mov_b32 v15, s30
  s_mov_b64 exec, 1
  buffer_store_dword v15, off, s[8:11], s34 sc1
  s_mov_b64 exec, -1
we_36:
  s_add_u32 s35, s35, 393216
  s_add_u32 s38, s38, 40960
  s_cmp_eq_u32 s38, 122880
  s_cselect_b32 s38, 0, s38
  s_add_u32 s72, s72, 40960
  s_cmp_eq_u32 s72, 122880
  s_cselect_b32 s72, 0, s72
  s_add_u32 s36, s36, 1
  s_cmp_lt_u32 s36, 64
  s_cbranch_scc1 WV_loop
  s_waitcnt vmcnt(0)
  v_mov_b32 v15, s36
  s_mov_b64 exec, 1
  buffer_store_dword v15, off, s[8:11], s34 sc1
  s_mov_b64 exec, -1
  s_branch L_exit2
WQ:
  s_mov_b32 s12, s44
  s_and_b32 s13, s45, 0xffff
  s_mov_b32 s14, 7864320
  s_mov_b32 s15, 0x20000
  s_mov_b32 s30, 12288
  v_add_u32 v68, 0, v1
  s_mov_b32 s27, 43691
  v_mul_lo_u32 v69, v68, s27
  v_lshrrev_b32 v69, 18, v69
  v_mul_u32_u24 v4, 6, v69
  v_sub_u32 v70, v68, v4
  v_mul_lo_u32 v69, v69, s30
  v_lshl_add_u32 v4, v70, 4, v69
  v_add_u32 v68, 64, v1
  s_mov_b32 s27, 43691
  v_mul_lo_u32 v69, v68, s27
  v_lshrrev_b32 v69, 18, v69
  v_mul_u32_u24 v5, 6, v69
  v_sub_u32 v70, v68, v5
  v_mul_lo_u32 v69, v69, s30
  v_lshl_add_u32 v5, v70, 4, v69
  v_add_u32 v68, 128, v1
  s_mov_b32 s27, 43691
  v_mul_lo_u32 v69, v68, s27
  v_lshrrev_b32 v69, 18, v69
  v_mul_u32_u24 v6, 6, v69
  v_sub_u32 v70, v68, v6
  v_mul_lo_u32 v69, v69, s30
  v_lshl_add_u32 v6, v70, 4, v69
  v_add_u32 v68, 192, v1
  s_mov_b32 s27, 43691
  v_mul_lo_u32 v69, v68, s27
  v_lshrrev_b32 v69, 18, v69
  v_mul_u32_u24 v7, 6, v69
  v_sub_u32 v70, v68, v7
  v_mul_lo_u32 v69, v69, s30
  v_lshl_add_u32 v7, v70, 4, v69
  v_add_u32 v68, 256, v1
  s_mov_b32 s27, 43691
  v_mul_lo_u32 v69, v68, s27
  v_lshrrev_b32 v69, 18, v69
  v_mul_u32_u24 v8, 6, v69
  v_sub_u32 v70, v68, v8
  v_mul_lo_u32 v69, v69, s30
  v_lshl_add_u32 v8, v70, 4, v69
  v_add_u32 v68, 320, v1
  s_mov_b32 s27, 43691
  v_mul_lo_u32 v69, v68, s27
  v_lshrrev_b32 v69, 18, v69
  v_mul_u32_u24 v9, 6, v69
  v_sub_u32 v70, v68, v9
  v_mul_lo_u32 v69, v69, s30
  v_lshl_add_u32 v9, v70, 4, v69
  v_bfe_u32 v68, v1, 5, 1
  v_mul_u32_u24 v3, 1536, v68
  v_bfe_u32 v68, v1, 4, 1
  v_mul_u32_u24 v68, 768, v68
  v_add_u32 v3, v3, v68
  v_bfe_u32 v68, v1, 2, 1
  v_mul_u32_u24 v68, 96, v68
  v_add_u32 v3, v3, v68
  v_bfe_u32 v68, v1, 3, 1
  v_mul_u32_u24 v68, 192, v68
  v_add_u32 v3, v3, v68
  v_and_b32 v68, 3, v1
  v_lshl_add_u32 v3, v68, 3, v3
  s_mul_i32 s27, s24, 30720
  v_add_u32 v3, s27, v3
  s_mul_i32 s32, s25, 384
  s_mul_i32 s27, s24, 96
  s_add_u32 s32, s32, s27
  s_mul_i32 s31, s24, 30720
  s_add_u32 m0, s31, 0
  s_add_u32 s27, s32, 0
  buffer_load_dwordx4 v4, s[12:15], s27 offen  lds
  s_add_u32 m0, s31, 1024
  s_add_u32 s27, s32, 0
  buffer_load_dwordx4 v5, s[12:15], s27 offen  lds
  s_add_u32 m0, s31, 2048
  s_add_u32 s27, s32, 0
  buffer_load_dwordx4 v6, s[12:15], s27 offen  lds
  s_add_u32 m0, s31, 3072
  s_add_u32 s27, s32, 0
  buffer_load_dwordx4 v7, s[12:15], s27 offen  lds
  s_add_u32 m0, s31, 4096
  s_add_u32 s27, s32, 0
  buffer_load_dwordx4 v8, s[12:15], s27 offen  lds
  s_add_u32 m0, s31, 5120
  s_add_u32 s27, s32, 0
  buffer_load_dwordx4 v9, s[12:15], s27 offen  lds
  s_add_u32 m0, s31, 6144
  s_add_u32 s27, s32, 786432
  buffer_load_dwordx4 v4, s[12:15], s27 offen  lds
  s_add_u32 m0, s31, 7168
  s_add_u32 s27, s32, 786432
  buffer_load_dwordx4 v5, s[12:15], s27 offen  lds
  s_add_u32 m0, s31, 8192
  s_add_u32 s27, s32, 786432
  buffer_load_dwordx4 v6, s[12:15], s27 offen  lds
  s_add_u32 m0, s31, 9216
  s_add_u32 s27, s32, 786432
  buffer_load_dwordx4 v7, s[12:15], s27 offen  lds
  s_add_u32 m0, s31, 10240
  s_add_u32 s27, s32, 786432
  buffer_load_dwordx4 v8, s[12:15], s27 offen  lds
  s_add_u32 m0, s31, 11264
  s_add_u32 s27, s32, 786432
  buffer_load_dwordx4 v9, s[12:15], s27 offen  lds
  s_add_u32 m0, s31, 12288
  s_add_u32 s27, s32, 1572864
  buffer_load_dwordx4 v4, s[12:15], s27 offen  lds
  s_add_u32 m0, s31, 13312
  s_add_u32 s27, s32, 1572864
  buffer_load_dwordx4 v5, s[12:15], s27 offen  lds
  s_add_u32 m0, s31, 14336
  s_add_u32 s27, s32, 1572864
  buffer_load_dwordx4 v6, s[12:15], s27 offen  lds
  s_add_u32 m0, s31, 15360
  s_add_u32 s27, s32, 1572864
  buffer_load_dwordx4 v7, s[12:15], s27 offen  lds
  s_add_u32 m0, s31, 16384
  s_add_u32 s27, s32, 1572864
  buffer_load_dwordx4 v8, s[12:15], s27 offen  lds
  s_add_u32 m0, s31, 17408
  s_add_u32 s27, s32, 1572864
  buffer_load_dwordx4 v9, s[12:15], s27 offen  lds
  s_add_u32 m0, s31, 18432
  s_add_u32 s27, s32, 2359296
  buffer_load_dwordx4 v4, s[12:15], s27 offen  lds
  s_add_u32 m0, s31, 19456
  s_add_u32 s27, s32, 2359296
  buffer_load_dwordx4 v5, s[12:15], s27 offen  lds
  s_add_u32 m0, s31, 20480
  s_add_u32 s27, s32, 2359296
  buffer_load_dwordx4 v6, s[12:15], s27 offen  lds
  s_add_u32 m0, s31, 21504
  s_add_u32 s27, s32, 2359296
  buffer_load_dwordx4 v7, s[12:15], s27 offen  lds
  s_add_u32 m0, s31, 22528
  s_add_u32 s27, s32, 2359296
  buffer_load_dwordx4 v8, s[12:15], s27 offen  lds
  s_add_u32 m0, s31, 23552
  s_add_u32 s27, s32, 2359296
  buffer_load_dwordx4 v9, s[12:15], s27 offen  lds
  s_add_u32 m0, s31, 24576
  s_add_u32 s27, s32, 3145728
  buffer_load_dwordx4 v4, s[12:15], s27 offen  lds
  s_add_u32 m0, s31, 25600
  s_add_u32 s27, s32, 3145728
  buffer_load_dwordx4 v5, s[12:15], s27 offen  lds
  s_add_u32 m0, s31, 26624
  s_add_u32 s27, s32, 3145728
  buffer_load_dwordx4 v6, s[12:15], s27 offen  lds
  s_add_u32 m0, s31, 27648
  s_add_u32 s27, s32, 3145728
  buffer_load_dwordx4 v7, s[12:15], s27 offen  lds
  s_add_u32 m0, s31, 28672
  s_add_u32 s27, s32, 3145728
  buffer_load_dwordx4 v8, s[12:15], s27 offen  lds
  s_add_u32 m0, s31, 29696
  s_add_u32 s27, s32, 3145728
  buffer_load_dwordx4 v9, s[12:15], s27 offen  lds
  s_waitcnt vmcnt(24)
  ds_read_b64_tr_b16 a[0:1], v3 offset:0
  ds_read_b64_tr_b16 a[2:3], v3 offset:384
  ds_read_b64_tr_b16 a[4:5], v3 offset:3072
  ds_read_b64_tr_b16 a[6:7], v3 offset:3456
  ds_read_b64_tr_b16 a[80:81], v3 offset:32
  ds_read_b64_tr_b16 a[82:83], v3 offset:416
  ds_read_b64_tr_b16 a[84:85], v3 offset:3104
  ds_read_b64_tr_b16 a[86:87], v3 offset:3488
  ds_read_b64_tr_b16 a[160:161], v3 offset:64
  ds_read_b64_tr_b16 a[162:163], v3 offset:448
  ds_read_b64_tr_b16 a[164:165], v3 offset:3136
  ds_read_b64_tr_b16 a[166:167], v3 offset:3520
  s_waitcnt lgkmcnt(0)
  s_add_u32 m0, s31, 0
  s_add_u32 s27, s32, 3932160
  buffer_load_dwordx4 v4, s[12:15], s27 offen  lds
  s_add_u32 m0, s31, 1024
  s_add_u32 s27, s32, 3932160
  buffer_load_dwordx4 v5, s[12:15], s27 offen  lds
  s_add_u32 m0, s31, 2048
  s_add_u32 s27, s32, 3932160
  buffer_load_dwordx4 v6, s[12:15], s27 offen  lds
  s_add_u32 m0, s31, 3072
  s_add_u32 s27, s32, 3932160
  buffer_load_dwordx4 v7, s[12:15], s27 offen  lds
  s_add_u32 m0, s31, 4096
  s_add_u32 s27, s32, 3932160
  buffer_load_dwordx4 v8, s[12:15], s27 offen  lds
  s_add_u32 m0, s31, 5120
  s_add_u32 s27, s32, 3932160
  buffer_load_dwordx4 v9, s[12:15], s27 offen  lds
  s_waitcnt vmcnt(24)
  ds_read_b64_tr_b16 a[8:9], v3 offset:6144
  ds_read_b64_tr_b16 a[10:11], v3 offset:6528
  ds_read_b64_tr_b16 a[12:13], v3 offset:9216
  ds_read_b64_tr_b16 a[14:15], v3 offset:9600
  ds_read_b64_tr_b16 a[88:89], v3 offset:6176
  ds_read_b64_tr_b16 a[90:91], v3 offset:6560
  ds_read_b64_tr_b16 a[92:93], v3 offset:9248
  ds_read_b64_tr_b16 a[94:95], v3 offset:9632
  ds_read_b64_tr_b16 a[168:169], v3 offset:6208
  ds_read_b64_tr_b16 a[170:171], v3 offset:6592
  ds_read_b64_tr_b16 a[172:173], v3 offset:9280
  ds_read_b64_tr_b16 a[174:175], v3 offset:9664
  s_waitcnt lgkmcnt(0)
  s_add_u32 m0, s31, 6144
  s_add_u32 s27, s32, 4718592
  buffer_load_dwordx4 v4, s[12:15], s27 offen  lds
  s_add_u32 m0, s31, 7168
  s_add_u32 s27, s32, 4718592
  buffer_load_dwordx4 v5, s[12:15], s27 offen  lds
  s_add_u32 m0, s31, 8192
  s_add_u32 s27, s32, 4718592
  buffer_load_dwordx4 v6, s[12:15], s27 offen  lds
  s_add_u32 m0, s31, 9216
  s_add_u32 s27, s32, 4718592
  buffer_load_dwordx4 v7, s[12:15], s27 offen  lds
  s_add_u32 m0, s31, 10240
  s_add_u32 s27, s32, 4718592
  buffer_load_dwordx4 v8, s[12:15], s27 offen  lds
  s_add_u32 m0, s31, 11264
  s_add_u32 s27, s32, 4718592
  buffer_load_dwordx4 v9, s[12:15], s27 offen  lds
  s_waitcnt vmcnt(24)
  ds_read_b64_tr_b16 a[16:17], v3 offset:12288
  ds_read_b64_tr_b16 a[18:19], v3 offset:12672
  ds_read_b64_tr_b16 a[20:21], v3 offset:15360
  ds_read_b64_tr_b16 a[22:23], v3 offset:15744
  ds_read_b64_tr_b16 a[96:97], v3 offset:12320
  ds_read_b64_tr_b16 a[98:99], v3 offset:12704
  ds_read_b64_tr_b16 a[100:101], v3 offset:15392
  ds_read_b64_tr_b16 a[102:103], v3 offset:15776
  ds_read_b64_tr_b16 a[176:177], v3 offset:12352
  ds_read_b64_tr_b16 a[178:179], v3 offset:12736
  ds_read_b64_tr_b16 a[180:181], v3 offset:15424
  ds_read_b64_tr_b16 a[182:183], v3 offset:15808
  s_waitcnt lgkmcnt(0)
  s_add_u32 m0, s31, 12288
  s_add_u32 s27, s32, 5505024
  buffer_load_dwordx4 v4, s[12:15], s27 offen  lds
  s_add_u32 m0, s31, 13312
  s_add_u32 s27, s32, 5505024
  buffer_load_dwordx4 v5, s[12:15], s27 offen  lds
  s_add_u32 m0, s31, 14336
  s_add_u32 s27, s32, 5505024
  buffer_load_dwordx4 v6, s[12:15], s27 offen  lds
  s_add_u32 m0, s31, 15360
  s_add_u32 s27, s32, 5505024
  buffer_load_dwordx4 v7, s[12:15], s27 offen  lds
  s_add_u32 m0, s31, 16384
  s_add_u32 s27, s32, 5505024
  buffer_load_dwordx4 v8, s[12:15], s27 offen  lds
  s_add_u32 m0, s31, 17408
  s_add_u32 s27, s32, 5505024
  buffer_load_dwordx4 v9, s[12:15], s27 offen  lds
  s_waitcnt vmcnt(24)
  ds_read_b64_tr_b16 a[24:25], v3 offset:18432
  ds_read_b64_tr_b16 a[26:27], v3 offset:18816
  ds_read_b64_tr_b16 a[28:29], v3 offset:21504
  ds_read_b64_tr_b16 a[30:31], v3 offset:21888
  ds_read_b64_tr_b16 a[104:105], v3 offset:18464
  ds_read_b64_tr_b16 a[106:107], v3 offset:18848
  ds_read_b64_tr_b16 a[108:109], v3 offset:21536
  ds_read_b64_tr_b16 a[110:111], v3 offset:21920
  ds_read_b64_tr_b16 a[184:185], v3 offset:18496
  ds_read_b64_tr_b16 a[186:187], v3 offset:18880
  ds_read_b64_tr_b16 a[188:189], v3 offset:21568
  ds_read_b64_tr_b16 a[190:191], v3 offset:21952
  s_waitcnt lgkmcnt(0)
  s_add_u32 m0, s31, 18432
  s_add_u32 s27, s32, 6291456
  buffer_load_dwordx4 v4, s[12:15], s27 offen  lds
  s_add_u32 m0, s31, 19456
  s_add_u32 s27, s32, 6291456
  buffer_load_dwordx4 v5, s[12:15], s27 offen  lds
  s_add_u32 m0, s31, 20480
  s_add_u32 s27, s32, 6291456
  buffer_load_dwordx4 v6, s[12:15], s27 offen  lds
  s_add_u32 m0, s31, 21504
  s_add_u32 s27, s32, 6291456
  buffer_load_dwordx4 v7, s[12:15], s27 offen  lds
  s_add_u32 m0, s31, 22528
  s_add_u32 s27, s32, 6291456
  buffer_load_dwordx4 v8, s[12:15], s27 offen  lds
  s_add_u32 m0, s31, 23552
  s_add_u32 s27, s32, 6291456
  buffer_load_dwordx4 v9, s[12:15], s27 offen  lds
  s_waitcnt vmcnt(24)
  ds_read_b64_tr_b16 a[32:33], v3 offset:24576
  ds_read_b64_tr_b16 a[34:35], v3 offset:24960
  ds_read_b64_tr_b16 a[36:37], v3 offset:27648
  ds_read_b64_tr_b16 a[38:39], v3 offset:28032
  ds_read_b64_tr_b16 a[112:113], v3 offset:24608
  ds_read_b64_tr_b16 a[114:115], v3 offset:24992
  ds_read_b64_tr_b16 a[116:117], v3 offset:27680
  ds_read_b64_tr_b16 a[118:119], v3 offset:28064
  ds_read_b64_tr_b16 a[192:193], v3 offset:24640
  ds_read_b64_tr_b16 a[194:195], v3 offset:25024
  ds_read_b64_tr_b16 a[196:197], v3 offset:27712
  ds_read_b64_tr_b16 a[198:199], v3 offset:28096
  s_waitcnt lgkmcnt(0)
  s_add_u32 m0, s31, 24576
  s_add_u32 s27, s32, 7077888
  buffer_load_dwordx4 v4, s[12:15], s27 offen  lds
  s_add_u32 m0, s31, 25600
  s_add_u32 s27, s32, 7077888
  buffer_load_dwordx4 v5, s[12:15], s27 offen  lds
  s_add_u32 m0, s31, 26624
  s_add_u32 s27, s32, 7077888
  buffer_load_dwordx4 v6, s[12:15], s27 offen  lds
  s_add_u32 m0, s31, 27648
  s_add_u32 s27, s32, 7077888
  buffer_load_dwordx4 v7, s[12:15], s27 offen  lds
  s_add_u32 m0, s31, 28672
  s_add_u32 s27, s32, 7077888
  buffer_load_dwordx4 v8, s[12:15], s27 offen  lds
  s_add_u32 m0, s31, 29696
  s_add_u32 s27, s32, 7077888
  buffer_load_dwordx4 v9, s[12:15], s27 offen  lds
  s_waitcnt vmcnt(24)
  ds_read_b64_tr_b16 a[40:41], v3 offset:0
  ds_read_b64_tr_b16 a[42:43], v3 offset:384
  ds_read_b64_tr_b16 a[44:45], v3 offset:3072
  ds_read_b64_tr_b16 a[46:47], v3 offset:3456
  ds_read_b64_tr_b16 a[120:121], v3 offset:32
  ds_read_b64_tr_b16 a[122:123], v3 offset:416
  ds_read_b64_tr_b16 a[124:125], v3 offset:3104
  ds_read_b64_tr_b16 a[126:127], v3 offset:3488
  ds_read_b64_tr_b16 a[200:201], v3 offset:64
  ds_read_b64_tr_b16 a[202:203], v3 offset:448
  ds_read_b64_tr_b16 a[204:205], v3 offset:3136
  ds_read_b64_tr_b16 a[206:207], v3 offset:3520
  s_waitcnt lgkmcnt(0)
  s_waitcnt vmcnt(18)
  ds_read_b64_tr_b16 a[48:49], v3 offset:6144
  ds_read_b64_tr_b16 a[50:51], v3 offset:6528
  ds_read_b64_tr_b16 a[52:53], v3 offset:9216
  ds_read_b64_tr_b16 a[54:55], v3 offset:9600
  ds_read_b64_tr_b16 a[128:129], v3 offset:6176
  ds_read_b64_tr_b16 a[130:131], v3 offset:6560
  ds_read_b64_tr_b16 a[132:133], v3 offset:9248
  ds_read_b64_tr_b16 a[134:135], v3 offset:9632
  ds_read_b64_tr_b16 a[208:209], v3 offset:6208
  ds_read_b64_tr_b16 a[210:211], v3 offset:6592
  ds_read_b64_tr_b16 a[212:213], v3 offset:9280
  ds_read_b64_tr_b16 a[214:215], v3 offset:9664
  s_waitcnt lgkmcnt(0)
  s_waitcnt vmcnt(12)
  ds_read_b64_tr_b16 a[56:57], v3 offset:12288
  ds_read_b64_tr_b16 a[58:59], v3 offset:12672
  ds_read_b64_tr_b16 a[60:61], v3 offset:15360
  ds_read_b64_tr_b16 a[62:63], v3 offset:15744
  ds_read_b64_tr_b16 a[136:137], v3 offset:12320
  ds_read_b64_tr_b16 a[138:139], v3 offset:12704
  ds_read_b64_tr_b16 a[140:141], v3 offset:15392
  ds_read_b64_tr_b16 a[142:143], v3 offset:15776
  ds_read_b64_tr_b16 a[216:217], v3 offset:12352
  ds_read_b64_tr_b16 a[218:219], v3 offset:12736
  ds_read_b64_tr_b16 a[220:221], v3 offset:15424
  ds_read_b64_tr_b16 a[222:223], v3 offset:15808
  s_waitcnt lgkmcnt(0)
  s_waitcnt vmcnt(6)
  ds_read_b64_tr_b16 a[64:65], v3 offset:18432
  ds_read_b64_tr_b16 a[66:67], v3 offset:18816
  ds_read_b64_tr_b16 a[68:69], v3 offset:21504
  ds_read_b64_tr_b16 a[70:71], v3 offset:21888
  ds_read_b64_tr_b16 a[144:145], v3 offset:18464
  ds_read_b64_tr_b16 a[146:147], v3 offset:18848
  ds_read_b64_tr_b16 a[148:149], v3 offset:21536
  ds_read_b64_tr_b16 a[150:151], v3 offset:21920
  ds_read_b64_tr_b16 a[224:225], v3 offset:18496
  ds_read_b64_tr_b16 a[226:227], v3 offset:18880
  ds_read_b64_tr_b16 a[228:229], v3 offset:21568
  ds_read_b64_tr_b16 a[230:231], v3 offset:21952
  s_waitcnt lgkmcnt(0)
  s_waitcnt vmcnt(0)
  ds_read_b64_tr_b16 a[72:73], v3 offset:24576
  ds_read_b64_tr_b16 a[74:75], v3 offset:24960
  ds_read_b64_tr_b16 a[76:77], v3 offset:27648
  ds_read_b64_tr_b16 a[78:79], v3 offset:28032
  ds_read_b64_tr_b16 a[152:153], v3 offset:24608
  ds_read_b64_tr_b16 a[154:155], v3 offset:24992
  ds_read_b64_tr_b16 a[156:157], v3 offset:27680
  ds_read_b64_tr_b16 a[158:159], v3 offset:28064
  ds_read_b64_tr_b16 a[232:233], v3 offset:24640
  ds_read_b64_tr_b16 a[234:235], v3 offset:25024
  ds_read_b64_tr_b16 a[236:237], v3 offset:27712
  ds_read_b64_tr_b16 a[238:239], v3 offset:28096
  s_waitcnt lgkmcnt(0)
  s_cmp_lg_u32 s24, 0
  s_cbranch_scc1 wwd_38
ww_37:
  buffer_load_dword v8, off, s[68:71], 0 offset:72 sc1
  s_add_u32 s26, s26, 1
  s_mov_b32 s39, 113
  s_cmp_gt_u32 s26, 2097152
  s_cbranch_scc1 L_abort
  s_waitcnt vmcnt(0)
  v_cmp_gt_u32 vcc, 4, v8
  s_cbranch_vccz wwd_38
  s_sleep 4
  s_branch ww_37
wwd_38:
  s_barrier
  s_barrier
  s_mul_i32 s33, s24, 10240
  v_mov_b32 v14, 0
  s_add_u32 s34, s25, 96
  s_lshl_b32 s34, s34, 7
  s_lshl_b32 s27, s24, 2
  s_add_u32 s34, s34, s27
  s_add_u32 s34, s34, 4096
  s_lshl_b32 s35, s25, 2
  s_add_u32 s35, s35, s24
  s_mul_i32 s35, s35, 3072
  s_add_u32 s35, s35, 67633152
  s_mov_b32 s36, 0
  s_add_u32 s37, s33, 2097152
  s_mov_b32 s38, 0
  s_mov_b32 s73, s33
  s_add_u32 m0, s73, 0
  s_add_u32 s27, s37, 0
  buffer_load_dwordx4 v2, s[8:11], s27 offen offset:0 lds
  buffer_load_dwordx4 v2, s[8:11], s27 offen offset:1024 lds
  buffer_load_dwordx4 v2, s[8:11], s27 offen offset:2048 lds
  buffer_load_dwordx4 v2, s[8:11], s27 offen offset:3072 lds
  s_add_u32 m0, s73, 4096
  s_add_u32 s27, s37, 4096
  buffer_load_dwordx4 v2, s[8:11], s27 offen offset:0 lds
  buffer_load_dwordx4 v2, s[8:11], s27 offen offset:1024 lds
  buffer_load_dwordx4 v2, s[8:11], s27 offen offset:2048 lds
  buffer_load_dwordx4 v2, s[8:11], s27 offen offset:3072 lds
  s_add_u32 m0, s73, 8192
  s_add_u32 s27, s37, 8192
  buffer_load_dwordx4 v2, s[8:11], s27 offen offset:0 lds
  buffer_load_dwordx4 v2, s[8:11], s27 offen offset:1024 lds
  s_add_u32 s37, s37, 40960
  s_add_u32 s73, s33, 40960
  s_add_u32 m0, s73, 0
  s_add_u32 s27, s37, 0
  buffer_load_dwordx4 v2, s[8:11], s27 offen offset:0 lds
  buffer_load_dwordx4 v2, s[8:11], s27 offen offset:1024 lds
  buffer_load_dwordx4 v2, s[8:11], s27 offen offset:2048 lds
  buffer_load_dwordx4 v2, s[8:11], s27 offen offset:3072 lds
  s_add_u32 m0, s73, 4096
  s_add_u32 s27, s37, 4096
  buffer_load_dwordx4 v2, s[8:11], s27 offen offset:0 lds
  buffer_load_dwordx4 v2, s[8:11], s27 offen offset:1024 lds
  buffer_load_dwordx4 v2, s[8:11], s27 offen offset:2048 lds
  buffer_load_dwordx4 v2, s[8:11], s27 offen offset:3072 lds
  s_add_u32 m0, s73, 8192
  s_add_u32 s27, s37, 8192
  buffer_load_dwordx4 v2, s[8:11], s27 offen offset:0 lds
  buffer_load_dwordx4 v2, s[8:11], s27 offen offset:1024 lds
  s_add_u32 s37, s37, 40960
  s_mov_b32 s72, 81920
  s_waitcnt vmcnt(10)
WQ_loop:
  s_cmp_lg_u32 s36, 2
  s_cbranch_scc1 g2_39
  s_cmp_lg_u32 s24, 0
  s_cbranch_scc1 wwd_41
ww_40:
  buffer_load_dword v8, off, s[68:71], 0 offset:64 sc1
  s_add_u32 s26, s26, 1
  s_mov_b32 s39, 121
  s_cmp_gt_u32 s26, 2097152
  s_cbranch_scc1 L_abort
  s_waitcnt vmcnt(0)
  v_cmp_gt_u32 vcc, 64, v8
  s_cbranch_vccz wwd_41
  s_sleep 8
  s_branch ww_40
wwd_41:
  s_barrier
g2_39:
  s_barrier
  v_add_u32 v11, s38, v2
  s_min_u32 s74, s37, 4708352
  s_add_u32 s73, s72, s33
  s_add_u32 s37, s37, 40960
  ds_read_b128 v[76:79], v11 offset:0
  ds_read_b128 v[80:83], v11 offset:20480
  ds_read_b128 v[84:87], v11 offset:1024
  ds_read_b128 v[88:91], v11 offset:21504
  s_waitcnt lgkmcnt(2)
  v_mfma_f32_16x16x32_bf16 v[32:35], a[0:3], v[76:79], 0
  ds_read_b128 v[92:95], v11 offset:2048
  v_mfma_f32_16x16x32_bf16 v[40:43], a[80:83], v[76:79], 0
  ds_read_b128 v[96:99], v11 offset:22528
  v_mfma_f32_16x16x32_bf16 v[48:51], a[160:163], v[76:79], 0
  s_add_u32 m0, s73, 0
  s_add_u32 s27, s74, 0
  v_mfma_f32_16x16x32_bf16 v[36:39], a[0:3], v[80:83], 0
  buffer_load_dwordx4 v2, s[8:11], s27 offen offset:0 lds
  v_mfma_f32_16x16x32_bf16 v[44:47], a[80:83], v[80:83], 0
  v_mfma_f32_16x16x32_bf16 v[52:55], a[160:163], v[80:83], 0
  s_waitcnt lgkmcnt(2)
  v_mfma_f32_16x16x32_bf16 v[32:35], a[4:7], v[84:87], v[32:35]
  ds_read_b128 v[76:79], v11 offset:3072
  v_mfma_f32_16x16x32_bf16 v[40:43], a[84:87], v[84:87], v[40:43]
  ds_read_b128 v[80:83], v11 offset:23552
  v_mfma_f32_16x16x32_bf16 v[48:51], a[164:167], v[84:87], v[48:51]
  v_mfma_f32_16x16x32_bf16 v[36:39], a[4:7], v[88:91], v[36:39]
  buffer_load_dwordx4 v2, s[8:11], s27 offen offset:1024 lds
  v_mfma_f32_16x16x32_bf16 v[44:47], a[84:87], v[88:91], v[44:47]
  v_mfma_f32_16x16x32_bf16 v[52:55], a[164:167], v[88:91], v[52:55]
  s_waitcnt lgkmcnt(2)
  v_mfma_f32_16x16x32_bf16 v[32:35], a[8:11], v[92:95], v[32:35]
  ds_read_b128 v[84:87], v11 offset:4096
  v_mfma_f32_16x16x32_bf16 v[40:43], a[88:91], v[92:95], v[40:43]
  ds_read_b128 v[88:91], v11 offset:24576
  v_mfma_f32_16x16x32_bf16 v[48:51], a[168:171], v[92:95], v[48:51]
  v_mfma_f32_16x16x32_bf16 v[36:39], a[8:11], v[96:99], v[36:39]
  buffer_load_dwordx4 v2, s[8:11], s27 offen offset:2048 lds
  v_mfma_f32_16x16x32_bf16 v[44:47], a[88:91], v[96:99], v[44:47]
  v_mfma_f32_16x16x32_bf16 v[52:55], a[168:171], v[96:99], v[52:55]
  s_waitcnt lgkmcnt(2)
  v_mfma_f32_16x16x32_bf16 v[32:35], a[12:15], v[76:79], v[32:35]
  ds_read_b128 v[92:95], v11 offset:5120
  v_mfma_f32_16x16x32_bf16 v[40:43], a[92:95], v[76:79], v[40:43]
  ds_read_b128 v[96:99], v11 offset:25600
  v_mfma_f32_16x16x32_bf16 v[48:51], a[172:175], v[76:79], v[48:51]
  v_mfma_f32_16x16x32_bf16 v[36:39], a[12:15], v[80:83], v[36:39]
  buffer_load_dwordx4 v2, s[8:11], s27 offen offset:3072 lds
  v_mfma_f32_16x16x32_bf16 v[44:47], a[92:95], v[80:83], v[44:47]
  v_mfma_f32_16x16x32_bf16 v[52:55], a[172:175], v[80:83], v[52:55]
  s_waitcnt lgkmcnt(2)
  v_mfma_f32_16x16x32_bf16 v[32:35], a[16:19], v[84:87], v[32:35]
  ds_read_b128 v[76:79], v11 offset:6144
  v_mfma_f32_16x16x32_bf16 v[40:43], a[96:99], v[84:87], v[40:43]
  ds_read_b128 v[80:83], v11 offset:26624
  v_mfma_f32_16x16x32_bf16 v[48:51], a[176:179], v[84:87], v[48:51]
  s_add_u32 m0, s73, 4096
  s_add_u32 s27, s74, 4096
  v_mfma_f32_16x16x32_bf16 v[36:39], a[16:19], v[88:91], v[36:39]
  buffer_load_dwordx4 v2, s[8:11], s27 offen offset:0 lds
  v_mfma_f32_16x16x32_bf16 v[44:47], a[96:99], v[88:91], v[44:47]
  v_mfma_f32_16x16x32_bf16 v[52:55], a[176:179], v[88:91], v[52:55]
  s_waitcnt lgkmcnt(2)
  v_mfma_f32_16x16x32_bf16 v[32:35], a[20:23], v[92:95], v[32:35]
  ds_read_b128 v[84:87], v11 offset:7168
  v_mfma_f32_16x16x32_bf16 v[40:43], a[100:103], v[92:95], v[40:43]
  ds_read_b128 v[88:91], v11 offset:27648
  v_mfma_f32_16x16x32_bf16 v[48:51], a[180:183], v[92:95], v[48:51]
  v_mfma_f32_16x16x32_bf16 v[36:39], a[20:23], v[96:99], v[36:39]
  buffer_load_dwordx4 v2, s[8:11], s27 offen offset:1024 lds
  v_mfma_f32_16x16x32_bf16 v[44:47], a[100:103], v[96:99], v[44:47]
  v_mfma_f32_16x16x32_bf16 v[52:55], a[180:183], v[96:99], v[52:55]
  s_waitcnt lgkmcnt(2)
  v_mfma_f32_16x16x32_bf16 v[32:35], a[24:27], v[76:79], v[32:35]
  ds_read_b128 v[92:95], v11 offset:8192
  v_mfma_f32_16x16x32_bf16 v[40:43], a[104:107], v[76:79], v[40:43]
  ds_read_b128 v[96:99], v11 offset:28672
  v_mfma_f32_16x16x32_bf16 v[48:51], a[184:187], v[76:79], v[48:51]
  v_mfma_f32_16x16x32_bf16 v[36:39], a[24:27], v[80:83], v[36:39]
  buffer_load_dwordx4 v2, s[8:11], s27 offen offset:2048 lds
  v_mfma_f32_16x16x32_bf16 v[44:47], a[104:107], v[80:83], v[44:47]
  v_mfma_f32_16x16x32_bf16 v[52:55], a[184:187], v[80:83], v[52:55]
  s_waitcnt lgkmcnt(2)
  v_mfma_f32_16x16x32_bf16 v[32:35], a[28:31], v[84:87], v[32:35]
  ds_read_b128 v[76:79], v11 offset:9216
  v_mfma_f32_16x16x32_bf16 v[40:43], a[108:111], v[84:87], v[40:43]
  ds_read_b128 v[80:83], v11 offset:29696
  v_mfma_f32_16x16x32_bf16 v[48:51], a[188:191], v[84:87], v[48:51]
  v_mfma_f32_16x16x32_bf16 v[36:39], a[28:31], v[88:91], v[36:39]
  buffer_load_dwordx4 v2, s[8:11], s27 offen offset:3072 lds
  v_mfma_f32_16x16x32_bf16 v[44:47], a[108:111], v[88:91], v[44:47]
  v_mfma_f32_16x16x32_bf16 v[52:55], a[188:191], v[88:91], v[52:55]
  s_waitcnt lgkmcnt(2)
  v_mfma_f32_16x16x32_bf16 v[32:35], a[32:35], v[92:95], v[32:35]
  ds_read_b128 v[84:87], v11 offset:10240
  v_mfma_f32_16x16x32_bf16 v[40:43], a[112:115], v[92:95], v[40:43]
  ds_read_b128 v[88:91], v11 offset:30720
  v_mfma_f32_16x16x32_bf16 v[48:51], a[192:195], v[92:95], v[48:51]
  s_add_u32 m0, s73, 8192
  s_add_u32 s27, s74, 8192
  v_mfma_f32_16x16x32_bf16 v[36:39], a[32:35], v[96:99], v[36:39]
  buffer_load_dwordx4 v2, s[8:11], s27 offen offset:0 lds
  v_mfma_f32_16x16x32_bf16 v[44:47], a[112:115], v[96:99], v[44:47]
  v_mfma_f32_16x16x32_bf16 v[52:55], a[192:195], v[96:99], v[52:55]
  s_waitcnt lgkmcnt(2)
  v_mfma_f32_16x16x32_bf16 v[32:35], a[36:39], v[76:79], v[32:35]
  ds_read_b128 v[92:95], v11 offset:11264
  v_mfma_f32_16x16x32_bf16 v[40:43], a[116:119], v[76:79], v[40:43]
  ds_read_b128 v[96:99], v11 offset:31744
  v_mfma_f32_16x16x32_bf16 v[48:51], a[196:199], v[76:79], v[48:51]
  v_mfma_f32_16x16x32_bf16 v[36:39], a[36:39], v[80:83], v[36:39]
  buffer_load_dwordx4 v2, s[8:11], s27 offen offset:1024 lds
  v_mfma_f32_16x16x32_bf16 v[44:47], a[116:119], v[80:83], v[44:47]
  v_mfma_f32_16x16x32_bf16 v[52:55], a[196:199], v[80:83], v[52:55]
  s_waitcnt lgkmcnt(2)
  v_mfma_f32_16x16x32_bf16 v[32:35], a[40:43], v[84:87], v[32:35]
  ds_read_b128 v[76:79], v11 offset:12288
  v_mfma_f32_16x16x32_bf16 v[40:43], a[120:123], v[84:87], v[40:43]
  ds_read_b128 v[80:83], v11 offset:32768
  v_mfma_f32_16x16x32_bf16 v[48:51], a[200:203], v[84:87], v[48:51]
  v_mfma_f32_16x16x32_bf16 v[36:39], a[40:43], v[88:91], v[36:39]
  v_mfma_f32_16x16x32_bf16 v[44:47], a[120:123], v[88:91], v[44:47]
  v_mfma_f32_16x16x32_bf16 v[52:55], a[200:203], v[88:91], v[52:55]
  s_waitcnt lgkmcnt(2)
  v_mfma_f32_16x16x32_bf16 v[32:35], a[44:47], v[92:95], v[32:35]
  ds_read_b128 v[84:87], v11 offset:13312
  v_mfma_f32_16x16x32_bf16 v[40:43], a[124:127], v[92:95], v[40:43]
  ds_read_b128 v[88:91], v11 offset:33792
  v_mfma_f32_16x16x32_bf16 v[48:51], a[204:207], v[92:95], v[48:51]
  v_mfma_f32_16x16x32_bf16 v[36:39], a[44:47], v[96:99], v[36:39]
  v_mfma_f32_16x16x32_bf16 v[44:47], a[124:127], v[96:99], v[44:47]
  v_mfma_f32_16x16x32_bf16 v[52:55], a[204:207], v[96:99], v[52:55]
  s_cmp_lt_u32 s36, 4
  s_cbranch_scc1 wa_42
  s_waitcnt vmcnt(14)
  s_sub_u32 s30, s36, 1
  s_branch wb_43
wa_42:
  s_waitcnt vmcnt(10)
  s_mov_b32 s30, s36
wb_43:
  v_mov_b32 v15, s30
  s_mov_b64 exec, 1
  buffer_store_dword v15, off, s[8:11], s34 sc1
  s_mov_b64 exec, -1
  s_waitcnt lgkmcnt(2)
  v_mfma_f32_16x16x32_bf16 v[32:35], a[48:51], v[76:79], v[32:35]
  ds_read_b128 v[92:95], v11 offset:14336
  v_mfma_f32_16x16x32_bf16 v[40:43], a[128:131], v[76:79], v[40:43]
  ds_read_b128 v[96:99], v11 offset:34816
  v_mfma_f32_16x16x32_bf16 v[48:51], a[208:211], v[76:79], v[48:51]
  v_mfma_f32_16x16x32_bf16 v[36:39], a[48:51], v[80:83], v[36:39]
  v_mfma_f32_16x16x32_bf16 v[44:47], a[128:131], v[80:83], v[44:47]
  v_mfma_f32_16x16x32_bf16 v[52:55], a[208:211], v[80:83], v[52:55]
  s_waitcnt lgkmcnt(2)
  v_mfma_f32_16x16x32_bf16 v[32:35], a[52:55], v[84:87], v[32:35]
  ds_read_b128 v[76:79], v11 offset:15360
  v_mfma_f32_16x16x32_bf16 v[40:43], a[132:135], v[84:87], v[40:43]
  ds_read_b128 v[80:83], v11 offset:35840
  v_mfma_f32_16x16x32_bf16 v[48:51], a[212:215], v[84:87], v[48:51]
  v_mfma_f32_16x16x32_bf16 v[36:39], a[52:55], v[88:91], v[36:39]
  v_mfma_f32_16x16x32_bf16 v[44:47], a[132:135], v[88:91], v[44:47]
  v_mfma_f32_16x16x32_bf16 v[52:55], a[212:215], v[88:91], v[52:55]
  s_waitcnt lgkmcnt(2)
  v_mfma_f32_16x16x32_bf16 v[32:35], a[56:59], v[92:95], v[32:35]
  ds_read_b128 v[84:87], v11 offset:16384
  v_mfma_f32_16x16x32_bf16 v[40:43], a[136:139], v[92:95], v[40:43]
  ds_read_b128 v[88:91], v11 offset:36864
  v_mfma_f32_16x16x32_bf16 v[48:51], a[216:219], v[92:95], v[48:51]
  v_mfma_f32_16x16x32_bf16 v[36:39], a[56:59], v[96:99], v[36:39]
  v_mfma_f32_16x16x32_bf16 v[44:47], a[136:139], v[96:99], v[44:47]
  v_mfma_f32_16x16x32_bf16 v[52:55], a[216:219], v[96:99], v[52:55]
  s_waitcnt lgkmcnt(2)
  v_mfma_f32_16x16x32_bf16 v[32:35], a[60:63], v[76:79], v[32:35]
  ds_read_b128 v[92:95], v11 offset:17408
  v_mfma_f32_16x16x32_bf16 v[40:43], a[140:143], v[76:79], v[40:43]
  ds_read_b128 v[96:99], v11 offset:37888
  v_mfma_f32_16x16x32_bf16 v[48:51], a[220:223], v[76:79], v[48:51]
  v_mfma_f32_16x16x32_bf16 v[36:39], a[60:63], v[80:83], v[36:39]
  v_mfma_f32_16x16x32_bf16 v[44:47], a[140:143], v[80:83], v[44:47]
  v_mfma_f32_16x16x32_bf16 v[52:55], a[220:223], v[80:83], v[52:55]
  s_waitcnt lgkmcnt(2)
  v_mfma_f32_16x16x32_bf16 v[32:35], a[64:67], v[84:87], v[32:35]
  ds_read_b128 v[76:79], v11 offset:18432
  v_mfma_f32_16x16x32_bf16 v[40:43], a[144:147], v[84:87], v[40:43]
  ds_read_b128 v[80:83], v11 offset:38912
  v_mfma_f32_16x16x32_bf16 v[48:51], a[224:227], v[84:87], v[48:51]
  v_mfma_f32_16x16x32_bf16 v[36:39], a[64:67], v[88:91], v[36:39]
  v_mfma_f32_16x16x32_bf16 v[44:47], a[144:147], v[88:91], v[44:47]
  v_mfma_f32_16x16x32_bf16 v[52:55], a[224:227], v[88:91], v[52:55]
  s_waitcnt lgkmcnt(2)
  v_mfma_f32_16x16x32_bf16 v[32:35], a[68:71], v[92:95], v[32:35]
  ds_read_b128 v[84:87], v11 offset:19456
  v_mfma_f32_16x16x32_bf16 v[40:43], a[148:151], v[92:95], v[40:43]
  ds_read_b128 v[88:91], v11 offset:39936
  v_mfma_f32_16x16x32_bf16 v[48:51], a[228:231], v[92:95], v[48:51]
  v_mfma_f32_16x16x32_bf16 v[36:39], a[68:71], v[96:99], v[36:39]
  v_mfma_f32_16x16x32_bf16 v[44:47], a[148:151], v[96:99], v[44:47]
  v_mfma_f32_16x16x32_bf16 v[52:55], a[228:231], v[96:99], v[52:55]
  s_waitcnt lgkmcnt(2)
  v_mfma_f32_16x16x32_bf16 v[32:35], a[72:75], v[76:79], v[32:35]
  v_mfma_f32_16x16x32_bf16 v[40:43], a[152:155], v[76:79], v[40:43]
  v_mfma_f32_16x16x32_bf16 v[48:51], a[232:235], v[76:79], v[48:51]
  v_mfma_f32_16x16x32_bf16 v[36:39], a[72:75], v[80:83], v[36:39]
  v_mfma_f32_16x16x32_bf16 v[44:47], a[152:155], v[80:83], v[44:47]
  v_mfma_f32_16x16x32_bf16 v[52:55], a[232:235], v[80:83], v[52:55]
  s_waitcnt lgkmcnt(0)
  v_mfma_f32_16x16x32_bf16 v[32:35], a[76:79], v[84:87], v[32:35]
  v_mfma_f32_16x16x32_bf16 v[40:43], a[156:159], v[84:87], v[40:43]
  v_mfma_f32_16x16x32_bf16 v[48:51], a[236:239], v[84:87], v[48:51]
  v_mfma_f32_16x16x32_bf16 v[36:39], a[76:79], v[88:91], v[36:39]
  v_mfma_f32_16x16x32_bf16 v[44:47], a[156:159], v[88:91], v[44:47]
  v_mfma_f32_16x16x32_bf16 v[52:55], a[236:239], v[88:91], v[52:55]
  s_nop 2
  v_cvt_pk_bf16_f32 v56, v32, v33
  v_cvt_pk_bf16_f32 v57, v34, v35
  v_cvt_pk_bf16_f32 v58, v40, v41
  v_cvt_pk_bf16_f32 v59, v42, v43
  v_cvt_pk_bf16_f32 v64, v48, v49
  v_cvt_pk_bf16_f32 v65, v50, v51
  v_cvt_pk_bf16_f32 v60, v36, v37
  v_cvt_pk_bf16_f32 v61, v38, v39
  v_cvt_pk_bf16_f32 v62, v44, v45
  v_cvt_pk_bf16_f32 v63, v46, v47
  v_cvt_pk_bf16_f32 v66, v52, v53
  v_cvt_pk_bf16_f32 v67, v54, v55
  buffer_store_dwordx4 v[56:59], v2, s[8:11], s35 offen offset:0 sc1
  buffer_store_dwordx4 v[60:63], v2, s[8:11], s35 offen offset:1024 sc1
  buffer_store_dwordx4 v[64:67], v2, s[8:11], s35 offen offset:2048 sc1
  s_cmp_ge_u32 s36, 2
  s_cbranch_scc1 we_44
  s_waitcnt vmcnt(0)
  s_add_u32 s30, s36, 1
  v_mov_b32 v15, s30
  s_mov_b64 exec, 1
  buffer_store_dword v15, off, s[8:11], s34 sc1
  s_mov_b64 exec, -1
we_44:
  s_add_u32 s35, s35, 393216
  s_add_u32 s38, s38, 40960
  s_cmp_eq_u32 s38, 122880
  s_cselect_b32 s38, 0, s38
  s_add_u32 s72, s72, 40960
  s_cmp_eq_u32 s72, 122880
  s_cselect_b32 s72, 0, s72
  s_add_u32 s36, s36, 1
  s_cmp_lt_u32 s36, 64
  s_cbranch_scc1 WQ_loop
  s_waitcnt vmcnt(0)
  v_mov_b32 v15, s36
  s_mov_b64 exec, 1
  buffer_store_dword v15, off, s[8:11], s34 sc1
  s_mov_b64 exec, -1
  s_branch L_exit2
WGU:
  s_cmp_lg_u32 s24, 0
  s_cbranch_scc1 wwd_46
ww_45:
  buffer_load_dword v8, off, s[68:71], 0 offset:64 sc1
  s_add_u32 s26, s26, 1
  s_mov_b32 s39, 115
  s_cmp_gt_u32 s26, 2097152
  s_cbranch_scc1 L_abort
  s_waitcnt vmcnt(0)
  v_cmp_gt_u32 vcc, 64, v8
  s_cbranch_vccz wwd_46
  s_sleep 8
  s_branch ww_45
wwd_46:
  s_barrier
  v_mov_b32 v10, 12288
  s_mov_b32 s36, 1
wp_47:
  buffer_load_dword v8, v10, s[8:11], 0 offen sc1
  s_add_u32 s26, s26, 1
  s_mov_b32 s39, 116
  s_cmp_gt_u32 s26, 2097152
  s_cbranch_scc1 L_abort
  s_waitcnt vmcnt(0)
  v_cmp_ge_u32 vcc, s36, v8
  s_cbranch_vccz wpd_48
  s_sleep 64
  s_branch wp_47
wpd_48:
  s_barrier
  s_mov_b32 s12, s56
  s_and_b32 s13, s57, 0xffff
  s_mov_b32 s14, 1966080
  s_mov_b32 s15, 0x20000
  s_mov_b32 s16, s58
  s_and_b32 s17, s59, 0xffff
  s_mov_b32 s18, 1966080
  s_mov_b32 s19, 0x20000
  s_mov_b32 s30, 3072
  v_add_u32 v68, 0, v1
  v_lshrrev_b32 v69, 1, v68
  v_and_b32 v70, 1, v68
  v_mul_lo_u32 v69, v69, s30
  v_lshl_add_u32 v4, v70, 4, v69
  v_add_u32 v68, 64, v1
  v_lshrrev_b32 v69, 1, v68
  v_and_b32 v70, 1, v68
  v_mul_lo_u32 v69, v69, s30
  v_lshl_add_u32 v5, v70, 4, v69
  v_bfe_u32 v68, v1, 5, 1
  v_mul_u32_u24 v3, 512, v68
  v_bfe_u32 v68, v1, 4, 1
  v_mul_u32_u24 v68, 256, v68
  v_add_u32 v3, v3, v68
  v_bfe_u32 v68, v1, 2, 1
  v_mul_u32_u24 v68, 32, v68
  v_add_u32 v3, v3, v68
  v_bfe_u32 v68, v1, 3, 1
  v_mul_u32_u24 v68, 64, v68
  v_add_u32 v3, v3, v68
  v_and_b32 v68, 3, v1
  v_lshl_add_u32 v3, v68, 3, v3
  s_mul_i32 s27, s24, 30720
  v_add_u32 v3, s27, v3
  s_lshl_b32 s32, s25, 7
  s_lshl_b32 s27, s24, 5
  s_add_u32 s32, s32, s27
  s_mul_i32 s31, s24, 30720
  s_add_u32 m0, s31, 0
  s_add_u32 s27, s32, 0
  buffer_load_dwordx4 v4, s[12:15], s27 offen  lds
  s_add_u32 m0, s31, 1024
  s_add_u32 s27, s32, 0
  buffer_load_dwordx4 v5, s[12:15], s27 offen  lds
  s_add_u32 m0, s31, 2048
  s_add_u32 s27, s32, 0
  buffer_load_dwordx4 v4, s[16:19], s27 offen  lds
  s_add_u32 m0, s31, 3072
  s_add_u32 s27, s32, 0
  buffer_load_dwordx4 v5, s[16:19], s27 offen  lds
  s_add_u32 m0, s31, 6144
  s_add_u32 s27, s32, 196608
  buffer_load_dwordx4 v4, s[12:15], s27 offen  lds
  s_add_u32 m0, s31, 7168
  s_add_u32 s27, s32, 196608
  buffer_load_dwordx4 v5, s[12:15], s27 offen  lds
  s_add_u32 m0, s31, 8192
  s_add_u32 s27, s32, 196608
  buffer_load_dwordx4 v4, s[16:19], s27 offen  lds
  s_add_u32 m0, s31, 9216
  s_add_u32 s27, s32, 196608
  buffer_load_dwordx4 v5, s[16:19], s27 offen  lds
  s_add_u32 m0, s31, 12288
  s_add_u32 s27, s32, 393216
  buffer_load_dwordx4 v4, s[12:15], s27 offen  lds
  s_add_u32 m0, s31, 13312
  s_add_u32 s27, s32, 393216
  buffer_load_dwordx4 v5, s[12:15], s27 offen  lds
  s_add_u32 m0, s31, 14336
  s_add_u32 s27, s32, 393216
  buffer_load_dwordx4 v4, s[16:19], s27 offen  lds
  s_add_u32 m0, s31, 15360
  s_add_u32 s27, s32, 393216
  buffer_load_dwordx4 v5, s[16:19], s27 offen  lds
  s_add_u32 m0, s31, 18432
  s_add_u32 s27, s32, 589824
  buffer_load_dwordx4 v4, s[12:15], s27 offen  lds
  s_add_u32 m0, s31, 19456
  s_add_u32 s27, s32, 589824
  buffer_load_dwordx4 v5, s[12:15], s27 offen  lds
  s_add_u32 m0, s31, 20480
  s_add_u32 s27, s32, 589824
  buffer_load_dwordx4 v4, s[16:19], s27 offen  lds
  s_add_u32 m0, s31, 21504
  s_add_u32 s27, s32, 589824
  buffer_load_dwordx4 v5, s[16:19], s27 offen  lds
  s_add_u32 m0, s31, 24576
  s_add_u32 s27, s32, 786432
  buffer_load_dwordx4 v4, s[12:15], s27 offen  lds
  s_add_u32 m0, s31, 25600
  s_add_u32 s27, s32, 786432
  buffer_load_dwordx4 v5, s[12:15], s27 offen  lds
  s_add_u32 m0, s31, 26624
  s_add_u32 s27, s32, 786432
  buffer_load_dwordx4 v4, s[16:19], s27 offen  lds
  s_add_u32 m0, s31, 27648
  s_add_u32 s27, s32, 786432
  buffer_load_dwordx4 v5, s[16:19], s27 offen  lds
  s_waitcnt vmcnt(16)
  ds_read_b64_tr_b16 a[0:1], v3 offset:0
  ds_read_b64_tr_b16 a[2:3], v3 offset:128
  ds_read_b64_tr_b16 a[4:5], v3 offset:1024
  ds_read_b64_tr_b16 a[6:7], v3 offset:1152
  ds_read_b64_tr_b16 a[80:81], v3 offset:2048
  ds_read_b64_tr_b16 a[82:83], v3 offset:2176
  ds_read_b64_tr_b16 a[84:85], v3 offset:3072
  ds_read_b64_tr_b16 a[86:87], v3 offset:3200
  s_waitcnt lgkmcnt(0)
  s_add_u32 m0, s31, 0
  s_add_u32 s27, s32, 983040
  buffer_load_dwordx4 v4, s[12:15], s27 offen  lds
  s_add_u32 m0, s31, 1024
  s_add_u32 s27, s32, 983040
  buffer_load_dwordx4 v5, s[12:15], s27 offen  lds
  s_add_u32 m0, s31, 2048
  s_add_u32 s27, s32, 983040
  buffer_load_dwordx4 v4, s[16:19], s27 offen  lds
  s_add_u32 m0, s31, 3072
  s_add_u32 s27, s32, 983040
  buffer_load_dwordx4 v5, s[16:19], s27 offen  lds
  s_waitcnt vmcnt(16)
  ds_read_b64_tr_b16 a[8:9], v3 offset:6144
  ds_read_b64_tr_b16 a[10:11], v3 offset:6272
  ds_read_b64_tr_b16 a[12:13], v3 offset:7168
  ds_read_b64_tr_b16 a[14:15], v3 offset:7296
  ds_read_b64_tr_b16 a[88:89], v3 offset:8192
  ds_read_b64_tr_b16 a[90:91], v3 offset:8320
  ds_read_b64_tr_b16 a[92:93], v3 offset:9216
  ds_read_b64_tr_b16 a[94:95], v3 offset:9344
  s_waitcnt lgkmcnt(0)
  s_add_u32 m0, s31, 6144
  s_add_u32 s27, s32, 1179648
  buffer_load_dwordx4 v4, s[12:15], s27 offen  lds
  s_add_u32 m0, s31, 7168
  s_add_u32 s27, s32, 1179648
  buffer_load_dwordx4 v5, s[12:15], s27 offen  lds
  s_add_u32 m0, s31, 8192
  s_add_u32 s27, s32, 1179648
  buffer_load_dwordx4 v4, s[16:19], s27 offen  lds
  s_add_u32 m0, s31, 9216
  s_add_u32 s27, s32, 1179648
  buffer_load_dwordx4 v5, s[16:19], s27 offen  lds
  s_waitcnt vmcnt(16)
  ds_read_b64_tr_b16 a[16:17], v3 offset:12288
  ds_read_b64_tr_b16 a[18:19], v3 offset:12416
  ds_read_b64_tr_b16 a[20:21], v3 offset:13312
  ds_read_b64_tr_b16 a[22:23], v3 offset:13440
  ds_read_b64_tr_b16 a[96:97], v3 offset:14336
  ds_read_b64_tr_b16 a[98:99], v3 offset:14464
  ds_read_b64_tr_b16 a[100:101], v3 offset:15360
  ds_read_b64_tr_b16 a[102:103], v3 offset:15488
  s_waitcnt lgkmcnt(0)
  s_add_u32 m0, s31, 12288
  s_add_u32 s27, s32, 1376256
  buffer_load_dwordx4 v4, s[12:15], s27 offen  lds
  s_add_u32 m0, s31, 13312
  s_add_u32 s27, s32, 1376256
  buffer_load_dwordx4 v5, s[12:15], s27 offen  lds
  s_add_u32 m0, s31, 14336
  s_add_u32 s27, s32, 1376256
  buffer_load_dwordx4 v4, s[16:19], s27 offen  lds
  s_add_u32 m0, s31, 15360
  s_add_u32 s27, s32, 1376256
  buffer_load_dwordx4 v5, s[16:19], s27 offen  lds
  s_waitcnt vmcnt(16)
  ds_read_b64_tr_b16 a[24:25], v3 offset:18432
  ds_read_b64_tr_b16 a[26:27], v3 offset:18560
  ds_read_b64_tr_b16 a[28:29], v3 offset:19456
  ds_read_b64_tr_b16 a[30:31], v3 offset:19584
  ds_read_b64_tr_b16 a[104:105], v3 offset:20480
  ds_read_b64_tr_b16 a[106:107], v3 offset:20608
  ds_read_b64_tr_b16 a[108:109], v3 offset:21504
  ds_read_b64_tr_b16 a[110:111], v3 offset:21632
  s_waitcnt lgkmcnt(0)
  s_add_u32 m0, s31, 18432
  s_add_u32 s27, s32, 1572864
  buffer_load_dwordx4 v4, s[12:15], s27 offen  lds
  s_add_u32 m0, s31, 19456
  s_add_u32 s27, s32, 1572864
  buffer_load_dwordx4 v5, s[12:15], s27 offen  lds
  s_add_u32 m0, s31, 20480
  s_add_u32 s27, s32, 1572864
  buffer_load_dwordx4 v4, s[16:19], s27 offen  lds
  s_add_u32 m0, s31, 21504
  s_add_u32 s27, s32, 1572864
  buffer_load_dwordx4 v5, s[16:19], s27 offen  lds
  s_waitcnt vmcnt(16)
  ds_read_b64_tr_b16 a[32:33], v3 offset:24576
  ds_read_b64_tr_b16 a[34:35], v3 offset:24704
  ds_read_b64_tr_b16 a[36:37], v3 offset:25600
  ds_read_b64_tr_b16 a[38:39], v3 offset:25728
  ds_read_b64_tr_b16 a[112:113], v3 offset:26624
  ds_read_b64_tr_b16 a[114:115], v3 offset:26752
  ds_read_b64_tr_b16 a[116:117], v3 offset:27648
  ds_read_b64_tr_b16 a[118:119], v3 offset:27776
  s_waitcnt lgkmcnt(0)
  s_add_u32 m0, s31, 24576
  s_add_u32 s27, s32, 1769472
  buffer_load_dwordx4 v4, s[12:15], s27 offen  lds
  s_add_u32 m0, s31, 25600
  s_add_u32 s27, s32, 1769472
  buffer_load_dwordx4 v5, s[12:15], s27 offen  lds
  s_add_u32 m0, s31, 26624
  s_add_u32 s27, s32, 1769472
  buffer_load_dwordx4 v4, s[16:19], s27 offen  lds
  s_add_u32 m0, s31, 27648
  s_add_u32 s27, s32, 1769472
  buffer_load_dwordx4 v5, s[16:19], s27 offen  lds
  s_waitcnt vmcnt(16)
  ds_read_b64_tr_b16 a[40:41], v3 offset:0
  ds_read_b64_tr_b16 a[42:43], v3 offset:128
  ds_read_b64_tr_b16 a[44:45], v3 offset:1024
  ds_read_b64_tr_b16 a[46:47], v3 offset:1152
  ds_read_b64_tr_b16 a[120:121], v3 offset:2048
  ds_read_b64_tr_b16 a[122:123], v3 offset:2176
  ds_read_b64_tr_b16 a[124:125], v3 offset:3072
  ds_read_b64_tr_b16 a[126:127], v3 offset:3200
  s_waitcnt lgkmcnt(0)
  s_waitcnt vmcnt(12)
  ds_read_b64_tr_b16 a[48:49], v3 offset:6144
  ds_read_b64_tr_b16 a[50:51], v3 offset:6272
  ds_read_b64_tr_b16 a[52:53], v3 offset:7168
  ds_read_b64_tr_b16 a[54:55], v3 offset:7296
  ds_read_b64_tr_b16 a[128:129], v3 offset:8192
  ds_read_b64_tr_b16 a[130:131], v3 offset:8320
  ds_read_b64_tr_b16 a[132:133], v3 offset:9216
  ds_read_b64_tr_b16 a[134:135], v3 offset:9344
  s_waitcnt lgkmcnt(0)
  s_waitcnt vmcnt(8)
  ds_read_b64_tr_b16 a[56:57], v3 offset:12288
  ds_read_b64_tr_b16 a[58:59], v3 offset:12416
  ds_read_b64_tr_b16 a[60:61], v3 offset:13312
  ds_read_b64_tr_b16 a[62:63], v3 offset:13440
  ds_read_b64_tr_b16 a[136:137], v3 offset:14336
  ds_read_b64_tr_b16 a[138:139], v3 offset:14464
  ds_read_b64_tr_b16 a[140:141], v3 offset:15360
  ds_read_b64_tr_b16 a[142:143], v3 offset:15488
  s_waitcnt lgkmcnt(0)
  s_waitcnt vmcnt(4)
  ds_read_b64_tr_b16 a[64:65], v3 offset:18432
  ds_read_b64_tr_b16 a[66:67], v3 offset:18560
  ds_read_b64_tr_b16 a[68:69], v3 offset:19456
  ds_read_b64_tr_b16 a[70:71], v3 offset:19584
  ds_read_b64_tr_b16 a[144:145], v3 offset:20480
  ds_read_b64_tr_b16 a[146:147], v3 offset:20608
  ds_read_b64_tr_b16 a[148:149], v3 offset:21504
  ds_read_b64_tr_b16 a[150:151], v3 offset:21632
  s_waitcnt lgkmcnt(0)
  s_waitcnt vmcnt(0)
  ds_read_b64_tr_b16 a[72:73], v3 offset:24576
  ds_read_b64_tr_b16 a[74:75], v3 offset:24704
  ds_read_b64_tr_b16 a[76:77], v3 offset:25600
  ds_read_b64_tr_b16 a[78:79], v3 offset:25728
  ds_read_b64_tr_b16 a[152:153], v3 offset:26624
  ds_read_b64_tr_b16 a[154:155], v3 offset:26752
  ds_read_b64_tr_b16 a[156:157], v3 offset:27648
  ds_read_b64_tr_b16 a[158:159], v3 offset:27776
  s_waitcnt lgkmcnt(0)
  s_barrier
  s_mul_i32 s33, s24, 10240
  v_mov_b32 v14, 0
  s_add_u32 s34, s25, 128
  s_lshl_b32 s34, s34, 7
  s_lshl_b32 s27, s24, 2
  s_add_u32 s34, s34, s27
  s_add_u32 s34, s34, 4096
  s_lshl_b32 s35, s25, 1
  s_lshr_b32 s27, s24, 1
  s_add_u32 s35, s35, s27
  s_lshl_b32 s35, s35, 11
  s_add_u32 s35, s35, 4718592
  s_and_b32 s30, s24, 1
  s_lshl_b32 s30, s30, 3
  v_add_u32 v12, s30, v2
  s_mov_b32 s36, 0
  s_add_u32 s37, s33, 2097152
  s_mov_b32 s38, 0
  s_mov_b32 s73, s33
  s_add_u32 m0, s73, 0
  s_add_u32 s27, s37, 0
  buffer_load_dwordx4 v2, s[8:11], s27 offen offset:0 lds
  buffer_load_dwordx4 v2, s[8:11], s27 offen offset:1024 lds
  buffer_load_dwordx4 v2, s[8:11], s27 offen offset:2048 lds
  buffer_load_dwordx4 v2, s[8:11], s27 offen offset:3072 lds
  s_add_u32 m0, s73, 4096
  s_add_u32 s27, s37, 4096
  buffer_load_dwordx4 v2, s[8:11], s27 offen offset:0 lds
  buffer_load_dwordx4 v2, s[8:11], s27 offen offset:1024 lds
  buffer_load_dwordx4 v2, s[8:11], s27 offen offset:2048 lds
  buffer_load_dwordx4 v2, s[8:11], s27 offen offset:3072 lds
  s_add_u32 m0, s73, 8192
  s_add_u32 s27, s37, 8192
  buffer_load_dwordx4 v2, s[8:11], s27 offen offset:0 lds
  buffer_load_dwordx4 v2, s[8:11], s27 offen offset:1024 lds
  s_add_u32 s37, s37, 40960
  s_add_u32 s73, s33, 40960
  s_add_u32 m0, s73, 0
  s_add_u32 s27, s37, 0
  buffer_load_dwordx4 v2, s[8:11], s27 offen offset:0 lds
  buffer_load_dwordx4 v2, s[8:11], s27 offen offset:1024 lds
  buffer_load_dwordx4 v2, s[8:11], s27 offen offset:2048 lds
  buffer_load_dwordx4 v2, s[8:11], s27 offen offset:3072 lds
  s_add_u32 m0, s73, 4096
  s_add_u32 s27, s37, 4096
  buffer_load_dwordx4 v2, s[8:11], s27 offen offset:0 lds
  buffer_load_dwordx4 v2, s[8:11], s27 offen offset:1024 lds
  buffer_load_dwordx4 v2, s[8:11], s27 offen offset:2048 lds
  buffer_load_dwordx4 v2, s[8:11], s27 offen offset:3072 lds
  s_add_u32 m0, s73, 8192
  s_add_u32 s27, s37, 8192
  buffer_load_dwordx4 v2, s[8:11], s27 offen offset:0 lds
  buffer_load_dwordx4 v2, s[8:11], s27 offen offset:1024 lds
  s_add_u32 s37, s37, 40960
  s_mov_b32 s72, 81920
  s_waitcnt vmcnt(10)
WGU_loop:
  s_barrier
  v_add_u32 v11, s38, v2
  s_min_u32 s74, s37, 4708352
  s_add_u32 s73, s72, s33
  s_add_u32 s37, s37, 40960
  ds_read_b128 v[76:79], v11 offset:0
  ds_read_b128 v[80:83], v11 offset:20480
  ds_read_b128 v[84:87], v11 offset:1024
  ds_read_b128 v[88:91], v11 offset:21504
  s_waitcnt lgkmcnt(2)
  v_mfma_f32_16x16x32_bf16 v[32:35], a[0:3], v[76:79], 0
  ds_read_b128 v[92:95], v11 offset:2048
  v_mfma_f32_16x16x32_bf16 v[40:43], a[80:83], v[76:79], 0
  ds_read_b128 v[96:99], v11 offset:22528
  v_mfma_f32_16x16x32_bf16 v[36:39], a[0:3], v[80:83], 0
  s_add_u32 m0, s73, 0
  s_add_u32 s27, s74, 0
  v_mfma_f32_16x16x32_bf16 v[44:47], a[80:83], v[80:83], 0
  buffer_load_dwordx4 v2, s[8:11], s27 offen offset:0 lds
  s_waitcnt lgkmcnt(2)
  v_mfma_f32_16x16x32_bf16 v[32:35], a[4:7], v[84:87], v[32:35]
  ds_read_b128 v[76:79], v11 offset:3072
  v_mfma_f32_16x16x32_bf16 v[40:43], a[84:87], v[84:87], v[40:43]
  ds_read_b128 v[80:83], v11 offset:23552
  v_mfma_f32_16x16x32_bf16 v[36:39], a[4:7], v[88:91], v[36:39]
  v_mfma_f32_16x16x32_bf16 v[44:47], a[84:87], v[88:91], v[44:47]
  buffer_load_dwordx4 v2, s[8:11], s27 offen offset:1024 lds
  s_waitcnt lgkmcnt(2)
  v_mfma_f32_16x16x32_bf16 v[32:35], a[8:11], v[92:95], v[32:35]
  ds_read_b128 v[84:87], v11 offset:4096
  v_mfma_f32_16x16x32_bf16 v[40:43], a[88:91], v[92:95], v[40:43]
  ds_read_b128 v[88:91], v11 offset:24576
  v_mfma_f32_16x16x32_bf16 v[36:39], a[8:11], v[96:99], v[36:39]
  v_mfma_f32_16x16x32_bf16 v[44:47], a[88:91], v[96:99], v[44:47]
  buffer_load_dwordx4 v2, s[8:11], s27 offen offset:2048 lds
  s_waitcnt lgkmcnt(2)
  v_mfma_f32_16x16x32_bf16 v[32:35], a[12:15], v[76:79], v[32:35]
  ds_read_b128 v[92:95], v11 offset:5120
  v_mfma_f32_16x16x32_bf16 v[40:43], a[92:95], v[76:79], v[40:43]
  ds_read_b128 v[96:99], v11 offset:25600
  v_mfma_f32_16x16x32_bf16 v[36:39], a[12:15], v[80:83], v[36:39]
  v_mfma_f32_16x16x32_bf16 v[44:47], a[92:95], v[80:83], v[44:47]
  buffer_load_dwordx4 v2, s[8:11], s27 offen offset:3072 lds
  s_waitcnt lgkmcnt(2)
  v_mfma_f32_16x16x32_bf16 v[32:35], a[16:19], v[84:87], v[32:35]
  ds_read_b128 v[76:79], v11 offset:6144
  v_mfma_f32_16x16x32_bf16 v[40:43], a[96:99], v[84:87], v[40:43]
  ds_read_b128 v[80:83], v11 offset:26624
  v_mfma_f32_16x16x32_bf16 v[36:39], a[16:19], v[88:91], v[36:39]
  s_add_u32 m0, s73, 4096
  s_add_u32 s27, s74, 4096
  v_mfma_f32_16x16x32_bf16 v[44:47], a[96:99], v[88:91], v[44:47]
  buffer_load_dwordx4 v2, s[8:11], s27 offen offset:0 lds
  s_waitcnt lgkmcnt(2)
  v_mfma_f32_16x16x32_bf16 v[32:35], a[20:23], v[92:95], v[32:35]
  ds_read_b128 v[84:87], v11 offset:7168
  v_mfma_f32_16x16x32_bf16 v[40:43], a[100:103], v[92:95], v[40:43]
  ds_read_b128 v[88:91], v11 offset:27648
  v_mfma_f32_16x16x32_bf16 v[36:39], a[20:23], v[96:99], v[36:39]
  v_mfma_f32_16x16x32_bf16 v[44:47], a[100:103], v[96:99], v[44:47]
  buffer_load_dwordx4 v2, s[8:11], s27 offen offset:1024 lds
  s_waitcnt lgkmcnt(2)
  v_mfma_f32_16x16x32_bf16 v[32:35], a[24:27], v[76:79], v[32:35]
  ds_read_b128 v[92:95], v11 offset:8192
  v_mfma_f32_16x16x32_bf16 v[40:43], a[104:107], v[76:79], v[40:43]
  ds_read_b128 v[96:99], v11 offset:28672
  v_mfma_f32_16x16x32_bf16 v[36:39], a[24:27], v[80:83], v[36:39]
  v_mfma_f32_16x16x32_bf16 v[44:47], a[104:107], v[80:83], v[44:47]
  buffer_load_dwordx4 v2, s[8:11], s27 offen offset:2048 lds
  s_waitcnt lgkmcnt(2)
  v_mfma_f32_16x16x32_bf16 v[32:35], a[28:31], v[84:87], v[32:35]
  ds_read_b128 v[76:79], v11 offset:9216
  v_mfma_f32_16x16x32_bf16 v[40:43], a[108:111], v[84:87], v[40:43]
  ds_read_b128 v[80:83], v11 offset:29696
  v_mfma_f32_16x16x32_bf16 v[36:39], a[28:31], v[88:91], v[36:39]
  v_mfma_f32_16x16x32_bf16 v[44:47], a[108:111], v[88:91], v[44:47]
  buffer_load_dwordx4 v2, s[8:11], s27 offen offset:3072 lds
  s_waitcnt lgkmcnt(2)
  v_mfma_f32_16x16x32_bf16 v[32:35], a[32:35], v[92:95], v[32:35]
  ds_read_b128 v[84:87], v11 offset:10240
  v_mfma_f32_16x16x32_bf16 v[40:43], a[112:115], v[92:95], v[40:43]
  ds_read_b128 v[88:91], v11 offset:30720
  v_mfma_f32_16x16x32_bf16 v[36:39], a[32:35], v[96:99], v[36:39]
  s_add_u32 m0, s73, 8192
  s_add_u32 s27, s74, 8192
  v_mfma_f32_16x16x32_bf16 v[44:47], a[112:115], v[96:99], v[44:47]
  buffer_load_dwordx4 v2, s[8:11], s27 offen offset:0 lds
  s_waitcnt lgkmcnt(2)
  v_mfma_f32_16x16x32_bf16 v[32:35], a[36:39], v[76:79], v[32:35]
  ds_read_b128 v[92:95], v11 offset:11264
  v_mfma_f32_16x16x32_bf16 v[40:43], a[116:119], v[76:79], v[40:43]
  ds_read_b128 v[96:99], v11 offset:31744
  v_mfma_f32_16x16x32_bf16 v[36:39], a[36:39], v[80:83], v[36:39]
  v_mfma_f32_16x16x32_bf16 v[44:47], a[116:119], v[80:83], v[44:47]
  buffer_load_dwordx4 v2, s[8:11], s27 offen offset:1024 lds
  s_waitcnt lgkmcnt(2)
  v_mfma_f32_16x16x32_bf16 v[32:35], a[40:43], v[84:87], v[32:35]
  ds_read_b128 v[76:79], v11 offset:12288
  v_mfma_f32_16x16x32_bf16 v[40:43], a[120:123], v[84:87], v[40:43]
  ds_read_b128 v[80:83], v11 offset:32768
  v_mfma_f32_16x16x32_bf16 v[36:39], a[40:43], v[88:91], v[36:39]
  v_mfma_f32_16x16x32_bf16 v[44:47], a[120:123], v[88:91], v[44:47]
  s_waitcnt lgkmcnt(2)
  v_mfma_f32_16x16x32_bf16 v[32:35], a[44:47], v[92:95], v[32:35]
  ds_read_b128 v[84:87], v11 offset:13312
  v_mfma_f32_16x16x32_bf16 v[40:43], a[124:127], v[92:95], v[40:43]
  ds_read_b128 v[88:91], v11 offset:33792
  v_mfma_f32_16x16x32_bf16 v[36:39], a[44:47], v[96:99], v[36:39]
  v_mfma_f32_16x16x32_bf16 v[44:47], a[124:127], v[96:99], v[44:47]
  s_cmp_lt_u32 s36, 4
  s_cbranch_scc1 wa_49
  s_waitcnt vmcnt(13)
  s_sub_u32 s30, s36, 1
  s_branch wb_50
wa_49:
  s_waitcnt vmcnt(10)
  s_mov_b32 s30, s36
wb_50:
  v_mov_b32 v15, s30
  s_mov_b64 exec, 1
  buffer_store_dword v15, off, s[8:11], s34 sc1
  s_mov_b64 exec, -1
  s_waitcnt lgkmcnt(2)
  v_mfma_f32_16x16x32_bf16 v[32:35], a[48:51], v[76:79], v[32:35]
  ds_read_b128 v[92:95], v11 offset:14336
  v_mfma_f32_16x16x32_bf16 v[40:43], a[128:131], v[76:79], v[40:43]
  ds_read_b128 v[96:99], v11 offset:34816
  v_mfma_f32_16x16x32_bf16 v[36:39], a[48:51], v[80:83], v[36:39]
  v_mfma_f32_16x16x32_bf16 v[44:47], a[128:131], v[80:83], v[44:47]
  s_waitcnt lgkmcnt(2)
  v_mfma_f32_16x16x32_bf16 v[32:35], a[52:55], v[84:87], v[32:35]
  ds_read_b128 v[76:79], v11 offset:15360
  v_mfma_f32_16x16x32_bf16 v[40:43], a[132:135], v[84:87], v[40:43]
  ds_read_b128 v[80:83], v11 offset:35840
  v_mfma_f32_16x16x32_bf16 v[36:39], a[52:55], v[88:91], v[36:39]
  v_mfma_f32_16x16x32_bf16 v[44:47], a[132:135], v[88:91], v[44:47]
  s_waitcnt lgkmcnt(2)
  v_mfma_f32_16x16x32_bf16 v[32:35], a[56:59], v[92:95], v[32:35]
  ds_read_b128 v[84:87], v11 offset:16384
  v_mfma_f32_16x16x32_bf16 v[40:43], a[136:139], v[92:95], v[40:43]
  ds_read_b128 v[88:91], v11 offset:36864
  v_mfma_f32_16x16x32_bf16 v[36:39], a[56:59], v[96:99], v[36:39]
  v_mfma_f32_16x16x32_bf16 v[44:47], a[136:139], v[96:99], v[44:47]
  s_waitcnt lgkmcnt(2)
  v_mfma_f32_16x16x32_bf16 v[32:35], a[60:63], v[76:79], v[32:35]
  ds_read_b128 v[92:95], v11 offset:17408
  v_mfma_f32_16x16x32_bf16 v[40:43], a[140:143], v[76:79], v[40:43]
  ds_read_b128 v[96:99], v11 offset:37888
  v_mfma_f32_16x16x32_bf16 v[36:39], a[60:63], v[80:83], v[36:39]
  v_mfma_f32_16x16x32_bf16 v[44:47], a[140:143], v[80:83], v[44:47]
  s_waitcnt lgkmcnt(2)
  v_mfma_f32_16x16x32_bf16 v[32:35], a[64:67], v[84:87], v[32:35]
  ds_read_b128 v[76:79], v11 offset:18432
  v_mfma_f32_16x16x32_bf16 v[40:43], a[144:147], v[84:87], v[40:43]
  ds_read_b128 v[80:83], v11 offset:38912
  v_mfma_f32_16x16x32_bf16 v[36:39], a[64:67], v[88:91], v[36:39]
  v_mfma_f32_16x16x32_bf16 v[44:47], a[144:147], v[88:91], v[44:47]
  s_waitcnt lgkmcnt(2)
  v_mfma_f32_16x16x32_bf16 v[32:35], a[68:71], v[92:95], v[32:35]
  ds_read_b128 v[84:87], v11 offset:19456
  v_mfma_f32_16x16x32_bf16 v[40:43], a[148:151], v[92:95], v[40:43]
  ds_read_b128 v[88:91], v11 offset:39936
  v_mfma_f32_16x16x32_bf16 v[36:39], a[68:71], v[96:99], v[36:39]
  v_mfma_f32_16x16x32_bf16 v[44:47], a[148:151], v[96:99], v[44:47]
  s_waitcnt lgkmcnt(2)
  v_mfma_f32_16x16x32_bf16 v[32:35], a[72:75], v[76:79], v[32:35]
  v_mfma_f32_16x16x32_bf16 v[40:43], a[152:155], v[76:79], v[40:43]
  v_mfma_f32_16x16x32_bf16 v[36:39], a[72:75], v[80:83], v[36:39]
  v_mfma_f32_16x16x32_bf16 v[44:47], a[152:155], v[80:83], v[44:47]
  s_waitcnt lgkmcnt(0)
  v_mfma_f32_16x16x32_bf16 v[32:35], a[76:79], v[84:87], v[32:35]
  v_mfma_f32_16x16x32_bf16 v[40:43], a[156:159], v[84:87], v[40:43]
  v_mfma_f32_16x16x32_bf16 v[36:39], a[76:79], v[88:91], v[36:39]
  v_mfma_f32_16x16x32_bf16 v[44:47], a[156:159], v[88:91], v[44:47]
  s_nop 4
  v_cvt_pk_bf16_f32 v68, v32, v33
  v_cvt_pk_bf16_f32 v69, v40, v41
  v_lshlrev_b32 v32, 16, v68
  v_and_b32 v33, 0xffff0000, v68
  v_lshlrev_b32 v40, 16, v69
  v_and_b32 v41, 0xffff0000, v69
  v_mul_f32 v70, 0xbfb8aa3b, v32
  v_mul_f32 v71, 0xbfb8aa3b, v33
  v_exp_f32 v70, v70
  v_exp_f32 v71, v71
  v_add_f32 v70, 1.0, v70
  v_add_f32 v71, 1.0, v71
  v_rcp_f32 v70, v70
  v_rcp_f32 v71, v71
  v_mul_f32 v70, v32, v70
  v_mul_f32 v71, v33, v71
  v_cvt_pk_bf16_f32 v68, v70, v71
  v_lshlrev_b32 v70, 16, v68
  v_and_b32 v71, 0xffff0000, v68
  v_mul_f32 v70, v70, v40
  v_mul_f32 v71, v71, v41
  v_cvt_pk_bf16_f32 v56, v70, v71
  v_cvt_pk_bf16_f32 v68, v34, v35
  v_cvt_pk_bf16_f32 v69, v42, v43
  v_lshlrev_b32 v34, 16, v68
  v_and_b32 v35, 0xffff0000, v68
  v_lshlrev_b32 v42, 16, v69
  v_and_b32 v43, 0xffff0000, v69
  v_mul_f32 v70, 0xbfb8aa3b, v34
  v_mul_f32 v71, 0xbfb8aa3b, v35
  v_exp_f32 v70, v70
  v_exp_f32 v71, v71
  v_add_f32 v70, 1.0, v70
  v_add_f32 v71, 1.0, v71
  v_rcp_f32 v70, v70
  v_rcp_f32 v71, v71
  v_mul_f32 v70, v34, v70
  v_mul_f32 v71, v35, v71
  v_cvt_pk_bf16_f32 v68, v70, v71
  v_lshlrev_b32 v70, 16, v68
  v_and_b32 v71, 0xffff0000, v68
  v_mul_f32 v70, v70, v42
  v_mul_f32 v71, v71, v43
  v_cvt_pk_bf16_f32 v57, v70, v71
  v_cvt_pk_bf16_f32 v68, v36, v37
  v_cvt_pk_bf16_f32 v69, v44, v45
  v_lshlrev_b32 v36, 16, v68
  v_and_b32 v37, 0xffff0000, v68
  v_lshlrev_b32 v44, 16, v69
  v_and_b32 v45, 0xffff0000, v69
  v_mul_f32 v70, 0xbfb8aa3b, v36
  v_mul_f32 v71, 0xbfb8aa3b, v37
  v_exp_f32 v70, v70
  v_exp_f32 v71, v71
  v_add_f32 v70, 1.0, v70
  v_add_f32 v71, 1.0, v71
  v_rcp_f32 v70, v70
  v_rcp_f32 v71, v71
  v_mul_f32 v70, v36, v70
  v_mul_f32 v71, v37, v71
  v_cvt_pk_bf16_f32 v68, v70, v71
  v_lshlrev_b32 v70, 16, v68
  v_and_b32 v71, 0xffff0000, v68
  v_mul_f32 v70, v70, v44
  v_mul_f32 v71, v71, v45
  v_cvt_pk_bf16_f32 v58, v70, v71
  v_cvt_pk_bf16_f32 v68, v38, v39
  v_cvt_pk_bf16_f32 v69, v46, v47
  v_lshlrev_b32 v38, 16, v68
  v_and_b32 v39, 0xffff0000, v68
  v_lshlrev_b32 v46, 16, v69
  v_and_b32 v47, 0xffff0000, v69
  v_mul_f32 v70, 0xbfb8aa3b, v38
  v_mul_f32 v71, 0xbfb8aa3b, v39
  v_exp_f32 v70, v70
  v_exp_f32 v71, v71
  v_add_f32 v70, 1.0, v70
  v_add_f32 v71, 1.0, v71
  v_rcp_f32 v70, v70
  v_rcp_f32 v71, v71
  v_mul_f32 v70, v38, v70
  v_mul_f32 v71, v39, v71
  v_cvt_pk_bf16_f32 v68, v70, v71
  v_lshlrev_b32 v70, 16, v68
  v_and_b32 v71, 0xffff0000, v68
  v_mul_f32 v70, v70, v46
  v_mul_f32 v71, v71, v47
  v_cvt_pk_bf16_f32 v59, v70, v71
  buffer_store_dwordx2 v[56:57], v12, s[8:11], s35 offen offset:0 sc1
  buffer_store_dwordx2 v[58:59], v12, s[8:11], s35 offen offset:1024 sc1
  s_cmp_ge_u32 s36, 2
  s_cbranch_scc1 we_51
  s_waitcnt vmcnt(0)
  s_add_u32 s30, s36, 1
  v_mov_b32 v15, s30
  s_mov_b64 exec, 1
  buffer_store_dword v15, off, s[8:11], s34 sc1
  s_mov_b64 exec, -1
we_51:
  s_add_u32 s35, s35, 98304
  s_add_u32 s38, s38, 40960
  s_cmp_eq_u32 s38, 122880
  s_cselect_b32 s38, 0, s38
  s_add_u32 s72, s72, 40960
  s_cmp_eq_u32 s72, 122880
  s_cselect_b32 s72, 0, s72
  s_add_u32 s36, s36, 1
  s_cmp_lt_u32 s36, 64
  s_cbranch_scc1 WGU_loop
  s_waitcnt vmcnt(0)
  v_mov_b32 v15, s36
  s_mov_b64 exec, 1
  buffer_store_dword v15, off, s[8:11], s34 sc1
  s_mov_b64 exec, -1
  s_branch PY
WO:
  s_mov_b32 s12, s50
  s_and_b32 s13, s51, 0xffff
  s_mov_b32 s14, 7864320
  s_mov_b32 s15, 0x20000
  s_mov_b32 s30, 1280
  v_add_u32 v68, 0, v1
  v_lshrrev_b32 v69, 2, v68
  v_and_b32 v70, 3, v68
  v_mul_lo_u32 v69, v69, s30
  v_lshl_add_u32 v4, v70, 4, v69
  v_add_u32 v68, 64, v1
  v_lshrrev_b32 v69, 2, v68
  v_and_b32 v70, 3, v68
  v_mul_lo_u32 v69, v69, s30
  v_lshl_add_u32 v5, v70, 4, v69
  v_add_u32 v68, 128, v1
  v_lshrrev_b32 v69, 2, v68
  v_and_b32 v70, 3, v68
  v_mul_lo_u32 v69, v69, s30
  v_lshl_add_u32 v6, v70, 4, v69
  v_add_u32 v68, 192, v1
  v_lshrrev_b32 v69, 2, v68
  v_and_b32 v70, 3, v68
  v_mul_lo_u32 v69, v69, s30
  v_lshl_add_u32 v7, v70, 4, v69
  v_add_u32 v68, 256, v1
  v_lshrrev_b32 v69, 2, v68
  v_and_b32 v70, 3, v68
  v_mul_lo_u32 v69, v69, s30
  v_lshl_add_u32 v8, v70, 4, v69
  v_add_u32 v68, 320, v1
  v_lshrrev_b32 v69, 2, v68
  v_and_b32 v70, 3, v68
  v_mul_lo_u32 v69, v69, s30
  v_lshl_add_u32 v9, v70, 4, v69
  v_bfe_u32 v68, v1, 5, 1
  v_mul_u32_u24 v3, 512, v68
  v_bfe_u32 v68, v1, 4, 1
  v_mul_u32_u24 v68, 256, v68
  v_add_u32 v3, v3, v68
  v_bfe_u32 v68, v1, 2, 1
  v_mul_u32_u24 v68, 64, v68
  v_add_u32 v3, v3, v68
  v_bfe_u32 v68, v1, 3, 1
  v_mul_u32_u24 v68, 128, v68
  v_add_u32 v3, v3, v68
  v_and_b32 v68, 3, v1
  v_lshl_add_u32 v3, v68, 3, v3
  s_mul_i32 s27, s24, 30720
  v_add_u32 v3, s27, v3
  s_mul_i32 s32, s25, 245760
  s_mul_i32 s27, s24, 320
  s_add_u32 s32, s32, s27
  s_mul_i32 s31, s24, 30720
  s_add_u32 m0, s31, 0
  s_add_u32 s27, s32, 0
  buffer_load_dwordx4 v4, s[12:15], s27 offen  lds
  s_add_u32 m0, s31, 1024
  s_add_u32 s27, s32, 0
  buffer_load_dwordx4 v5, s[12:15], s27 offen  lds
  s_add_u32 m0, s31, 2048
  s_add_u32 s27, s32, 0
  buffer_load_dwordx4 v6, s[12:15], s27 offen  lds
  s_add_u32 m0, s31, 3072
  s_add_u32 s27, s32, 0
  buffer_load_dwordx4 v7, s[12:15], s27 offen  lds
  s_add_u32 m0, s31, 4096
  s_add_u32 s27, s32, 0
  buffer_load_dwordx4 v8, s[12:15], s27 offen  lds
  s_add_u32 m0, s31, 5120
  s_add_u32 s27, s32, 0
  buffer_load_dwordx4 v9, s[12:15], s27 offen  lds
  s_add_u32 m0, s31, 6144
  s_add_u32 s27, s32, 64
  buffer_load_dwordx4 v4, s[12:15], s27 offen  lds
  s_add_u32 m0, s31, 7168
  s_add_u32 s27, s32, 64
  buffer_load_dwordx4 v5, s[12:15], s27 offen  lds
  s_add_u32 m0, s31, 8192
  s_add_u32 s27, s32, 64
  buffer_load_dwordx4 v6, s[12:15], s27 offen  lds
  s_add_u32 m0, s31, 9216
  s_add_u32 s27, s32, 64
  buffer_load_dwordx4 v7, s[12:15], s27 offen  lds
  s_add_u32 m0, s31, 10240
  s_add_u32 s27, s32, 64
  buffer_load_dwordx4 v8, s[12:15], s27 offen  lds
  s_add_u32 m0, s31, 11264
  s_add_u32 s27, s32, 64
  buffer_load_dwordx4 v9, s[12:15], s27 offen  lds
  s_add_u32 m0, s31, 12288
  s_add_u32 s27, s32, 128
  buffer_load_dwordx4 v4, s[12:15], s27 offen  lds
  s_add_u32 m0, s31, 13312
  s_add_u32 s27, s32, 128
  buffer_load_dwordx4 v5, s[12:15], s27 offen  lds
  s_add_u32 m0, s31, 14336
  s_add_u32 s27, s32, 128
  buffer_load_dwordx4 v6, s[12:15], s27 offen  lds
  s_add_u32 m0, s31, 15360
  s_add_u32 s27, s32, 128
  buffer_load_dwordx4 v7, s[12:15], s27 offen  lds
  s_add_u32 m0, s31, 16384
  s_add_u32 s27, s32, 128
  buffer_load_dwordx4 v8, s[12:15], s27 offen  lds
  s_add_u32 m0, s31, 17408
  s_add_u32 s27, s32, 128
  buffer_load_dwordx4 v9, s[12:15], s27 offen  lds
  s_add_u32 m0, s31, 18432
  s_add_u32 s27, s32, 192
  buffer_load_dwordx4 v4, s[12:15], s27 offen  lds
  s_add_u32 m0, s31, 19456
  s_add_u32 s27, s32, 192
  buffer_load_dwordx4 v5, s[12:15], s27 offen  lds
  s_add_u32 m0, s31, 20480
  s_add_u32 s27, s32, 192
  buffer_load_dwordx4 v6, s[12:15], s27 offen  lds
  s_add_u32 m0, s31, 21504
  s_add_u32 s27, s32, 192
  buffer_load_dwordx4 v7, s[12:15], s27 offen  lds
  s_add_u32 m0, s31, 22528
  s_add_u32 s27, s32, 192
  buffer_load_dwordx4 v8, s[12:15], s27 offen  lds
  s_add_u32 m0, s31, 23552
  s_add_u32 s27, s32, 192
  buffer_load_dwordx4 v9, s[12:15], s27 offen  lds
  s_add_u32 m0, s31, 24576
  s_add_u32 s27, s32, 256
  buffer_load_dwordx4 v4, s[12:15], s27 offen  lds
  s_add_u32 m0, s31, 25600
  s_add_u32 s27, s32, 256
  buffer_load_dwordx4 v5, s[12:15], s27 offen  lds
  s_add_u32 m0, s31, 26624
  s_add_u32 s27, s32, 256
  buffer_load_dwordx4 v6, s[12:15], s27 offen  lds
  s_add_u32 m0, s31, 27648
  s_add_u32 s27, s32, 256
  buffer_load_dwordx4 v7, s[12:15], s27 offen  lds
  s_add_u32 m0, s31, 28672
  s_add_u32 s27, s32, 256
  buffer_load_dwordx4 v8, s[12:15], s27 offen  lds
  s_add_u32 m0, s31, 29696
  s_add_u32 s27, s32, 256
  buffer_load_dwordx4 v9, s[12:15], s27 offen  lds
  s_waitcnt vmcnt(24)
  ds_read_b64_tr_b16 a[0:1], v3 offset:0
  ds_read_b64_tr_b16 a[2:3], v3 offset:1024
  ds_read_b64_tr_b16 a[4:5], v3 offset:3072
  ds_read_b64_tr_b16 a[6:7], v3 offset:4096
  ds_read_b64_tr_b16 a[16:17], v3 offset:2048
  ds_read_b64_tr_b16 a[18:19], v3 offset:5120
  ds_read_b64_tr_b16 a[24:25], v3 offset:32
  ds_read_b64_tr_b16 a[26:27], v3 offset:1056
  ds_read_b64_tr_b16 a[28:29], v3 offset:3104
  ds_read_b64_tr_b16 a[30:31], v3 offset:4128
  ds_read_b64_tr_b16 a[40:41], v3 offset:2080
  ds_read_b64_tr_b16 a[42:43], v3 offset:5152
  s_waitcnt lgkmcnt(0)
  s_add_u32 m0, s31, 0
  s_add_u32 s27, s32, 122880
  buffer_load_dwordx4 v4, s[12:15], s27 offen  lds
  s_add_u32 m0, s31, 1024
  s_add_u32 s27, s32, 122880
  buffer_load_dwordx4 v5, s[12:15], s27 offen  lds
  s_add_u32 m0, s31, 2048
  s_add_u32 s27, s32, 122880
  buffer_load_dwordx4 v6, s[12:15], s27 offen  lds
  s_add_u32 m0, s31, 3072
  s_add_u32 s27, s32, 122880
  buffer_load_dwordx4 v7, s[12:15], s27 offen  lds
  s_add_u32 m0, s31, 4096
  s_add_u32 s27, s32, 122880
  buffer_load_dwordx4 v8, s[12:15], s27 offen  lds
  s_add_u32 m0, s31, 5120
  s_add_u32 s27, s32, 122880
  buffer_load_dwordx4 v9, s[12:15], s27 offen  lds
  s_waitcnt vmcnt(24)
  ds_read_b64_tr_b16 a[48:49], v3 offset:6144
  ds_read_b64_tr_b16 a[50:51], v3 offset:7168
  ds_read_b64_tr_b16 a[52:53], v3 offset:9216
  ds_read_b64_tr_b16 a[54:55], v3 offset:10240
  ds_read_b64_tr_b16 a[64:65], v3 offset:8192
  ds_read_b64_tr_b16 a[66:67], v3 offset:11264
  ds_read_b64_tr_b16 a[72:73], v3 offset:6176
  ds_read_b64_tr_b16 a[74:75], v3 offset:7200
  ds_read_b64_tr_b16 a[76:77], v3 offset:9248
  ds_read_b64_tr_b16 a[78:79], v3 offset:10272
  ds_read_b64_tr_b16 a[88:89], v3 offset:8224
  ds_read_b64_tr_b16 a[90:91], v3 offset:11296
  s_waitcnt lgkmcnt(0)
  s_add_u32 m0, s31, 6144
  s_add_u32 s27, s32, 122944
  buffer_load_dwordx4 v4, s[12:15], s27 offen  lds
  s_add_u32 m0, s31, 7168
  s_add_u32 s27, s32, 122944
  buffer_load_dwordx4 v5, s[12:15], s27 offen  lds
  s_add_u32 m0, s31, 8192
  s_add_u32 s27, s32, 122944
  buffer_load_dwordx4 v6, s[12:15], s27 offen  lds
  s_add_u32 m0, s31, 9216
  s_add_u32 s27, s32, 122944
  buffer_load_dwordx4 v7, s[12:15], s27 offen  lds
  s_add_u32 m0, s31, 10240
  s_add_u32 s27, s32, 122944
  buffer_load_dwordx4 v8, s[12:15], s27 offen  lds
  s_add_u32 m0, s31, 11264
  s_add_u32 s27, s32, 122944
  buffer_load_dwordx4 v9, s[12:15], s27 offen  lds
  s_waitcnt vmcnt(24)
  ds_read_b64_tr_b16 a[96:97], v3 offset:12288
  ds_read_b64_tr_b16 a[98:99], v3 offset:13312
  ds_read_b64_tr_b16 a[100:101], v3 offset:15360
  ds_read_b64_tr_b16 a[102:103], v3 offset:16384
  ds_read_b64_tr_b16 a[112:113], v3 offset:14336
  ds_read_b64_tr_b16 a[114:115], v3 offset:17408
  ds_read_b64_tr_b16 a[120:121], v3 offset:12320
  ds_read_b64_tr_b16 a[122:123], v3 offset:13344
  ds_read_b64_tr_b16 a[124:125], v3 offset:15392
  ds_read_b64_tr_b16 a[126:127], v3 offset:16416
  ds_read_b64_tr_b16 a[136:137], v3 offset:14368
  ds_read_b64_tr_b16 a[138:139], v3 offset:17440
  s_waitcnt lgkmcnt(0)
  s_add_u32 m0, s31, 12288
  s_add_u32 s27, s32, 123008
  buffer_load_dwordx4 v4, s[12:15], s27 offen  lds
  s_add_u32 m0, s31, 13312
  s_add_u32 s27, s32, 123008
  buffer_load_dwordx4 v5, s[12:15], s27 offen  lds
  s_add_u32 m0, s31, 14336
  s_add_u32 s27, s32, 123008
  buffer_load_dwordx4 v6, s[12:15], s27 offen  lds
  s_add_u32 m0, s31, 15360
  s_add_u32 s27, s32, 123008
  buffer_load_dwordx4 v7, s[12:15], s27 offen  lds
  s_add_u32 m0, s31, 16384
  s_add_u32 s27, s32, 123008
  buffer_load_dwordx4 v8, s[12:15], s27 offen  lds
  s_add_u32 m0, s31, 17408
  s_add_u32 s27, s32, 123008
  buffer_load_dwordx4 v9, s[12:15], s27 offen  lds
  s_waitcnt vmcnt(24)
  ds_read_b64_tr_b16 a[144:145], v3 offset:18432
  ds_read_b64_tr_b16 a[146:147], v3 offset:19456
  ds_read_b64_tr_b16 a[148:149], v3 offset:21504
  ds_read_b64_tr_b16 a[150:151], v3 offset:22528
  ds_read_b64_tr_b16 a[160:161], v3 offset:20480
  ds_read_b64_tr_b16 a[162:163], v3 offset:23552
  ds_read_b64_tr_b16 a[168:169], v3 offset:18464
  ds_read_b64_tr_b16 a[170:171], v3 offset:19488
  ds_read_b64_tr_b16 a[172:173], v3 offset:21536
  ds_read_b64_tr_b16 a[174:175], v3 offset:22560
  ds_read_b64_tr_b16 a[184:185], v3 offset:20512
  ds_read_b64_tr_b16 a[186:187], v3 offset:23584
  s_waitcnt lgkmcnt(0)
  s_add_u32 m0, s31, 18432
  s_add_u32 s27, s32, 123072
  buffer_load_dwordx4 v4, s[12:15], s27 offen  lds
  s_add_u32 m0, s31, 19456
  s_add_u32 s27, s32, 123072
  buffer_load_dwordx4 v5, s[12:15], s27 offen  lds
  s_add_u32 m0, s31, 20480
  s_add_u32 s27, s32, 123072
  buffer_load_dwordx4 v6, s[12:15], s27 offen  lds
  s_add_u32 m0, s31, 21504
  s_add_u32 s27, s32, 123072
  buffer_load_dwordx4 v7, s[12:15], s27 offen  lds
  s_add_u32 m0, s31, 22528
  s_add_u32 s27, s32, 123072
  buffer_load_dwordx4 v8, s[12:15], s27 offen  lds
  s_add_u32 m0, s31, 23552
  s_add_u32 s27, s32, 123072
  buffer_load_dwordx4 v9, s[12:15], s27 offen  lds
  s_waitcnt vmcnt(24)
  ds_read_b64_tr_b16 a[192:193], v3 offset:24576
  ds_read_b64_tr_b16 a[194:195], v3 offset:25600
  ds_read_b64_tr_b16 a[196:197], v3 offset:27648
  ds_read_b64_tr_b16 a[198:199], v3 offset:28672
  ds_read_b64_tr_b16 a[208:209], v3 offset:26624
  ds_read_b64_tr_b16 a[210:211], v3 offset:29696
  ds_read_b64_tr_b16 a[216:217], v3 offset:24608
  ds_read_b64_tr_b16 a[218:219], v3 offset:25632
  ds_read_b64_tr_b16 a[220:221], v3 offset:27680
  ds_read_b64_tr_b16 a[222:223], v3 offset:28704
  ds_read_b64_tr_b16 a[232:233], v3 offset:26656
  ds_read_b64_tr_b16 a[234:235], v3 offset:29728
  s_waitcnt lgkmcnt(0)
  s_add_u32 m0, s31, 24576
  s_add_u32 s27, s32, 123136
  buffer_load_dwordx4 v4, s[12:15], s27 offen  lds
  s_add_u32 m0, s31, 25600
  s_add_u32 s27, s32, 123136
  buffer_load_dwordx4 v5, s[12:15], s27 offen  lds
  s_add_u32 m0, s31, 26624
  s_add_u32 s27, s32, 123136
  buffer_load_dwordx4 v6, s[12:15], s27 offen  lds
  s_add_u32 m0, s31, 27648
  s_add_u32 s27, s32, 123136
  buffer_load_dwordx4 v7, s[12:15], s27 offen  lds
  s_add_u32 m0, s31, 28672
  s_add_u32 s27, s32, 123136
  buffer_load_dwordx4 v8, s[12:15], s27 offen  lds
  s_add_u32 m0, s31, 29696
  s_add_u32 s27, s32, 123136
  buffer_load_dwordx4 v9, s[12:15], s27 offen  lds
  s_waitcnt vmcnt(24)
  ds_read_b64_tr_b16 a[8:9], v3 offset:0
  ds_read_b64_tr_b16 a[10:11], v3 offset:1024
  ds_read_b64_tr_b16 a[12:13], v3 offset:3072
  ds_read_b64_tr_b16 a[14:15], v3 offset:4096
  ds_read_b64_tr_b16 a[20:21], v3 offset:2048
  ds_read_b64_tr_b16 a[22:23], v3 offset:5120
  ds_read_b64_tr_b16 a[32:33], v3 offset:32
  ds_read_b64_tr_b16 a[34:35], v3 offset:1056
  ds_read_b64_tr_b16 a[36:37], v3 offset:3104
  ds_read_b64_tr_b16 a[38:39], v3 offset:4128
  ds_read_b64_tr_b16 a[44:45], v3 offset:2080
  ds_read_b64_tr_b16 a[46:47], v3 offset:5152
  s_waitcnt lgkmcnt(0)
  s_waitcnt vmcnt(18)
  ds_read_b64_tr_b16 a[56:57], v3 offset:6144
  ds_read_b64_tr_b16 a[58:59], v3 offset:7168
  ds_read_b64_tr_b16 a[60:61], v3 offset:9216
  ds_read_b64_tr_b16 a[62:63], v3 offset:10240
  ds_read_b64_tr_b16 a[68:69], v3 offset:8192
  ds_read_b64_tr_b16 a[70:71], v3 offset:11264
  ds_read_b64_tr_b16 a[80:81], v3 offset:6176
  ds_read_b64_tr_b16 a[82:83], v3 offset:7200
  ds_read_b64_tr_b16 a[84:85], v3 offset:9248
  ds_read_b64_tr_b16 a[86:87], v3 offset:10272
  ds_read_b64_tr_b16 a[92:93], v3 offset:8224
  ds_read_b64_tr_b16 a[94:95], v3 offset:11296
  s_waitcnt lgkmcnt(0)
  s_waitcnt vmcnt(12)
  ds_read_b64_tr_b16 a[104:105], v3 offset:12288
  ds_read_b64_tr_b16 a[106:107], v3 offset:13312
  ds_read_b64_tr_b16 a[108:109], v3 offset:15360
  ds_read_b64_tr_b16 a[110:111], v3 offset:16384
  ds_read_b64_tr_b16 a[116:117], v3 offset:14336
  ds_read_b64_tr_b16 a[118:119], v3 offset:17408
  ds_read_b64_tr_b16 a[128:129], v3 offset:12320
  ds_read_b64_tr_b16 a[130:131], v3 offset:13344
  ds_read_b64_tr_b16 a[132:133], v3 offset:15392
  ds_read_b64_tr_b16 a[134:135], v3 offset:16416
  ds_read_b64_tr_b16 a[140:141], v3 offset:14368
  ds_read_b64_tr_b16 a[142:143], v3 offset:17440
  s_waitcnt lgkmcnt(0)
  s_waitcnt vmcnt(6)
  ds_read_b64_tr_b16 a[152:153], v3 offset:18432
  ds_read_b64_tr_b16 a[154:155], v3 offset:19456
  ds_read_b64_tr_b16 a[156:157], v3 offset:21504
  ds_read_b64_tr_b16 a[158:159], v3 offset:22528
  ds_read_b64_tr_b16 a[164:165], v3 offset:20480
  ds_read_b64_tr_b16 a[166:167], v3 offset:23552
  ds_read_b64_tr_b16 a[176:177], v3 offset:18464
  ds_read_b64_tr_b16 a[178:179], v3 offset:19488
  ds_read_b64_tr_b16 a[180:181], v3 offset:21536
  ds_read_b64_tr_b16 a[182:183], v3 offset:22560
  ds_read_b64_tr_b16 a[188:189], v3 offset:20512
  ds_read_b64_tr_b16 a[190:191], v3 offset:23584
  s_waitcnt lgkmcnt(0)
  s_waitcnt vmcnt(0)
  ds_read_b64_tr_b16 a[200:201], v3 offset:24576
  ds_read_b64_tr_b16 a[202:203], v3 offset:25600
  ds_read_b64_tr_b16 a[204:205], v3 offset:27648
  ds_read_b64_tr_b16 a[206:207], v3 offset:28672
  ds_read_b64_tr_b16 a[212:213], v3 offset:26624
  ds_read_b64_tr_b16 a[214:215], v3 offset:29696
  ds_read_b64_tr_b16 a[224:225], v3 offset:24608
  ds_read_b64_tr_b16 a[226:227], v3 offset:25632
  ds_read_b64_tr_b16 a[228:229], v3 offset:27680
  ds_read_b64_tr_b16 a[230:231], v3 offset:28704
  ds_read_b64_tr_b16 a[236:237], v3 offset:26656
  ds_read_b64_tr_b16 a[238:239], v3 offset:29728
  s_waitcnt lgkmcnt(0)
  s_cmp_lg_u32 s24, 0
  s_cbranch_scc1 wwd_53
ww_52:
  buffer_load_dword v8, off, s[68:71], 0 offset:72 sc1
  s_add_u32 s26, s26, 1
  s_mov_b32 s39, 114
  s_cmp_gt_u32 s26, 2097152
  s_cbranch_scc1 L_abort
  s_waitcnt vmcnt(0)
  v_cmp_gt_u32 vcc, 4, v8
  s_cbranch_vccz wwd_53
  s_sleep 4
  s_branch ww_52
wwd_53:
  s_barrier
  v_mov_b32 v14, 0
  s_add_u32 s34, s25, 64
  s_lshl_b32 s34, s34, 7
  s_lshl_b32 s27, s24, 2
  s_add_u32 s34, s34, s27
  s_add_u32 s34, s34, 4096
  s_add_u32 s27, s25, 32
  v_lshrrev_b32 v68, 2, v1
  v_min_u32 v68, 0, v68
  v_add_u32 v68, s27, v68
  v_lshlrev_b32 v68, 7, v68
  v_and_b32 v10, 3, v1
  v_lshl_add_u32 v10, v10, 2, v68
  v_add_u32 v10, 4096, v10
  s_mul_i32 s37, s25, 12288
  s_mul_i32 s33, s24, 3072
  s_add_u32 s37, s37, s33
  s_add_u32 s37, s37, 92798976
  s_mul_i32 s35, s25, 40960
  s_mul_i32 s27, s24, 10240
  s_add_u32 s35, s35, s27
  s_add_u32 s35, s35, 117964800
  v_add_u32 v11, 4096, v2
  v_add_u32 v12, 8192, v2
  s_mov_b32 s36, 0
  s_mov_b32 s72, 0
  s_mov_b32 s73, 0
wp_54:
  buffer_load_dword v9, v10, s[8:11], 0 offen sc1
  s_add_u32 s26, s26, 1
  s_mov_b32 s39, 16
  s_cmp_gt_u32 s26, 2097152
  s_cbranch_scc1 L_abort
  s_waitcnt vmcnt(0)
  v_cmp_ge_u32 vcc, s36, v9
  s_cbranch_vccnz wp_54
  s_add_u32 m0, s72, s33
  buffer_load_dword v9, v10, s[8:11], 0 offen sc1
  buffer_load_dwordx4 v2, s[8:11], s37 offen offset:0 sc1 lds
  buffer_load_dwordx4 v2, s[8:11], s37 offen offset:1024 sc1 lds
  buffer_load_dwordx4 v2, s[8:11], s37 offen offset:2048 sc1 lds
  s_add_u32 s37, s37, 393216
  s_xor_b32 s72, s72, 12288
  s_mov_b32 s38, 0
WO_loop:
  s_cmp_lt_u32 s36, 3
  s_cselect_b32 s38, 0, s38
  s_cmp_eq_u32 s38, 0
  s_cbranch_scc1 WO_56
  s_waitcnt vmcnt(10)
  s_branch WO_57
WO_56:
  s_waitcnt vmcnt(0)
WO_57:
  s_sub_u32 s30, s36, s38
  s_max_i32 s30, s30, 0
  v_mov_b32 v15, s30
  s_mov_b64 exec, 1
  buffer_store_dword v15, off, s[8:11], s34 sc1
  s_mov_b64 exec, -1
  s_barrier
  v_add_u32 v13, s73, v2
  s_xor_b32 s73, s73, 12288
  ds_read_b128 v[64:67], v13 offset:0
  ds_read_b128 v[68:71], v13 offset:1024
  ds_read_b128 v[72:75], v13 offset:2048
  ds_read_b128 v[76:79], v13 offset:3072
  ds_read_b128 v[80:83], v13 offset:4096
  ds_read_b128 v[84:87], v13 offset:5120
  ds_read_b128 v[88:91], v13 offset:6144
  ds_read_b128 v[92:95], v13 offset:7168
  ds_read_b128 v[96:99], v13 offset:8192
  ds_read_b128 v[100:103], v13 offset:9216
  ds_read_b128 v[104:107], v13 offset:10240
  ds_read_b128 v[108:111], v13 offset:11264
  s_add_u32 s31, s36, 1
  v_cmp_ge_u32 vcc, s31, v9
  s_nop 0
  s_cmp_eq_u64 vcc, 0
  s_cselect_b32 s38, 1, 0
  s_cbranch_scc0 WO_58
  s_waitcnt lgkmcnt(10)
  v_mfma_f32_16x16x32_bf16 v[16:19], v[64:67], a[0:3], 0
  v_mfma_f32_16x16x32_bf16 v[20:23], v[68:71], a[0:3], 0
  s_waitcnt lgkmcnt(8)
  v_mfma_f32_16x16x32_bf16 v[16:19], v[72:75], a[4:7], v[16:19]
  v_mfma_f32_16x16x32_bf16 v[20:23], v[76:79], a[4:7], v[20:23]
  s_waitcnt lgkmcnt(6)
  v_mfma_f32_16x16x32_bf16 v[16:19], v[80:83], a[8:11], v[16:19]
  v_mfma_f32_16x16x32_bf16 v[20:23], v[84:87], a[8:11], v[20:23]
  s_waitcnt lgkmcnt(4)
  v_mfma_f32_16x16x32_bf16 v[16:19], v[88:91], a[12:15], v[16:19]
  v_mfma_f32_16x16x32_bf16 v[20:23], v[92:95], a[12:15], v[20:23]
  s_waitcnt lgkmcnt(2)
  v_mfma_f32_16x16x32_bf16 v[16:19], v[96:99], a[16:19], v[16:19]
  v_mfma_f32_16x16x32_bf16 v[20:23], v[100:103], a[16:19], v[20:23]
  s_waitcnt lgkmcnt(0)
  v_mfma_f32_16x16x32_bf16 v[16:19], v[104:107], a[20:23], v[16:19]
  v_mfma_f32_16x16x32_bf16 v[20:23], v[108:111], a[20:23], v[20:23]
  v_mfma_f32_16x16x32_bf16 v[24:27], v[64:67], a[24:27], 0
  v_mfma_f32_16x16x32_bf16 v[28:31], v[68:71], a[24:27], 0
  s_add_u32 m0, s72, s33
  buffer_load_dword v9, v10, s[8:11], 0 offen sc1
  v_mfma_f32_16x16x32_bf16 v[24:27], v[72:75], a[28:31], v[24:27]
  v_mfma_f32_16x16x32_bf16 v[28:31], v[76:79], a[28:31], v[28:31]
  buffer_load_dwordx4 v2, s[8:11], s37 offen offset:0 sc1 lds
  v_mfma_f32_16x16x32_bf16 v[24:27], v[80:83], a[32:35], v[24:27]
  v_mfma_f32_16x16x32_bf16 v[28:31], v[84:87], a[32:35], v[28:31]
  buffer_load_dwordx4 v2, s[8:11], s37 offen offset:1024 sc1 lds
  v_mfma_f32_16x16x32_bf16 v[24:27], v[88:91], a[36:39], v[24:27]
  v_mfma_f32_16x16x32_bf16 v[28:31], v[92:95], a[36:39], v[28:31]
  v_cvt_pk_bf16_f32 v40, v16, v17
  v_cvt_pk_bf16_f32 v41, v18, v19
  v_cvt_pk_bf16_f32 v42, v20, v21
  v_cvt_pk_bf16_f32 v43, v22, v23
  buffer_store_dwordx4 v[40:43], v2, s[8:11], s35 offen offset:0 sc1
  v_mfma_f32_16x16x32_bf16 v[24:27], v[96:99], a[40:43], v[24:27]
  v_mfma_f32_16x16x32_bf16 v[28:31], v[100:103], a[40:43], v[28:31]
  buffer_load_dwordx4 v2, s[8:11], s37 offen offset:2048 sc1 lds
  v_mfma_f32_16x16x32_bf16 v[24:27], v[104:107], a[44:47], v[24:27]
  v_mfma_f32_16x16x32_bf16 v[28:31], v[108:111], a[44:47], v[28:31]
  v_mfma_f32_16x16x32_bf16 v[32:35], v[64:67], a[48:51], 0
  v_mfma_f32_16x16x32_bf16 v[36:39], v[68:71], a[48:51], 0
  v_mfma_f32_16x16x32_bf16 v[32:35], v[72:75], a[52:55], v[32:35]
  v_mfma_f32_16x16x32_bf16 v[36:39], v[76:79], a[52:55], v[36:39]
  v_mfma_f32_16x16x32_bf16 v[32:35], v[80:83], a[56:59], v[32:35]
  v_mfma_f32_16x16x32_bf16 v[36:39], v[84:87], a[56:59], v[36:39]
  v_mfma_f32_16x16x32_bf16 v[32:35], v[88:91], a[60:63], v[32:35]
  v_mfma_f32_16x16x32_bf16 v[36:39], v[92:95], a[60:63], v[36:39]
  v_cvt_pk_bf16_f32 v44, v24, v25
  v_cvt_pk_bf16_f32 v45, v26, v27
  v_cvt_pk_bf16_f32 v46, v28, v29
  v_cvt_pk_bf16_f32 v47, v30, v31
  buffer_store_dwordx4 v[44:47], v2, s[8:11], s35 offen offset:1024 sc1
  v_mfma_f32_16x16x32_bf16 v[32:35], v[96:99], a[64:67], v[32:35]
  v_mfma_f32_16x16x32_bf16 v[36:39], v[100:103], a[64:67], v[36:39]
  v_mfma_f32_16x16x32_bf16 v[32:35], v[104:107], a[68:71], v[32:35]
  v_mfma_f32_16x16x32_bf16 v[36:39], v[108:111], a[68:71], v[36:39]
  v_mfma_f32_16x16x32_bf16 v[16:19], v[64:67], a[72:75], 0
  v_mfma_f32_16x16x32_bf16 v[20:23], v[68:71], a[72:75], 0
  v_mfma_f32_16x16x32_bf16 v[16:19], v[72:75], a[76:79], v[16:19]
  v_mfma_f32_16x16x32_bf16 v[20:23], v[76:79], a[76:79], v[20:23]
  v_mfma_f32_16x16x32_bf16 v[16:19], v[80:83], a[80:83], v[16:19]
  v_mfma_f32_16x16x32_bf16 v[20:23], v[84:87], a[80:83], v[20:23]
  v_mfma_f32_16x16x32_bf16 v[16:19], v[88:91], a[84:87], v[16:19]
  v_mfma_f32_16x16x32_bf16 v[20:23], v[92:95], a[84:87], v[20:23]
  v_cvt_pk_bf16_f32 v40, v32, v33
  v_cvt_pk_bf16_f32 v41, v34, v35
  v_cvt_pk_bf16_f32 v42, v36, v37
  v_cvt_pk_bf16_f32 v43, v38, v39
  buffer_store_dwordx4 v[40:43], v2, s[8:11], s35 offen offset:2048 sc1
  v_mfma_f32_16x16x32_bf16 v[16:19], v[96:99], a[88:91], v[16:19]
  v_mfma_f32_16x16x32_bf16 v[20:23], v[100:103], a[88:91], v[20:23]
  v_mfma_f32_16x16x32_bf16 v[16:19], v[104:107], a[92:95], v[16:19]
  v_mfma_f32_16x16x32_bf16 v[20:23], v[108:111], a[92:95], v[20:23]
  v_mfma_f32_16x16x32_bf16 v[24:27], v[64:67], a[96:99], 0
  v_mfma_f32_16x16x32_bf16 v[28:31], v[68:71], a[96:99], 0
  v_mfma_f32_16x16x32_bf16 v[24:27], v[72:75], a[100:103], v[24:27]
  v_mfma_f32_16x16x32_bf16 v[28:31], v[76:79], a[100:103], v[28:31]
  v_mfma_f32_16x16x32_bf16 v[24:27], v[80:83], a[104:107], v[24:27]
  v_mfma_f32_16x16x32_bf16 v[28:31], v[84:87], a[104:107], v[28:31]
  v_mfma_f32_16x16x32_bf16 v[24:27], v[88:91], a[108:111], v[24:27]
  v_mfma_f32_16x16x32_bf16 v[28:31], v[92:95], a[108:111], v[28:31]
  v_cvt_pk_bf16_f32 v44, v16, v17
  v_cvt_pk_bf16_f32 v45, v18, v19
  v_cvt_pk_bf16_f32 v46, v20, v21
  v_cvt_pk_bf16_f32 v47, v22, v23
  buffer_store_dwordx4 v[44:47], v2, s[8:11], s35 offen offset:3072 sc1
  v_mfma_f32_16x16x32_bf16 v[24:27], v[96:99], a[112:115], v[24:27]
  v_mfma_f32_16x16x32_bf16 v[28:31], v[100:103], a[112:115], v[28:31]
  v_mfma_f32_16x16x32_bf16 v[24:27], v[104:107], a[116:119], v[24:27]
  v_mfma_f32_16x16x32_bf16 v[28:31], v[108:111], a[116:119], v[28:31]
  v_mfma_f32_16x16x32_bf16 v[32:35], v[64:67], a[120:123], 0
  v_mfma_f32_16x16x32_bf16 v[36:39], v[68:71], a[120:123], 0
  s_waitcnt vmcnt(9)
  v_mov_b32 v15, s36
  s_mov_b64 exec, 1
  buffer_store_dword v15, off, s[8:11], s34 sc1
  s_mov_b64 exec, -1
  v_mfma_f32_16x16x32_bf16 v[32:35], v[72:75], a[124:127], v[32:35]
  v_mfma_f32_16x16x32_bf16 v[36:39], v[76:79], a[124:127], v[36:39]
  v_mfma_f32_16x16x32_bf16 v[32:35], v[80:83], a[128:131], v[32:35]
  v_mfma_f32_16x16x32_bf16 v[36:39], v[84:87], a[128:131], v[36:39]
  v_mfma_f32_16x16x32_bf16 v[32:35], v[88:91], a[132:135], v[32:35]
  v_mfma_f32_16x16x32_bf16 v[36:39], v[92:95], a[132:135], v[36:39]
  v_cvt_pk_bf16_f32 v40, v24, v25
  v_cvt_pk_bf16_f32 v41, v26, v27
  v_cvt_pk_bf16_f32 v42, v28, v29
  v_cvt_pk_bf16_f32 v43, v30, v31
  buffer_store_dwordx4 v[40:43], v11, s[8:11], s35 offen offset:0 sc1
  v_mfma_f32_16x16x32_bf16 v[32:35], v[96:99], a[136:139], v[32:35]
  v_mfma_f32_16x16x32_bf16 v[36:39], v[100:103], a[136:139], v[36:39]
  v_mfma_f32_16x16x32_bf16 v[32:35], v[104:107], a[140:143], v[32:35]
  v_mfma_f32_16x16x32_bf16 v[36:39], v[108:111], a[140:143], v[36:39]
  v_mfma_f32_16x16x32_bf16 v[16:19], v[64:67], a[144:147], 0
  v_mfma_f32_16x16x32_bf16 v[20:23], v[68:71], a[144:147], 0
  v_mfma_f32_16x16x32_bf16 v[16:19], v[72:75], a[148:151], v[16:19]
  v_mfma_f32_16x16x32_bf16 v[20:23], v[76:79], a[148:151], v[20:23]
  v_mfma_f32_16x16x32_bf16 v[16:19], v[80:83], a[152:155], v[16:19]
  v_mfma_f32_16x16x32_bf16 v[20:23], v[84:87], a[152:155], v[20:23]
  v_mfma_f32_16x16x32_bf16 v[16:19], v[88:91], a[156:159], v[16:19]
  v_mfma_f32_16x16x32_bf16 v[20:23], v[92:95], a[156:159], v[20:23]
  v_cvt_pk_bf16_f32 v44, v32, v33
  v_cvt_pk_bf16_f32 v45, v34, v35
  v_cvt_pk_bf16_f32 v46, v36, v37
  v_cvt_pk_bf16_f32 v47, v38, v39
  buffer_store_dwordx4 v[44:47], v11, s[8:11], s35 offen offset:1024 sc1
  v_mfma_f32_16x16x32_bf16 v[16:19], v[96:99], a[160:163], v[16:19]
  v_mfma_f32_16x16x32_bf16 v[20:23], v[100:103], a[160:163], v[20:23]
  v_mfma_f32_16x16x32_bf16 v[16:19], v[104:107], a[164:167], v[16:19]
  v_mfma_f32_16x16x32_bf16 v[20:23], v[108:111], a[164:167], v[20:23]
  v_mfma_f32_16x16x32_bf16 v[24:27], v[64:67], a[168:171], 0
  v_mfma_f32_16x16x32_bf16 v[28:31], v[68:71], a[168:171], 0
  v_mfma_f32_16x16x32_bf16 v[24:27], v[72:75], a[172:175], v[24:27]
  v_mfma_f32_16x16x32_bf16 v[28:31], v[76:79], a[172:175], v[28:31]
  v_mfma_f32_16x16x32_bf16 v[24:27], v[80:83], a[176:179], v[24:27]
  v_mfma_f32_16x16x32_bf16 v[28:31], v[84:87], a[176:179], v[28:31]
  v_mfma_f32_16x16x32_bf16 v[24:27], v[88:91], a[180:183], v[24:27]
  v_mfma_f32_16x16x32_bf16 v[28:31], v[92:95], a[180:183], v[28:31]
  v_cvt_pk_bf16_f32 v40, v16, v17
  v_cvt_pk_bf16_f32 v41, v18, v19
  v_cvt_pk_bf16_f32 v42, v20, v21
  v_cvt_pk_bf16_f32 v43, v22, v23
  buffer_store_dwordx4 v[40:43], v11, s[8:11], s35 offen offset:2048 sc1
  v_mfma_f32_16x16x32_bf16 v[24:27], v[96:99], a[184:187], v[24:27]
  v_mfma_f32_16x16x32_bf16 v[28:31], v[100:103], a[184:187], v[28:31]
  v_mfma_f32_16x16x32_bf16 v[24:27], v[104:107], a[188:191], v[24:27]
  v_mfma_f32_16x16x32_bf16 v[28:31], v[108:111], a[188:191], v[28:31]
  v_mfma_f32_16x16x32_bf16 v[32:35], v[64:67], a[192:195], 0
  v_mfma_f32_16x16x32_bf16 v[36:39], v[68:71], a[192:195], 0
  v_mfma_f32_16x16x32_bf16 v[32:35], v[72:75], a[196:199], v[32:35]
  v_mfma_f32_16x16x32_bf16 v[36:39], v[76:79], a[196:199], v[36:39]
  v_mfma_f32_16x16x32_bf16 v[32:35], v[80:83], a[200:203], v[32:35]
  v_mfma_f32_16x16x32_bf16 v[36:39], v[84:87], a[200:203], v[36:39]
  v_mfma_f32_16x16x32_bf16 v[32:35], v[88:91], a[204:207], v[32:35]
  v_mfma_f32_16x16x32_bf16 v[36:39], v[92:95], a[204:207], v[36:39]
  v_cvt_pk_bf16_f32 v44, v24, v25
  v_cvt_pk_bf16_f32 v45, v26, v27
  v_cvt_pk_bf16_f32 v46, v28, v29
  v_cvt_pk_bf16_f32 v47, v30, v31
  buffer_store_dwordx4 v[44:47], v11, s[8:11], s35 offen offset:3072 sc1
  v_mfma_f32_16x16x32_bf16 v[32:35], v[96:99], a[208:211], v[32:35]
  v_mfma_f32_16x16x32_bf16 v[36:39], v[100:103], a[208:211], v[36:39]
  v_mfma_f32_16x16x32_bf16 v[32:35], v[104:107], a[212:215], v[32:35]
  v_mfma_f32_16x16x32_bf16 v[36:39], v[108:111], a[212:215], v[36:39]
  v_mfma_f32_16x16x32_bf16 v[16:19], v[64:67], a[216:219], 0
  v_mfma_f32_16x16x32_bf16 v[20:23], v[68:71], a[216:219], 0
  v_mfma_f32_16x16x32_bf16 v[16:19], v[72:75], a[220:223], v[16:19]
  v_mfma_f32_16x16x32_bf16 v[20:23], v[76:79], a[220:223], v[20:23]
  v_mfma_f32_16x16x32_bf16 v[16:19], v[80:83], a[224:227], v[16:19]
  v_mfma_f32_16x16x32_bf16 v[20:23], v[84:87], a[224:227], v[20:23]
  v_mfma_f32_16x16x32_bf16 v[16:19], v[88:91], a[228:231], v[16:19]
  v_mfma_f32_16x16x32_bf16 v[20:23], v[92:95], a[228:231], v[20:23]
  v_cvt_pk_bf16_f32 v40, v32, v33
  v_cvt_pk_bf16_f32 v41, v34, v35
  v_cvt_pk_bf16_f32 v42, v36, v37
  v_cvt_pk_bf16_f32 v43, v38, v39
  buffer_store_dwordx4 v[40:43], v12, s[8:11], s35 offen offset:0 sc1
  v_mfma_f32_16x16x32_bf16 v[16:19], v[96:99], a[232:235], v[16:19]
  v_mfma_f32_16x16x32_bf16 v[20:23], v[100:103], a[232:235], v[20:23]
  v_mfma_f32_16x16x32_bf16 v[16:19], v[104:107], a[236:239], v[16:19]
  v_mfma_f32_16x16x32_bf16 v[20:23], v[108:111], a[236:239], v[20:23]
  s_add_u32 s37, s37, 393216
  s_xor_b32 s72, s72, 12288
  s_nop 3
  s_branch WO_60
WO_58:
  s_waitcnt lgkmcnt(10)
  v_mfma_f32_16x16x32_bf16 v[16:19], v[64:67], a[0:3], 0
  v_mfma_f32_16x16x32_bf16 v[20:23], v[68:71], a[0:3], 0
  s_waitcnt lgkmcnt(8)
  v_mfma_f32_16x16x32_bf16 v[16:19], v[72:75], a[4:7], v[16:19]
  v_mfma_f32_16x16x32_bf16 v[20:23], v[76:79], a[4:7], v[20:23]
  s_waitcnt lgkmcnt(6)
  v_mfma_f32_16x16x32_bf16 v[16:19], v[80:83], a[8:11], v[16:19]
  v_mfma_f32_16x16x32_bf16 v[20:23], v[84:87], a[8:11], v[20:23]
  s_waitcnt lgkmcnt(4)
  v_mfma_f32_16x16x32_bf16 v[16:19], v[88:91], a[12:15], v[16:19]
  v_mfma_f32_16x16x32_bf16 v[20:23], v[92:95], a[12:15], v[20:23]
  s_waitcnt lgkmcnt(2)
  v_mfma_f32_16x16x32_bf16 v[16:19], v[96:99], a[16:19], v[16:19]
  v_mfma_f32_16x16x32_bf16 v[20:23], v[100:103], a[16:19], v[20:23]
  s_waitcnt lgkmcnt(0)
  v_mfma_f32_16x16x32_bf16 v[16:19], v[104:107], a[20:23], v[16:19]
  v_mfma_f32_16x16x32_bf16 v[20:23], v[108:111], a[20:23], v[20:23]
  v_mfma_f32_16x16x32_bf16 v[24:27], v[64:67], a[24:27], 0
  v_mfma_f32_16x16x32_bf16 v[28:31], v[68:71], a[24:27], 0
  v_mfma_f32_16x16x32_bf16 v[24:27], v[72:75], a[28:31], v[24:27]
  v_mfma_f32_16x16x32_bf16 v[28:31], v[76:79], a[28:31], v[28:31]
  v_mfma_f32_16x16x32_bf16 v[24:27], v[80:83], a[32:35], v[24:27]
  v_mfma_f32_16x16x32_bf16 v[28:31], v[84:87], a[32:35], v[28:31]
  v_mfma_f32_16x16x32_bf16 v[24:27], v[88:91], a[36:39], v[24:27]
  v_mfma_f32_16x16x32_bf16 v[28:31], v[92:95], a[36:39], v[28:31]
  v_cvt_pk_bf16_f32 v40, v16, v17
  v_cvt_pk_bf16_f32 v41, v18, v19
  v_cvt_pk_bf16_f32 v42, v20, v21
  v_cvt_pk_bf16_f32 v43, v22, v23
  buffer_store_dwordx4 v[40:43], v2, s[8:11], s35 offen offset:0 sc1
  v_mfma_f32_16x16x32_bf16 v[24:27], v[96:99], a[40:43], v[24:27]
  v_mfma_f32_16x16x32_bf16 v[28:31], v[100:103], a[40:43], v[28:31]
  v_mfma_f32_16x16x32_bf16 v[24:27], v[104:107], a[44:47], v[24:27]
  v_mfma_f32_16x16x32_bf16 v[28:31], v[108:111], a[44:47], v[28:31]
  v_mfma_f32_16x16x32_bf16 v[32:35], v[64:67], a[48:51], 0
  v_mfma_f32_16x16x32_bf16 v[36:39], v[68:71], a[48:51], 0
  v_mfma_f32_16x16x32_bf16 v[32:35], v[72:75], a[52:55], v[32:35]
  v_mfma_f32_16x16x32_bf16 v[36:39], v[76:79], a[52:55], v[36:39]
  v_mfma_f32_16x16x32_bf16 v[32:35], v[80:83], a[56:59], v[32:35]
  v_mfma_f32_16x16x32_bf16 v[36:39], v[84:87], a[56:59], v[36:39]
  v_mfma_f32_16x16x32_bf16 v[32:35], v[88:91], a[60:63], v[32:35]
  v_mfma_f32_16x16x32_bf16 v[36:39], v[92:95], a[60:63], v[36:39]
  v_cvt_pk_bf16_f32 v44, v24, v25
  v_cvt_pk_bf16_f32 v45, v26, v27
  v_cvt_pk_bf16_f32 v46, v28, v29
  v_cvt_pk_bf16_f32 v47, v30, v31
  buffer_store_dwordx4 v[44:47], v2, s[8:11], s35 offen offset:1024 sc1
  v_mfma_f32_16x16x32_bf16 v[32:35], v[96:99], a[64:67], v[32:35]
  v_mfma_f32_16x16x32_bf16 v[36:39], v[100:103], a[64:67], v[36:39]
  v_mfma_f32_16x16x32_bf16 v[32:35], v[104:107], a[68:71], v[32:35]
  v_mfma_f32_16x16x32_bf16 v[36:39], v[108:111], a[68:71], v[36:39]
  v_mfma_f32_16x16x32_bf16 v[16:19], v[64:67], a[72:75], 0
  v_mfma_f32_16x16x32_bf16 v[20:23], v[68:71], a[72:75], 0
  v_mfma_f32_16x16x32_bf16 v[16:19], v[72:75], a[76:79], v[16:19]
  v_mfma_f32_16x16x32_bf16 v[20:23], v[76:79], a[76:79], v[20:23]
  v_mfma_f32_16x16x32_bf16 v[16:19], v[80:83], a[80:83], v[16:19]
  v_mfma_f32_16x16x32_bf16 v[20:23], v[84:87], a[80:83], v[20:23]
  v_mfma_f32_16x16x32_bf16 v[16:19], v[88:91], a[84:87], v[16:19]
  v_mfma_f32_16x16x32_bf16 v[20:23], v[92:95], a[84:87], v[20:23]
  v_cvt_pk_bf16_f32 v40, v32, v33
  v_cvt_pk_bf16_f32 v41, v34, v35
  v_cvt_pk_bf16_f32 v42, v36, v37
  v_cvt_pk_bf16_f32 v43, v38, v39
  buffer_store_dwordx4 v[40:43], v2, s[8:11], s35 offen offset:2048 sc1
  v_mfma_f32_16x16x32_bf16 v[16:19], v[96:99], a[88:91], v[16:19]
  v_mfma_f32_16x16x32_bf16 v[20:23], v[100:103], a[88:91], v[20:23]
  v_mfma_f32_16x16x32_bf16 v[16:19], v[104:107], a[92:95], v[16:19]
  v_mfma_f32_16x16x32_bf16 v[20:23], v[108:111], a[92:95], v[20:23]
  v_mfma_f32_16x16x32_bf16 v[24:27], v[64:67], a[96:99], 0
  v_mfma_f32_16x16x32_bf16 v[28:31], v[68:71], a[96:99], 0
  v_mfma_f32_16x16x32_bf16 v[24:27], v[72:75], a[100:103], v[24:27]
  v_mfma_f32_16x16x32_bf16 v[28:31], v[76:79], a[100:103], v[28:31]
  v_mfma_f32_16x16x32_bf16 v[24:27], v[80:83], a[104:107], v[24:27]
  v_mfma_f32_16x16x32_bf16 v[28:31], v[84:87], a[104:107], v[28:31]
  v_mfma_f32_16x16x32_bf16 v[24:27], v[88:91], a[108:111], v[24:27]
  v_mfma_f32_16x16x32_bf16 v[28:31], v[92:95], a[108:111], v[28:31]
  v_cvt_pk_bf16_f32 v44, v16, v17
  v_cvt_pk_bf16_f32 v45, v18, v19
  v_cvt_pk_bf16_f32 v46, v20, v21
  v_cvt_pk_bf16_f32 v47, v22, v23
  buffer_store_dwordx4 v[44:47], v2, s[8:11], s35 offen offset:3072 sc1
  v_mfma_f32_16x16x32_bf16 v[24:27], v[96:99], a[112:115], v[24:27]
  v_mfma_f32_16x16x32_bf16 v[28:31], v[100:103], a[112:115], v[28:31]
  v_mfma_f32_16x16x32_bf16 v[24:27], v[104:107], a[116:119], v[24:27]
  v_mfma_f32_16x16x32_bf16 v[28:31], v[108:111], a[116:119], v[28:31]
  v_mfma_f32_16x16x32_bf16 v[32:35], v[64:67], a[120:123], 0
  v_mfma_f32_16x16x32_bf16 v[36:39], v[68:71], a[120:123], 0
  s_waitcnt vmcnt(5)
  v_mov_b32 v15, s36
  s_mov_b64 exec, 1
  buffer_store_dword v15, off, s[8:11], s34 sc1
  s_mov_b64 exec, -1
  v_mfma_f32_16x16x32_bf16 v[32:35], v[72:75], a[124:127], v[32:35]
  v_mfma_f32_16x16x32_bf16 v[36:39], v[76:79], a[124:127], v[36:39]
  v_mfma_f32_16x16x32_bf16 v[32:35], v[80:83], a[128:131], v[32:35]
  v_mfma_f32_16x16x32_bf16 v[36:39], v[84:87], a[128:131], v[36:39]
  v_mfma_f32_16x16x32_bf16 v[32:35], v[88:91], a[132:135], v[32:35]
  v_mfma_f32_16x16x32_bf16 v[36:39], v[92:95], a[132:135], v[36:39]
  v_cvt_pk_bf16_f32 v40, v24, v25
  v_cvt_pk_bf16_f32 v41, v26, v27
  v_cvt_pk_bf16_f32 v42, v28, v29
  v_cvt_pk_bf16_f32 v43, v30, v31
  buffer_store_dwordx4 v[40:43], v11, s[8:11], s35 offen offset:0 sc1
  v_mfma_f32_16x16x32_bf16 v[32:35], v[96:99], a[136:139], v[32:35]
  v_mfma_f32_16x16x32_bf16 v[36:39], v[100:103], a[136:139], v[36:39]
  v_mfma_f32_16x16x32_bf16 v[32:35], v[104:107], a[140:143], v[32:35]
  v_mfma_f32_16x16x32_bf16 v[36:39], v[108:111], a[140:143], v[36:39]
  v_mfma_f32_16x16x32_bf16 v[16:19], v[64:67], a[144:147], 0
  v_mfma_f32_16x16x32_bf16 v[20:23], v[68:71], a[144:147], 0
  v_mfma_f32_16x16x32_bf16 v[16:19], v[72:75], a[148:151], v[16:19]
  v_mfma_f32_16x16x32_bf16 v[20:23], v[76:79], a[148:151], v[20:23]
  v_mfma_f32_16x16x32_bf16 v[16:19], v[80:83], a[152:155], v[16:19]
  v_mfma_f32_16x16x32_bf16 v[20:23], v[84:87], a[152:155], v[20:23]
  v_mfma_f32_16x16x32_bf16 v[16:19], v[88:91], a[156:159], v[16:19]
  v_mfma_f32_16x16x32_bf16 v[20:23], v[92:95], a[156:159], v[20:23]
  v_cvt_pk_bf16_f32 v44, v32, v33
  v_cvt_pk_bf16_f32 v45, v34, v35
  v_cvt_pk_bf16_f32 v46, v36, v37
  v_cvt_pk_bf16_f32 v47, v38, v39
  buffer_store_dwordx4 v[44:47], v11, s[8:11], s35 offen offset:1024 sc1
  v_mfma_f32_16x16x32_bf16 v[16:19], v[96:99], a[160:163], v[16:19]
  v_mfma_f32_16x16x32_bf16 v[20:23], v[100:103], a[160:163], v[20:23]
  v_mfma_f32_16x16x32_bf16 v[16:19], v[104:107], a[164:167], v[16:19]
  v_mfma_f32_16x16x32_bf16 v[20:23], v[108:111], a[164:167], v[20:23]
  v_mfma_f32_16x16x32_bf16 v[24:27], v[64:67], a[168:171], 0
  v_mfma_f32_16x16x32_bf16 v[28:31], v[68:71], a[168:171], 0
  v_mfma_f32_16x16x32_bf16 v[24:27], v[72:75], a[172:175], v[24:27]
  v_mfma_f32_16x16x32_bf16 v[28:31], v[76:79], a[172:175], v[28:31]
  v_mfma_f32_16x16x32_bf16 v[24:27], v[80:83], a[176:179], v[24:27]
  v_mfma_f32_16x16x32_bf16 v[28:31], v[84:87], a[176:179], v[28:31]
  v_mfma_f32_16x16x32_bf16 v[24:27], v[88:91], a[180:183], v[24:27]
  v_mfma_f32_16x16x32_bf16 v[28:31], v[92:95], a[180:183], v[28:31]
  v_cvt_pk_bf16_f32 v40, v16, v17
  v_cvt_pk_bf16_f32 v41, v18, v19
  v_cvt_pk_bf16_f32 v42, v20, v21
  v_cvt_pk_bf16_f32 v43, v22, v23
  buffer_store_dwordx4 v[40:43], v11, s[8:11], s35 offen offset:2048 sc1
  v_mfma_f32_16x16x32_bf16 v[24:27], v[96:99], a[184:187], v[24:27]
  v_mfma_f32_16x16x32_bf16 v[28:31], v[100:103], a[184:187], v[28:31]
  v_mfma_f32_16x16x32_bf16 v[24:27], v[104:107], a[188:191], v[24:27]
  v_mfma_f32_16x16x32_bf16 v[28:31], v[108:111], a[188:191], v[28:31]
  v_mfma_f32_16x16x32_bf16 v[32:35], v[64:67], a[192:195], 0
  v_mfma_f32_16x16x32_bf16 v[36:39], v[68:71], a[192:195], 0
  v_mfma_f32_16x16x32_bf16 v[32:35], v[72:75], a[196:199], v[32:35]
  v_mfma_f32_16x16x32_bf16 v[36:39], v[76:79], a[196:199], v[36:39]
  v_mfma_f32_16x16x32_bf16 v[32:35], v[80:83], a[200:203], v[32:35]
  v_mfma_f32_16x16x32_bf16 v[36:39], v[84:87], a[200:203], v[36:39]
  v_mfma_f32_16x16x32_bf16 v[32:35], v[88:91], a[204:207], v[32:35]
  v_mfma_f32_16x16x32_bf16 v[36:39], v[92:95], a[204:207], v[36:39]
  v_cvt_pk_bf16_f32 v44, v24, v25
  v_cvt_pk_bf16_f32 v45, v26, v27
  v_cvt_pk_bf16_f32 v46, v28, v29
  v_cvt_pk_bf16_f32 v47, v30, v31
  buffer_store_dwordx4 v[44:47], v11, s[8:11], s35 offen offset:3072 sc1
  v_mfma_f32_16x16x32_bf16 v[32:35], v[96:99], a[208:211], v[32:35]
  v_mfma_f32_16x16x32_bf16 v[36:39], v[100:103], a[208:211], v[36:39]
  v_mfma_f32_16x16x32_bf16 v[32:35], v[104:107], a[212:215], v[32:35]
  v_mfma_f32_16x16x32_bf16 v[36:39], v[108:111], a[212:215], v[36:39]
  v_mfma_f32_16x16x32_bf16 v[16:19], v[64:67], a[216:219], 0
  v_mfma_f32_16x16x32_bf16 v[20:23], v[68:71], a[216:219], 0
  v_mfma_f32_16x16x32_bf16 v[16:19], v[72:75], a[220:223], v[16:19]
  v_mfma_f32_16x16x32_bf16 v[20:23], v[76:79], a[220:223], v[20:23]
  v_mfma_f32_16x16x32_bf16 v[16:19], v[80:83], a[224:227], v[16:19]
  v_mfma_f32_16x16x32_bf16 v[20:23], v[84:87], a[224:227], v[20:23]
  v_mfma_f32_16x16x32_bf16 v[16:19], v[88:91], a[228:231], v[16:19]
  v_mfma_f32_16x16x32_bf16 v[20:23], v[92:95], a[228:231], v[20:23]
  v_cvt_pk_bf16_f32 v40, v32, v33
  v_cvt_pk_bf16_f32 v41, v34, v35
  v_cvt_pk_bf16_f32 v42, v36, v37
  v_cvt_pk_bf16_f32 v43, v38, v39
  buffer_store_dwordx4 v[40:43], v12, s[8:11], s35 offen offset:0 sc1
  v_mfma_f32_16x16x32_bf16 v[16:19], v[96:99], a[232:235], v[16:19]
  v_mfma_f32_16x16x32_bf16 v[20:23], v[100:103], a[232:235], v[20:23]
  v_mfma_f32_16x16x32_bf16 v[16:19], v[104:107], a[236:239], v[16:19]
  v_mfma_f32_16x16x32_bf16 v[20:23], v[108:111], a[236:239], v[20:23]
WO_60:
  s_nop 6
  v_cvt_pk_bf16_f32 v44, v16, v17
  v_cvt_pk_bf16_f32 v45, v18, v19
  v_cvt_pk_bf16_f32 v46, v20, v21
  v_cvt_pk_bf16_f32 v47, v22, v23
  buffer_store_dwordx4 v[44:47], v12, s[8:11], s35 offen offset:1024 sc1
  s_add_u32 s35, s35, 1310720
  s_add_u32 s36, s36, 1
  s_cmp_ge_u32 s36, 64
  s_cbranch_scc1 WO_end
  s_cmp_lg_u32 s38, 0
  s_cbranch_scc1 WO_loop
wp_61:
  buffer_load_dword v9, v10, s[8:11], 0 offen sc1
  s_add_u32 s26, s26, 1
  s_mov_b32 s39, 17
  s_cmp_gt_u32 s26, 2097152
  s_cbranch_scc1 L_abort
  s_waitcnt vmcnt(0)
  v_cmp_ge_u32 vcc, s36, v9
  s_cbranch_vccnz wp_61
  s_add_u32 m0, s72, s33
  buffer_load_dword v9, v10, s[8:11], 0 offen sc1
  buffer_load_dwordx4 v2, s[8:11], s37 offen offset:0 sc1 lds
  buffer_load_dwordx4 v2, s[8:11], s37 offen offset:1024 sc1 lds
  buffer_load_dwordx4 v2, s[8:11], s37 offen offset:2048 sc1 lds
  s_add_u32 s37, s37, 393216
  s_xor_b32 s72, s72, 12288
  s_branch WO_loop
WO_end:
  s_waitcnt vmcnt(0)
  v_mov_b32 v15, s36
  s_mov_b64 exec, 1
  buffer_store_dword v15, off, s[8:11], s34 sc1
  s_mov_b64 exec, -1
  s_branch L_exit2
WD:
  s_cmp_lg_u32 s24, 0
  s_cbranch_scc1 wwd_64
ww_63:
  buffer_load_dword v8, off, s[68:71], 0 offset:64 sc1
  s_add_u32 s26, s26, 1
  s_mov_b32 s39, 115
  s_cmp_gt_u32 s26, 2097152
  s_cbranch_scc1 L_abort
  s_waitcnt vmcnt(0)
  v_cmp_gt_u32 vcc, 64, v8
  s_cbranch_vccz wwd_64
  s_sleep 8
  s_branch ww_63
wwd_64:
  s_barrier
  v_mov_b32 v10, 12288
  s_mov_b32 s36, 1
wp_65:
  buffer_load_dword v8, v10, s[8:11], 0 offen sc1
  s_add_u32 s26, s26, 1
  s_mov_b32 s39, 116
  s_cmp_gt_u32 s26, 2097152
  s_cbranch_scc1 L_abort
  s_waitcnt vmcnt(0)
  v_cmp_ge_u32 vcc, s36, v8
  s_cbranch_vccz wpd_66
  s_sleep 64
  s_branch wp_65
wpd_66:
  s_barrier
  s_mov_b32 s12, s60
  s_and_b32 s13, s61, 0xffff
  s_mov_b32 s14, 1966080
  s_mov_b32 s15, 0x20000
  s_mov_b32 s16, s40
  s_and_b32 s17, s41, 0xffff
  s_mov_b32 s18, 2621440
  s_mov_b32 s19, 0x20000
  s_mul_i32 s33, s25, 52
  s_lshr_b32 s33, s33, 8
  s_mul_i32 s27, s33, 5
  s_sub_u32 s75, s25, s27
  s_mov_b32 s30, 1280
  v_add_u32 v68, 0, v1
  v_lshrrev_b32 v69, 2, v68
  v_and_b32 v70, 3, v68
  v_mul_lo_u32 v69, v69, s30
  v_lshl_add_u32 v4, v70, 4, v69
  v_add_u32 v68, 64, v1
  v_lshrrev_b32 v69, 2, v68
  v_and_b32 v70, 3, v68
  v_mul_lo_u32 v69, v69, s30
  v_lshl_add_u32 v5, v70, 4, v69
  v_add_u32 v68, 128, v1
  v_lshrrev_b32 v69, 2, v68
  v_and_b32 v70, 3, v68
  v_mul_lo_u32 v69, v69, s30
  v_lshl_add_u32 v6, v70, 4, v69
  v_add_u32 v68, 192, v1
  v_lshrrev_b32 v69, 2, v68
  v_and_b32 v70, 3, v68
  v_mul_lo_u32 v69, v69, s30
  v_lshl_add_u32 v7, v70, 4, v69
  v_add_u32 v68, 256, v1
  v_lshrrev_b32 v69, 2, v68
  v_and_b32 v70, 3, v68
  v_mul_lo_u32 v69, v69, s30
  v_lshl_add_u32 v8, v70, 4, v69
  v_add_u32 v68, 320, v1
  v_lshrrev_b32 v69, 2, v68
  v_and_b32 v70, 3, v68
  v_mul_lo_u32 v69, v69, s30
  v_lshl_add_u32 v9, v70, 4, v69
  v_bfe_u32 v68, v1, 5, 1
  v_mul_u32_u24 v3, 512, v68
  v_bfe_u32 v68, v1, 4, 1
  v_mul_u32_u24 v68, 256, v68
  v_add_u32 v3, v3, v68
  v_bfe_u32 v68, v1, 2, 1
  v_mul_u32_u24 v68, 64, v68
  v_add_u32 v3, v3, v68
  v_bfe_u32 v68, v1, 3, 1
  v_mul_u32_u24 v68, 128, v68
  v_add_u32 v3, v3, v68
  v_and_b32 v68, 3, v1
  v_lshl_add_u32 v3, v68, 3, v3
  s_mul_i32 s27, s24, 30720
  v_add_u32 v3, s27, v3
  s_lshl_b32 s32, s75, 8
  s_lshl_b32 s27, s24, 6
  s_add_u32 s32, s32, s27
  s_mul_i32 s31, s24, 30720
  s_add_u32 m0, s31, 0
  s_add_u32 s27, s32, 0
  buffer_load_dwordx4 v4, s[12:15], s27 offen  lds
  s_add_u32 m0, s31, 1024
  s_add_u32 s27, s32, 0
  buffer_load_dwordx4 v5, s[12:15], s27 offen  lds
  s_add_u32 m0, s31, 2048
  s_add_u32 s27, s32, 0
  buffer_load_dwordx4 v6, s[12:15], s27 offen  lds
  s_add_u32 m0, s31, 3072
  s_add_u32 s27, s32, 0
  buffer_load_dwordx4 v7, s[12:15], s27 offen  lds
  s_add_u32 m0, s31, 4096
  s_add_u32 s27, s32, 0
  buffer_load_dwordx4 v8, s[12:15], s27 offen  lds
  s_add_u32 m0, s31, 5120
  s_add_u32 s27, s32, 0
  buffer_load_dwordx4 v9, s[12:15], s27 offen  lds
  s_add_u32 m0, s31, 6144
  s_add_u32 s27, s32, 122880
  buffer_load_dwordx4 v4, s[12:15], s27 offen  lds
  s_add_u32 m0, s31, 7168
  s_add_u32 s27, s32, 122880
  buffer_load_dwordx4 v5, s[12:15], s27 offen  lds
  s_add_u32 m0, s31, 8192
  s_add_u32 s27, s32, 122880
  buffer_load_dwordx4 v6, s[12:15], s27 offen  lds
  s_add_u32 m0, s31, 9216
  s_add_u32 s27, s32, 122880
  buffer_load_dwordx4 v7, s[12:15], s27 offen  lds
  s_add_u32 m0, s31, 10240
  s_add_u32 s27, s32, 122880
  buffer_load_dwordx4 v8, s[12:15], s27 offen  lds
  s_add_u32 m0, s31, 11264
  s_add_u32 s27, s32, 122880
  buffer_load_dwordx4 v9, s[12:15], s27 offen  lds
  s_add_u32 m0, s31, 12288
  s_add_u32 s27, s32, 245760
  buffer_load_dwordx4 v4, s[12:15], s27 offen  lds
  s_add_u32 m0, s31, 13312
  s_add_u32 s27, s32, 245760
  buffer_load_dwordx4 v5, s[12:15], s27 offen  lds
  s_add_u32 m0, s31, 14336
  s_add_u32 s27, s32, 245760
  buffer_load_dwordx4 v6, s[12:15], s27 offen  lds
  s_add_u32 m0, s31, 15360
  s_add_u32 s27, s32, 245760
  buffer_load_dwordx4 v7, s[12:15], s27 offen  lds
  s_add_u32 m0, s31, 16384
  s_add_u32 s27, s32, 245760
  buffer_load_dwordx4 v8, s[12:15], s27 offen  lds
  s_add_u32 m0, s31, 17408
  s_add_u32 s27, s32, 245760
  buffer_load_dwordx4 v9, s[12:15], s27 offen  lds
  s_add_u32 m0, s31, 18432
  s_add_u32 s27, s32, 368640
  buffer_load_dwordx4 v4, s[12:15], s27 offen  lds
  s_add_u32 m0, s31, 19456
  s_add_u32 s27, s32, 368640
  buffer_load_dwordx4 v5, s[12:15], s27 offen  lds
  s_add_u32 m0, s31, 20480
  s_add_u32 s27, s32, 368640
  buffer_load_dwordx4 v6, s[12:15], s27 offen  lds
  s_add_u32 m0, s31, 21504
  s_add_u32 s27, s32, 368640
  buffer_load_dwordx4 v7, s[12:15], s27 offen  lds
  s_add_u32 m0, s31, 22528
  s_add_u32 s27, s32, 368640
  buffer_load_dwordx4 v8, s[12:15], s27 offen  lds
  s_add_u32 m0, s31, 23552
  s_add_u32 s27, s32, 368640
  buffer_load_dwordx4 v9, s[12:15], s27 offen  lds
  s_add_u32 m0, s31, 24576
  s_add_u32 s27, s32, 491520
  buffer_load_dwordx4 v4, s[12:15], s27 offen  lds
  s_add_u32 m0, s31, 25600
  s_add_u32 s27, s32, 491520
  buffer_load_dwordx4 v5, s[12:15], s27 offen  lds
  s_add_u32 m0, s31, 26624
  s_add_u32 s27, s32, 491520
  buffer_load_dwordx4 v6, s[12:15], s27 offen  lds
  s_add_u32 m0, s31, 27648
  s_add_u32 s27, s32, 491520
  buffer_load_dwordx4 v7, s[12:15], s27 offen  lds
  s_add_u32 m0, s31, 28672
  s_add_u32 s27, s32, 491520
  buffer_load_dwordx4 v8, s[12:15], s27 offen  lds
  s_add_u32 m0, s31, 29696
  s_add_u32 s27, s32, 491520
  buffer_load_dwordx4 v9, s[12:15], s27 offen  lds
  s_waitcnt vmcnt(24)
  ds_read_b64_tr_b16 a[0:1], v3 offset:0
  ds_read_b64_tr_b16 a[2:3], v3 offset:1024
  ds_read_b64_tr_b16 a[4:5], v3 offset:2048
  ds_read_b64_tr_b16 a[6:7], v3 offset:3072
  ds_read_b64_tr_b16 a[8:9], v3 offset:4096
  ds_read_b64_tr_b16 a[10:11], v3 offset:5120
  ds_read_b64_tr_b16 a[192:193], v3 offset:32
  ds_read_b64_tr_b16 a[194:195], v3 offset:1056
  ds_read_b64_tr_b16 a[196:197], v3 offset:2080
  ds_read_b64_tr_b16 a[198:199], v3 offset:3104
  ds_read_b64_tr_b16 a[200:201], v3 offset:4128
  ds_read_b64_tr_b16 a[202:203], v3 offset:5152
  s_waitcnt lgkmcnt(0)
  s_add_u32 m0, s31, 0
  s_add_u32 s27, s32, 614400
  buffer_load_dwordx4 v4, s[12:15], s27 offen  lds
  s_add_u32 m0, s31, 1024
  s_add_u32 s27, s32, 614400
  buffer_load_dwordx4 v5, s[12:15], s27 offen  lds
  s_add_u32 m0, s31, 2048
  s_add_u32 s27, s32, 614400
  buffer_load_dwordx4 v6, s[12:15], s27 offen  lds
  s_add_u32 m0, s31, 3072
  s_add_u32 s27, s32, 614400
  buffer_load_dwordx4 v7, s[12:15], s27 offen  lds
  s_add_u32 m0, s31, 4096
  s_add_u32 s27, s32, 614400
  buffer_load_dwordx4 v8, s[12:15], s27 offen  lds
  s_add_u32 m0, s31, 5120
  s_add_u32 s27, s32, 614400
  buffer_load_dwordx4 v9, s[12:15], s27 offen  lds
  s_waitcnt vmcnt(24)
  ds_read_b64_tr_b16 a[12:13], v3 offset:6144
  ds_read_b64_tr_b16 a[14:15], v3 offset:7168
  ds_read_b64_tr_b16 a[16:17], v3 offset:8192
  ds_read_b64_tr_b16 a[18:19], v3 offset:9216
  ds_read_b64_tr_b16 a[20:21], v3 offset:10240
  ds_read_b64_tr_b16 a[22:23], v3 offset:11264
  ds_read_b64_tr_b16 a[204:205], v3 offset:6176
  ds_read_b64_tr_b16 a[206:207], v3 offset:7200
  ds_read_b64_tr_b16 a[208:209], v3 offset:8224
  ds_read_b64_tr_b16 a[210:211], v3 offset:9248
  ds_read_b64_tr_b16 a[212:213], v3 offset:10272
  ds_read_b64_tr_b16 a[214:215], v3 offset:11296
  s_waitcnt lgkmcnt(0)
  s_add_u32 m0, s31, 6144
  s_add_u32 s27, s32, 737280
  buffer_load_dwordx4 v4, s[12:15], s27 offen  lds
  s_add_u32 m0, s31, 7168
  s_add_u32 s27, s32, 737280
  buffer_load_dwordx4 v5, s[12:15], s27 offen  lds
  s_add_u32 m0, s31, 8192
  s_add_u32 s27, s32, 737280
  buffer_load_dwordx4 v6, s[12:15], s27 offen  lds
  s_add_u32 m0, s31, 9216
  s_add_u32 s27, s32, 737280
  buffer_load_dwordx4 v7, s[12:15], s27 offen  lds
  s_add_u32 m0, s31, 10240
  s_add_u32 s27, s32, 737280
  buffer_load_dwordx4 v8, s[12:15], s27 offen  lds
  s_add_u32 m0, s31, 11264
  s_add_u32 s27, s32, 737280
  buffer_load_dwordx4 v9, s[12:15], s27 offen  lds
  s_waitcnt vmcnt(24)
  ds_read_b64_tr_b16 a[24:25], v3 offset:12288
  ds_read_b64_tr_b16 a[26:27], v3 offset:13312
  ds_read_b64_tr_b16 a[28:29], v3 offset:14336
  ds_read_b64_tr_b16 a[30:31], v3 offset:15360
  ds_read_b64_tr_b16 a[32:33], v3 offset:16384
  ds_read_b64_tr_b16 a[34:35], v3 offset:17408
  ds_read_b64_tr_b16 a[216:217], v3 offset:12320
  ds_read_b64_tr_b16 a[218:219], v3 offset:13344
  ds_read_b64_tr_b16 a[220:221], v3 offset:14368
  ds_read_b64_tr_b16 a[222:223], v3 offset:15392
  ds_read_b64_tr_b16 a[224:225], v3 offset:16416
  ds_read_b64_tr_b16 a[226:227], v3 offset:17440
  s_waitcnt lgkmcnt(0)
  s_add_u32 m0, s31, 12288
  s_add_u32 s27, s32, 860160
  buffer_load_dwordx4 v4, s[12:15], s27 offen  lds
  s_add_u32 m0, s31, 13312
  s_add_u32 s27, s32, 860160
  buffer_load_dwordx4 v5, s[12:15], s27 offen  lds
  s_add_u32 m0, s31, 14336
  s_add_u32 s27, s32, 860160
  buffer_load_dwordx4 v6, s[12:15], s27 offen  lds
  s_add_u32 m0, s31, 15360
  s_add_u32 s27, s32, 860160
  buffer_load_dwordx4 v7, s[12:15], s27 offen  lds
  s_add_u32 m0, s31, 16384
  s_add_u32 s27, s32, 860160
  buffer_load_dwordx4 v8, s[12:15], s27 offen  lds
  s_add_u32 m0, s31, 17408
  s_add_u32 s27, s32, 860160
  buffer_load_dwordx4 v9, s[12:15], s27 offen  lds
  s_waitcnt vmcnt(24)
  ds_read_b64_tr_b16 a[36:37], v3 offset:18432
  ds_read_b64_tr_b16 a[38:39], v3 offset:19456
  ds_read_b64_tr_b16 a[40:41], v3 offset:20480
  ds_read_b64_tr_b16 a[42:43], v3 offset:21504
  ds_read_b64_tr_b16 a[44:45], v3 offset:22528
  ds_read_b64_tr_b16 a[46:47], v3 offset:23552
  ds_read_b64_tr_b16 a[228:229], v3 offset:18464
  ds_read_b64_tr_b16 a[230:231], v3 offset:19488
  ds_read_b64_tr_b16 a[232:233], v3 offset:20512
  ds_read_b64_tr_b16 a[234:235], v3 offset:21536
  ds_read_b64_tr_b16 a[236:237], v3 offset:22560
  ds_read_b64_tr_b16 a[238:239], v3 offset:23584
  s_waitcnt lgkmcnt(0)
  s_add_u32 m0, s31, 18432
  s_add_u32 s27, s32, 983040
  buffer_load_dwordx4 v4, s[12:15], s27 offen  lds
  s_add_u32 m0, s31, 19456
  s_add_u32 s27, s32, 983040
  buffer_load_dwordx4 v5, s[12:15], s27 offen  lds
  s_add_u32 m0, s31, 20480
  s_add_u32 s27, s32, 983040
  buffer_load_dwordx4 v6, s[12:15], s27 offen  lds
  s_add_u32 m0, s31, 21504
  s_add_u32 s27, s32, 983040
  buffer_load_dwordx4 v7, s[12:15], s27 offen  lds
  s_add_u32 m0, s31, 22528
  s_add_u32 s27, s32, 983040
  buffer_load_dwordx4 v8, s[12:15], s27 offen  lds
  s_add_u32 m0, s31, 23552
  s_add_u32 s27, s32, 983040
  buffer_load_dwordx4 v9, s[12:15], s27 offen  lds
  s_waitcnt vmcnt(24)
  ds_read_b64_tr_b16 a[48:49], v3 offset:24576
  ds_read_b64_tr_b16 a[50:51], v3 offset:25600
  ds_read_b64_tr_b16 a[52:53], v3 offset:26624
  ds_read_b64_tr_b16 a[54:55], v3 offset:27648
  ds_read_b64_tr_b16 a[56:57], v3 offset:28672
  ds_read_b64_tr_b16 a[58:59], v3 offset:29696
  ds_read_b64_tr_b16 a[240:241], v3 offset:24608
  ds_read_b64_tr_b16 a[242:243], v3 offset:25632
  ds_read_b64_tr_b16 a[244:245], v3 offset:26656
  ds_read_b64_tr_b16 a[246:247], v3 offset:27680
  ds_read_b64_tr_b16 a[248:249], v3 offset:28704
  ds_read_b64_tr_b16 a[250:251], v3 offset:29728
  s_waitcnt lgkmcnt(0)
  s_add_u32 m0, s31, 24576
  s_add_u32 s27, s32, 1105920
  buffer_load_dwordx4 v4, s[12:15], s27 offen  lds
  s_add_u32 m0, s31, 25600
  s_add_u32 s27, s32, 1105920
  buffer_load_dwordx4 v5, s[12:15], s27 offen  lds
  s_add_u32 m0, s31, 26624
  s_add_u32 s27, s32, 1105920
  buffer_load_dwordx4 v6, s[12:15], s27 offen  lds
  s_add_u32 m0, s31, 27648
  s_add_u32 s27, s32, 1105920
  buffer_load_dwordx4 v7, s[12:15], s27 offen  lds
  s_add_u32 m0, s31, 28672
  s_add_u32 s27, s32, 1105920
  buffer_load_dwordx4 v8, s[12:15], s27 offen  lds
  s_add_u32 m0, s31, 29696
  s_add_u32 s27, s32, 1105920
  buffer_load_dwordx4 v9, s[12:15], s27 offen  lds
  s_waitcnt vmcnt(24)
  ds_read_b64_tr_b16 a[60:61], v3 offset:0
  ds_read_b64_tr_b16 a[62:63], v3 offset:1024
  ds_read_b64_tr_b16 a[64:65], v3 offset:2048
  ds_read_b64_tr_b16 a[66:67], v3 offset:3072
  ds_read_b64_tr_b16 a[68:69], v3 offset:4096
  ds_read_b64_tr_b16 a[70:71], v3 offset:5120
  ds_read_b64_tr_b16 a[252:253], v3 offset:32
  ds_read_b64_tr_b16 a[254:255], v3 offset:1056
  ds_read_b64_tr_b16 v[128:129], v3 offset:2080
  ds_read_b64_tr_b16 v[130:131], v3 offset:3104
  ds_read_b64_tr_b16 v[132:133], v3 offset:4128
  ds_read_b64_tr_b16 v[134:135], v3 offset:5152
  s_waitcnt lgkmcnt(0)
  s_add_u32 m0, s31, 0
  s_add_u32 s27, s32, 1228800
  buffer_load_dwordx4 v4, s[12:15], s27 offen  lds
  s_add_u32 m0, s31, 1024
  s_add_u32 s27, s32, 1228800
  buffer_load_dwordx4 v5, s[12:15], s27 offen  lds
  s_add_u32 m0, s31, 2048
  s_add_u32 s27, s32, 1228800
  buffer_load_dwordx4 v6, s[12:15], s27 offen  lds
  s_add_u32 m0, s31, 3072
  s_add_u32 s27, s32, 1228800
  buffer_load_dwordx4 v7, s[12:15], s27 offen  lds
  s_add_u32 m0, s31, 4096
  s_add_u32 s27, s32, 1228800
  buffer_load_dwordx4 v8, s[12:15], s27 offen  lds
  s_add_u32 m0, s31, 5120
  s_add_u32 s27, s32, 1228800
  buffer_load_dwordx4 v9, s[12:15], s27 offen  lds
  s_waitcnt vmcnt(24)
  ds_read_b64_tr_b16 a[72:73], v3 offset:6144
  ds_read_b64_tr_b16 a[74:75], v3 offset:7168
  ds_read_b64_tr_b16 a[76:77], v3 offset:8192
  ds_read_b64_tr_b16 a[78:79], v3 offset:9216
  ds_read_b64_tr_b16 a[80:81], v3 offset:10240
  ds_read_b64_tr_b16 a[82:83], v3 offset:11264
  ds_read_b64_tr_b16 v[136:137], v3 offset:6176
  ds_read_b64_tr_b16 v[138:139], v3 offset:7200
  ds_read_b64_tr_b16 v[140:141], v3 offset:8224
  ds_read_b64_tr_b16 v[142:143], v3 offset:9248
  ds_read_b64_tr_b16 v[144:145], v3 offset:10272
  ds_read_b64_tr_b16 v[146:147], v3 offset:11296
  s_waitcnt lgkmcnt(0)
  s_add_u32 m0, s31, 6144
  s_add_u32 s27, s32, 1351680
  buffer_load_dwordx4 v4, s[12:15], s27 offen  lds
  s_add_u32 m0, s31, 7168
  s_add_u32 s27, s32, 1351680
  buffer_load_dwordx4 v5, s[12:15], s27 offen  lds
  s_add_u32 m0, s31, 8192
  s_add_u32 s27, s32, 1351680
  buffer_load_dwordx4 v6, s[12:15], s27 offen  lds
  s_add_u32 m0, s31, 9216
  s_add_u32 s27, s32, 1351680
  buffer_load_dwordx4 v7, s[12:15], s27 offen  lds
  s_add_u32 m0, s31, 10240
  s_add_u32 s27, s32, 1351680
  buffer_load_dwordx4 v8, s[12:15], s27 offen  lds
  s_add_u32 m0, s31, 11264
  s_add_u32 s27, s32, 1351680
  buffer_load_dwordx4 v9, s[12:15], s27 offen  lds
  s_waitcnt vmcnt(24)
  ds_read_b64_tr_b16 a[84:85], v3 offset:12288
  ds_read_b64_tr_b16 a[86:87], v3 offset:13312
  ds_read_b64_tr_b16 a[88:89], v3 offset:14336
  ds_read_b64_tr_b16 a[90:91], v3 offset:15360
  ds_read_b64_tr_b16 a[92:93], v3 offset:16384
  ds_read_b64_tr_b16 a[94:95], v3 offset:17408
  ds_read_b64_tr_b16 v[148:149], v3 offset:12320
  ds_read_b64_tr_b16 v[150:151], v3 offset:13344
  ds_read_b64_tr_b16 v[152:153], v3 offset:14368
  ds_read_b64_tr_b16 v[154:155], v3 offset:15392
  ds_read_b64_tr_b16 v[156:157], v3 offset:16416
  ds_read_b64_tr_b16 v[158:159], v3 offset:17440
  s_waitcnt lgkmcnt(0)
  s_add_u32 m0, s31, 12288
  s_add_u32 s27, s32, 1474560
  buffer_load_dwordx4 v4, s[12:15], s27 offen  lds
  s_add_u32 m0, s31, 13312
  s_add_u32 s27, s32, 1474560
  buffer_load_dwordx4 v5, s[12:15], s27 offen  lds
  s_add_u32 m0, s31, 14336
  s_add_u32 s27, s32, 1474560
  buffer_load_dwordx4 v6, s[12:15], s27 offen  lds
  s_add_u32 m0, s31, 15360
  s_add_u32 s27, s32, 1474560
  buffer_load_dwordx4 v7, s[12:15], s27 offen  lds
  s_add_u32 m0, s31, 16384
  s_add_u32 s27, s32, 1474560
  buffer_load_dwordx4 v8, s[12:15], s27 offen  lds
  s_add_u32 m0, s31, 17408
  s_add_u32 s27, s32, 1474560
  buffer_load_dwordx4 v9, s[12:15], s27 offen  lds
  s_waitcnt vmcnt(24)
  ds_read_b64_tr_b16 a[96:97], v3 offset:18432
  ds_read_b64_tr_b16 a[98:99], v3 offset:19456
  ds_read_b64_tr_b16 a[100:101], v3 offset:20480
  ds_read_b64_tr_b16 a[102:103], v3 offset:21504
  ds_read_b64_tr_b16 a[104:105], v3 offset:22528
  ds_read_b64_tr_b16 a[106:107], v3 offset:23552
  ds_read_b64_tr_b16 v[160:161], v3 offset:18464
  ds_read_b64_tr_b16 v[162:163], v3 offset:19488
  ds_read_b64_tr_b16 v[164:165], v3 offset:20512
  ds_read_b64_tr_b16 v[166:167], v3 offset:21536
  ds_read_b64_tr_b16 v[168:169], v3 offset:22560
  ds_read_b64_tr_b16 v[170:171], v3 offset:23584
  s_waitcnt lgkmcnt(0)
  s_add_u32 m0, s31, 18432
  s_add_u32 s27, s32, 1597440
  buffer_load_dwordx4 v4, s[12:15], s27 offen  lds
  s_add_u32 m0, s31, 19456
  s_add_u32 s27, s32, 1597440
  buffer_load_dwordx4 v5, s[12:15], s27 offen  lds
  s_add_u32 m0, s31, 20480
  s_add_u32 s27, s32, 1597440
  buffer_load_dwordx4 v6, s[12:15], s27 offen  lds
  s_add_u32 m0, s31, 21504
  s_add_u32 s27, s32, 1597440
  buffer_load_dwordx4 v7, s[12:15], s27 offen  lds
  s_add_u32 m0, s31, 22528
  s_add_u32 s27, s32, 1597440
  buffer_load_dwordx4 v8, s[12:15], s27 offen  lds
  s_add_u32 m0, s31, 23552
  s_add_u32 s27, s32, 1597440
  buffer_load_dwordx4 v9, s[12:15], s27 offen  lds
  s_waitcnt vmcnt(24)
  ds_read_b64_tr_b16 a[108:109], v3 offset:24576
  ds_read_b64_tr_b16 a[110:111], v3 offset:25600
  ds_read_b64_tr_b16 a[112:113], v3 offset:26624
  ds_read_b64_tr_b16 a[114:115], v3 offset:27648
  ds_read_b64_tr_b16 a[116:117], v3 offset:28672
  ds_read_b64_tr_b16 a[118:119], v3 offset:29696
  ds_read_b64_tr_b16 v[172:173], v3 offset:24608
  ds_read_b64_tr_b16 v[174:175], v3 offset:25632
  ds_read_b64_tr_b16 v[176:177], v3 offset:26656
  ds_read_b64_tr_b16 v[178:179], v3 offset:27680
  ds_read_b64_tr_b16 v[180:181], v3 offset:28704
  ds_read_b64_tr_b16 v[182:183], v3 offset:29728
  s_waitcnt lgkmcnt(0)
  s_add_u32 m0, s31, 24576
  s_add_u32 s27, s32, 1720320
  buffer_load_dwordx4 v4, s[12:15], s27 offen  lds
  s_add_u32 m0, s31, 25600
  s_add_u32 s27, s32, 1720320
  buffer_load_dwordx4 v5, s[12:15], s27 offen  lds
  s_add_u32 m0, s31, 26624
  s_add_u32 s27, s32, 1720320
  buffer_load_dwordx4 v6, s[12:15], s27 offen  lds
  s_add_u32 m0, s31, 27648
  s_add_u32 s27, s32, 1720320
  buffer_load_dwordx4 v7, s[12:15], s27 offen  lds
  s_add_u32 m0, s31, 28672
  s_add_u32 s27, s32, 1720320
  buffer_load_dwordx4 v8, s[12:15], s27 offen  lds
  s_add_u32 m0, s31, 29696
  s_add_u32 s27, s32, 1720320
  buffer_load_dwordx4 v9, s[12:15], s27 offen  lds
  s_waitcnt vmcnt(24)
  ds_read_b64_tr_b16 a[120:121], v3 offset:0
  ds_read_b64_tr_b16 a[122:123], v3 offset:1024
  ds_read_b64_tr_b16 a[124:125], v3 offset:2048
  ds_read_b64_tr_b16 a[126:127], v3 offset:3072
  ds_read_b64_tr_b16 a[128:129], v3 offset:4096
  ds_read_b64_tr_b16 a[130:131], v3 offset:5120
  ds_read_b64_tr_b16 v[184:185], v3 offset:32
  ds_read_b64_tr_b16 v[186:187], v3 offset:1056
  ds_read_b64_tr_b16 v[188:189], v3 offset:2080
  ds_read_b64_tr_b16 v[190:191], v3 offset:3104
  ds_read_b64_tr_b16 v[192:193], v3 offset:4128
  ds_read_b64_tr_b16 v[194:195], v3 offset:5152
  s_waitcnt lgkmcnt(0)
  s_add_u32 m0, s31, 0
  s_add_u32 s27, s32, 1843200
  buffer_load_dwordx4 v4, s[12:15], s27 offen  lds
  s_add_u32 m0, s31, 1024
  s_add_u32 s27, s32, 1843200
  buffer_load_dwordx4 v5, s[12:15], s27 offen  lds
  s_add_u32 m0, s31, 2048
  s_add_u32 s27, s32, 1843200
  buffer_load_dwordx4 v6, s[12:15], s27 offen  lds
  s_add_u32 m0, s31, 3072
  s_add_u32 s27, s32, 1843200
  buffer_load_dwordx4 v7, s[12:15], s27 offen  lds
  s_add_u32 m0, s31, 4096
  s_add_u32 s27, s32, 1843200
  buffer_load_dwordx4 v8, s[12:15], s27 offen  lds
  s_add_u32 m0, s31, 5120
  s_add_u32 s27, s32, 1843200
  buffer_load_dwordx4 v9, s[12:15], s27 offen  lds
  s_waitcnt vmcnt(24)
  ds_read_b64_tr_b16 a[132:133], v3 offset:6144
  ds_read_b64_tr_b16 a[134:135], v3 offset:7168
  ds_read_b64_tr_b16 a[136:137], v3 offset:8192
  ds_read_b64_tr_b16 a[138:139], v3 offset:9216
  ds_read_b64_tr_b16 a[140:141], v3 offset:10240
  ds_read_b64_tr_b16 a[142:143], v3 offset:11264
  ds_read_b64_tr_b16 v[196:197], v3 offset:6176
  ds_read_b64_tr_b16 v[198:199], v3 offset:7200
  ds_read_b64_tr_b16 v[200:201], v3 offset:8224
  ds_read_b64_tr_b16 v[202:203], v3 offset:9248
  ds_read_b64_tr_b16 v[204:205], v3 offset:10272
  ds_read_b64_tr_b16 v[206:207], v3 offset:11296
  s_waitcnt lgkmcnt(0)
  s_waitcnt vmcnt(18)
  ds_read_b64_tr_b16 a[144:145], v3 offset:12288
  ds_read_b64_tr_b16 a[146:147], v3 offset:13312
  ds_read_b64_tr_b16 a[148:149], v3 offset:14336
  ds_read_b64_tr_b16 a[150:151], v3 offset:15360
  ds_read_b64_tr_b16 a[152:153], v3 offset:16384
  ds_read_b64_tr_b16 a[154:155], v3 offset:17408
  ds_read_b64_tr_b16 v[208:209], v3 offset:12320
  ds_read_b64_tr_b16 v[210:211], v3 offset:13344
  ds_read_b64_tr_b16 v[212:213], v3 offset:14368
  ds_read_b64_tr_b16 v[214:215], v3 offset:15392
  ds_read_b64_tr_b16 v[216:217], v3 offset:16416
  ds_read_b64_tr_b16 v[218:219], v3 offset:17440
  s_waitcnt lgkmcnt(0)
  s_waitcnt vmcnt(12)
  ds_read_b64_tr_b16 a[156:157], v3 offset:18432
  ds_read_b64_tr_b16 a[158:159], v3 offset:19456
  ds_read_b64_tr_b16 a[160:161], v3 offset:20480
  ds_read_b64_tr_b16 a[162:163], v3 offset:21504
  ds_read_b64_tr_b16 a[164:165], v3 offset:22528
  ds_read_b64_tr_b16 a[166:167], v3 offset:23552
  ds_read_b64_tr_b16 v[220:221], v3 offset:18464
  ds_read_b64_tr_b16 v[222:223], v3 offset:19488
  ds_read_b64_tr_b16 v[224:225], v3 offset:20512
  ds_read_b64_tr_b16 v[226:227], v3 offset:21536
  ds_read_b64_tr_b16 v[228:229], v3 offset:22560
  ds_read_b64_tr_b16 v[230:231], v3 offset:23584
  s_waitcnt lgkmcnt(0)
  s_waitcnt vmcnt(6)
  ds_read_b64_tr_b16 a[168:169], v3 offset:24576
  ds_read_b64_tr_b16 a[170:171], v3 offset:25600
  ds_read_b64_tr_b16 a[172:173], v3 offset:26624
  ds_read_b64_tr_b16 a[174:175], v3 offset:27648
  ds_read_b64_tr_b16 a[176:177], v3 offset:28672
  ds_read_b64_tr_b16 a[178:179], v3 offset:29696
  ds_read_b64_tr_b16 v[232:233], v3 offset:24608
  ds_read_b64_tr_b16 v[234:235], v3 offset:25632
  ds_read_b64_tr_b16 v[236:237], v3 offset:26656
  ds_read_b64_tr_b16 v[238:239], v3 offset:27680
  ds_read_b64_tr_b16 v[240:241], v3 offset:28704
  ds_read_b64_tr_b16 v[242:243], v3 offset:29728
  s_waitcnt lgkmcnt(0)
  s_waitcnt vmcnt(0)
  ds_read_b64_tr_b16 a[180:181], v3 offset:0
  ds_read_b64_tr_b16 a[182:183], v3 offset:1024
  ds_read_b64_tr_b16 a[184:185], v3 offset:2048
  ds_read_b64_tr_b16 a[186:187], v3 offset:3072
  ds_read_b64_tr_b16 a[188:189], v3 offset:4096
  ds_read_b64_tr_b16 a[190:191], v3 offset:5120
  ds_read_b64_tr_b16 v[244:245], v3 offset:32
  ds_read_b64_tr_b16 v[246:247], v3 offset:1056
  ds_read_b64_tr_b16 v[248:249], v3 offset:2080
  ds_read_b64_tr_b16 v[250:251], v3 offset:3104
  ds_read_b64_tr_b16 v[252:253], v3 offset:4128
  ds_read_b64_tr_b16 v[254:255], v3 offset:5152
  s_waitcnt lgkmcnt(0)
  v_mov_b32 v14, 0
  s_add_u32 s34, s25, 152
  s_lshl_b32 s34, s34, 7
  s_lshl_b32 s27, s24, 2
  s_add_u32 s34, s34, s27
  s_add_u32 s34, s34, 4096
  s_mov_b32 s27, 128
  v_lshrrev_b32 v68, 2, v1
  v_min_u32 v68, 15, v68
  v_add_u32 v68, s27, v68
  v_lshlrev_b32 v68, 7, v68
  v_and_b32 v10, 3, v1
  v_lshl_add_u32 v10, v10, 2, v68
  v_add_u32 v10, 4096, v10
  s_mov_b32 s27, 144
  v_lshrrev_b32 v68, 2, v1
  v_min_u32 v68, 7, v68
  v_add_u32 v68, s27, v68
  v_lshlrev_b32 v68, 7, v68
  v_and_b32 v11, 3, v1
  v_lshl_add_u32 v11, v11, 2, v68
  v_add_u32 v11, 4096, v11
  v_and_b32 v12, 15, v1
  v_mul_u32_u24 v12, 1280, v12
  v_lshrrev_b32 v68, 4, v1
  v_lshl_add_u32 v12, v68, 3, v12
  v_add_u32 v13, 20480, v12
  s_mov_b32 s36, s33
WD_loop:
wp_67:
  buffer_load_dword v8, v10, s[8:11], 0 offen sc1
  buffer_load_dword v9, v11, s[8:11], 0 offen sc1
  s_add_u32 s26, s26, 1
  s_mov_b32 s39, 32
  s_cmp_gt_u32 s26, 2097152
  s_cbranch_scc1 L_abort
  s_waitcnt vmcnt(0)
  v_min_u32 v8, v8, v9
  v_cmp_ge_u32 vcc, s36, v8
  s_cbranch_vccz wpd_68
  s_sleep 4
  s_branch wp_67
wpd_68:
  s_barrier
  s_mul_i32 s37, s36, 98304
  s_add_u32 s37, s37, 4718592
  s_mul_i32 s27, s24, 12288
  s_add_u32 s37, s37, s27
  s_mul_i32 s27, s24, 12288
  s_add_u32 m0, s27, 0
  s_add_u32 s27, s37, 0
  buffer_load_dwordx4 v2, s[8:11], s27 offen offset:0 sc1 lds
  buffer_load_dwordx4 v2, s[8:11], s27 offen offset:1024 sc1 lds
  buffer_load_dwordx4 v2, s[8:11], s27 offen offset:2048 sc1 lds
  buffer_load_dwordx4 v2, s[8:11], s27 offen offset:3072 sc1 lds
  s_mul_i32 s27, s24, 12288
  s_add_u32 m0, s27, 4096
  s_add_u32 s27, s37, 4096
  buffer_load_dwordx4 v2, s[8:11], s27 offen offset:0 sc1 lds
  buffer_load_dwordx4 v2, s[8:11], s27 offen offset:1024 sc1 lds
  buffer_load_dwordx4 v2, s[8:11], s27 offen offset:2048 sc1 lds
  buffer_load_dwordx4 v2, s[8:11], s27 offen offset:3072 sc1 lds
  s_mul_i32 s27, s24, 12288
  s_add_u32 m0, s27, 8192
  s_add_u32 s27, s37, 8192
  buffer_load_dwordx4 v2, s[8:11], s27 offen offset:0 sc1 lds
  buffer_load_dwordx4 v2, s[8:11], s27 offen offset:1024 sc1 lds
  buffer_load_dwordx4 v2, s[8:11], s27 offen offset:2048 sc1 lds
  buffer_load_dwordx4 v2, s[8:11], s27 offen offset:3072 sc1 lds
  s_mul_i32 s27, s24, 12288
  s_add_u32 m0, s27, 49152
  s_add_u32 s27, s37, 49152
  buffer_load_dwordx4 v2, s[8:11], s27 offen offset:0 sc1 lds
  buffer_load_dwordx4 v2, s[8:11], s27 offen offset:1024 sc1 lds
  buffer_load_dwordx4 v2, s[8:11], s27 offen offset:2048 sc1 lds
  buffer_load_dwordx4 v2, s[8:11], s27 offen offset:3072 sc1 lds
  s_mul_i32 s27, s24, 12288
  s_add_u32 m0, s27, 53248
  s_add_u32 s27, s37, 53248
  buffer_load_dwordx4 v2, s[8:11], s27 offen offset:0 sc1 lds
  buffer_load_dwordx4 v2, s[8:11], s27 offen offset:1024 sc1 lds
  buffer_load_dwordx4 v2, s[8:11], s27 offen offset:2048 sc1 lds
  buffer_load_dwordx4 v2, s[8:11], s27 offen offset:3072 sc1 lds
  s_mul_i32 s27, s24, 12288
  s_add_u32 m0, s27, 57344
  s_add_u32 s27, s37, 57344
  buffer_load_dwordx4 v2, s[8:11], s27 offen offset:0 sc1 lds
  buffer_load_dwordx4 v2, s[8:11], s27 offen offset:1024 sc1 lds
  buffer_load_dwordx4 v2, s[8:11], s27 offen offset:2048 sc1 lds
  buffer_load_dwordx4 v2, s[8:11], s27 offen offset:3072 sc1 lds
  s_mul_i32 s38, s36, 40960
  s_add_u32 s38, s38, s32
  buffer_load_dwordx2 v[56:57], v12, s[16:19], s38 offen offset:0
  buffer_load_dwordx2 v[58:59], v13, s[16:19], s38 offen offset:0
  buffer_load_dwordx2 v[60:61], v12, s[16:19], s38 offen offset:32
  buffer_load_dwordx2 v[62:63], v13, s[16:19], s38 offen offset:32
  s_waitcnt vmcnt(16)
  s_barrier
  ds_read_b128 v[76:79], v2 offset:0
  ds_read_b128 v[80:83], v2 offset:1024
  ds_read_b128 v[84:87], v2 offset:2048
  ds_read_b128 v[88:91], v2 offset:3072
  ds_read_b128 v[92:95], v2 offset:4096
  ds_read_b128 v[96:99], v2 offset:5120
  s_waitcnt lgkmcnt(4)
  v_mfma_f32_16x16x32_bf16 v[32:35], a[0:3], v[76:79], 0
  v_mfma_f32_16x16x32_bf16 v[40:43], a[192:195], v[76:79], 0
  v_mfma_f32_16x16x32_bf16 v[36:39], a[0:3], v[80:83], 0
  v_mfma_f32_16x16x32_bf16 v[44:47], a[192:195], v[80:83], 0
  ds_read_b128 v[76:79], v2 offset:6144
  ds_read_b128 v[80:83], v2 offset:7168
  s_waitcnt lgkmcnt(4)
  v_mfma_f32_16x16x32_bf16 v[32:35], a[4:7], v[84:87], v[32:35]
  v_mfma_f32_16x16x32_bf16 v[40:43], a[196:199], v[84:87], v[40:43]
  v_mfma_f32_16x16x32_bf16 v[36:39], a[4:7], v[88:91], v[36:39]
  v_mfma_f32_16x16x32_bf16 v[44:47], a[196:199], v[88:91], v[44:47]
  ds_read_b128 v[84:87], v2 offset:8192
  ds_read_b128 v[88:91], v2 offset:9216
  s_waitcnt lgkmcnt(4)
  v_mfma_f32_16x16x32_bf16 v[32:35], a[8:11], v[92:95], v[32:35]
  v_mfma_f32_16x16x32_bf16 v[40:43], a[200:203], v[92:95], v[40:43]
  v_mfma_f32_16x16x32_bf16 v[36:39], a[8:11], v[96:99], v[36:39]
  v_mfma_f32_16x16x32_bf16 v[44:47], a[200:203], v[96:99], v[44:47]
  ds_read_b128 v[92:95], v2 offset:10240
  ds_read_b128 v[96:99], v2 offset:11264
  s_waitcnt lgkmcnt(4)
  v_mfma_f32_16x16x32_bf16 v[32:35], a[12:15], v[76:79], v[32:35]
  v_mfma_f32_16x16x32_bf16 v[40:43], a[204:207], v[76:79], v[40:43]
  v_mfma_f32_16x16x32_bf16 v[36:39], a[12:15], v[80:83], v[36:39]
  v_mfma_f32_16x16x32_bf16 v[44:47], a[204:207], v[80:83], v[44:47]
  ds_read_b128 v[76:79], v2 offset:12288
  ds_read_b128 v[80:83], v2 offset:13312
  s_waitcnt lgkmcnt(4)
  v_mfma_f32_16x16x32_bf16 v[32:35], a[16:19], v[84:87], v[32:35]
  v_mfma_f32_16x16x32_bf16 v[40:43], a[208:211], v[84:87], v[40:43]
  v_mfma_f32_16x16x32_bf16 v[36:39], a[16:19], v[88:91], v[36:39]
  v_mfma_f32_16x16x32_bf16 v[44:47], a[208:211], v[88:91], v[44:47]
  ds_read_b128 v[84:87], v2 offset:14336
  ds_read_b128 v[88:91], v2 offset:15360
  s_waitcnt lgkmcnt(4)
  v_mfma_f32_16x16x32_bf16 v[32:35], a[20:23], v[92:95], v[32:35]
  v_mfma_f32_16x16x32_bf16 v[40:43], a[212:215], v[92:95], v[40:43]
  v_mfma_f32_16x16x32_bf16 v[36:39], a[20:23], v[96:99], v[36:39]
  v_mfma_f32_16x16x32_bf16 v[44:47], a[212:215], v[96:99], v[44:47]
  ds_read_b128 v[92:95], v2 offset:16384
  ds_read_b128 v[96:99], v2 offset:17408
  s_waitcnt lgkmcnt(4)
  v_mfma_f32_16x16x32_bf16 v[32:35], a[24:27], v[76:79], v[32:35]
  v_mfma_f32_16x16x32_bf16 v[40:43], a[216:219], v[76:79], v[40:43]
  v_mfma_f32_16x16x32_bf16 v[36:39], a[24:27], v[80:83], v[36:39]
  v_mfma_f32_16x16x32_bf16 v[44:47], a[216:219], v[80:83], v[44:47]
  ds_read_b128 v[76:79], v2 offset:18432
  ds_read_b128 v[80:83], v2 offset:19456
  s_waitcnt lgkmcnt(4)
  v_mfma_f32_16x16x32_bf16 v[32:35], a[28:31], v[84:87], v[32:35]
  v_mfma_f32_16x16x32_bf16 v[40:43], a[220:223], v[84:87], v[40:43]
  v_mfma_f32_16x16x32_bf16 v[36:39], a[28:31], v[88:91], v[36:39]
  v_mfma_f32_16x16x32_bf16 v[44:47], a[220:223], v[88:91], v[44:47]
  ds_read_b128 v[84:87], v2 offset:20480
  ds_read_b128 v[88:91], v2 offset:21504
  s_waitcnt lgkmcnt(4)
  v_mfma_f32_16x16x32_bf16 v[32:35], a[32:35], v[92:95], v[32:35]
  v_mfma_f32_16x16x32_bf16 v[40:43], a[224:227], v[92:95], v[40:43]
  v_mfma_f32_16x16x32_bf16 v[36:39], a[32:35], v[96:99], v[36:39]
  v_mfma_f32_16x16x32_bf16 v[44:47], a[224:227], v[96:99], v[44:47]
  ds_read_b128 v[92:95], v2 offset:22528
  ds_read_b128 v[96:99], v2 offset:23552
  s_waitcnt lgkmcnt(4)
  v_mfma_f32_16x16x32_bf16 v[32:35], a[36:39], v[76:79], v[32:35]
  v_mfma_f32_16x16x32_bf16 v[40:43], a[228:231], v[76:79], v[40:43]
  v_mfma_f32_16x16x32_bf16 v[36:39], a[36:39], v[80:83], v[36:39]
  v_mfma_f32_16x16x32_bf16 v[44:47], a[228:231], v[80:83], v[44:47]
  ds_read_b128 v[76:79], v2 offset:24576
  ds_read_b128 v[80:83], v2 offset:25600
  s_waitcnt lgkmcnt(4)
  v_mfma_f32_16x16x32_bf16 v[32:35], a[40:43], v[84:87], v[32:35]
  v_mfma_f32_16x16x32_bf16 v[40:43], a[232:235], v[84:87], v[40:43]
  v_mfma_f32_16x16x32_bf16 v[36:39], a[40:43], v[88:91], v[36:39]
  v_mfma_f32_16x16x32_bf16 v[44:47], a[232:235], v[88:91], v[44:47]
  ds_read_b128 v[84:87], v2 offset:26624
  ds_read_b128 v[88:91], v2 offset:27648
  s_waitcnt lgkmcnt(4)
  v_mfma_f32_16x16x32_bf16 v[32:35], a[44:47], v[92:95], v[32:35]
  v_mfma_f32_16x16x32_bf16 v[40:43], a[236:239], v[92:95], v[40:43]
  v_mfma_f32_16x16x32_bf16 v[36:39], a[44:47], v[96:99], v[36:39]
  v_mfma_f32_16x16x32_bf16 v[44:47], a[236:239], v[96:99], v[44:47]
  ds_read_b128 v[92:95], v2 offset:28672
  ds_read_b128 v[96:99], v2 offset:29696
  s_waitcnt lgkmcnt(4)
  v_mfma_f32_16x16x32_bf16 v[32:35], a[48:51], v[76:79], v[32:35]
  v_mfma_f32_16x16x32_bf16 v[40:43], a[240:243], v[76:79], v[40:43]
  v_mfma_f32_16x16x32_bf16 v[36:39], a[48:51], v[80:83], v[36:39]
  v_mfma_f32_16x16x32_bf16 v[44:47], a[240:243], v[80:83], v[44:47]
  ds_read_b128 v[76:79], v2 offset:30720
  ds_read_b128 v[80:83], v2 offset:31744
  s_waitcnt lgkmcnt(4)
  v_mfma_f32_16x16x32_bf16 v[32:35], a[52:55], v[84:87], v[32:35]
  v_mfma_f32_16x16x32_bf16 v[40:43], a[244:247], v[84:87], v[40:43]
  v_mfma_f32_16x16x32_bf16 v[36:39], a[52:55], v[88:91], v[36:39]
  v_mfma_f32_16x16x32_bf16 v[44:47], a[244:247], v[88:91], v[44:47]
  ds_read_b128 v[84:87], v2 offset:32768
  ds_read_b128 v[88:91], v2 offset:33792
  s_waitcnt lgkmcnt(4)
  v_mfma_f32_16x16x32_bf16 v[32:35], a[56:59], v[92:95], v[32:35]
  v_mfma_f32_16x16x32_bf16 v[40:43], a[248:251], v[92:95], v[40:43]
  v_mfma_f32_16x16x32_bf16 v[36:39], a[56:59], v[96:99], v[36:39]
  v_mfma_f32_16x16x32_bf16 v[44:47], a[248:251], v[96:99], v[44:47]
  ds_read_b128 v[92:95], v2 offset:34816
  ds_read_b128 v[96:99], v2 offset:35840
  s_waitcnt lgkmcnt(4)
  v_mfma_f32_16x16x32_bf16 v[32:35], a[60:63], v[76:79], v[32:35]
  v_mfma_f32_16x16x32_bf16 v[40:43], a[252:255], v[76:79], v[40:43]
  v_mfma_f32_16x16x32_bf16 v[36:39], a[60:63], v[80:83], v[36:39]
  v_mfma_f32_16x16x32_bf16 v[44:47], a[252:255], v[80:83], v[44:47]
  ds_read_b128 v[76:79], v2 offset:36864
  ds_read_b128 v[80:83], v2 offset:37888
  s_waitcnt lgkmcnt(4)
  v_mfma_f32_16x16x32_bf16 v[32:35], a[64:67], v[84:87], v[32:35]
  v_mfma_f32_16x16x32_bf16 v[40:43], v[128:131], v[84:87], v[40:43]
  v_mfma_f32_16x16x32_bf16 v[36:39], a[64:67], v[88:91], v[36:39]
  v_mfma_f32_16x16x32_bf16 v[44:47], v[128:131], v[88:91], v[44:47]
  ds_read_b128 v[84:87], v2 offset:38912
  ds_read_b128 v[88:91], v2 offset:39936
  s_waitcnt lgkmcnt(4)
  v_mfma_f32_16x16x32_bf16 v[32:35], a[68:71], v[92:95], v[32:35]
  v_mfma_f32_16x16x32_bf16 v[40:43], v[132:135], v[92:95], v[40:43]
  v_mfma_f32_16x16x32_bf16 v[36:39], a[68:71], v[96:99], v[36:39]
  v_mfma_f32_16x16x32_bf16 v[44:47], v[132:135], v[96:99], v[44:47]
  ds_read_b128 v[92:95], v2 offset:40960
  ds_read_b128 v[96:99], v2 offset:41984
  s_waitcnt lgkmcnt(4)
  v_mfma_f32_16x16x32_bf16 v[32:35], a[72:75], v[76:79], v[32:35]
  v_mfma_f32_16x16x32_bf16 v[40:43], v[136:139], v[76:79], v[40:43]
  v_mfma_f32_16x16x32_bf16 v[36:39], a[72:75], v[80:83], v[36:39]
  v_mfma_f32_16x16x32_bf16 v[44:47], v[136:139], v[80:83], v[44:47]
  ds_read_b128 v[76:79], v2 offset:43008
  ds_read_b128 v[80:83], v2 offset:44032
  s_waitcnt lgkmcnt(4)
  v_mfma_f32_16x16x32_bf16 v[32:35], a[76:79], v[84:87], v[32:35]
  v_mfma_f32_16x16x32_bf16 v[40:43], v[140:143], v[84:87], v[40:43]
  v_mfma_f32_16x16x32_bf16 v[36:39], a[76:79], v[88:91], v[36:39]
  v_mfma_f32_16x16x32_bf16 v[44:47], v[140:143], v[88:91], v[44:47]
  ds_read_b128 v[84:87], v2 offset:45056
  ds_read_b128 v[88:91], v2 offset:46080
  s_waitcnt lgkmcnt(4)
  v_mfma_f32_16x16x32_bf16 v[32:35], a[80:83], v[92:95], v[32:35]
  v_mfma_f32_16x16x32_bf16 v[40:43], v[144:147], v[92:95], v[40:43]
  v_mfma_f32_16x16x32_bf16 v[36:39], a[80:83], v[96:99], v[36:39]
  v_mfma_f32_16x16x32_bf16 v[44:47], v[144:147], v[96:99], v[44:47]
  ds_read_b128 v[92:95], v2 offset:47104
  ds_read_b128 v[96:99], v2 offset:48128
  s_waitcnt lgkmcnt(4)
  v_mfma_f32_16x16x32_bf16 v[32:35], a[84:87], v[76:79], v[32:35]
  v_mfma_f32_16x16x32_bf16 v[40:43], v[148:151], v[76:79], v[40:43]
  v_mfma_f32_16x16x32_bf16 v[36:39], a[84:87], v[80:83], v[36:39]
  v_mfma_f32_16x16x32_bf16 v[44:47], v[148:151], v[80:83], v[44:47]
  s_waitcnt lgkmcnt(2)
  v_mfma_f32_16x16x32_bf16 v[32:35], a[88:91], v[84:87], v[32:35]
  v_mfma_f32_16x16x32_bf16 v[40:43], v[152:155], v[84:87], v[40:43]
  v_mfma_f32_16x16x32_bf16 v[36:39], a[88:91], v[88:91], v[36:39]
  v_mfma_f32_16x16x32_bf16 v[44:47], v[152:155], v[88:91], v[44:47]
  s_waitcnt lgkmcnt(0)
  v_mfma_f32_16x16x32_bf16 v[32:35], a[92:95], v[92:95], v[32:35]
  v_mfma_f32_16x16x32_bf16 v[40:43], v[156:159], v[92:95], v[40:43]
  v_mfma_f32_16x16x32_bf16 v[36:39], a[92:95], v[96:99], v[36:39]
  v_mfma_f32_16x16x32_bf16 v[44:47], v[156:159], v[96:99], v[44:47]
  s_waitcnt vmcnt(4)
  s_barrier
  v_add_u32 v7, 49152, v2
  ds_read_b128 v[76:79], v7 offset:0
  ds_read_b128 v[80:83], v7 offset:1024
  ds_read_b128 v[84:87], v7 offset:2048
  ds_read_b128 v[88:91], v7 offset:3072
  ds_read_b128 v[92:95], v7 offset:4096
  ds_read_b128 v[96:99], v7 offset:5120
  s_waitcnt lgkmcnt(4)
  v_mfma_f32_16x16x32_bf16 v[32:35], a[96:99], v[76:79], v[32:35]
  v_mfma_f32_16x16x32_bf16 v[40:43], v[160:163], v[76:79], v[40:43]
  v_mfma_f32_16x16x32_bf16 v[36:39], a[96:99], v[80:83], v[36:39]
  v_mfma_f32_16x16x32_bf16 v[44:47], v[160:163], v[80:83], v[44:47]
  ds_read_b128 v[76:79], v7 offset:6144
  ds_read_b128 v[80:83], v7 offset:7168
  s_waitcnt lgkmcnt(4)
  v_mfma_f32_16x16x32_bf16 v[32:35], a[100:103], v[84:87], v[32:35]
  v_mfma_f32_16x16x32_bf16 v[40:43], v[164:167], v[84:87], v[40:43]
  v_mfma_f32_16x16x32_bf16 v[36:39], a[100:103], v[88:91], v[36:39]
  v_mfma_f32_16x16x32_bf16 v[44:47], v[164:167], v[88:91], v[44:47]
  ds_read_b128 v[84:87], v7 offset:8192
  ds_read_b128 v[88:91], v7 offset:9216
  s_waitcnt lgkmcnt(4)
  v_mfma_f32_16x16x32_bf16 v[32:35], a[104:107], v[92:95], v[32:35]
  v_mfma_f32_16x16x32_bf16 v[40:43], v[168:171], v[92:95], v[40:43]
  v_mfma_f32_16x16x32_bf16 v[36:39], a[104:107], v[96:99], v[36:39]
  v_mfma_f32_16x16x32_bf16 v[44:47], v[168:171], v[96:99], v[44:47]
  ds_read_b128 v[92:95], v7 offset:10240
  ds_read_b128 v[96:99], v7 offset:11264
  s_waitcnt lgkmcnt(4)
  v_mfma_f32_16x16x32_bf16 v[32:35], a[108:111], v[76:79], v[32:35]
  v_mfma_f32_16x16x32_bf16 v[40:43], v[172:175], v[76:79], v[40:43]
  v_mfma_f32_16x16x32_bf16 v[36:39], a[108:111], v[80:83], v[36:39]
  v_mfma_f32_16x16x32_bf16 v[44:47], v[172:175], v[80:83], v[44:47]
  ds_read_b128 v[76:79], v7 offset:12288
  ds_read_b128 v[80:83], v7 offset:13312
  s_waitcnt lgkmcnt(4)
  v_mfma_f32_16x16x32_bf16 v[32:35], a[112:115], v[84:87], v[32:35]
  v_mfma_f32_16x16x32_bf16 v[40:43], v[176:179], v[84:87], v[40:43]
  v_mfma_f32_16x16x32_bf16 v[36:39], a[112:115], v[88:91], v[36:39]
  v_mfma_f32_16x16x32_bf16 v[44:47], v[176:179], v[88:91], v[44:47]
  ds_read_b128 v[84:87], v7 offset:14336
  ds_read_b128 v[88:91], v7 offset:15360
  s_waitcnt lgkmcnt(4)
  v_mfma_f32_16x16x32_bf16 v[32:35], a[116:119], v[92:95], v[32:35]
  v_mfma_f32_16x16x32_bf16 v[40:43], v[180:183], v[92:95], v[40:43]
  v_mfma_f32_16x16x32_bf16 v[36:39], a[116:119], v[96:99], v[36:39]
  v_mfma_f32_16x16x32_bf16 v[44:47], v[180:183], v[96:99], v[44:47]
  ds_read_b128 v[92:95], v7 offset:16384
  ds_read_b128 v[96:99], v7 offset:17408
  s_waitcnt lgkmcnt(4)
  v_mfma_f32_16x16x32_bf16 v[32:35], a[120:123], v[76:79], v[32:35]
  v_mfma_f32_16x16x32_bf16 v[40:43], v[184:187], v[76:79], v[40:43]
  v_mfma_f32_16x16x32_bf16 v[36:39], a[120:123], v[80:83], v[36:39]
  v_mfma_f32_16x16x32_bf16 v[44:47], v[184:187], v[80:83], v[44:47]
  ds_read_b128 v[76:79], v7 offset:18432
  ds_read_b128 v[80:83], v7 offset:19456
  s_waitcnt lgkmcnt(4)
  v_mfma_f32_16x16x32_bf16 v[32:35], a[124:127], v[84:87], v[32:35]
  v_mfma_f32_16x16x32_bf16 v[40:43], v[188:191], v[84:87], v[40:43]
  v_mfma_f32_16x16x32_bf16 v[36:39], a[124:127], v[88:91], v[36:39]
  v_mfma_f32_16x16x32_bf16 v[44:47], v[188:191], v[88:91], v[44:47]
  ds_read_b128 v[84:87], v7 offset:20480
  ds_read_b128 v[88:91], v7 offset:21504
  s_waitcnt lgkmcnt(4)
  v_mfma_f32_16x16x32_bf16 v[32:35], a[128:131], v[92:95], v[32:35]
  v_mfma_f32_16x16x32_bf16 v[40:43], v[192:195], v[92:95], v[40:43]
  v_mfma_f32_16x16x32_bf16 v[36:39], a[128:131], v[96:99], v[36:39]
  v_mfma_f32_16x16x32_bf16 v[44:47], v[192:195], v[96:99], v[44:47]
  ds_read_b128 v[92:95], v7 offset:22528
  ds_read_b128 v[96:99], v7 offset:23552
  s_waitcnt lgkmcnt(4)
  v_mfma_f32_16x16x32_bf16 v[32:35], a[132:135], v[76:79], v[32:35]
  v_mfma_f32_16x16x32_bf16 v[40:43], v[196:199], v[76:79], v[40:43]
  v_mfma_f32_16x16x32_bf16 v[36:39], a[132:135], v[80:83], v[36:39]
  v_mfma_f32_16x16x32_bf16 v[44:47], v[196:199], v[80:83], v[44:47]
  ds_read_b128 v[76:79], v7 offset:24576
  ds_read_b128 v[80:83], v7 offset:25600
  s_waitcnt lgkmcnt(4)
  v_mfma_f32_16x16x32_bf16 v[32:35], a[136:139], v[84:87], v[32:35]
  v_mfma_f32_16x16x32_bf16 v[40:43], v[200:203], v[84:87], v[40:43]
  v_mfma_f32_16x16x32_bf16 v[36:39], a[136:139], v[88:91], v[36:39]
  v_mfma_f32_16x16x32_bf16 v[44:47], v[200:203], v[88:91], v[44:47]
  ds_read_b128 v[84:87], v7 offset:26624
  ds_read_b128 v[88:91], v7 offset:27648
  s_waitcnt lgkmcnt(4)
  v_mfma_f32_16x16x32_bf16 v[32:35], a[140:143], v[92:95], v[32:35]
  v_mfma_f32_16x16x32_bf16 v[40:43], v[204:207], v[92:95], v[40:43]
  v_mfma_f32_16x16x32_bf16 v[36:39], a[140:143], v[96:99], v[36:39]
  v_mfma_f32_16x16x32_bf16 v[44:47], v[204:207], v[96:99], v[44:47]
  ds_read_b128 v[92:95], v7 offset:28672
  ds_read_b128 v[96:99], v7 offset:29696
  s_waitcnt lgkmcnt(4)
  v_mfma_f32_16x16x32_bf16 v[32:35], a[144:147], v[76:79], v[32:35]
  v_mfma_f32_16x16x32_bf16 v[40:43], v[208:211], v[76:79], v[40:43]
  v_mfma_f32_16x16x32_bf16 v[36:39], a[144:147], v[80:83], v[36:39]
  v_mfma_f32_16x16x32_bf16 v[44:47], v[208:211], v[80:83], v[44:47]
  ds_read_b128 v[76:79], v7 offset:30720
  ds_read_b128 v[80:83], v7 offset:31744
  s_waitcnt lgkmcnt(4)
  v_mfma_f32_16x16x32_bf16 v[32:35], a[148:151], v[84:87], v[32:35]
  v_mfma_f32_16x16x32_bf16 v[40:43], v[212:215], v[84:87], v[40:43]
  v_mfma_f32_16x16x32_bf16 v[36:39], a[148:151], v[88:91], v[36:39]
  v_mfma_f32_16x16x32_bf16 v[44:47], v[212:215], v[88:91], v[44:47]
  ds_read_b128 v[84:87], v7 offset:32768
  ds_read_b128 v[88:91], v7 offset:33792
  s_waitcnt lgkmcnt(4)
  v_mfma_f32_16x16x32_bf16 v[32:35], a[152:155], v[92:95], v[32:35]
  v_mfma_f32_16x16x32_bf16 v[40:43], v[216:219], v[92:95], v[40:43]
  v_mfma_f32_16x16x32_bf16 v[36:39], a[152:155], v[96:99], v[36:39]
  v_mfma_f32_16x16x32_bf16 v[44:47], v[216:219], v[96:99], v[44:47]
  ds_read_b128 v[92:95], v7 offset:34816
  ds_read_b128 v[96:99], v7 offset:35840
  s_waitcnt lgkmcnt(4)
  v_mfma_f32_16x16x32_bf16 v[32:35], a[156:159], v[76:79], v[32:35]
  v_mfma_f32_16x16x32_bf16 v[40:43], v[220:223], v[76:79], v[40:43]
  v_mfma_f32_16x16x32_bf16 v[36:39], a[156:159], v[80:83], v[36:39]
  v_mfma_f32_16x16x32_bf16 v[44:47], v[220:223], v[80:83], v[44:47]
  ds_read_b128 v[76:79], v7 offset:36864
  ds_read_b128 v[80:83], v7 offset:37888
  s_waitcnt lgkmcnt(4)
  v_mfma_f32_16x16x32_bf16 v[32:35], a[160:163], v[84:87], v[32:35]
  v_mfma_f32_16x16x32_bf16 v[40:43], v[224:227], v[84:87], v[40:43]
  v_mfma_f32_16x16x32_bf16 v[36:39], a[160:163], v[88:91], v[36:39]
  v_mfma_f32_16x16x32_bf16 v[44:47], v[224:227], v[88:91], v[44:47]
  ds_read_b128 v[84:87], v7 offset:38912
  ds_read_b128 v[88:91], v7 offset:39936
  s_waitcnt lgkmcnt(4)
  v_mfma_f32_16x16x32_bf16 v[32:35], a[164:167], v[92:95], v[32:35]
  v_mfma_f32_16x16x32_bf16 v[40:43], v[228:231], v[92:95], v[40:43]
  v_mfma_f32_16x16x32_bf16 v[36:39], a[164:167], v[96:99], v[36:39]
  v_mfma_f32_16x16x32_bf16 v[44:47], v[228:231], v[96:99], v[44:47]
  ds_read_b128 v[92:95], v7 offset:40960
  ds_read_b128 v[96:99], v7 offset:41984
  s_waitcnt lgkmcnt(4)
  v_mfma_f32_16x16x32_bf16 v[32:35], a[168:171], v[76:79], v[32:35]
  v_mfma_f32_16x16x32_bf16 v[40:43], v[232:235], v[76:79], v[40:43]
  v_mfma_f32_16x16x32_bf16 v[36:39], a[168:171], v[80:83], v[36:39]
  v_mfma_f32_16x16x32_bf16 v[44:47], v[232:235], v[80:83], v[44:47]
  ds_read_b128 v[76:79], v7 offset:43008
  ds_read_b128 v[80:83], v7 offset:44032
  s_waitcnt lgkmcnt(4)
  v_mfma_f32_16x16x32_bf16 v[32:35], a[172:175], v[84:87], v[32:35]
  v_mfma_f32_16x16x32_bf16 v[40:43], v[236:239], v[84:87], v[40:43]
  v_mfma_f32_16x16x32_bf16 v[36:39], a[172:175], v[88:91], v[36:39]
  v_mfma_f32_16x16x32_bf16 v[44:47], v[236:239], v[88:91], v[44:47]
  ds_read_b128 v[84:87], v7 offset:45056
  ds_read_b128 v[88:91], v7 offset:46080
  s_waitcnt lgkmcnt(4)
  v_mfma_f32_16x16x32_bf16 v[32:35], a[176:179], v[92:95], v[32:35]
  v_mfma_f32_16x16x32_bf16 v[40:43], v[240:243], v[92:95], v[40:43]
  v_mfma_f32_16x16x32_bf16 v[36:39], a[176:179], v[96:99], v[36:39]
  v_mfma_f32_16x16x32_bf16 v[44:47], v[240:243], v[96:99], v[44:47]
  ds_read_b128 v[92:95], v7 offset:47104
  ds_read_b128 v[96:99], v7 offset:48128
  s_waitcnt lgkmcnt(4)
  v_mfma_f32_16x16x32_bf16 v[32:35], a[180:183], v[76:79], v[32:35]
  v_mfma_f32_16x16x32_bf16 v[40:43], v[244:247], v[76:79], v[40:43]
  v_mfma_f32_16x16x32_bf16 v[36:39], a[180:183], v[80:83], v[36:39]
  v_mfma_f32_16x16x32_bf16 v[44:47], v[244:247], v[80:83], v[44:47]
  s_waitcnt lgkmcnt(2)
  v_mfma_f32_16x16x32_bf16 v[32:35], a[184:187], v[84:87], v[32:35]
  v_mfma_f32_16x16x32_bf16 v[40:43], v[248:251], v[84:87], v[40:43]
  v_mfma_f32_16x16x32_bf16 v[36:39], a[184:187], v[88:91], v[36:39]
  v_mfma_f32_16x16x32_bf16 v[44:47], v[248:251], v[88:91], v[44:47]
  s_waitcnt lgkmcnt(0)
  v_mfma_f32_16x16x32_bf16 v[32:35], a[188:191], v[92:95], v[32:35]
  v_mfma_f32_16x16x32_bf16 v[40:43], v[252:255], v[92:95], v[40:43]
  v_mfma_f32_16x16x32_bf16 v[36:39], a[188:191], v[96:99], v[36:39]
  v_mfma_f32_16x16x32_bf16 v[44:47], v[252:255], v[96:99], v[44:47]
  s_waitcnt vmcnt(0)
  s_mul_i32 s37, s36, 81920
  s_add_u32 s37, s37, 11010048
  s_lshl_b32 s27, s75, 13
  s_add_u32 s37, s37, s27
  s_lshl_b32 s27, s24, 11
  s_add_u32 s37, s37, s27
  v_add_u32 v6, 40960, v2
  v_cvt_pk_bf16_f32 v68, v32, v33
  v_lshlrev_b32 v32, 16, v68
  v_and_b32 v33, 0xffff0000, v68
  v_lshlrev_b32 v69, 16, v56
  v_and_b32 v70, 0xffff0000, v56
  v_add_f32 v32, v32, v69
  v_add_f32 v33, v33, v70
  v_cvt_pk_bf16_f32 v68, v34, v35
  v_lshlrev_b32 v34, 16, v68
  v_and_b32 v35, 0xffff0000, v68
  v_lshlrev_b32 v69, 16, v57
  v_and_b32 v70, 0xffff0000, v57
  v_add_f32 v34, v34, v69
  v_add_f32 v35, v35, v70
  buffer_store_dwordx4 v[32:35], v2, s[8:11], s37 offen offset:0 sc1
  v_cvt_pk_bf16_f32 v68, v36, v37
  v_lshlrev_b32 v36, 16, v68
  v_and_b32 v37, 0xffff0000, v68
  v_lshlrev_b32 v69, 16, v58
  v_and_b32 v70, 0xffff0000, v58
  v_add_f32 v36, v36, v69
  v_add_f32 v37, v37, v70
  v_cvt_pk_bf16_f32 v68, v38, v39
  v_lshlrev_b32 v38, 16, v68
  v_and_b32 v39, 0xffff0000, v68
  v_lshlrev_b32 v69, 16, v59
  v_and_b32 v70, 0xffff0000, v59
  v_add_f32 v38, v38, v69
  v_add_f32 v39, v39, v70
  buffer_store_dwordx4 v[36:39], v6, s[8:11], s37 offen offset:0 sc1
  v_cvt_pk_bf16_f32 v68, v40, v41
  v_lshlrev_b32 v40, 16, v68
  v_and_b32 v41, 0xffff0000, v68
  v_lshlrev_b32 v69, 16, v60
  v_and_b32 v70, 0xffff0000, v60
  v_add_f32 v40, v40, v69
  v_add_f32 v41, v41, v70
  v_cvt_pk_bf16_f32 v68, v42, v43
  v_lshlrev_b32 v42, 16, v68
  v_and_b32 v43, 0xffff0000, v68
  v_lshlrev_b32 v69, 16, v61
  v_and_b32 v70, 0xffff0000, v61
  v_add_f32 v42, v42, v69
  v_add_f32 v43, v43, v70
  buffer_store_dwordx4 v[40:43], v2, s[8:11], s37 offen offset:1024 sc1
  v_cvt_pk_bf16_f32 v68, v44, v45
  v_lshlrev_b32 v44, 16, v68
  v_and_b32 v45, 0xffff0000, v68
  v_lshlrev_b32 v69, 16, v62
  v_and_b32 v70, 0xffff0000, v62
  v_add_f32 v44, v44, v69
  v_add_f32 v45, v45, v70
  v_cvt_pk_bf16_f32 v68, v46, v47
  v_lshlrev_b32 v46, 16, v68
  v_and_b32 v47, 0xffff0000, v68
  v_lshlrev_b32 v69, 16, v63
  v_and_b32 v70, 0xffff0000, v63
  v_add_f32 v46, v46, v69
  v_add_f32 v47, v47, v70
  buffer_store_dwordx4 v[44:47], v6, s[8:11], s37 offen offset:1024 sc1
  s_waitcnt vmcnt(0)
  s_add_u32 s36, s36, 1
  v_mov_b32 v15, s36
  s_mov_b64 exec, 1
  buffer_store_dword v15, off, s[8:11], s34 sc1
  s_mov_b64 exec, -1
  s_add_u32 s36, s36, 3
  s_cmp_lt_u32 s36, 64
  s_cbranch_scc1 WD_loop
  s_branch PY
AT:
  s_cmp_lg_u32 s24, 0
  s_cbranch_scc1 wwd_70
ww_69:
  buffer_load_dword v8, off, s[68:71], 0 offset:64 sc1
  s_add_u32 s26, s26, 1
  s_mov_b32 s39, 128
  s_cmp_gt_u32 s26, 2097152
  s_cbranch_scc1 L_abort
  s_waitcnt vmcnt(0)
  v_cmp_gt_u32 vcc, 64, v8
  s_cbranch_vccz wwd_70
  s_sleep 8
  s_branch ww_69
wwd_70:
  s_barrier
  s_and_b32 s32, s25, 7
  s_lshl_b32 s32, s32, 2
  s_add_u32 s32, s32, s24
  s_lshr_b32 s33, s25, 3
  v_and_b32 v3, 3, v1
  v_lshlrev_b32 v3, 2, v3
  v_bfe_u32 v4, v1, 2, 1
  v_mul_u32_u24 v4, 12288, v4
  s_lshl_b32 s27, s32, 7
  s_add_u32 s30, s27, 4096
  v_add3_u32 v10, v3, v4, s30
  s_add_u32 s30, s27, 28672
  v_add_u32 v11, s30, v3
  s_add_u32 s34, s25, 172
  s_lshl_b32 s34, s34, 7
  s_lshl_b32 s27, s24, 2
  s_add_u32 s34, s34, s27
  s_add_u32 s34, s34, 4096
  v_add_u32 v12, 4096, v2
  v_add_u32 v13, 8192, v2
  v_lshlrev_b32 v14, 3, v1
  s_lshl_b32 s35, s32, 11
  s_add_u32 s35, s35, 16252928
  s_lshr_b32 s36, s32, 2
  s_lshl_b32 s36, s36, 11
  s_and_b32 s27, s32, 3
  s_lshl_b32 s27, s27, 8
  s_add_u32 s36, s36, s27
  s_add_u32 s36, s36, 16318464
  v_and_b32 v5, 15, v1
  v_lshrrev_b32 v6, 4, v1
  v_lshlrev_b32 v15, 4, v5
  v_and_b32 v7, 1, v6
  v_lshl_add_u32 v15, v7, 3, v15
  v_lshl_add_u32 v7, v6, 2, 0
  v_cmp_le_u32 s[80:81], v7, v5
  v_lshl_add_u32 v7, v6, 2, 1
  v_cmp_le_u32 s[82:83], v7, v5
  v_lshl_add_u32 v7, v6, 2, 2
  v_cmp_le_u32 s[84:85], v7, v5
  v_lshl_add_u32 v7, v6, 2, 3
  v_cmp_le_u32 s[86:87], v7, v5
  s_mov_b32 s88, 0
  s_mov_b32 s89, -1
  s_mov_b32 s90, 0x3dd53b95
  s_mov_b32 s91, 0x3dd53b95
  v_mov_b32 v16, 0xceabfb8f
  v_mov_b32 v18, 0xff800000
  s_mul_i32 s37, s32, 12288
  s_lshl_b32 s38, s32, 12
  s_add_u32 s38, s38, 201850880
  s_lshl_b32 s72, s32, 11
  s_add_u32 s72, s72, 210239488
  s_mov_b32 s73, s33
  s_mul_i32 s27, s33, 81920
  s_add_u32 s35, s35, s27
  s_mul_i32 s27, s33, 81920
  s_add_u32 s36, s36, s27
  s_mul_i32 s27, s33, 393216
  s_add_u32 s37, s37, s27
  s_mul_i32 s27, s33, 131072
  s_add_u32 s38, s38, s27
  s_mul_i32 s27, s33, 65536
  s_add_u32 s72, s72, s27
wp_71:
  buffer_load_dword v9, v10, s[8:11], 0 offen sc1
  s_add_u32 s26, s26, 1
  s_mov_b32 s39, 129
  s_cmp_gt_u32 s26, 2097152
  s_cbranch_scc1 L_abort
  s_waitcnt vmcnt(0)
  v_cmp_ge_u32 vcc, s73, v9
  s_cbranch_vccz wpd_72
  s_sleep 8
  s_branch wp_71
wpd_72:
  s_add_u32 s27, s37, 42467328
  s_add_u32 s30, s37, 67633152
  buffer_load_dwordx4 v[96:99], v2, s[8:11], s27 offen offset:0 sc1
  buffer_load_dwordx4 v[100:103], v2, s[8:11], s27 offen offset:1024 sc1
  buffer_load_dwordx4 v[104:107], v2, s[8:11], s27 offen offset:2048 sc1
  buffer_load_dwordx4 v[108:111], v2, s[8:11], s27 offen offset:3072 sc1
  buffer_load_dwordx4 v[112:115], v12, s[8:11], s27 offen offset:0 sc1
  buffer_load_dwordx4 v[116:119], v12, s[8:11], s27 offen offset:1024 sc1
  buffer_load_dwordx4 v[120:123], v12, s[8:11], s27 offen offset:2048 sc1
  buffer_load_dwordx4 v[124:127], v12, s[8:11], s27 offen offset:3072 sc1
  buffer_load_dwordx4 v[128:131], v13, s[8:11], s27 offen offset:0 sc1
  buffer_load_dwordx4 v[132:135], v13, s[8:11], s27 offen offset:1024 sc1
  buffer_load_dwordx4 v[136:139], v13, s[8:11], s27 offen offset:2048 sc1
  buffer_load_dwordx4 v[140:143], v13, s[8:11], s27 offen offset:3072 sc1
  buffer_load_dwordx4 v[144:147], v2, s[8:11], s30 offen offset:0 sc1
  buffer_load_dwordx4 v[148:151], v2, s[8:11], s30 offen offset:1024 sc1
  buffer_load_dwordx4 v[152:155], v2, s[8:11], s30 offen offset:2048 sc1
  buffer_load_dwordx4 v[156:159], v2, s[8:11], s30 offen offset:3072 sc1
  buffer_load_dwordx4 v[160:163], v12, s[8:11], s30 offen offset:0 sc1
  buffer_load_dwordx4 v[164:167], v12, s[8:11], s30 offen offset:1024 sc1
  buffer_load_dwordx4 v[168:171], v12, s[8:11], s30 offen offset:2048 sc1
  buffer_load_dwordx4 v[172:175], v12, s[8:11], s30 offen offset:3072 sc1
  buffer_load_dwordx4 v[176:179], v13, s[8:11], s30 offen offset:0 sc1
  buffer_load_dwordx4 v[180:183], v13, s[8:11], s30 offen offset:1024 sc1
  buffer_load_dwordx4 v[184:187], v13, s[8:11], s30 offen offset:2048 sc1
  buffer_load_dwordx4 v[188:191], v13, s[8:11], s30 offen offset:3072 sc1
  s_add_u32 s37, s37, 786432
  v_mov_b32 v17, 0
  s_mov_b32 s74, 0
  s_waitcnt vmcnt(0)
AT_loop:
  s_mov_b32 s75, 0
  v_cmp_ge_u32 vcc, s73, v17
  s_cbranch_vccz at_73
  v_mfma_f32_16x16x32_bf16 v[48:51], v[96:99], v[144:147], 0
  v_mfma_f32_16x16x32_bf16 v[52:55], v[96:99], v[148:151], 0
  v_mfma_f32_16x16x32_bf16 v[56:59], v[100:103], v[148:151], 0
  v_mfma_f32_16x16x16_bf16 v[48:51], v[104:105], v[152:153], v[48:51]
  v_mfma_f32_16x16x16_bf16 v[52:55], v[104:105], v[154:155], v[52:55]
  v_mfma_f32_16x16x16_bf16 v[56:59], v[106:107], v[154:155], v[56:59]
  v_mfma_f32_16x16x32_bf16 v[48:51], v[108:111], v[156:159], v[48:51]
  v_mfma_f32_16x16x32_bf16 v[52:55], v[108:111], v[160:163], v[52:55]
  v_mfma_f32_16x16x32_bf16 v[56:59], v[112:115], v[160:163], v[56:59]
  v_mfma_f32_16x16x16_bf16 v[48:51], v[116:117], v[164:165], v[48:51]
  v_mfma_f32_16x16x16_bf16 v[52:55], v[116:117], v[166:167], v[52:55]
  v_mfma_f32_16x16x16_bf16 v[56:59], v[118:119], v[166:167], v[56:59]
  v_mfma_f32_16x16x32_bf16 v[48:51], v[120:123], v[168:171], v[48:51]
  v_mfma_f32_16x16x32_bf16 v[52:55], v[120:123], v[172:175], v[52:55]
  v_mfma_f32_16x16x32_bf16 v[56:59], v[124:127], v[172:175], v[56:59]
  v_mfma_f32_16x16x16_bf16 v[48:51], v[128:129], v[176:177], v[48:51]
  v_mfma_f32_16x16x16_bf16 v[52:55], v[128:129], v[178:179], v[52:55]
  v_mfma_f32_16x16x16_bf16 v[56:59], v[130:131], v[178:179], v[56:59]
  v_mfma_f32_16x16x32_bf16 v[48:51], v[132:135], v[180:183], v[48:51]
  v_mfma_f32_16x16x32_bf16 v[52:55], v[132:135], v[184:187], v[52:55]
  v_mfma_f32_16x16x32_bf16 v[56:59], v[136:139], v[184:187], v[56:59]
  v_mfma_f32_16x16x16_bf16 v[48:51], v[140:141], v[188:189], v[48:51]
  v_mfma_f32_16x16x16_bf16 v[52:55], v[140:141], v[190:191], v[52:55]
  v_mfma_f32_16x16x16_bf16 v[56:59], v[142:143], v[190:191], v[56:59]
  s_mov_b32 s75, 1
  s_waitcnt vmcnt(0)
  v_mov_b32 v8, s74
  s_mov_b64 exec, 1
  buffer_store_dword v8, off, s[8:11], s34 sc1
  s_mov_b64 exec, -1
wp_78:
  buffer_load_dword v17, v11, s[8:11], 0 offen sc1
  s_add_u32 s26, s26, 1
  s_mov_b32 s39, 130
  s_cmp_gt_u32 s26, 2097152
  s_cbranch_scc1 L_abort
  s_waitcnt vmcnt(0)
  v_cmp_ge_u32 vcc, s73, v17
  s_cbranch_vccz wpd_79
  s_sleep 1
  s_branch wp_78
wpd_79:
at_73:
  buffer_load_dwordx4 v[24:27], v2, s[8:11], s38 offen offset:0 sc1
  buffer_load_dwordx2 v[40:41], v14, s[8:11], s72 offen offset:0 sc1
  buffer_load_dwordx4 v[28:31], v2, s[8:11], s38 offen offset:1024 sc1
  buffer_load_dwordx2 v[42:43], v14, s[8:11], s72 offen offset:512 sc1
  buffer_load_dwordx4 v[32:35], v2, s[8:11], s38 offen offset:2048 sc1
  buffer_load_dwordx2 v[44:45], v14, s[8:11], s72 offen offset:1024 sc1
  buffer_load_dwordx4 v[36:39], v2, s[8:11], s38 offen offset:3072 sc1
  buffer_load_dwordx2 v[46:47], v14, s[8:11], s72 offen offset:1536 sc1
  buffer_load_dword v17, v11, s[8:11], 0 offen sc1
  s_add_u32 s38, s38, 262144
  s_add_u32 s72, s72, 131072
  s_add_u32 s76, s73, 2
  s_mov_b32 s77, 0
  s_cmp_ge_u32 s76, 63
  s_cbranch_scc1 at_74
  v_cmp_ge_u32 vcc, s76, v9
  s_cbranch_vccnz at_74
  s_add_u32 s27, s37, 42467328
  s_add_u32 s30, s37, 67633152
  buffer_load_dwordx4 a[0:3], v2, s[8:11], s27 offen offset:0 sc1
  buffer_load_dwordx4 a[4:7], v2, s[8:11], s27 offen offset:1024 sc1
  buffer_load_dwordx4 a[8:11], v2, s[8:11], s27 offen offset:2048 sc1
  buffer_load_dwordx4 a[12:15], v2, s[8:11], s27 offen offset:3072 sc1
  buffer_load_dwordx4 a[16:19], v12, s[8:11], s27 offen offset:0 sc1
  buffer_load_dwordx4 a[20:23], v12, s[8:11], s27 offen offset:1024 sc1
  buffer_load_dwordx4 a[24:27], v12, s[8:11], s27 offen offset:2048 sc1
  buffer_load_dwordx4 a[28:31], v12, s[8:11], s27 offen offset:3072 sc1
  buffer_load_dwordx4 a[32:35], v13, s[8:11], s27 offen offset:0 sc1
  buffer_load_dwordx4 a[36:39], v13, s[8:11], s27 offen offset:1024 sc1
  buffer_load_dwordx4 a[40:43], v13, s[8:11], s27 offen offset:2048 sc1
  buffer_load_dwordx4 a[44:47], v13, s[8:11], s27 offen offset:3072 sc1
  buffer_load_dwordx4 a[48:51], v2, s[8:11], s30 offen offset:0 sc1
  buffer_load_dwordx4 a[52:55], v2, s[8:11], s30 offen offset:1024 sc1
  buffer_load_dwordx4 a[56:59], v2, s[8:11], s30 offen offset:2048 sc1
  buffer_load_dwordx4 a[60:63], v2, s[8:11], s30 offen offset:3072 sc1
  buffer_load_dwordx4 a[64:67], v12, s[8:11], s30 offen offset:0 sc1
  buffer_load_dwordx4 a[68:71], v12, s[8:11], s30 offen offset:1024 sc1
  buffer_load_dwordx4 a[72:75], v12, s[8:11], s30 offen offset:2048 sc1
  buffer_load_dwordx4 a[76:79], v12, s[8:11], s30 offen offset:3072 sc1
  buffer_load_dwordx4 a[80:83], v13, s[8:11], s30 offen offset:0 sc1
  buffer_load_dwordx4 a[84:87], v13, s[8:11], s30 offen offset:1024 sc1
  buffer_load_dwordx4 a[88:91], v13, s[8:11], s30 offen offset:2048 sc1
  buffer_load_dwordx4 a[92:95], v13, s[8:11], s30 offen offset:3072 sc1
  s_add_u32 s37, s37, 786432
  s_mov_b32 s77, 1
at_74:
  s_cmp_lg_u32 s75, 0
  s_cbranch_scc1 at_75
  v_mfma_f32_16x16x32_bf16 v[48:51], v[96:99], v[144:147], 0
  v_mfma_f32_16x16x32_bf16 v[52:55], v[96:99], v[148:151], 0
  v_mfma_f32_16x16x32_bf16 v[56:59], v[100:103], v[148:151], 0
  v_mfma_f32_16x16x16_bf16 v[48:51], v[104:105], v[152:153], v[48:51]
  v_mfma_f32_16x16x16_bf16 v[52:55], v[104:105], v[154:155], v[52:55]
  v_mfma_f32_16x16x16_bf16 v[56:59], v[106:107], v[154:155], v[56:59]
  v_mfma_f32_16x16x32_bf16 v[48:51], v[108:111], v[156:159], v[48:51]
  v_mfma_f32_16x16x32_bf16 v[52:55], v[108:111], v[160:163], v[52:55]
  v_mfma_f32_16x16x32_bf16 v[56:59], v[112:115], v[160:163], v[56:59]
  v_mfma_f32_16x16x16_bf16 v[48:51], v[116:117], v[164:165], v[48:51]
  v_mfma_f32_16x16x16_bf16 v[52:55], v[116:117], v[166:167], v[52:55]
  v_mfma_f32_16x16x16_bf16 v[56:59], v[118:119], v[166:167], v[56:59]
  v_mfma_f32_16x16x32_bf16 v[48:51], v[120:123], v[168:171], v[48:51]
  v_mfma_f32_16x16x32_bf16 v[52:55], v[120:123], v[172:175], v[52:55]
  v_mfma_f32_16x16x32_bf16 v[56:59], v[124:127], v[172:175], v[56:59]
  v_mfma_f32_16x16x16_bf16 v[48:51], v[128:129], v[176:177], v[48:51]
  v_mfma_f32_16x16x16_bf16 v[52:55], v[128:129], v[178:179], v[52:55]
  v_mfma_f32_16x16x16_bf16 v[56:59], v[130:131], v[178:179], v[56:59]
  v_mfma_f32_16x16x32_bf16 v[48:51], v[132:135], v[180:183], v[48:51]
  v_mfma_f32_16x16x32_bf16 v[52:55], v[132:135], v[184:187], v[52:55]
  v_mfma_f32_16x16x32_bf16 v[56:59], v[136:139], v[184:187], v[56:59]
  v_mfma_f32_16x16x16_bf16 v[48:51], v[140:141], v[188:189], v[48:51]
  v_mfma_f32_16x16x16_bf16 v[52:55], v[140:141], v[190:191], v[52:55]
  v_mfma_f32_16x16x16_bf16 v[56:59], v[142:143], v[190:191], v[56:59]
at_75:
  s_cmp_lg_u32 s77, 0
  s_cbranch_scc1 at_76
  s_waitcnt vmcnt(0)
at_76:
  s_waitcnt vmcnt(24)
  v_mov_b32 v8, s74
  s_mov_b64 exec, 1
  buffer_store_dword v8, off, s[8:11], s34 sc1
  s_mov_b64 exec, -1
  v_mfma_f32_16x16x32_bf16 v[60:63], v[24:27], v[144:147], 0
  v_mfma_f32_16x16x32_bf16 v[64:67], v[24:27], v[148:151], 0
  v_mfma_f32_16x16x16_bf16 v[60:63], v[40:41], v[152:153], v[60:63]
  v_mfma_f32_16x16x16_bf16 v[64:67], v[40:41], v[154:155], v[64:67]
  v_mfma_f32_16x16x32_bf16 v[60:63], v[28:31], v[156:159], v[60:63]
  v_mfma_f32_16x16x32_bf16 v[64:67], v[28:31], v[160:163], v[64:67]
  v_mfma_f32_16x16x16_bf16 v[60:63], v[42:43], v[164:165], v[60:63]
  v_mfma_f32_16x16x16_bf16 v[64:67], v[42:43], v[166:167], v[64:67]
  v_mfma_f32_16x16x32_bf16 v[60:63], v[32:35], v[168:171], v[60:63]
  v_mfma_f32_16x16x32_bf16 v[64:67], v[32:35], v[172:175], v[64:67]
  v_mfma_f32_16x16x16_bf16 v[60:63], v[44:45], v[176:177], v[60:63]
  v_mfma_f32_16x16x16_bf16 v[64:67], v[44:45], v[178:179], v[64:67]
  v_mfma_f32_16x16x32_bf16 v[60:63], v[36:39], v[180:183], v[60:63]
  v_mfma_f32_16x16x32_bf16 v[64:67], v[36:39], v[184:187], v[64:67]
  v_mfma_f32_16x16x16_bf16 v[60:63], v[46:47], v[188:189], v[60:63]
  v_mfma_f32_16x16x16_bf16 v[64:67], v[46:47], v[190:191], v[64:67]
  v_pk_mul_f32 v[48:49], v[48:49], s[90:91]
  v_pk_mul_f32 v[50:51], v[50:51], s[90:91]
  v_pk_mul_f32 v[52:53], v[52:53], s[90:91]
  v_pk_mul_f32 v[54:55], v[54:55], s[90:91]
  v_pk_mul_f32 v[56:57], v[56:57], s[90:91]
  v_pk_mul_f32 v[58:59], v[58:59], s[90:91]
  s_nop 0
  v_pk_mul_f32 v[60:61], v[60:61], s[90:91]
  v_pk_mul_f32 v[62:63], v[62:63], s[90:91]
  v_pk_mul_f32 v[64:65], v[64:65], s[90:91]
  v_pk_mul_f32 v[66:67], v[66:67], s[90:91]
  v_cndmask_b32 v48, v16, v48, s[80:81]
  v_cndmask_b32 v56, v16, v56, s[80:81]
  v_cndmask_b32 v49, v16, v49, s[82:83]
  v_cndmask_b32 v57, v16, v57, s[82:83]
  v_cndmask_b32 v50, v16, v50, s[84:85]
  v_cndmask_b32 v58, v16, v58, s[84:85]
  v_cndmask_b32 v51, v16, v51, s[86:87]
  v_cndmask_b32 v59, v16, v59, s[86:87]
  v_cndmask_b32 v60, v18, v60, s[88:89]
  v_cndmask_b32 v61, v18, v61, s[88:89]
  v_cndmask_b32 v62, v18, v62, s[88:89]
  v_cndmask_b32 v63, v18, v63, s[88:89]
  v_cndmask_b32 v64, v18, v64, s[88:89]
  v_cndmask_b32 v65, v18, v65, s[88:89]
  v_cndmask_b32 v66, v18, v66, s[88:89]
  v_cndmask_b32 v67, v18, v67, s[88:89]
  v_max3_f32 v68, v48, v49, v50
  v_max3_f32 v68, v68, v51, v60
  v_max3_f32 v68, v68, v61, v62
  v_max_f32 v68, v68, v63
  v_max3_f32 v70, v52, v53, v54
  v_max3_f32 v70, v70, v55, v56
  v_max3_f32 v70, v70, v57, v58
  v_max3_f32 v70, v70, v59, v64
  v_max3_f32 v70, v70, v65, v66
  v_max_f32 v70, v70, v67
  v_mov_b32 v69, v68
  s_nop 1
  v_permlane32_swap_b32 v69, v68
  v_max_f32 v68, v68, v69
  v_mov_b32 v69, v68
  s_nop 1
  v_permlane16_swap_b32 v69, v68
  v_max_f32 v68, v68, v69
  v_mov_b32 v71, v70
  s_nop 1
  v_permlane32_swap_b32 v71, v70
  v_max_f32 v70, v70, v71
  v_mov_b32 v71, v70
  s_nop 1
  v_permlane16_swap_b32 v71, v70
  v_max_f32 v70, v70, v71
  v_pk_add_f32 v[48:49], v[48:49], v[68:69] op_sel_hi:[1,0] neg_lo:[0,1] neg_hi:[0,1]
  v_pk_add_f32 v[50:51], v[50:51], v[68:69] op_sel_hi:[1,0] neg_lo:[0,1] neg_hi:[0,1]
  v_pk_add_f32 v[60:61], v[60:61], v[68:69] op_sel_hi:[1,0] neg_lo:[0,1] neg_hi:[0,1]
  v_pk_add_f32 v[62:63], v[62:63], v[68:69] op_sel_hi:[1,0] neg_lo:[0,1] neg_hi:[0,1]
  v_pk_add_f32 v[52:53], v[52:53], v[70:71] op_sel_hi:[1,0] neg_lo:[0,1] neg_hi:[0,1]
  v_pk_add_f32 v[54:55], v[54:55], v[70:71] op_sel_hi:[1,0] neg_lo:[0,1] neg_hi:[0,1]
  v_pk_add_f32 v[56:57], v[56:57], v[70:71] op_sel_hi:[1,0] neg_lo:[0,1] neg_hi:[0,1]
  v_pk_add_f32 v[58:59], v[58:59], v[70:71] op_sel_hi:[1,0] neg_lo:[0,1] neg_hi:[0,1]
  v_pk_add_f32 v[64:65], v[64:65], v[70:71] op_sel_hi:[1,0] neg_lo:[0,1] neg_hi:[0,1]
  v_pk_add_f32 v[66:67], v[66:67], v[70:71] op_sel_hi:[1,0] neg_lo:[0,1] neg_hi:[0,1]
  v_exp_f32 v48, v48
  v_exp_f32 v49, v49
  v_exp_f32 v50, v50
  v_exp_f32 v51, v51
  v_exp_f32 v60, v60
  v_exp_f32 v61, v61
  v_exp_f32 v62, v62
  v_exp_f32 v63, v63
  v_exp_f32 v52, v52
  v_exp_f32 v53, v53
  v_exp_f32 v54, v54
  v_exp_f32 v55, v55
  v_exp_f32 v56, v56
  v_exp_f32 v57, v57
  v_exp_f32 v58, v58
  v_exp_f32 v59, v59
  v_exp_f32 v64, v64
  v_exp_f32 v65, v65
  v_exp_f32 v66, v66
  v_exp_f32 v67, v67
  v_pk_add_f32 v[68:69], v[48:49], v[50:51]
  v_pk_add_f32 v[68:69], v[68:69], v[60:61]
  v_pk_add_f32 v[68:69], v[68:69], v[62:63]
  v_add_f32 v68, v68, v69
  v_pk_add_f32 v[70:71], v[52:53], v[54:55]
  v_pk_add_f32 v[70:71], v[70:71], v[56:57]
  v_pk_add_f32 v[70:71], v[70:71], v[58:59]
  v_pk_add_f32 v[70:71], v[70:71], v[64:65]
  v_pk_add_f32 v[70:71], v[70:71], v[66:67]
  v_add_f32 v70, v70, v71
  v_mov_b32 v69, v68
  s_nop 1
  v_permlane32_swap_b32 v69, v68
  v_add_f32 v68, v68, v69
  v_mov_b32 v69, v68
  s_nop 1
  v_permlane16_swap_b32 v69, v68
  v_add_f32 v68, v68, v69
  v_mov_b32 v71, v70
  s_nop 1
  v_permlane32_swap_b32 v71, v70
  v_add_f32 v70, v70, v71
  v_mov_b32 v71, v70
  s_nop 1
  v_permlane16_swap_b32 v71, v70
  v_add_f32 v70, v70, v71
  v_rcp_f32 v68, v68
  v_rcp_f32 v70, v70
  v_pk_mul_f32 v[48:49], v[48:49], v[68:69] op_sel_hi:[1,0]
  v_pk_mul_f32 v[50:51], v[50:51], v[68:69] op_sel_hi:[1,0]
  v_pk_mul_f32 v[60:61], v[60:61], v[68:69] op_sel_hi:[1,0]
  v_pk_mul_f32 v[62:63], v[62:63], v[68:69] op_sel_hi:[1,0]
  v_pk_mul_f32 v[52:53], v[52:53], v[70:71] op_sel_hi:[1,0]
  v_pk_mul_f32 v[54:55], v[54:55], v[70:71] op_sel_hi:[1,0]
  v_pk_mul_f32 v[56:57], v[56:57], v[70:71] op_sel_hi:[1,0]
  v_pk_mul_f32 v[58:59], v[58:59], v[70:71] op_sel_hi:[1,0]
  v_pk_mul_f32 v[64:65], v[64:65], v[70:71] op_sel_hi:[1,0]
  v_pk_mul_f32 v[66:67], v[66:67], v[70:71] op_sel_hi:[1,0]
  v_cvt_pk_bf16_f32 v72, v48, v49
  v_cvt_pk_bf16_f32 v73, v50, v51
  v_mov_b64 v[74:75], 0
  v_cvt_pk_bf16_f32 v76, v52, v53
  v_cvt_pk_bf16_f32 v77, v54, v55
  v_cvt_pk_bf16_f32 v78, v56, v57
  v_cvt_pk_bf16_f32 v79, v58, v59
  v_cvt_pk_bf16_f32 v80, v60, v61
  v_cvt_pk_bf16_f32 v81, v62, v63
  v_cvt_pk_bf16_f32 v82, v64, v65
  v_cvt_pk_bf16_f32 v83, v66, v67
  buffer_store_dwordx4 v[72:75], v2, s[8:11], s35 offen offset:0 sc1
  buffer_store_dwordx4 v[76:79], v2, s[8:11], s35 offen offset:1024 sc1
  s_mov_b32 exec_lo, 0
  buffer_store_dwordx2 v[80:81], v15, s[8:11], s36 offen offset:0 sc1
  buffer_store_dwordx2 v[82:83], v15, s[8:11], s36 offen offset:1024 sc1
  s_mov_b32 exec_lo, -1
  s_add_u32 s35, s35, 163840
  s_add_u32 s36, s36, 163840
  s_add_u32 s74, s73, 1
  s_mov_b32 s73, s76
  s_cmp_ge_u32 s73, 63
  s_cbranch_scc1 AT_end
  s_cmp_lg_u32 s77, 0
  s_cbranch_scc1 at_77
wp_80:
  buffer_load_dword v9, v10, s[8:11], 0 offen sc1
  s_add_u32 s26, s26, 1
  s_mov_b32 s39, 131
  s_cmp_gt_u32 s26, 2097152
  s_cbranch_scc1 L_abort
  s_waitcnt vmcnt(0)
  v_cmp_ge_u32 vcc, s73, v9
  s_cbranch_vccz wpd_81
  s_sleep 4
  s_branch wp_80
wpd_81:
  s_add_u32 s27, s37, 42467328
  s_add_u32 s30, s37, 67633152
  buffer_load_dwordx4 a[0:3], v2, s[8:11], s27 offen offset:0 sc1
  buffer_load_dwordx4 a[4:7], v2, s[8:11], s27 offen offset:1024 sc1
  buffer_load_dwordx4 a[8:11], v2, s[8:11], s27 offen offset:2048 sc1
  buffer_load_dwordx4 a[12:15], v2, s[8:11], s27 offen offset:3072 sc1
  buffer_load_dwordx4 a[16:19], v12, s[8:11], s27 offen offset:0 sc1
  buffer_load_dwordx4 a[20:23], v12, s[8:11], s27 offen offset:1024 sc1
  buffer_load_dwordx4 a[24:27], v12, s[8:11], s27 offen offset:2048 sc1
  buffer_load_dwordx4 a[28:31], v12, s[8:11], s27 offen offset:3072 sc1
  buffer_load_dwordx4 a[32:35], v13, s[8:11], s27 offen offset:0 sc1
  buffer_load_dwordx4 a[36:39], v13, s[8:11], s27 offen offset:1024 sc1
  buffer_load_dwordx4 a[40:43], v13, s[8:11], s27 offen offset:2048 sc1
  buffer_load_dwordx4 a[44:47], v13, s[8:11], s27 offen offset:3072 sc1
  buffer_load_dwordx4 a[48:51], v2, s[8:11], s30 offen offset:0 sc1
  buffer_load_dwordx4 a[52:55], v2, s[8:11], s30 offen offset:1024 sc1
  buffer_load_dwordx4 a[56:59], v2, s[8:11], s30 offen offset:2048 sc1
  buffer_load_dwordx4 a[60:63], v2, s[8:11], s30 offen offset:3072 sc1
  buffer_load_dwordx4 a[64:67], v12, s[8:11], s30 offen offset:0 sc1
  buffer_load_dwordx4 a[68:71], v12, s[8:11], s30 offen offset:1024 sc1
  buffer_load_dwordx4 a[72:75], v12, s[8:11], s30 offen offset:2048 sc1
  buffer_load_dwordx4 a[76:79], v12, s[8:11], s30 offen offset:3072 sc1
  buffer_load_dwordx4 a[80:83], v13, s[8:11], s30 offen offset:0 sc1
  buffer_load_dwordx4 a[84:87], v13, s[8:11], s30 offen offset:1024 sc1
  buffer_load_dwordx4 a[88:91], v13, s[8:11], s30 offen offset:2048 sc1
  buffer_load_dwordx4 a[92:95], v13, s[8:11], s30 offen offset:3072 sc1
  s_add_u32 s37, s37, 786432
  s_waitcnt vmcnt(0)
at_77:
  s_waitcnt vmcnt(4)
  s_mov_b32 s75, 0
  v_cmp_ge_u32 vcc, s73, v17
  s_cbranch_vccz at_82
  v_mfma_f32_16x16x32_bf16 v[48:51], a[0:3], a[48:51], 0
  v_mfma_f32_16x16x32_bf16 v[52:55], a[0:3], a[52:55], 0
  v_mfma_f32_16x16x32_bf16 v[56:59], a[4:7], a[52:55], 0
  v_mfma_f32_16x16x16_bf16 v[48:51], a[8:9], a[56:57], v[48:51]
  v_mfma_f32_16x16x16_bf16 v[52:55], a[8:9], a[58:59], v[52:55]
  v_mfma_f32_16x16x16_bf16 v[56:59], a[10:11], a[58:59], v[56:59]
  v_mfma_f32_16x16x32_bf16 v[48:51], a[12:15], a[60:63], v[48:51]
  v_mfma_f32_16x16x32_bf16 v[52:55], a[12:15], a[64:67], v[52:55]
  v_mfma_f32_16x16x32_bf16 v[56:59], a[16:19], a[64:67], v[56:59]
  v_mfma_f32_16x16x16_bf16 v[48:51], a[20:21], a[68:69], v[48:51]
  v_mfma_f32_16x16x16_bf16 v[52:55], a[20:21], a[70:71], v[52:55]
  v_mfma_f32_16x16x16_bf16 v[56:59], a[22:23], a[70:71], v[56:59]
  v_mfma_f32_16x16x32_bf16 v[48:51], a[24:27], a[72:75], v[48:51]
  v_mfma_f32_16x16x32_bf16 v[52:55], a[24:27], a[76:79], v[52:55]
  v_mfma_f32_16x16x32_bf16 v[56:59], a[28:31], a[76:79], v[56:59]
  v_mfma_f32_16x16x16_bf16 v[48:51], a[32:33], a[80:81], v[48:51]
  v_mfma_f32_16x16x16_bf16 v[52:55], a[32:33], a[82:83], v[52:55]
  v_mfma_f32_16x16x16_bf16 v[56:59], a[34:35], a[82:83], v[56:59]
  v_mfma_f32_16x16x32_bf16 v[48:51], a[36:39], a[84:87], v[48:51]
  v_mfma_f32_16x16x32_bf16 v[52:55], a[36:39], a[88:91], v[52:55]
  v_mfma_f32_16x16x32_bf16 v[56:59], a[40:43], a[88:91], v[56:59]
  v_mfma_f32_16x16x16_bf16 v[48:51], a[44:45], a[92:93], v[48:51]
  v_mfma_f32_16x16x16_bf16 v[52:55], a[44:45], a[94:95], v[52:55]
  v_mfma_f32_16x16x16_bf16 v[56:59], a[46:47], a[94:95], v[56:59]
  s_mov_b32 s75, 1
  s_waitcnt vmcnt(0)
  v_mov_b32 v8, s74
  s_mov_b64 exec, 1
  buffer_store_dword v8, off, s[8:11], s34 sc1
  s_mov_b64 exec, -1
wp_87:
  buffer_load_dword v17, v11, s[8:11], 0 offen sc1
  s_add_u32 s26, s26, 1
  s_mov_b32 s39, 130
  s_cmp_gt_u32 s26, 2097152
  s_cbranch_scc1 L_abort
  s_waitcnt vmcnt(0)
  v_cmp_ge_u32 vcc, s73, v17
  s_cbranch_vccz wpd_88
  s_sleep 1
  s_branch wp_87
wpd_88:
at_82:
  buffer_load_dwordx4 v[24:27], v2, s[8:11], s38 offen offset:0 sc1
  buffer_load_dwordx2 v[40:41], v14, s[8:11], s72 offen offset:0 sc1
  buffer_load_dwordx4 v[28:31], v2, s[8:11], s38 offen offset:1024 sc1
  buffer_load_dwordx2 v[42:43], v14, s[8:11], s72 offen offset:512 sc1
  buffer_load_dwordx4 v[32:35], v2, s[8:11], s38 offen offset:2048 sc1
  buffer_load_dwordx2 v[44:45], v14, s[8:11], s72 offen offset:1024 sc1
  buffer_load_dwordx4 v[36:39], v2, s[8:11], s38 offen offset:3072 sc1
  buffer_load_dwordx2 v[46:47], v14, s[8:11], s72 offen offset:1536 sc1
  buffer_load_dword v17, v11, s[8:11], 0 offen sc1
  s_add_u32 s38, s38, 262144
  s_add_u32 s72, s72, 131072
  s_add_u32 s76, s73, 2
  s_mov_b32 s77, 0
  s_cmp_ge_u32 s76, 63
  s_cbranch_scc1 at_83
  v_cmp_ge_u32 vcc, s76, v9
  s_cbranch_vccnz at_83
  s_add_u32 s27, s37, 42467328
  s_add_u32 s30, s37, 67633152
  buffer_load_dwordx4 v[96:99], v2, s[8:11], s27 offen offset:0 sc1
  buffer_load_dwordx4 v[100:103], v2, s[8:11], s27 offen offset:1024 sc1
  buffer_load_dwordx4 v[104:107], v2, s[8:11], s27 offen offset:2048 sc1
  buffer_load_dwordx4 v[108:111], v2, s[8:11], s27 offen offset:3072 sc1
  buffer_load_dwordx4 v[112:115], v12, s[8:11], s27 offen offset:0 sc1
  buffer_load_dwordx4 v[116:119], v12, s[8:11], s27 offen offset:1024 sc1
  buffer_load_dwordx4 v[120:123], v12, s[8:11], s27 offen offset:2048 sc1
  buffer_load_dwordx4 v[124:127], v12, s[8:11], s27 offen offset:3072 sc1
  buffer_load_dwordx4 v[128:131], v13, s[8:11], s27 offen offset:0 sc1
  buffer_load_dwordx4 v[132:135], v13, s[8:11], s27 offen offset:1024 sc1
  buffer_load_dwordx4 v[136:139], v13, s[8:11], s27 offen offset:2048 sc1
  buffer_load_dwordx4 v[140:143], v13, s[8:11], s27 offen offset:3072 sc1
  buffer_load_dwordx4 v[144:147], v2, s[8:11], s30 offen offset:0 sc1
  buffer_load_dwordx4 v[148:151], v2, s[8:11], s30 offen offset:1024 sc1
  buffer_load_dwordx4 v[152:155], v2, s[8:11], s30 offen offset:2048 sc1
  buffer_load_dwordx4 v[156:159], v2, s[8:11], s30 offen offset:3072 sc1
  buffer_load_dwordx4 v[160:163], v12, s[8:11], s30 offen offset:0 sc1
  buffer_load_dwordx4 v[164:167], v12, s[8:11], s30 offen offset:1024 sc1
  buffer_load_dwordx4 v[168:171], v12, s[8:11], s30 offen offset:2048 sc1
  buffer_load_dwordx4 v[172:175], v12, s[8:11], s30 offen offset:3072 sc1
  buffer_load_dwordx4 v[176:179], v13, s[8:11], s30 offen offset:0 sc1
  buffer_load_dwordx4 v[180:183], v13, s[8:11], s30 offen offset:1024 sc1
  buffer_load_dwordx4 v[184:187], v13, s[8:11], s30 offen offset:2048 sc1
  buffer_load_dwordx4 v[188:191], v13, s[8:11], s30 offen offset:3072 sc1
  s_add_u32 s37, s37, 786432
  s_mov_b32 s77, 1
at_83:
  s_cmp_lg_u32 s75, 0
  s_cbranch_scc1 at_84
  v_mfma_f32_16x16x32_bf16 v[48:51], a[0:3], a[48:51], 0
  v_mfma_f32_16x16x32_bf16 v[52:55], a[0:3], a[52:55], 0
  v_mfma_f32_16x16x32_bf16 v[56:59], a[4:7], a[52:55], 0
  v_mfma_f32_16x16x16_bf16 v[48:51], a[8:9], a[56:57], v[48:51]
  v_mfma_f32_16x16x16_bf16 v[52:55], a[8:9], a[58:59], v[52:55]
  v_mfma_f32_16x16x16_bf16 v[56:59], a[10:11], a[58:59], v[56:59]
  v_mfma_f32_16x16x32_bf16 v[48:51], a[12:15], a[60:63], v[48:51]
  v_mfma_f32_16x16x32_bf16 v[52:55], a[12:15], a[64:67], v[52:55]
  v_mfma_f32_16x16x32_bf16 v[56:59], a[16:19], a[64:67], v[56:59]
  v_mfma_f32_16x16x16_bf16 v[48:51], a[20:21], a[68:69], v[48:51]
  v_mfma_f32_16x16x16_bf16 v[52:55], a[20:21], a[70:71], v[52:55]
  v_mfma_f32_16x16x16_bf16 v[56:59], a[22:23], a[70:71], v[56:59]
  v_mfma_f32_16x16x32_bf16 v[48:51], a[24:27], a[72:75], v[48:51]
  v_mfma_f32_16x16x32_bf16 v[52:55], a[24:27], a[76:79], v[52:55]
  v_mfma_f32_16x16x32_bf16 v[56:59], a[28:31], a[76:79], v[56:59]
  v_mfma_f32_16x16x16_bf16 v[48:51], a[32:33], a[80:81], v[48:51]
  v_mfma_f32_16x16x16_bf16 v[52:55], a[32:33], a[82:83], v[52:55]
  v_mfma_f32_16x16x16_bf16 v[56:59], a[34:35], a[82:83], v[56:59]
  v_mfma_f32_16x16x32_bf16 v[48:51], a[36:39], a[84:87], v[48:51]
  v_mfma_f32_16x16x32_bf16 v[52:55], a[36:39], a[88:91], v[52:55]
  v_mfma_f32_16x16x32_bf16 v[56:59], a[40:43], a[88:91], v[56:59]
  v_mfma_f32_16x16x16_bf16 v[48:51], a[44:45], a[92:93], v[48:51]
  v_mfma_f32_16x16x16_bf16 v[52:55], a[44:45], a[94:95], v[52:55]
  v_mfma_f32_16x16x16_bf16 v[56:59], a[46:47], a[94:95], v[56:59]
at_84:
  s_cmp_lg_u32 s77, 0
  s_cbranch_scc1 at_85
  s_waitcnt vmcnt(0)
at_85:
  s_waitcnt vmcnt(24)
  v_mov_b32 v8, s74
  s_mov_b64 exec, 1
  buffer_store_dword v8, off, s[8:11], s34 sc1
  s_mov_b64 exec, -1
  v_mfma_f32_16x16x32_bf16 v[60:63], v[24:27], a[48:51], 0
  v_mfma_f32_16x16x32_bf16 v[64:67], v[24:27], a[52:55], 0
  v_mfma_f32_16x16x16_bf16 v[60:63], v[40:41], a[56:57], v[60:63]
  v_mfma_f32_16x16x16_bf16 v[64:67], v[40:41], a[58:59], v[64:67]
  v_mfma_f32_16x16x32_bf16 v[60:63], v[28:31], a[60:63], v[60:63]
  v_mfma_f32_16x16x32_bf16 v[64:67], v[28:31], a[64:67], v[64:67]
  v_mfma_f32_16x16x16_bf16 v[60:63], v[42:43], a[68:69], v[60:63]
  v_mfma_f32_16x16x16_bf16 v[64:67], v[42:43], a[70:71], v[64:67]
  v_mfma_f32_16x16x32_bf16 v[60:63], v[32:35], a[72:75], v[60:63]
  v_mfma_f32_16x16x32_bf16 v[64:67], v[32:35], a[76:79], v[64:67]
  v_mfma_f32_16x16x16_bf16 v[60:63], v[44:45], a[80:81], v[60:63]
  v_mfma_f32_16x16x16_bf16 v[64:67], v[44:45], a[82:83], v[64:67]
  v_mfma_f32_16x16x32_bf16 v[60:63], v[36:39], a[84:87], v[60:63]
  v_mfma_f32_16x16x32_bf16 v[64:67], v[36:39], a[88:91], v[64:67]
  v_mfma_f32_16x16x16_bf16 v[60:63], v[46:47], a[92:93], v[60:63]
  v_mfma_f32_16x16x16_bf16 v[64:67], v[46:47], a[94:95], v[64:67]
  v_pk_mul_f32 v[48:49], v[48:49], s[90:91]
  v_pk_mul_f32 v[50:51], v[50:51], s[90:91]
  v_pk_mul_f32 v[52:53], v[52:53], s[90:91]
  v_pk_mul_f32 v[54:55], v[54:55], s[90:91]
  v_pk_mul_f32 v[56:57], v[56:57], s[90:91]
  v_pk_mul_f32 v[58:59], v[58:59], s[90:91]
  s_nop 0
  v_pk_mul_f32 v[60:61], v[60:61], s[90:91]
  v_pk_mul_f32 v[62:63], v[62:63], s[90:91]
  v_pk_mul_f32 v[64:65], v[64:65], s[90:91]
  v_pk_mul_f32 v[66:67], v[66:67], s[90:91]
  v_cndmask_b32 v48, v16, v48, s[80:81]
  v_cndmask_b32 v56, v16, v56, s[80:81]
  v_cndmask_b32 v49, v16, v49, s[82:83]
  v_cndmask_b32 v57, v16, v57, s[82:83]
  v_cndmask_b32 v50, v16, v50, s[84:85]
  v_cndmask_b32 v58, v16, v58, s[84:85]
  v_cndmask_b32 v51, v16, v51, s[86:87]
  v_cndmask_b32 v59, v16, v59, s[86:87]
  v_cndmask_b32 v60, v18, v60, s[88:89]
  v_cndmask_b32 v61, v18, v61, s[88:89]
  v_cndmask_b32 v62, v18, v62, s[88:89]
  v_cndmask_b32 v63, v18, v63, s[88:89]
  v_cndmask_b32 v64, v18, v64, s[88:89]
  v_cndmask_b32 v65, v18, v65, s[88:89]
  v_cndmask_b32 v66, v18, v66, s[88:89]
  v_cndmask_b32 v67, v18, v67, s[88:89]
  v_max3_f32 v68, v48, v49, v50
  v_max3_f32 v68, v68, v51, v60
  v_max3_f32 v68, v68, v61, v62
  v_max_f32 v68, v68, v63
  v_max3_f32 v70, v52, v53, v54
  v_max3_f32 v70, v70, v55, v56
  v_max3_f32 v70, v70, v57, v58
  v_max3_f32 v70, v70, v59, v64
  v_max3_f32 v70, v70, v65, v66
  v_max_f32 v70, v70, v67
  v_mov_b32 v69, v68
  s_nop 1
  v_permlane32_swap_b32 v69, v68
  v_max_f32 v68, v68, v69
  v_mov_b32 v69, v68
  s_nop 1
  v_permlane16_swap_b32 v69, v68
  v_max_f32 v68, v68, v69
  v_mov_b32 v71, v70
  s_nop 1
  v_permlane32_swap_b32 v71, v70
  v_max_f32 v70, v70, v71
  v_mov_b32 v71, v70
  s_nop 1
  v_permlane16_swap_b32 v71, v70
  v_max_f32 v70, v70, v71
  v_pk_add_f32 v[48:49], v[48:49], v[68:69] op_sel_hi:[1,0] neg_lo:[0,1] neg_hi:[0,1]
  v_pk_add_f32 v[50:51], v[50:51], v[68:69] op_sel_hi:[1,0] neg_lo:[0,1] neg_hi:[0,1]
  v_pk_add_f32 v[60:61], v[60:61], v[68:69] op_sel_hi:[1,0] neg_lo:[0,1] neg_hi:[0,1]
  v_pk_add_f32 v[62:63], v[62:63], v[68:69] op_sel_hi:[1,0] neg_lo:[0,1] neg_hi:[0,1]
  v_pk_add_f32 v[52:53], v[52:53], v[70:71] op_sel_hi:[1,0] neg_lo:[0,1] neg_hi:[0,1]
  v_pk_add_f32 v[54:55], v[54:55], v[70:71] op_sel_hi:[1,0] neg_lo:[0,1] neg_hi:[0,1]
  v_pk_add_f32 v[56:57], v[56:57], v[70:71] op_sel_hi:[1,0] neg_lo:[0,1] neg_hi:[0,1]
  v_pk_add_f32 v[58:59], v[58:59], v[70:71] op_sel_hi:[1,0] neg_lo:[0,1] neg_hi:[0,1]
  v_pk_add_f32 v[64:65], v[64:65], v[70:71] op_sel_hi:[1,0] neg_lo:[0,1] neg_hi:[0,1]
  v_pk_add_f32 v[66:67], v[66:67], v[70:71] op_sel_hi:[1,0] neg_lo:[0,1] neg_hi:[0,1]
  v_exp_f32 v48, v48
  v_exp_f32 v49, v49
  v_exp_f32 v50, v50
  v_exp_f32 v51, v51
  v_exp_f32 v60, v60
  v_exp_f32 v61, v61
  v_exp_f32 v62, v62
  v_exp_f32 v63, v63
  v_exp_f32 v52, v52
  v_exp_f32 v53, v53
  v_exp_f32 v54, v54
  v_exp_f32 v55, v55
  v_exp_f32 v56, v56
  v_exp_f32 v57, v57
  v_exp_f32 v58, v58
  v_exp_f32 v59, v59
  v_exp_f32 v64, v64
  v_exp_f32 v65, v65
  v_exp_f32 v66, v66
  v_exp_f32 v67, v67
  v_pk_add_f32 v[68:69], v[48:49], v[50:51]
  v_pk_add_f32 v[68:69], v[68:69], v[60:61]
  v_pk_add_f32 v[68:69], v[68:69], v[62:63]
  v_add_f32 v68, v68, v69
  v_pk_add_f32 v[70:71], v[52:53], v[54:55]
  v_pk_add_f32 v[70:71], v[70:71], v[56:57]
  v_pk_add_f32 v[70:71], v[70:71], v[58:59]
  v_pk_add_f32 v[70:71], v[70:71], v[64:65]
  v_pk_add_f32 v[70:71], v[70:71], v[66:67]
  v_add_f32 v70, v70, v71
  v_mov_b32 v69, v68
  s_nop 1
  v_permlane32_swap_b32 v69, v68
  v_add_f32 v68, v68, v69
  v_mov_b32 v69, v68
  s_nop 1
  v_permlane16_swap_b32 v69, v68
  v_add_f32 v68, v68, v69
  v_mov_b32 v71, v70
  s_nop 1
  v_permlane32_swap_b32 v71, v70
  v_add_f32 v70, v70, v71
  v_mov_b32 v71, v70
  s_nop 1
  v_permlane16_swap_b32 v71, v70
  v_add_f32 v70, v70, v71
  v_rcp_f32 v68, v68
  v_rcp_f32 v70, v70
  v_pk_mul_f32 v[48:49], v[48:49], v[68:69] op_sel_hi:[1,0]
  v_pk_mul_f32 v[50:51], v[50:51], v[68:69] op_sel_hi:[1,0]
  v_pk_mul_f32 v[60:61], v[60:61], v[68:69] op_sel_hi:[1,0]
  v_pk_mul_f32 v[62:63], v[62:63], v[68:69] op_sel_hi:[1,0]
  v_pk_mul_f32 v[52:53], v[52:53], v[70:71] op_sel_hi:[1,0]
  v_pk_mul_f32 v[54:55], v[54:55], v[70:71] op_sel_hi:[1,0]
  v_pk_mul_f32 v[56:57], v[56:57], v[70:71] op_sel_hi:[1,0]
  v_pk_mul_f32 v[58:59], v[58:59], v[70:71] op_sel_hi:[1,0]
  v_pk_mul_f32 v[64:65], v[64:65], v[70:71] op_sel_hi:[1,0]
  v_pk_mul_f32 v[66:67], v[66:67], v[70:71] op_sel_hi:[1,0]
  v_cvt_pk_bf16_f32 v72, v48, v49
  v_cvt_pk_bf16_f32 v73, v50, v51
  v_mov_b64 v[74:75], 0
  v_cvt_pk_bf16_f32 v76, v52, v53
  v_cvt_pk_bf16_f32 v77, v54, v55
  v_cvt_pk_bf16_f32 v78, v56, v57
  v_cvt_pk_bf16_f32 v79, v58, v59
  v_cvt_pk_bf16_f32 v80, v60, v61
  v_cvt_pk_bf16_f32 v81, v62, v63
  v_cvt_pk_bf16_f32 v82, v64, v65
  v_cvt_pk_bf16_f32 v83, v66, v67
  buffer_store_dwordx4 v[72:75], v2, s[8:11], s35 offen offset:0 sc1
  buffer_store_dwordx4 v[76:79], v2, s[8:11], s35 offen offset:1024 sc1
  s_mov_b32 exec_lo, 0
  buffer_store_dwordx2 v[80:81], v15, s[8:11], s36 offen offset:0 sc1
  buffer_store_dwordx2 v[82:83], v15, s[8:11], s36 offen offset:1024 sc1
  s_mov_b32 exec_lo, -1
  s_add_u32 s35, s35, 163840
  s_add_u32 s36, s36, 163840
  s_add_u32 s74, s73, 1
  s_mov_b32 s73, s76
  s_cmp_ge_u32 s73, 63
  s_cbranch_scc1 AT_end
  s_cmp_lg_u32 s77, 0
  s_cbranch_scc1 at_86
wp_89:
  buffer_load_dword v9, v10, s[8:11], 0 offen sc1
  s_add_u32 s26, s26, 1
  s_mov_b32 s39, 131
  s_cmp_gt_u32 s26, 2097152
  s_cbranch_scc1 L_abort
  s_waitcnt vmcnt(0)
  v_cmp_ge_u32 vcc, s73, v9
  s_cbranch_vccz wpd_90
  s_sleep 4
  s_branch wp_89
wpd_90:
  s_add_u32 s27, s37, 42467328
  s_add_u32 s30, s37, 67633152
  buffer_load_dwordx4 v[96:99], v2, s[8:11], s27 offen offset:0 sc1
  buffer_load_dwordx4 v[100:103], v2, s[8:11], s27 offen offset:1024 sc1
  buffer_load_dwordx4 v[104:107], v2, s[8:11], s27 offen offset:2048 sc1
  buffer_load_dwordx4 v[108:111], v2, s[8:11], s27 offen offset:3072 sc1
  buffer_load_dwordx4 v[112:115], v12, s[8:11], s27 offen offset:0 sc1
  buffer_load_dwordx4 v[116:119], v12, s[8:11], s27 offen offset:1024 sc1
  buffer_load_dwordx4 v[120:123], v12, s[8:11], s27 offen offset:2048 sc1
  buffer_load_dwordx4 v[124:127], v12, s[8:11], s27 offen offset:3072 sc1
  buffer_load_dwordx4 v[128:131], v13, s[8:11], s27 offen offset:0 sc1
  buffer_load_dwordx4 v[132:135], v13, s[8:11], s27 offen offset:1024 sc1
  buffer_load_dwordx4 v[136:139], v13, s[8:11], s27 offen offset:2048 sc1
  buffer_load_dwordx4 v[140:143], v13, s[8:11], s27 offen offset:3072 sc1
  buffer_load_dwordx4 v[144:147], v2, s[8:11], s30 offen offset:0 sc1
  buffer_load_dwordx4 v[148:151], v2, s[8:11], s30 offen offset:1024 sc1
  buffer_load_dwordx4 v[152:155], v2, s[8:11], s30 offen offset:2048 sc1
  buffer_load_dwordx4 v[156:159], v2, s[8:11], s30 offen offset:3072 sc1
  buffer_load_dwordx4 v[160:163], v12, s[8:11], s30 offen offset:0 sc1
  buffer_load_dwordx4 v[164:167], v12, s[8:11], s30 offen offset:1024 sc1
  buffer_load_dwordx4 v[168:171], v12, s[8:11], s30 offen offset:2048 sc1
  buffer_load_dwordx4 v[172:175], v12, s[8:11], s30 offen offset:3072 sc1
  buffer_load_dwordx4 v[176:179], v13, s[8:11], s30 offen offset:0 sc1
  buffer_load_dwordx4 v[180:183], v13, s[8:11], s30 offen offset:1024 sc1
  buffer_load_dwordx4 v[184:187], v13, s[8:11], s30 offen offset:2048 sc1
  buffer_load_dwordx4 v[188:191], v13, s[8:11], s30 offen offset:3072 sc1
  s_add_u32 s37, s37, 786432
  s_waitcnt vmcnt(0)
at_86:
  s_waitcnt vmcnt(4)
  s_branch AT_loop
AT_end:
  s_waitcnt vmcnt(0)
  v_mov_b32 v8, s74
  s_mov_b64 exec, 1
  buffer_store_dword v8, off, s[8:11], s34 sc1
  s_mov_b64 exec, -1
  s_branch L_exit3
L_exit3:
  s_endpgm
PY:
  s_cmp_lg_u32 s24, 0
  s_cbranch_scc1 wwd_92
ww_91:
  buffer_load_dword v8, off, s[68:71], 0 offset:64 sc1
  s_add_u32 s26, s26, 1
  s_mov_b32 s39, 117
  s_cmp_gt_u32 s26, 2097152
  s_cbranch_scc1 L_abort
  s_waitcnt vmcnt(0)
  v_cmp_gt_u32 vcc, 64, v8
  s_cbranch_vccz wwd_92
  s_sleep 8
  s_branch ww_91
wwd_92:
  s_barrier
  s_mov_b32 s12, s62
  s_and_b32 s13, s63, 0xffff
  s_mov_b32 s14, 2621440
  s_mov_b32 s15, 0x20000
  v_mov_b32 v14, 0
  v_mov_b32 v4, 163832
  s_mov_b32 s27, 64
  v_lshrrev_b32 v68, 2, v1
  v_min_u32 v68, 15, v68
  v_add_u32 v68, s27, v68
  v_lshlrev_b32 v68, 7, v68
  v_and_b32 v16, 3, v1
  v_lshl_add_u32 v16, v16, 2, v68
  v_add_u32 v16, 4096, v16
  s_mov_b32 s27, 80
  v_lshrrev_b32 v68, 2, v1
  v_min_u32 v68, 15, v68
  v_add_u32 v68, s27, v68
  v_lshlrev_b32 v68, 7, v68
  v_and_b32 v17, 3, v1
  v_lshl_add_u32 v17, v17, 2, v68
  v_add_u32 v17, 4096, v17
  s_mov_b32 s27, 192
  v_lshrrev_b32 v68, 2, v1
  v_min_u32 v68, 15, v68
  v_add_u32 v68, s27, v68
  v_lshlrev_b32 v68, 7, v68
  v_and_b32 v18, 3, v1
  v_lshl_add_u32 v18, v18, 2, v68
  v_add_u32 v18, 4096, v18
  s_mov_b32 s27, 208
  v_lshrrev_b32 v68, 2, v1
  v_min_u32 v68, 15, v68
  v_add_u32 v68, s27, v68
  v_lshlrev_b32 v68, 7, v68
  v_and_b32 v19, 3, v1
  v_lshl_add_u32 v19, v19, 2, v68
  v_add_u32 v19, 4096, v19
  s_mov_b32 s27, 172
  v_lshrrev_b32 v68, 2, v1
  v_min_u32 v68, 7, v68
  v_add_u32 v68, s27, v68
  v_lshlrev_b32 v68, 7, v68
  v_and_b32 v20, 3, v1
  v_lshl_add_u32 v20, v20, 2, v68
  v_add_u32 v20, 4096, v20
  v_lshrrev_b32 v22, 4, v1
  v_mul_u32_u24 v22, 10240, v22
  v_and_b32 v68, 15, v1
  v_lshl_add_u32 v22, v68, 4, v22
  v_mul_u32_u24 v23, 1280, v68
  v_lshrrev_b32 v68, 4, v1
  v_lshl_add_u32 v23, v68, 3, v23
  v_add_u32 v24, 20480, v23
  v_add_u32 v25, 40960, v2
PY_loop:
  s_barrier
  s_cmp_lg_u32 s24, 0
  s_cbranch_scc1 PY_tk
  v_mov_b32 v3, 1
  s_mov_b32 s27, 1152
  s_mov_b64 exec, 1
  buffer_atomic_add v3, v14, s[8:11], s27 offen sc0 sc1
  s_waitcnt vmcnt(0)
  ds_write_b32 v4, v3
  s_mov_b64 exec, -1
  s_waitcnt lgkmcnt(0)
PY_tk:
  s_barrier
  ds_read_b32 v3, v4
  s_waitcnt lgkmcnt(0)
  v_readfirstlane_b32 s30, v3
  s_nop 0
  s_cmp_ge_u32 s30, 640
  s_cbranch_scc1 L_exit
  s_mul_i32 s36, s30, 6554
  s_lshr_b32 s36, s36, 16
  s_mul_i32 s27, s36, 10
  s_sub_u32 s33, s30, s27
  s_lshl_b32 s32, s33, 2
  s_add_u32 s32, s32, s24
  s_and_b32 s27, s36, 3
  s_mul_i32 s27, s27, 5
  s_lshr_b32 s31, s33, 1
  s_add_u32 s27, s27, s31
  s_add_u32 s27, s27, 152
  v_lshrrev_b32 v68, 2, v1
  v_min_u32 v68, 0, v68
  v_add_u32 v68, s27, v68
  v_lshlrev_b32 v68, 7, v68
  v_and_b32 v26, 3, v1
  v_lshl_add_u32 v26, v26, 2, v68
  v_add_u32 v26, 4096, v26
  s_cmp_lg_u32 s24, 0
  s_cbranch_scc1 pq_93
wp_94:
  buffer_load_dword v8, v16, s[8:11], 0 offen sc1
  buffer_load_dword v9, v17, s[8:11], 0 offen sc1
  buffer_load_dword v10, v26, s[8:11], 0 offen sc1
  s_add_u32 s26, s26, 1
  s_mov_b32 s39, 48
  s_cmp_gt_u32 s26, 2097152
  s_cbranch_scc1 L_abort
  s_waitcnt vmcnt(0)
  v_min_u32 v8, v8, v9
  v_min_u32 v8, v8, v10
  v_cmp_ge_u32 vcc, s36, v8
  s_cbranch_vccz wpd_95
  s_sleep 32
  s_branch wp_94
wpd_95:
pq_93:
  s_barrier
  s_mul_i32 s37, s36, 1310720
  s_lshl_b32 s27, s32, 10
  s_add_u32 s37, s37, s27
  s_add_u32 s37, s37, 117964800
  buffer_load_dwordx4 v[80:83], v2, s[8:11], s37 offen sc1
  s_add_u32 s37, s37, 40960
  buffer_load_dwordx4 v[84:87], v2, s[8:11], s37 offen sc1
  s_add_u32 s37, s37, 40960
  buffer_load_dwordx4 v[88:91], v2, s[8:11], s37 offen sc1
  s_add_u32 s37, s37, 40960
  buffer_load_dwordx4 v[92:95], v2, s[8:11], s37 offen sc1
  s_add_u32 s37, s37, 40960
  buffer_load_dwordx4 v[96:99], v2, s[8:11], s37 offen sc1
  s_add_u32 s37, s37, 40960
  buffer_load_dwordx4 v[100:103], v2, s[8:11], s37 offen sc1
  s_add_u32 s37, s37, 40960
  buffer_load_dwordx4 v[104:107], v2, s[8:11], s37 offen sc1
  s_add_u32 s37, s37, 40960
  buffer_load_dwordx4 v[108:111], v2, s[8:11], s37 offen sc1
  s_add_u32 s37, s37, 40960
  buffer_load_dwordx4 v[112:115], v2, s[8:11], s37 offen sc1
  s_add_u32 s37, s37, 40960
  buffer_load_dwordx4 v[116:119], v2, s[8:11], s37 offen sc1
  s_add_u32 s37, s37, 40960
  buffer_load_dwordx4 v[120:123], v2, s[8:11], s37 offen sc1
  s_add_u32 s37, s37, 40960
  buffer_load_dwordx4 v[124:127], v2, s[8:11], s37 offen sc1
  s_add_u32 s37, s37, 40960
  buffer_load_dwordx4 v[128:131], v2, s[8:11], s37 offen sc1
  s_add_u32 s37, s37, 40960
  buffer_load_dwordx4 v[132:135], v2, s[8:11], s37 offen sc1
  s_add_u32 s37, s37, 40960
  buffer_load_dwordx4 v[136:139], v2, s[8:11], s37 offen sc1
  s_add_u32 s37, s37, 40960
  buffer_load_dwordx4 v[140:143], v2, s[8:11], s37 offen sc1
  s_add_u32 s37, s37, 40960
  buffer_load_dwordx4 v[144:147], v2, s[8:11], s37 offen sc1
  s_add_u32 s37, s37, 40960
  buffer_load_dwordx4 v[148:151], v2, s[8:11], s37 offen sc1
  s_add_u32 s37, s37, 40960
  buffer_load_dwordx4 v[152:155], v2, s[8:11], s37 offen sc1
  s_add_u32 s37, s37, 40960
  buffer_load_dwordx4 v[156:159], v2, s[8:11], s37 offen sc1
  s_add_u32 s37, s37, 40960
  buffer_load_dwordx4 v[160:163], v2, s[8:11], s37 offen sc1
  s_add_u32 s37, s37, 40960
  buffer_load_dwordx4 v[164:167], v2, s[8:11], s37 offen sc1
  s_add_u32 s37, s37, 40960
  buffer_load_dwordx4 v[168:171], v2, s[8:11], s37 offen sc1
  s_add_u32 s37, s37, 40960
  buffer_load_dwordx4 v[172:175], v2, s[8:11], s37 offen sc1
  s_add_u32 s37, s37, 40960
  buffer_load_dwordx4 v[176:179], v2, s[8:11], s37 offen sc1
  s_add_u32 s37, s37, 40960
  buffer_load_dwordx4 v[180:183], v2, s[8:11], s37 offen sc1
  s_add_u32 s37, s37, 40960
  buffer_load_dwordx4 v[184:187], v2, s[8:11], s37 offen sc1
  s_add_u32 s37, s37, 40960
  buffer_load_dwordx4 v[188:191], v2, s[8:11], s37 offen sc1
  s_add_u32 s37, s37, 40960
  buffer_load_dwordx4 v[192:195], v2, s[8:11], s37 offen sc1
  s_add_u32 s37, s37, 40960
  buffer_load_dwordx4 v[196:199], v2, s[8:11], s37 offen sc1
  s_add_u32 s37, s37, 40960
  buffer_load_dwordx4 v[200:203], v2, s[8:11], s37 offen sc1
  s_add_u32 s37, s37, 40960
  buffer_load_dwordx4 v[204:207], v2, s[8:11], s37 offen sc1
  s_mul_i32 s37, s36, 81920
  s_add_u32 s37, s37, s27
  s_add_u32 s37, s37, 11010048
  buffer_load_dwordx4 v[32:35], v2, s[8:11], s37 offen sc1
  buffer_load_dwordx4 v[36:39], v25, s[8:11], s37 offen sc1
  s_and_b32 s27, s36, 1
  s_lshl_b32 s27, s27, 10
  v_add_u32 v21, s27, v20
  s_cmp_eq_u32 s36, 63
  s_cselect_b32 s72, 64, 0
  s_sub_u32 s73, s36, 2
  s_cmp_lg_u32 s24, 0
  s_cbranch_scc1 pwd_97
pw_96:
  buffer_load_dword v8, v18, s[8:11], 0 offen sc1
  buffer_load_dword v9, v19, s[8:11], 0 offen sc1
  buffer_load_dword v10, v21, s[8:11], 0 offen sc1
  s_add_u32 s26, s26, 1
  s_mov_b32 s39, 49
  s_cmp_gt_u32 s26, 2097152
  s_cbranch_scc1 L_abort
  s_waitcnt vmcnt(0)
  v_min_u32 v8, v8, v9
  v_add_u32 v8, -1, v8
  v_max_u32 v10, s72, v10
  v_min_i32 v8, v8, v10
  v_cmp_ge_i32 vcc, s36, v8
  s_cbranch_vccz pwd_97
  v_cmp_ge_i32 vcc, s73, v8
  s_cbranch_vccnz pwl_98
  s_sleep 2
  s_branch pw_96
pwl_98:
  s_sleep 80
  s_branch pw_96
pwd_97:
  s_barrier
  s_mul_i32 s37, s36, 81920
  s_add_u32 s37, s37, 16252928
  s_mul_i32 s31, s24, 10240
  s_add_u32 s37, s37, s31
  s_add_u32 m0, s31, 0
  s_add_u32 s27, s37, 0
  buffer_load_dwordx4 v2, s[8:11], s27 offen offset:0 sc1 lds
  buffer_load_dwordx4 v2, s[8:11], s27 offen offset:1024 sc1 lds
  buffer_load_dwordx4 v2, s[8:11], s27 offen offset:2048 sc1 lds
  buffer_load_dwordx4 v2, s[8:11], s27 offen offset:3072 sc1 lds
  s_add_u32 m0, s31, 4096
  s_add_u32 s27, s37, 4096
  buffer_load_dwordx4 v2, s[8:11], s27 offen offset:0 sc1 lds
  buffer_load_dwordx4 v2, s[8:11], s27 offen offset:1024 sc1 lds
  buffer_load_dwordx4 v2, s[8:11], s27 offen offset:2048 sc1 lds
  buffer_load_dwordx4 v2, s[8:11], s27 offen offset:3072 sc1 lds
  s_add_u32 m0, s31, 8192
  s_add_u32 s27, s37, 8192
  buffer_load_dwordx4 v2, s[8:11], s27 offen offset:0 sc1 lds
  buffer_load_dwordx4 v2, s[8:11], s27 offen offset:1024 sc1 lds
  s_add_u32 m0, s31, 40960
  s_add_u32 s27, s37, 40960
  buffer_load_dwordx4 v2, s[8:11], s27 offen offset:0 sc1 lds
  buffer_load_dwordx4 v2, s[8:11], s27 offen offset:1024 sc1 lds
  buffer_load_dwordx4 v2, s[8:11], s27 offen offset:2048 sc1 lds
  buffer_load_dwordx4 v2, s[8:11], s27 offen offset:3072 sc1 lds
  s_add_u32 m0, s31, 45056
  s_add_u32 s27, s37, 45056
  buffer_load_dwordx4 v2, s[8:11], s27 offen offset:0 sc1 lds
  buffer_load_dwordx4 v2, s[8:11], s27 offen offset:1024 sc1 lds
  buffer_load_dwordx4 v2, s[8:11], s27 offen offset:2048 sc1 lds
  buffer_load_dwordx4 v2, s[8:11], s27 offen offset:3072 sc1 lds
  s_add_u32 m0, s31, 49152
  s_add_u32 s27, s37, 49152
  buffer_load_dwordx4 v2, s[8:11], s27 offen offset:0 sc1 lds
  buffer_load_dwordx4 v2, s[8:11], s27 offen offset:1024 sc1 lds
  s_mul_i32 s37, s36, 327680
  s_lshl_b32 s27, s32, 8
  s_add_u32 s37, s37, s27
  s_add_u32 s37, s37, 21495808
  buffer_load_dwordx4 v[208:211], v22, s[8:11], s37 offen sc1
  s_add_u32 s37, s37, 40960
  buffer_load_dwordx4 v[212:215], v22, s[8:11], s37 offen sc1
  s_add_u32 s37, s37, 40960
  buffer_load_dwordx4 v[216:219], v22, s[8:11], s37 offen sc1
  s_add_u32 s37, s37, 40960
  buffer_load_dwordx4 v[220:223], v22, s[8:11], s37 offen sc1
  s_add_u32 s37, s37, 40960
  buffer_load_dwordx4 v[224:227], v22, s[8:11], s37 offen sc1
  s_add_u32 s37, s37, 40960
  buffer_load_dwordx4 v[228:231], v22, s[8:11], s37 offen sc1
  s_add_u32 s37, s37, 40960
  buffer_load_dwordx4 v[232:235], v22, s[8:11], s37 offen sc1
  s_add_u32 s37, s37, 40960
  buffer_load_dwordx4 v[236:239], v22, s[8:11], s37 offen sc1
  s_mov_b32 s27, 1152
  buffer_load_dword v27, off, s[8:11], s27 sc1
  s_waitcnt vmcnt(19)
  s_barrier
  ds_read_b128 v[40:43], v2 offset:0
  ds_read_b128 v[44:47], v2 offset:1024
  ds_read_b128 v[48:51], v2 offset:2048
  ds_read_b128 v[52:55], v2 offset:3072
  ds_read_b128 v[56:59], v2 offset:4096
  ds_read_b128 v[60:63], v2 offset:5120
  s_waitcnt lgkmcnt(4)
  v_mfma_f32_16x16x32_bf16 v[32:35], v[80:83], v[40:43], v[32:35]
  v_mfma_f32_16x16x32_bf16 v[36:39], v[80:83], v[44:47], v[36:39]
  ds_read_b128 v[40:43], v2 offset:6144
  ds_read_b128 v[44:47], v2 offset:7168
  s_waitcnt lgkmcnt(4)
  v_mfma_f32_16x16x32_bf16 v[32:35], v[84:87], v[48:51], v[32:35]
  v_mfma_f32_16x16x32_bf16 v[36:39], v[84:87], v[52:55], v[36:39]
  ds_read_b128 v[48:51], v2 offset:8192
  ds_read_b128 v[52:55], v2 offset:9216
  s_waitcnt lgkmcnt(4)
  v_mfma_f32_16x16x32_bf16 v[32:35], v[88:91], v[56:59], v[32:35]
  v_mfma_f32_16x16x32_bf16 v[36:39], v[88:91], v[60:63], v[36:39]
  ds_read_b128 v[56:59], v2 offset:10240
  ds_read_b128 v[60:63], v2 offset:11264
  s_waitcnt lgkmcnt(4)
  v_mfma_f32_16x16x32_bf16 v[32:35], v[92:95], v[40:43], v[32:35]
  v_mfma_f32_16x16x32_bf16 v[36:39], v[92:95], v[44:47], v[36:39]
  ds_read_b128 v[40:43], v2 offset:12288
  ds_read_b128 v[44:47], v2 offset:13312
  s_waitcnt lgkmcnt(4)
  v_mfma_f32_16x16x32_bf16 v[32:35], v[96:99], v[48:51], v[32:35]
  v_mfma_f32_16x16x32_bf16 v[36:39], v[96:99], v[52:55], v[36:39]
  ds_read_b128 v[48:51], v2 offset:14336
  ds_read_b128 v[52:55], v2 offset:15360
  s_waitcnt lgkmcnt(4)
  v_mfma_f32_16x16x32_bf16 v[32:35], v[100:103], v[56:59], v[32:35]
  v_mfma_f32_16x16x32_bf16 v[36:39], v[100:103], v[60:63], v[36:39]
  ds_read_b128 v[56:59], v2 offset:16384
  ds_read_b128 v[60:63], v2 offset:17408
  s_waitcnt lgkmcnt(4)
  v_mfma_f32_16x16x32_bf16 v[32:35], v[104:107], v[40:43], v[32:35]
  v_mfma_f32_16x16x32_bf16 v[36:39], v[104:107], v[44:47], v[36:39]
  ds_read_b128 v[40:43], v2 offset:18432
  ds_read_b128 v[44:47], v2 offset:19456
  s_waitcnt lgkmcnt(4)
  v_mfma_f32_16x16x32_bf16 v[32:35], v[108:111], v[48:51], v[32:35]
  v_mfma_f32_16x16x32_bf16 v[36:39], v[108:111], v[52:55], v[36:39]
  ds_read_b128 v[48:51], v2 offset:20480
  ds_read_b128 v[52:55], v2 offset:21504
  s_waitcnt lgkmcnt(4)
  v_mfma_f32_16x16x32_bf16 v[32:35], v[112:115], v[56:59], v[32:35]
  v_mfma_f32_16x16x32_bf16 v[36:39], v[112:115], v[60:63], v[36:39]
  ds_read_b128 v[56:59], v2 offset:22528
  ds_read_b128 v[60:63], v2 offset:23552
  s_waitcnt lgkmcnt(4)
  v_mfma_f32_16x16x32_bf16 v[32:35], v[116:119], v[40:43], v[32:35]
  v_mfma_f32_16x16x32_bf16 v[36:39], v[116:119], v[44:47], v[36:39]
  ds_read_b128 v[40:43], v2 offset:24576
  ds_read_b128 v[44:47], v2 offset:25600
  s_waitcnt lgkmcnt(4)
  v_mfma_f32_16x16x32_bf16 v[32:35], v[120:123], v[48:51], v[32:35]
  v_mfma_f32_16x16x32_bf16 v[36:39], v[120:123], v[52:55], v[36:39]
  ds_read_b128 v[48:51], v2 offset:26624
  ds_read_b128 v[52:55], v2 offset:27648
  s_waitcnt lgkmcnt(4)
  v_mfma_f32_16x16x32_bf16 v[32:35], v[124:127], v[56:59], v[32:35]
  v_mfma_f32_16x16x32_bf16 v[36:39], v[124:127], v[60:63], v[36:39]
  ds_read_b128 v[56:59], v2 offset:28672
  ds_read_b128 v[60:63], v2 offset:29696
  s_waitcnt lgkmcnt(4)
  v_mfma_f32_16x16x32_bf16 v[32:35], v[128:131], v[40:43], v[32:35]
  v_mfma_f32_16x16x32_bf16 v[36:39], v[128:131], v[44:47], v[36:39]
  ds_read_b128 v[40:43], v2 offset:30720
  ds_read_b128 v[44:47], v2 offset:31744
  s_waitcnt lgkmcnt(4)
  v_mfma_f32_16x16x32_bf16 v[32:35], v[132:135], v[48:51], v[32:35]
  v_mfma_f32_16x16x32_bf16 v[36:39], v[132:135], v[52:55], v[36:39]
  ds_read_b128 v[48:51], v2 offset:32768
  ds_read_b128 v[52:55], v2 offset:33792
  s_waitcnt lgkmcnt(4)
  v_mfma_f32_16x16x32_bf16 v[32:35], v[136:139], v[56:59], v[32:35]
  v_mfma_f32_16x16x32_bf16 v[36:39], v[136:139], v[60:63], v[36:39]
  ds_read_b128 v[56:59], v2 offset:34816
  ds_read_b128 v[60:63], v2 offset:35840
  s_waitcnt lgkmcnt(4)
  v_mfma_f32_16x16x32_bf16 v[32:35], v[140:143], v[40:43], v[32:35]
  v_mfma_f32_16x16x32_bf16 v[36:39], v[140:143], v[44:47], v[36:39]
  ds_read_b128 v[40:43], v2 offset:36864
  ds_read_b128 v[44:47], v2 offset:37888
  s_waitcnt lgkmcnt(4)
  v_mfma_f32_16x16x32_bf16 v[32:35], v[144:147], v[48:51], v[32:35]
  v_mfma_f32_16x16x32_bf16 v[36:39], v[144:147], v[52:55], v[36:39]
  ds_read_b128 v[48:51], v2 offset:38912
  ds_read_b128 v[52:55], v2 offset:39936
  s_waitcnt lgkmcnt(4)
  v_mfma_f32_16x16x32_bf16 v[32:35], v[148:151], v[56:59], v[32:35]
  v_mfma_f32_16x16x32_bf16 v[36:39], v[148:151], v[60:63], v[36:39]
  s_waitcnt vmcnt(0)
  s_cmp_lg_u32 s24, 0
  s_cbranch_scc1 px_99
  ds_write_b32 v4, v27 offset:4
  s_waitcnt lgkmcnt(0)
px_99:
  s_barrier
  ds_read_b128 v[56:59], v25 offset:0
  ds_read_b128 v[60:63], v25 offset:1024
  s_waitcnt lgkmcnt(4)
  v_mfma_f32_16x16x32_bf16 v[32:35], v[152:155], v[40:43], v[32:35]
  v_mfma_f32_16x16x32_bf16 v[36:39], v[152:155], v[44:47], v[36:39]
  ds_read_b128 v[40:43], v25 offset:2048
  ds_read_b128 v[44:47], v25 offset:3072
  s_waitcnt lgkmcnt(4)
  v_mfma_f32_16x16x32_bf16 v[32:35], v[156:159], v[48:51], v[32:35]
  v_mfma_f32_16x16x32_bf16 v[36:39], v[156:159], v[52:55], v[36:39]
  ds_read_b128 v[48:51], v25 offset:4096
  ds_read_b128 v[52:55], v25 offset:5120
  s_waitcnt lgkmcnt(4)
  v_mfma_f32_16x16x32_bf16 v[32:35], v[160:163], v[56:59], v[32:35]
  v_mfma_f32_16x16x32_bf16 v[36:39], v[160:163], v[60:63], v[36:39]
  ds_read_b128 v[56:59], v25 offset:6144
  ds_read_b128 v[60:63], v25 offset:7168
  s_waitcnt lgkmcnt(4)
  v_mfma_f32_16x16x32_bf16 v[32:35], v[164:167], v[40:43], v[32:35]
  v_mfma_f32_16x16x32_bf16 v[36:39], v[164:167], v[44:47], v[36:39]
  ds_read_b128 v[40:43], v25 offset:8192
  ds_read_b128 v[44:47], v25 offset:9216
  s_waitcnt lgkmcnt(4)
  v_mfma_f32_16x16x32_bf16 v[32:35], v[168:171], v[48:51], v[32:35]
  v_mfma_f32_16x16x32_bf16 v[36:39], v[168:171], v[52:55], v[36:39]
  ds_read_b128 v[48:51], v25 offset:10240
  ds_read_b128 v[52:55], v25 offset:11264
  s_waitcnt lgkmcnt(4)
  v_mfma_f32_16x16x32_bf16 v[32:35], v[172:175], v[56:59], v[32:35]
  v_mfma_f32_16x16x32_bf16 v[36:39], v[172:175], v[60:63], v[36:39]
  ds_read_b128 v[56:59], v25 offset:12288
  ds_read_b128 v[60:63], v25 offset:13312
  s_waitcnt lgkmcnt(4)
  v_mfma_f32_16x16x32_bf16 v[32:35], v[176:179], v[40:43], v[32:35]
  v_mfma_f32_16x16x32_bf16 v[36:39], v[176:179], v[44:47], v[36:39]
  ds_read_b128 v[40:43], v25 offset:14336
  ds_read_b128 v[44:47], v25 offset:15360
  s_waitcnt lgkmcnt(4)
  v_mfma_f32_16x16x32_bf16 v[32:35], v[180:183], v[48:51], v[32:35]
  v_mfma_f32_16x16x32_bf16 v[36:39], v[180:183], v[52:55], v[36:39]
  ds_read_b128 v[48:51], v25 offset:16384
  ds_read_b128 v[52:55], v25 offset:17408
  s_waitcnt lgkmcnt(4)
  v_mfma_f32_16x16x32_bf16 v[32:35], v[184:187], v[56:59], v[32:35]
  v_mfma_f32_16x16x32_bf16 v[36:39], v[184:187], v[60:63], v[36:39]
  ds_read_b128 v[56:59], v25 offset:18432
  ds_read_b128 v[60:63], v25 offset:19456
  s_waitcnt lgkmcnt(4)
  v_mfma_f32_16x16x32_bf16 v[32:35], v[188:191], v[40:43], v[32:35]
  v_mfma_f32_16x16x32_bf16 v[36:39], v[188:191], v[44:47], v[36:39]
  ds_read_b128 v[40:43], v25 offset:20480
  ds_read_b128 v[44:47], v25 offset:21504
  s_waitcnt lgkmcnt(4)
  v_mfma_f32_16x16x32_bf16 v[32:35], v[192:195], v[48:51], v[32:35]
  v_mfma_f32_16x16x32_bf16 v[36:39], v[192:195], v[52:55], v[36:39]
  ds_read_b128 v[48:51], v25 offset:22528
  ds_read_b128 v[52:55], v25 offset:23552
  s_waitcnt lgkmcnt(4)
  v_mfma_f32_16x16x32_bf16 v[32:35], v[196:199], v[56:59], v[32:35]
  v_mfma_f32_16x16x32_bf16 v[36:39], v[196:199], v[60:63], v[36:39]
  ds_read_b128 v[56:59], v25 offset:24576
  ds_read_b128 v[60:63], v25 offset:25600
  s_waitcnt lgkmcnt(4)
  v_mfma_f32_16x16x32_bf16 v[32:35], v[200:203], v[40:43], v[32:35]
  v_mfma_f32_16x16x32_bf16 v[36:39], v[200:203], v[44:47], v[36:39]
  ds_read_b128 v[40:43], v25 offset:26624
  ds_read_b128 v[44:47], v25 offset:27648
  s_waitcnt lgkmcnt(4)
  v_mfma_f32_16x16x32_bf16 v[32:35], v[204:207], v[48:51], v[32:35]
  v_mfma_f32_16x16x32_bf16 v[36:39], v[204:207], v[52:55], v[36:39]
  ds_read_b128 v[48:51], v25 offset:28672
  ds_read_b128 v[52:55], v25 offset:29696
  s_waitcnt lgkmcnt(4)
  v_mfma_f32_16x16x32_bf16 v[32:35], v[208:211], v[56:59], v[32:35]
  v_mfma_f32_16x16x32_bf16 v[36:39], v[208:211], v[60:63], v[36:39]
  ds_read_b128 v[56:59], v25 offset:30720
  ds_read_b128 v[60:63], v25 offset:31744
  s_waitcnt lgkmcnt(4)
  v_mfma_f32_16x16x32_bf16 v[32:35], v[212:215], v[40:43], v[32:35]
  v_mfma_f32_16x16x32_bf16 v[36:39], v[212:215], v[44:47], v[36:39]
  ds_read_b128 v[40:43], v25 offset:32768
  ds_read_b128 v[44:47], v25 offset:33792
  s_waitcnt lgkmcnt(4)
  v_mfma_f32_16x16x32_bf16 v[32:35], v[216:219], v[48:51], v[32:35]
  v_mfma_f32_16x16x32_bf16 v[36:39], v[216:219], v[52:55], v[36:39]
  ds_read_b128 v[48:51], v25 offset:34816
  ds_read_b128 v[52:55], v25 offset:35840
  s_waitcnt lgkmcnt(4)
  v_mfma_f32_16x16x32_bf16 v[32:35], v[220:223], v[56:59], v[32:35]
  v_mfma_f32_16x16x32_bf16 v[36:39], v[220:223], v[60:63], v[36:39]
  ds_read_b128 v[56:59], v25 offset:36864
  ds_read_b128 v[60:63], v25 offset:37888
  s_waitcnt lgkmcnt(4)
  v_mfma_f32_16x16x32_bf16 v[32:35], v[224:227], v[40:43], v[32:35]
  v_mfma_f32_16x16x32_bf16 v[36:39], v[224:227], v[44:47], v[36:39]
  ds_read_b128 v[40:43], v25 offset:38912
  ds_read_b128 v[44:47], v25 offset:39936
  s_waitcnt lgkmcnt(4)
  v_mfma_f32_16x16x32_bf16 v[32:35], v[228:231], v[48:51], v[32:35]
  v_mfma_f32_16x16x32_bf16 v[36:39], v[228:231], v[52:55], v[36:39]
  s_waitcnt lgkmcnt(2)
  v_mfma_f32_16x16x32_bf16 v[32:35], v[232:235], v[56:59], v[32:35]
  v_mfma_f32_16x16x32_bf16 v[36:39], v[232:235], v[60:63], v[36:39]
  s_waitcnt lgkmcnt(0)
  v_mfma_f32_16x16x32_bf16 v[32:35], v[236:239], v[40:43], v[32:35]
  v_mfma_f32_16x16x32_bf16 v[36:39], v[236:239], v[44:47], v[36:39]
  ds_read_b32 v27, v4 offset:4
  s_mul_i32 s37, s36, 40960
  s_lshl_b32 s27, s32, 5
  s_add_u32 s37, s37, s27
  s_nop 2
  v_cvt_pk_bf16_f32 v64, v32, v33
  v_cvt_pk_bf16_f32 v65, v34, v35
  buffer_store_dwordx2 v[64:65], v23, s[12:15], s37 offen sc1
  v_cvt_pk_bf16_f32 v66, v36, v37
  v_cvt_pk_bf16_f32 v67, v38, v39
  buffer_store_dwordx2 v[66:67], v24, s[12:15], s37 offen sc1
  s_waitcnt lgkmcnt(0)
  v_readfirstlane_b32 s27, v27
  s_nop 0
  s_cmp_lt_u32 s27, 640
  s_cbranch_scc1 PY_loop
  s_endpgm
.section .rodata,"a"
.p2align 6
.amdhsa_kernel parallel_sum__memory_aug_recurrent_mem_tr__swiglu_ffn__prompt_kernel
  .amdhsa_next_free_vgpr 512
  .amdhsa_next_free_sgpr 102
  .amdhsa_accum_offset 256
  .amdhsa_group_segment_fixed_size 0
  .amdhsa_kernarg_size 112
  .amdhsa_user_sgpr_count 2
  .amdhsa_user_sgpr_kernarg_segment_ptr 1
  .amdhsa_system_sgpr_workgroup_id_x 1
  .amdhsa_float_denorm_mode_32 3
.end_amdhsa_kernel
```
